```python
import torch

def _softmax(x, axis=-1):
    return torch.softmax(x, dim=axis)

def _gelu(x):
    return torch.nn.functional.gelu(x, approximate='tanh')

def _silu(x):
    return torch.nn.functional.silu(x)

def _sigmoid(x):
    return torch.sigmoid(x)

def _layernorm(x, axis=-1, eps=1e-05):
    m = x.mean(dim=axis, keepdim=True)
    v = x.var(dim=axis, keepdim=True, unbiased=False)
    return (x - m) / torch.sqrt(v + eps)

def _scatter_add(tgt, idx, src, axis=0):
    return tgt.clone().index_add_(axis, idx, src)

def _segment_sum(src, seg, n):
    out = torch.zeros((n,) + src.shape[1:], dtype=src.dtype)
    return out.index_add_(0, seg, src)

def _pad(x, pw):
    flat = tuple((v for pair in reversed(pw) for v in pair))
    return torch.nn.functional.pad(x, flat)
kernel_name = 'adaLN_cond__sliding_block_cached__glu_gated_geglu__prompt'

def setup_inputs():

    _w = lambda a: (lambda t: t.to(torch.bfloat16) if t.is_floating_point() else t)(torch.as_tensor(a))

    def _A_setup():
        B, Sq, D = (1, 2048, 512)
        Hq, Hkv, Sk, Dh = (32, 32, 2048, 128)
        assert Hq % Hkv == 0, (Hq, Hkv)
        return {'x': _w((lambda *s: torch.randn(*s, dtype=torch.bfloat16) * 0.05)(B, Sq, D)), 'k_cache': _w((lambda *s: torch.randn(*s, dtype=torch.bfloat16) * 1.6)(B, Hkv, Sk, Dh)), 'v_cache': _w((lambda *s: torch.randn(*s, dtype=torch.bfloat16) * 0.8)(B, Hkv, Sk, Dh)), 'wq': _w((lambda *s: torch.randn(*s, dtype=torch.bfloat16) * 1.6)(D, Hq * Dh) * D ** (-0.5)), 'wo': _w((lambda *s: torch.randn(*s, dtype=torch.bfloat16) * 0.8)(Hq * Dh, D) * (Hq * Dh) ** (-0.5))}
    _A_in = _A_setup()

    def _B_setup():
        B, S, Dm, Df = (1, 2048, 512, 1376)
        return {'x': _w((lambda *s: torch.randn(*s, dtype=torch.bfloat16) * 0.05)(B, S, Dm)), 'w_gate': _w((lambda *s: torch.randn(*s, dtype=torch.bfloat16) * 0.8)(Dm, Df) * Dm ** (-0.5)), 'w_up': _w((lambda *s: torch.randn(*s, dtype=torch.bfloat16) * 0.8)(Dm, Df) * Dm ** (-0.5)), 'w_down': _w((lambda *s: torch.randn(*s, dtype=torch.bfloat16) * 0.8)(Df, Dm) * Df ** (-0.5))}
    _B_in = _B_setup()
    return {'A_x': _A_in['x'], 'A_k_cache': _A_in['k_cache'], 'A_v_cache': _A_in['v_cache'], 'A_wq': _A_in['wq'], 'A_wo': _A_in['wo'], 'B_x': _B_in['x'], 'B_w_gate': _B_in['w_gate'], 'B_w_up': _B_in['w_up'], 'B_w_down': _B_in['w_down'], 'c': _w((lambda *s: torch.randn(*s, dtype=torch.bfloat16) * 0.1)(1, 512) * 8.0), 'w_mod': _w((lambda *s: torch.randn(*s, dtype=torch.bfloat16) * 0.1)(512, 6 * 512) * 512 ** (-0.5) * 8.0)}

def reference(A_x, A_k_cache, A_v_cache, A_wq, A_wo, B_x, B_w_gate, B_w_up, B_w_down, c, w_mod):

    def _A_ref(x, k_cache, v_cache, wq, wo):
        B, Sq, D = x.shape
        Hq, Dh = (32, 128)
        Hkv, Sk = (k_cache.shape[1], k_cache.shape[2])
        W = min(4096, max(256, Sk // 4))
        rep = Hq // Hkv
        q = (lambda x, *d: x.permute(*d))((x @ wq).reshape(B, Sq, Hq, Dh), 0, 2, 1, 3)
        k = (lambda x, n, axis: torch.repeat_interleave(x, n, dim=axis))(k_cache[:, :, Sk - W:, :], rep, axis=1)
        v = (lambda x, n, axis: torch.repeat_interleave(x, n, dim=axis))(v_cache[:, :, Sk - W:, :], rep, axis=1)
        scores = torch.einsum('bhqd,bhkd->bhqk', q, k) * Dh ** (-0.5)
        p = _softmax(scores, axis=-1)
        o = torch.einsum('bhqk,bhkd->bhqd', p, v)
        return (lambda x, *d: x.permute(*d))(o, 0, 2, 1, 3).reshape(B, Sq, Hq * Dh) @ wo

    def _B_ref(x, w_gate, w_up, w_down):
        g = torch.einsum('bsd,df->bsf', x, w_gate)
        u = torch.einsum('bsd,df->bsf', x, w_up)
        h = _gelu(g) * u
        return torch.einsum('bsf,fd->bsd', h, w_down)
    x = A_x
    mod = (_silu(c) @ w_mod).reshape(c.shape[0], 6, 1, -1)
    sa, ca, ga, sb, cb, gb = (mod[:, 0].clone(), mod[:, 1].clone(), mod[:, 2].clone(), mod[:, 3].clone(), mod[:, 4].clone(), mod[:, 5].clone())
    h = _layernorm(x, axis=-1) * (1 + ca) + sa
    x = x + ga * _A_ref(h, A_k_cache, A_v_cache, A_wq, A_wo)
    h = _layernorm(x, axis=-1) * (1 + cb) + sb
    x = x + gb * _B_ref(h, B_w_gate, B_w_up, B_w_down)
    return x
```

```asm
; @launch kernel=k1_kernel grid=(448,1,1) block=(256,1,1) lds=1024
; @launch kernel=k2_kernel grid=(256,1,1) block=(256,1,1) lds=135168
; @launch kernel=k3_kernel grid=(256,1,1) block=(256,1,1) lds=149504
; @launch kernel=k4_kernel grid=(256,1,1) block=(256,1,1) lds=133120
; @launch kernel=k5_kernel grid=(256,1,1) block=(256,1,1) lds=131072
.amdgcn_target "amdgcn-amd-amdhsa--gfx950"
.text
.globl k1_kernel
.p2align 8
.type k1_kernel,@function
k1_kernel:
  s_cmp_lt_u32 s2, 448
  s_cbranch_scc1 k1a_go1
  s_endpgm
k1a_go1:
  s_load_dwordx2 s[4:5], s[0:1], 104
  v_and_b32 v1, 63, v0
  v_lshrrev_b32 v2, 6, v0
  s_nop 0
  v_readfirstlane_b32 s14, v2
  s_cmp_ge_u32 s2, 192
  s_cbranch_scc1 k1a_h2
  s_load_dwordx2 s[6:7], s[0:1], 72
  s_load_dwordx2 s[8:9], s[0:1], 80
  s_lshr_b32 s15, s2, 2
  s_and_b32 s16, s2, 3
  v_and_b32 v3, 7, v0
  v_lshrrev_b32 v4, 3, v0
  s_lshl_b32 s12, s16, 7
  v_lshl_add_u32 v4, v4, 2, s12
  v_lshlrev_b32 v6, 1, v4
  s_movk_i32 s32, 6144
  v_mul_lo_u32 v5, v4, s32
  s_lshl_b32 s12, s15, 7
  v_lshl_add_u32 v5, v3, 4, v5
  v_add_u32 v5, s12, v5
  s_waitcnt lgkmcnt(0)
  s_mov_b32 s20, s6
  s_mov_b32 s21, s7
  s_mov_b32 s22, 1024
  s_mov_b32 s23, 0x20000
  s_mov_b32 s24, s8
  s_mov_b32 s25, s9
  s_mov_b32 s26, 3145728
  s_mov_b32 s27, 0x20000
  s_mov_b32 s28, s4
  s_mov_b32 s29, s5
  s_mov_b32 s30, 49152
  s_mov_b32 s31, 0x20000
  s_movk_i32 s33, 6144
  s_movk_i32 s34, 12288
  s_movk_i32 s35, 18432
  buffer_load_dwordx2 v[8:9], v6, s[20:23], 0 offen
  buffer_load_dwordx4 v[12:15], v5, s[24:27], 0 offen
  buffer_load_dwordx4 v[16:19], v5, s[24:27], s33 offen
  buffer_load_dwordx4 v[20:23], v5, s[24:27], s34 offen
  buffer_load_dwordx4 v[24:27], v5, s[24:27], s35 offen
  s_waitcnt vmcnt(4)
  v_lshlrev_b32 v28, 16, v8
  v_and_b32 v29, 0xffff0000, v8
  v_lshlrev_b32 v30, 16, v9
  v_and_b32 v31, 0xffff0000, v9
  v_mul_f32 v32, 0xbfb8aa3b, v28
  v_mul_f32 v33, 0xbfb8aa3b, v29
  v_mul_f32 v34, 0xbfb8aa3b, v30
  v_mul_f32 v35, 0xbfb8aa3b, v31
  v_exp_f32 v32, v32
  v_exp_f32 v33, v33
  v_exp_f32 v34, v34
  v_exp_f32 v35, v35
  v_add_f32 v32, 1.0, v32
  v_add_f32 v33, 1.0, v33
  v_add_f32 v34, 1.0, v34
  v_add_f32 v35, 1.0, v35
  v_rcp_f32 v32, v32
  v_rcp_f32 v33, v33
  v_rcp_f32 v34, v34
  v_rcp_f32 v35, v35
  v_mul_f32 v28, v28, v32
  v_mul_f32 v29, v29, v33
  v_mul_f32 v30, v30, v34
  v_mul_f32 v31, v31, v35
  v_cvt_pk_bf16_f32 v32, v28, v29
  v_cvt_pk_bf16_f32 v33, v30, v31
  v_lshlrev_b32 v28, 16, v32
  v_and_b32 v29, 0xffff0000, v32
  v_lshlrev_b32 v30, 16, v33
  v_and_b32 v31, 0xffff0000, v33
  s_waitcnt vmcnt(3)
  v_lshlrev_b32 v44, 16, v12
  v_and_b32 v45, 0xffff0000, v12
  v_lshlrev_b32 v46, 16, v13
  v_and_b32 v47, 0xffff0000, v13
  v_lshlrev_b32 v48, 16, v14
  v_and_b32 v49, 0xffff0000, v14
  v_lshlrev_b32 v50, 16, v15
  v_and_b32 v51, 0xffff0000, v15
  v_mul_f32 v36, v28, v44
  v_mul_f32 v37, v28, v45
  v_mul_f32 v38, v28, v46
  v_mul_f32 v39, v28, v47
  v_mul_f32 v40, v28, v48
  v_mul_f32 v41, v28, v49
  v_mul_f32 v42, v28, v50
  v_mul_f32 v43, v28, v51
  s_waitcnt vmcnt(2)
  v_lshlrev_b32 v44, 16, v16
  v_and_b32 v45, 0xffff0000, v16
  v_lshlrev_b32 v46, 16, v17
  v_and_b32 v47, 0xffff0000, v17
  v_lshlrev_b32 v48, 16, v18
  v_and_b32 v49, 0xffff0000, v18
  v_lshlrev_b32 v50, 16, v19
  v_and_b32 v51, 0xffff0000, v19
  v_fmac_f32 v36, v29, v44
  v_fmac_f32 v37, v29, v45
  v_fmac_f32 v38, v29, v46
  v_fmac_f32 v39, v29, v47
  v_fmac_f32 v40, v29, v48
  v_fmac_f32 v41, v29, v49
  v_fmac_f32 v42, v29, v50
  v_fmac_f32 v43, v29, v51
  s_waitcnt vmcnt(1)
  v_lshlrev_b32 v44, 16, v20
  v_and_b32 v45, 0xffff0000, v20
  v_lshlrev_b32 v46, 16, v21
  v_and_b32 v47, 0xffff0000, v21
  v_lshlrev_b32 v48, 16, v22
  v_and_b32 v49, 0xffff0000, v22
  v_lshlrev_b32 v50, 16, v23
  v_and_b32 v51, 0xffff0000, v23
  v_fmac_f32 v36, v30, v44
  v_fmac_f32 v37, v30, v45
  v_fmac_f32 v38, v30, v46
  v_fmac_f32 v39, v30, v47
  v_fmac_f32 v40, v30, v48
  v_fmac_f32 v41, v30, v49
  v_fmac_f32 v42, v30, v50
  v_fmac_f32 v43, v30, v51
  s_waitcnt vmcnt(0)
  v_lshlrev_b32 v44, 16, v24
  v_and_b32 v45, 0xffff0000, v24
  v_lshlrev_b32 v46, 16, v25
  v_and_b32 v47, 0xffff0000, v25
  v_lshlrev_b32 v48, 16, v26
  v_and_b32 v49, 0xffff0000, v26
  v_lshlrev_b32 v50, 16, v27
  v_and_b32 v51, 0xffff0000, v27
  v_fmac_f32 v36, v31, v44
  v_fmac_f32 v37, v31, v45
  v_fmac_f32 v38, v31, v46
  v_fmac_f32 v39, v31, v47
  v_fmac_f32 v40, v31, v48
  v_fmac_f32 v41, v31, v49
  v_fmac_f32 v42, v31, v50
  v_fmac_f32 v43, v31, v51
  v_add_f32_dpp v36, v36, v36 row_ror:8 row_mask:0xf bank_mask:0xf
  v_add_f32_dpp v37, v37, v37 row_ror:8 row_mask:0xf bank_mask:0xf
  v_add_f32_dpp v38, v38, v38 row_ror:8 row_mask:0xf bank_mask:0xf
  v_add_f32_dpp v39, v39, v39 row_ror:8 row_mask:0xf bank_mask:0xf
  v_add_f32_dpp v40, v40, v40 row_ror:8 row_mask:0xf bank_mask:0xf
  v_add_f32_dpp v41, v41, v41 row_ror:8 row_mask:0xf bank_mask:0xf
  v_add_f32_dpp v42, v42, v42 row_ror:8 row_mask:0xf bank_mask:0xf
  v_add_f32_dpp v43, v43, v43 row_ror:8 row_mask:0xf bank_mask:0xf
  v_mov_b32 v52, v36
  v_mov_b32 v53, v37
  v_mov_b32 v54, v38
  v_mov_b32 v55, v39
  v_mov_b32 v56, v40
  v_mov_b32 v57, v41
  v_mov_b32 v58, v42
  v_mov_b32 v59, v43
  v_permlane16_swap_b32 v36, v52
  v_permlane16_swap_b32 v37, v53
  v_permlane16_swap_b32 v38, v54
  v_permlane16_swap_b32 v39, v55
  v_permlane16_swap_b32 v40, v56
  v_permlane16_swap_b32 v41, v57
  v_permlane16_swap_b32 v42, v58
  v_permlane16_swap_b32 v43, v59
  v_add_f32 v36, v36, v52
  v_add_f32 v37, v37, v53
  v_add_f32 v38, v38, v54
  v_add_f32 v39, v39, v55
  v_add_f32 v40, v40, v56
  v_add_f32 v41, v41, v57
  v_add_f32 v42, v42, v58
  v_add_f32 v43, v43, v59
  v_mov_b32 v52, v36
  v_mov_b32 v53, v37
  v_mov_b32 v54, v38
  v_mov_b32 v55, v39
  v_mov_b32 v56, v40
  v_mov_b32 v57, v41
  v_mov_b32 v58, v42
  v_mov_b32 v59, v43
  v_permlane32_swap_b32 v36, v52
  v_permlane32_swap_b32 v37, v53
  v_permlane32_swap_b32 v38, v54
  v_permlane32_swap_b32 v39, v55
  v_permlane32_swap_b32 v40, v56
  v_permlane32_swap_b32 v41, v57
  v_permlane32_swap_b32 v42, v58
  v_permlane32_swap_b32 v43, v59
  v_add_f32 v36, v36, v52
  v_add_f32 v37, v37, v53
  v_add_f32 v38, v38, v54
  v_add_f32 v39, v39, v55
  v_add_f32 v40, v40, v56
  v_add_f32 v41, v41, v57
  v_add_f32 v42, v42, v58
  v_add_f32 v43, v43, v59
  v_lshlrev_b32 v60, 5, v3
  s_lshl_b32 s12, s14, 8
  v_add_u32 v60, s12, v60
  v_cmp_gt_u32 vcc, 8, v1
  s_nop 0
  s_and_saveexec_b64 s[86:87], vcc
  ds_write_b128 v60, v[36:39]
  ds_write_b128 v60, v[40:43] offset:16
  s_mov_b64 exec, s[86:87]
  s_waitcnt lgkmcnt(0)
  s_barrier
  s_cmp_lg_u32 s14, 0
  s_cbranch_scc1 k1a_pd3
  v_lshlrev_b32 v60, 2, v1
  ds_read_b32 v64, v60 offset:0
  ds_read_b32 v65, v60 offset:256
  ds_read_b32 v66, v60 offset:512
  ds_read_b32 v67, v60 offset:768
  s_waitcnt lgkmcnt(2)
  v_add_f32 v64, v64, v65
  s_waitcnt lgkmcnt(0)
  v_add_f32 v66, v66, v67
  v_add_f32 v64, v64, v66
  s_mul_i32 s12, s16, 12288
  s_lshl_b32 s15, s15, 8
  s_add_u32 s12, s12, s15
  buffer_store_dword v64, v60, s[28:31], s12 offen
k1a_pd3:
  s_endpgm
k1a_h2:
  s_waitcnt lgkmcnt(0)
  s_load_dwordx2 s[6:7], s[0:1], 0
  s_load_dwordx2 s[8:9], s[0:1], 24
  s_sub_u32 s24, s2, 192
  v_lshrrev_b32 v3, 5, v1
  v_lshl_add_u32 v3, v2, 1, v3
  s_lshl_b32 s12, s24, 3
  v_add_u32 v3, s12, v3
  v_and_b32 v4, 31, v1
  v_lshlrev_b32 v5, 10, v3
  v_lshl_add_u32 v5, v4, 5, v5
  s_waitcnt lgkmcnt(0)
  s_mov_b32 s16, s6
  s_mov_b32 s17, s7
  s_mov_b32 s18, 2097152
  s_mov_b32 s19, 0x20000
  s_waitcnt vmcnt(0)
  buffer_load_dwordx4 v[8:11], v5, s[16:19], 0 offen
  buffer_load_dwordx4 v[12:15], v5, s[16:19], 0 offen offset:16
  s_add_u32 s20, s4, 1048576
  s_addc_u32 s21, s5, 0
  s_mov_b32 s22, 2097152
  s_mov_b32 s23, 0x20000
  s_waitcnt vmcnt(1)
  v_lshlrev_b32 v16, 16, v8
  v_and_b32 v17, 0xffff0000, v8
  v_lshlrev_b32 v18, 16, v9
  v_and_b32 v19, 0xffff0000, v9
  v_lshlrev_b32 v20, 16, v10
  v_and_b32 v21, 0xffff0000, v10
  v_lshlrev_b32 v22, 16, v11
  v_and_b32 v23, 0xffff0000, v11
  s_waitcnt vmcnt(0)
  v_lshlrev_b32 v24, 16, v12
  v_and_b32 v25, 0xffff0000, v12
  v_lshlrev_b32 v26, 16, v13
  v_and_b32 v27, 0xffff0000, v13
  v_lshlrev_b32 v28, 16, v14
  v_and_b32 v29, 0xffff0000, v14
  v_lshlrev_b32 v30, 16, v15
  v_and_b32 v31, 0xffff0000, v15
  s_cmp_eq_u32 s14, 0
  s_cbranch_scc1 k1a_pf4
  s_lshr_b32 s25, s24, 3
  s_cmp_eq_u32 s14, 3
  s_cbranch_scc1 k1a_pfc5
  s_lshl_b32 s25, s25, 1
  s_add_u32 s25, s25, s14
  s_sub_u32 s25, s25, 1
  s_and_b32 s26, s2, 7
  s_lshl_b32 s26, s26, 2
  s_lshr_b32 s27, s25, 4
  s_add_u32 s26, s26, s27
  s_and_b32 s25, s25, 15
  s_lshl_b32 s27, s25, 18
  s_lshl_b32 s28, s26, 8
  s_add_u32 s27, s27, s28
  v_lshrrev_b32 v32, 1, v1
  v_lshlrev_b32 v32, 13, v32
  v_and_b32 v33, 1, v1
  v_lshl_add_u32 v32, v33, 7, v32
  s_mov_b32 s32, s8
  s_mov_b32 s33, s9
  s_mov_b32 s34, 4194304
  s_mov_b32 s35, 0x20000
  buffer_load_dword v36, v32, s[32:35], s27 offen
  s_branch k1a_pf4
k1a_pfc5:
  s_getpc_b64 s[36:37]
k1a_pc6:
  s_add_u32 s36, s36, k2_kernel-k1a_pc6
  s_addc_u32 s37, s37, 0
  v_lshl_add_u32 v42, s25, 6, v1
  v_lshlrev_b32 v42, 7, v42
  v_min_u32 v42, text_end-k2_kernel-4, v42
  v_mov_b32 v41, s37
  v_add_co_u32 v40, vcc, s36, v42
  s_nop 1
  v_addc_co_u32 v41, vcc, 0, v41, vcc
  global_load_dword v39, v[40:41], off
k1a_pf4:
  v_add_f32 v43, v16, v17
  v_add_f32 v43, v43, v18
  v_add_f32 v43, v43, v19
  v_add_f32 v43, v43, v20
  v_add_f32 v43, v43, v21
  v_add_f32 v43, v43, v22
  v_add_f32 v43, v43, v23
  v_add_f32 v43, v43, v24
  v_add_f32 v43, v43, v25
  v_add_f32 v43, v43, v26
  v_add_f32 v43, v43, v27
  v_add_f32 v43, v43, v28
  v_add_f32 v43, v43, v29
  v_add_f32 v43, v43, v30
  v_add_f32 v43, v43, v31
  s_nop 1
  v_add_f32_dpp v43, v43, v43 quad_perm:[1,0,3,2] row_mask:0xf bank_mask:0xf
  s_nop 1
  v_add_f32_dpp v43, v43, v43 quad_perm:[2,3,0,1] row_mask:0xf bank_mask:0xf
  s_nop 1
  v_add_f32_dpp v43, v43, v43 row_half_mirror row_mask:0xf bank_mask:0xf
  s_nop 1
  v_add_f32_dpp v43, v43, v43 row_mirror row_mask:0xf bank_mask:0xf
  v_mov_b32 v44, v43
  s_nop 1
  v_permlane16_swap_b32 v43, v44
  v_add_f32 v43, v43, v44
  v_mul_f32 v43, 0x3b000000, v43
  v_sub_f32 v16, v16, v43
  v_sub_f32 v17, v17, v43
  v_sub_f32 v18, v18, v43
  v_sub_f32 v19, v19, v43
  v_sub_f32 v20, v20, v43
  v_sub_f32 v21, v21, v43
  v_sub_f32 v22, v22, v43
  v_sub_f32 v23, v23, v43
  v_sub_f32 v24, v24, v43
  v_sub_f32 v25, v25, v43
  v_sub_f32 v26, v26, v43
  v_sub_f32 v27, v27, v43
  v_sub_f32 v28, v28, v43
  v_sub_f32 v29, v29, v43
  v_sub_f32 v30, v30, v43
  v_sub_f32 v31, v31, v43
  v_mul_f32 v43, v16, v16
  v_fmac_f32 v43, v17, v17
  v_fmac_f32 v43, v18, v18
  v_fmac_f32 v43, v19, v19
  v_fmac_f32 v43, v20, v20
  v_fmac_f32 v43, v21, v21
  v_fmac_f32 v43, v22, v22
  v_fmac_f32 v43, v23, v23
  v_fmac_f32 v43, v24, v24
  v_fmac_f32 v43, v25, v25
  v_fmac_f32 v43, v26, v26
  v_fmac_f32 v43, v27, v27
  v_fmac_f32 v43, v28, v28
  v_fmac_f32 v43, v29, v29
  v_fmac_f32 v43, v30, v30
  v_fmac_f32 v43, v31, v31
  s_nop 1
  v_add_f32_dpp v43, v43, v43 quad_perm:[1,0,3,2] row_mask:0xf bank_mask:0xf
  s_nop 1
  v_add_f32_dpp v43, v43, v43 quad_perm:[2,3,0,1] row_mask:0xf bank_mask:0xf
  s_nop 1
  v_add_f32_dpp v43, v43, v43 row_half_mirror row_mask:0xf bank_mask:0xf
  s_nop 1
  v_add_f32_dpp v43, v43, v43 row_mirror row_mask:0xf bank_mask:0xf
  v_mov_b32 v44, v43
  s_nop 1
  v_permlane16_swap_b32 v43, v44
  v_add_f32 v43, v43, v44
  v_mov_b32 v44, 0x3727c5ac
  v_fmac_f32 v44, 0x3b000000, v43
  v_rsq_f32 v43, v44
  s_nop 0
  v_mul_f32 v16, v16, v43
  v_mul_f32 v17, v17, v43
  v_mul_f32 v18, v18, v43
  v_mul_f32 v19, v19, v43
  v_mul_f32 v20, v20, v43
  v_mul_f32 v21, v21, v43
  v_mul_f32 v22, v22, v43
  v_mul_f32 v23, v23, v43
  v_mul_f32 v24, v24, v43
  v_mul_f32 v25, v25, v43
  v_mul_f32 v26, v26, v43
  v_mul_f32 v27, v27, v43
  v_mul_f32 v28, v28, v43
  v_mul_f32 v29, v29, v43
  v_mul_f32 v30, v30, v43
  v_mul_f32 v31, v31, v43
  v_lshrrev_b32 v45, 6, v3
  v_lshlrev_b32 v45, 16, v45
  v_lshl_add_u32 v45, v4, 11, v45
  v_and_b32 v46, 63, v3
  v_lshrrev_b32 v44, 5, v46
  v_lshl_add_u32 v45, v44, 10, v45
  v_and_b32 v46, 31, v46
  v_lshl_add_u32 v45, v46, 4, v45
  v_cvt_pk_f16_f32 v8, v16, v17
  v_cvt_pk_f16_f32 v9, v18, v19
  v_cvt_pk_f16_f32 v10, v20, v21
  v_cvt_pk_f16_f32 v11, v22, v23
  v_cvt_pk_f16_f32 v12, v24, v25
  v_cvt_pk_f16_f32 v13, v26, v27
  v_cvt_pk_f16_f32 v14, v28, v29
  v_cvt_pk_f16_f32 v15, v30, v31
  buffer_store_dwordx4 v[8:11], v45, s[20:23], 0 offen
  buffer_store_dwordx4 v[12:15], v45, s[20:23], 0 offen offset:512
  s_endpgm
.text
.globl k2_kernel
.p2align 8
.type k2_kernel,@function
k2_kernel:
  s_cmp_lt_u32 s2, 256
  s_cbranch_scc1 k2_go1
  s_endpgm
k2_go1:
  s_load_dwordx2 s[8:9], s[0:1], 24
  s_load_dwordx2 s[4:5], s[0:1], 104
  s_load_dwordx2 s[16:17], s[0:1], 8
  s_load_dwordx2 s[20:21], s[0:1], 16
  s_load_dwordx2 s[28:29], s[0:1], 32
  s_load_dwordx2 s[32:33], s[0:1], 48
  s_load_dwordx2 s[36:37], s[0:1], 56
  v_and_b32 v1, 63, v0
  v_lshrrev_b32 v2, 6, v0
  s_nop 0
  v_readfirstlane_b32 s38, v2
  s_and_b32 s41, s2, 7
  s_lshr_b32 s42, s2, 3
  s_lshl_b32 s39, s41, 2
  s_and_b32 s41, s42, 3
  s_add_u32 s39, s39, s41
  s_lshr_b32 s40, s42, 2
  s_lshl_b32 s40, s40, 2
  s_add_u32 s40, s40, s38
  s_mov_b32 s10, 4194304
  s_mov_b32 s11, 0x00020000
  s_waitcnt lgkmcnt(0)
  s_add_u32 s12, s4, 1048576
  s_addc_u32 s13, s5, 0
  s_mov_b32 s14, 2097152
  s_mov_b32 s15, 0x20000
  s_mov_b32 s18, 16777216
  s_mov_b32 s19, 0x00020000
  s_mov_b32 s22, 16777216
  s_mov_b32 s23, 0x00020000
  s_add_u32 s24, s4, 16777216
  s_addc_u32 s25, s5, 0
  s_mov_b32 s26, 16777216
  s_mov_b32 s27, 0x20000
  s_mov_b32 s30, 4194304
  s_mov_b32 s31, 0x00020000
  s_lshl_b32 s43, s42, 17
  s_lshl_b32 s41, s38, 15
  s_add_u32 s43, s43, s41
  s_and_b32 s41, s2, 1
  s_lshl_b32 s41, s41, 9
  s_add_u32 s43, s43, s41
  s_mov_b32 s34, 1409024
  s_mov_b32 s35, 0x00020000
  s_bitcmp1_b32 s2, 2
  s_cselect_b32 s32, s36, s32
  s_cselect_b32 s33, s37, s33
  s_lshl_b32 s44, s42, 2
  s_add_u32 s44, s44, s38
  s_mul_i32 s44, s44, 11008
  s_and_b32 s45, s2, 3
  s_mul_i32 s45, s45, 704
  s_add_u32 s44, s44, s45
  v_lshlrev_b32 v3, 4, v1
  v_lshrrev_b32 v5, 2, v1
  v_and_b32 v6, 3, v1
  s_lshl_b32 s41, s38, 5
  v_add_u32 v4, s41, v5
  v_lshlrev_b32 v4, 13, v4
  v_lshl_add_u32 v4, v6, 4, v4
  s_lshl_b32 s46, s39, 8
  s_lshl_b32 s47, s38, 13
  s_mov_b32 s48, s4
  s_mov_b32 s49, s5
  s_mov_b32 s50, 49152
  s_mov_b32 s51, 0x20000
  s_add_u32 s52, s4, 65536
  s_addc_u32 s53, s5, 0
  s_mov_b32 s54, 12288
  s_mov_b32 s55, 0x20000
  v_lshlrev_b32 v218, 4, v0
  v_and_b32 v219, 7, v0
  s_lshl_b32 s41, s2, 3
  s_add_u32 s41, s41, 1024
  v_add_lshl_u32 v219, v219, s41, 2
  s_mov_b32 s56, 12288
  s_mov_b32 s57, 24576
  s_mov_b32 s58, 36864
  buffer_load_dwordx4 v[72:75], v218, s[48:51], 0 offen
  buffer_load_dwordx4 v[76:79], v218, s[48:51], s56 offen
  buffer_load_dwordx4 v[80:83], v218, s[48:51], s57 offen
  buffer_load_dwordx4 v[84:87], v218, s[48:51], s58 offen
  buffer_load_dword v88, v219, s[48:51], 0 offen
  buffer_load_dword v89, v219, s[48:51], s56 offen
  buffer_load_dword v90, v219, s[48:51], s57 offen
  buffer_load_dword v91, v219, s[48:51], s58 offen
  s_lshl_b32 s59, s40, 16
  s_add_u32 m0, s47, 0
  s_add_u32 s42, s46, 0
  buffer_load_dwordx4 v4, s[8:11], s42 offen offset:0 lds
  s_add_u32 m0, s47, 960
  s_nop 0
  buffer_load_dwordx4 v4, s[8:11], s42 offen offset:64 lds
  s_add_u32 m0, s47, 1920
  s_nop 0
  buffer_load_dwordx4 v4, s[8:11], s42 offen offset:128 lds
  s_add_u32 m0, s47, 2880
  s_nop 0
  buffer_load_dwordx4 v4, s[8:11], s42 offen offset:192 lds
  s_add_u32 m0, s47, 4096
  s_add_u32 s42, s46, 131072
  buffer_load_dwordx4 v4, s[8:11], s42 offen offset:0 lds
  s_add_u32 m0, s47, 5056
  s_nop 0
  buffer_load_dwordx4 v4, s[8:11], s42 offen offset:64 lds
  s_add_u32 m0, s47, 6016
  s_nop 0
  buffer_load_dwordx4 v4, s[8:11], s42 offen offset:128 lds
  s_add_u32 m0, s47, 6976
  s_nop 0
  buffer_load_dwordx4 v4, s[8:11], s42 offen offset:192 lds
  s_add_u32 s60, s59, 0
  buffer_load_dwordx4 v[104:107], v3, s[12:15], s60 offen offset:0
  s_add_u32 s60, s59, 0
  buffer_load_dwordx4 v[108:111], v3, s[12:15], s60 offen offset:1024
  s_add_u32 s60, s59, 0
  buffer_load_dwordx4 v[112:115], v3, s[12:15], s60 offen offset:2048
  s_add_u32 s60, s59, 0
  buffer_load_dwordx4 v[116:119], v3, s[12:15], s60 offen offset:3072
  s_add_u32 s60, s59, 4096
  buffer_load_dwordx4 v[120:123], v3, s[12:15], s60 offen offset:0
  s_add_u32 s60, s59, 4096
  buffer_load_dwordx4 v[124:127], v3, s[12:15], s60 offen offset:1024
  s_add_u32 s60, s59, 4096
  buffer_load_dwordx4 v[128:131], v3, s[12:15], s60 offen offset:2048
  s_add_u32 s60, s59, 4096
  buffer_load_dwordx4 v[132:135], v3, s[12:15], s60 offen offset:3072
  s_add_u32 s60, s59, 8192
  buffer_load_dwordx4 v[8:11], v3, s[12:15], s60 offen offset:0
  s_add_u32 s60, s59, 8192
  buffer_load_dwordx4 v[12:15], v3, s[12:15], s60 offen offset:1024
  s_add_u32 s60, s59, 8192
  buffer_load_dwordx4 v[16:19], v3, s[12:15], s60 offen offset:2048
  s_add_u32 s60, s59, 8192
  buffer_load_dwordx4 v[20:23], v3, s[12:15], s60 offen offset:3072
  s_add_u32 s60, s59, 12288
  buffer_load_dwordx4 v[24:27], v3, s[12:15], s60 offen offset:0
  s_add_u32 s60, s59, 12288
  buffer_load_dwordx4 v[28:31], v3, s[12:15], s60 offen offset:1024
  s_add_u32 s60, s59, 12288
  buffer_load_dwordx4 v[32:35], v3, s[12:15], s60 offen offset:2048
  s_add_u32 s60, s59, 12288
  buffer_load_dwordx4 v[36:39], v3, s[12:15], s60 offen offset:3072
  s_add_u32 s60, s59, 16384
  buffer_load_dwordx4 a[192:195], v3, s[12:15], s60 offen offset:0
  s_add_u32 s60, s59, 16384
  buffer_load_dwordx4 a[196:199], v3, s[12:15], s60 offen offset:1024
  s_add_u32 s60, s59, 16384
  buffer_load_dwordx4 a[200:203], v3, s[12:15], s60 offen offset:2048
  s_add_u32 s60, s59, 16384
  buffer_load_dwordx4 a[204:207], v3, s[12:15], s60 offen offset:3072
  s_add_u32 s60, s59, 20480
  buffer_load_dwordx4 a[208:211], v3, s[12:15], s60 offen offset:0
  s_add_u32 s60, s59, 20480
  buffer_load_dwordx4 a[212:215], v3, s[12:15], s60 offen offset:1024
  s_add_u32 s60, s59, 20480
  buffer_load_dwordx4 a[216:219], v3, s[12:15], s60 offen offset:2048
  s_add_u32 s60, s59, 20480
  buffer_load_dwordx4 a[220:223], v3, s[12:15], s60 offen offset:3072
  s_add_u32 s60, s59, 24576
  buffer_load_dwordx4 a[224:227], v3, s[12:15], s60 offen offset:0
  s_add_u32 s60, s59, 24576
  buffer_load_dwordx4 a[228:231], v3, s[12:15], s60 offen offset:1024
  s_add_u32 s60, s59, 24576
  buffer_load_dwordx4 a[232:235], v3, s[12:15], s60 offen offset:2048
  s_add_u32 s60, s59, 24576
  buffer_load_dwordx4 a[236:239], v3, s[12:15], s60 offen offset:3072
  s_add_u32 s60, s59, 28672
  buffer_load_dwordx4 a[240:243], v3, s[12:15], s60 offen offset:0
  s_add_u32 s60, s59, 28672
  buffer_load_dwordx4 a[244:247], v3, s[12:15], s60 offen offset:1024
  s_add_u32 s60, s59, 28672
  buffer_load_dwordx4 a[248:251], v3, s[12:15], s60 offen offset:2048
  s_add_u32 s60, s59, 28672
  buffer_load_dwordx4 a[252:255], v3, s[12:15], s60 offen offset:3072
  s_lshl_b32 s41, s38, 4
  v_add_u32 v221, s41, v5
  v_lshlrev_b32 v221, 8, v221
  v_lshrrev_b32 v2, 4, v1
  v_xor_b32 v2, v2, v6
  v_lshl_add_u32 v220, v2, 4, v221
  v_lshl_add_u32 v221, v6, 4, v221
  s_lshl_b32 s61, s39, 19
  s_add_u32 s61, s61, 393216
  s_lshr_b32 s41, s38, 1
  s_lshl_b32 s62, s41, 13
  s_and_b32 s41, s38, 1
  s_lshl_b32 s41, s41, 10
  s_add_u32 s62, s62, s41
  s_lshl_b32 s63, s38, 12
  s_add_u32 s63, s63, 16384
  v_lshrrev_b32 v222, 5, v1
  v_lshlrev_b32 v222, 9, v222
  v_bfe_u32 v2, v1, 2, 2
  v_lshl_add_u32 v222, v2, 6, v222
  v_bfe_u32 v2, v1, 4, 1
  v_lshl_add_u32 v222, v2, 5, v222
  v_and_b32 v2, 1, v1
  v_lshl_add_u32 v222, v2, 4, v222
  v_bfe_u32 v2, v1, 1, 1
  v_lshl_add_u32 v222, v2, 3, v222
  v_lshrrev_b32 v224, 5, v1
  v_lshlrev_b32 v224, 8, v224
  v_bfe_u32 v2, v1, 2, 2
  v_lshl_add_u32 v224, v2, 6, v224
  v_bfe_u32 v2, v1, 4, 1
  v_lshl_add_u32 v224, v2, 5, v224
  v_and_b32 v2, 1, v1
  v_lshl_add_u32 v224, v2, 4, v224
  v_bfe_u32 v2, v1, 1, 1
  v_lshl_add_u32 v224, v2, 3, v224
  v_and_b32 v2, 15, v1
  v_lshlrev_b32 v226, 6, v2
  v_lshrrev_b32 v2, 2, v2
  v_lshrrev_b32 v232, 5, v1
  v_xor_b32 v2, v2, v232
  v_lshl_add_u32 v226, v2, 4, v226
  v_bfe_u32 v2, v1, 4, 1
  v_lshl_add_u32 v226, v2, 10, v226
  v_xor_b32 v228, 32, v226
  v_add_u32 v223, 0x10000, v222
  v_add_u32 v225, 0x10000, v224
  v_add_u32 v227, 0x10000, v226
  v_add_u32 v229, 0x10000, v228
  s_mov_b32 s66, 0x53800000
  s_mov_b32 s67, 0x30800000
  v_lshrrev_b32 v233, 5, v1
  v_lshlrev_b32 v233, 5, v233
  v_add_u32 v233, 131072, v233
  s_waitcnt vmcnt(46)
  v_add_f32 v72, v72, v76
  s_waitcnt vmcnt(44)
  v_add_f32 v80, v80, v84
  v_add_f32 v73, v73, v77
  v_add_f32 v81, v81, v85
  v_add_f32 v74, v74, v78
  v_add_f32 v82, v82, v86
  v_add_f32 v75, v75, v79
  v_add_f32 v83, v83, v87
  s_waitcnt vmcnt(42)
  v_add_f32 v88, v88, v89
  s_waitcnt vmcnt(40)
  v_add_f32 v90, v90, v91
  v_add_f32 v72, v72, v80
  v_add_f32 v73, v73, v81
  v_add_f32 v74, v74, v82
  v_add_f32 v75, v75, v83
  v_add_f32 v88, v88, v90
  v_cvt_pk_bf16_f32 v76, v72, v73
  v_cvt_pk_bf16_f32 v77, v74, v75
  v_lshlrev_b32 v72, 16, v76
  v_and_b32 v73, 0xffff0000, v76
  v_lshlrev_b32 v74, 16, v77
  v_and_b32 v75, 0xffff0000, v77
  v_add_f32 v80, 1.0, v72
  v_add_f32 v81, 1.0, v73
  v_add_f32 v82, 1.0, v74
  v_add_f32 v83, 1.0, v75
  v_cvt_pk_bf16_f32 v76, v80, v81
  v_cvt_pk_bf16_f32 v77, v82, v83
  v_lshlrev_b32 v80, 16, v76
  v_and_b32 v81, 0xffff0000, v76
  v_lshlrev_b32 v82, 16, v77
  v_and_b32 v83, 0xffff0000, v77
  v_cmp_le_u32 vcc, 128, v0
  s_nop 1
  v_cndmask_b32 v72, v72, v80, vcc
  v_cndmask_b32 v73, v73, v81, vcc
  v_cndmask_b32 v74, v74, v82, vcc
  v_cndmask_b32 v75, v75, v83, vcc
  v_mul_f32 v72, 0x3e0293ee, v72
  v_mul_f32 v73, 0x3e0293ee, v73
  v_mul_f32 v74, 0x3e0293ee, v74
  v_mul_f32 v75, 0x3e0293ee, v75
  v_add_u32 v218, 131072, v218
  ds_write_b128 v218, v[72:75]
  v_cvt_pk_bf16_f32 v88, v88, v88
  v_and_b32 v88, 0xffff0000, v88
  v_add_f32 v89, 1.0, v88
  v_cvt_pk_bf16_f32 v89, v89, v89
  v_and_b32 v89, 0xffff0000, v89
  s_lshr_b32 s41, s2, 6
  s_cmp_eq_u32 s41, 2
  s_cselect_b64 vcc, -1, 0
  v_cndmask_b32 v88, v88, v89, vcc
  v_cmp_gt_u32 vcc, 8, v0
  s_nop 0
  s_and_saveexec_b64 s[68:69], vcc
  buffer_store_dword v88, v219, s[52:55], 0 offen
  s_mov_b64 exec, s[68:69]
  s_waitcnt lgkmcnt(0)
  s_barrier
  ds_read_b128 v[144:147], v233 offset:2048
  ds_read_b128 v[148:151], v233 offset:2064
  ds_read_b128 v[136:139], v233 offset:0
  ds_read_b128 v[140:143], v233 offset:16
  ds_read_b128 v[160:163], v233 offset:2112
  ds_read_b128 v[164:167], v233 offset:2128
  ds_read_b128 v[152:155], v233 offset:64
  ds_read_b128 v[156:159], v233 offset:80
  s_waitcnt vmcnt(32) lgkmcnt(5)
  v_fma_mix_f32 v200, v104, v144, v136 op_sel:[0,0,0] op_sel_hi:[1,0,0]
  v_fma_mix_f32 v201, v104, v145, v137 op_sel:[1,0,0] op_sel_hi:[1,0,0]
  v_fma_mix_f32 v202, v105, v146, v138 op_sel:[0,0,0] op_sel_hi:[1,0,0]
  v_fma_mix_f32 v203, v105, v147, v139 op_sel:[1,0,0] op_sel_hi:[1,0,0]
  s_waitcnt lgkmcnt(4)
  v_fma_mix_f32 v204, v106, v148, v140 op_sel:[0,0,0] op_sel_hi:[1,0,0]
  v_fma_mix_f32 v205, v106, v149, v141 op_sel:[1,0,0] op_sel_hi:[1,0,0]
  ds_read_b128 v[176:179], v233 offset:2176
  ds_read_b128 v[180:183], v233 offset:2192
  v_fma_mix_f32 v206, v107, v150, v142 op_sel:[0,0,0] op_sel_hi:[1,0,0]
  v_fma_mix_f32 v207, v107, v151, v143 op_sel:[1,0,0] op_sel_hi:[1,0,0]
  v_cvt_pk_bf16_f32 v104, v200, v201
  v_cvt_pk_bf16_f32 v105, v202, v203
  ds_read_b128 v[168:171], v233 offset:128
  ds_read_b128 v[172:175], v233 offset:144
  v_cvt_pk_bf16_f32 v106, v204, v205
  v_cvt_pk_bf16_f32 v107, v206, v207
  s_waitcnt vmcnt(31)
  v_fma_mix_f32 v200, v108, v144, v136 op_sel:[0,0,0] op_sel_hi:[1,0,0]
  v_fma_mix_f32 v201, v108, v145, v137 op_sel:[1,0,0] op_sel_hi:[1,0,0]
  v_fma_mix_f32 v202, v109, v146, v138 op_sel:[0,0,0] op_sel_hi:[1,0,0]
  v_fma_mix_f32 v203, v109, v147, v139 op_sel:[1,0,0] op_sel_hi:[1,0,0]
  v_fma_mix_f32 v204, v110, v148, v140 op_sel:[0,0,0] op_sel_hi:[1,0,0]
  v_fma_mix_f32 v205, v110, v149, v141 op_sel:[1,0,0] op_sel_hi:[1,0,0]
  v_fma_mix_f32 v206, v111, v150, v142 op_sel:[0,0,0] op_sel_hi:[1,0,0]
  v_fma_mix_f32 v207, v111, v151, v143 op_sel:[1,0,0] op_sel_hi:[1,0,0]
  v_cvt_pk_bf16_f32 v108, v200, v201
  v_cvt_pk_bf16_f32 v109, v202, v203
  v_cvt_pk_bf16_f32 v110, v204, v205
  v_cvt_pk_bf16_f32 v111, v206, v207
  s_waitcnt vmcnt(30) lgkmcnt(5)
  v_fma_mix_f32 v200, v112, v160, v152 op_sel:[0,0,0] op_sel_hi:[1,0,0]
  v_fma_mix_f32 v201, v112, v161, v153 op_sel:[1,0,0] op_sel_hi:[1,0,0]
  v_fma_mix_f32 v202, v113, v162, v154 op_sel:[0,0,0] op_sel_hi:[1,0,0]
  v_fma_mix_f32 v203, v113, v163, v155 op_sel:[1,0,0] op_sel_hi:[1,0,0]
  s_waitcnt lgkmcnt(4)
  v_fma_mix_f32 v204, v114, v164, v156 op_sel:[0,0,0] op_sel_hi:[1,0,0]
  v_fma_mix_f32 v205, v114, v165, v157 op_sel:[1,0,0] op_sel_hi:[1,0,0]
  ds_read_b128 v[192:195], v233 offset:2240
  ds_read_b128 v[196:199], v233 offset:2256
  v_fma_mix_f32 v206, v115, v166, v158 op_sel:[0,0,0] op_sel_hi:[1,0,0]
  v_fma_mix_f32 v207, v115, v167, v159 op_sel:[1,0,0] op_sel_hi:[1,0,0]
  v_cvt_pk_bf16_f32 v112, v200, v201
  v_cvt_pk_bf16_f32 v113, v202, v203
  ds_read_b128 v[184:187], v233 offset:192
  ds_read_b128 v[188:191], v233 offset:208
  v_cvt_pk_bf16_f32 v114, v204, v205
  v_cvt_pk_bf16_f32 v115, v206, v207
  s_waitcnt vmcnt(29)
  v_fma_mix_f32 v200, v116, v160, v152 op_sel:[0,0,0] op_sel_hi:[1,0,0]
  v_fma_mix_f32 v201, v116, v161, v153 op_sel:[1,0,0] op_sel_hi:[1,0,0]
  v_fma_mix_f32 v202, v117, v162, v154 op_sel:[0,0,0] op_sel_hi:[1,0,0]
  v_fma_mix_f32 v203, v117, v163, v155 op_sel:[1,0,0] op_sel_hi:[1,0,0]
  v_fma_mix_f32 v204, v118, v164, v156 op_sel:[0,0,0] op_sel_hi:[1,0,0]
  v_fma_mix_f32 v205, v118, v165, v157 op_sel:[1,0,0] op_sel_hi:[1,0,0]
  v_fma_mix_f32 v206, v119, v166, v158 op_sel:[0,0,0] op_sel_hi:[1,0,0]
  v_fma_mix_f32 v207, v119, v167, v159 op_sel:[1,0,0] op_sel_hi:[1,0,0]
  v_cvt_pk_bf16_f32 v116, v200, v201
  v_cvt_pk_bf16_f32 v117, v202, v203
  v_cvt_pk_bf16_f32 v118, v204, v205
  v_cvt_pk_bf16_f32 v119, v206, v207
  s_waitcnt vmcnt(28) lgkmcnt(5)
  v_fma_mix_f32 v200, v120, v176, v168 op_sel:[0,0,0] op_sel_hi:[1,0,0]
  v_fma_mix_f32 v201, v120, v177, v169 op_sel:[1,0,0] op_sel_hi:[1,0,0]
  v_fma_mix_f32 v202, v121, v178, v170 op_sel:[0,0,0] op_sel_hi:[1,0,0]
  v_fma_mix_f32 v203, v121, v179, v171 op_sel:[1,0,0] op_sel_hi:[1,0,0]
  s_waitcnt lgkmcnt(4)
  v_fma_mix_f32 v204, v122, v180, v172 op_sel:[0,0,0] op_sel_hi:[1,0,0]
  v_fma_mix_f32 v205, v122, v181, v173 op_sel:[1,0,0] op_sel_hi:[1,0,0]
  ds_read_b128 v[144:147], v233 offset:2304
  ds_read_b128 v[148:151], v233 offset:2320
  v_fma_mix_f32 v206, v123, v182, v174 op_sel:[0,0,0] op_sel_hi:[1,0,0]
  v_fma_mix_f32 v207, v123, v183, v175 op_sel:[1,0,0] op_sel_hi:[1,0,0]
  v_cvt_pk_bf16_f32 v120, v200, v201
  v_cvt_pk_bf16_f32 v121, v202, v203
  ds_read_b128 v[136:139], v233 offset:256
  ds_read_b128 v[140:143], v233 offset:272
  v_cvt_pk_bf16_f32 v122, v204, v205
  v_cvt_pk_bf16_f32 v123, v206, v207
  s_waitcnt vmcnt(27)
  v_fma_mix_f32 v200, v124, v176, v168 op_sel:[0,0,0] op_sel_hi:[1,0,0]
  v_fma_mix_f32 v201, v124, v177, v169 op_sel:[1,0,0] op_sel_hi:[1,0,0]
  v_fma_mix_f32 v202, v125, v178, v170 op_sel:[0,0,0] op_sel_hi:[1,0,0]
  v_fma_mix_f32 v203, v125, v179, v171 op_sel:[1,0,0] op_sel_hi:[1,0,0]
  v_fma_mix_f32 v204, v126, v180, v172 op_sel:[0,0,0] op_sel_hi:[1,0,0]
  v_fma_mix_f32 v205, v126, v181, v173 op_sel:[1,0,0] op_sel_hi:[1,0,0]
  v_fma_mix_f32 v206, v127, v182, v174 op_sel:[0,0,0] op_sel_hi:[1,0,0]
  v_fma_mix_f32 v207, v127, v183, v175 op_sel:[1,0,0] op_sel_hi:[1,0,0]
  v_cvt_pk_bf16_f32 v124, v200, v201
  v_cvt_pk_bf16_f32 v125, v202, v203
  v_cvt_pk_bf16_f32 v126, v204, v205
  v_cvt_pk_bf16_f32 v127, v206, v207
  s_waitcnt vmcnt(26) lgkmcnt(5)
  v_fma_mix_f32 v200, v128, v192, v184 op_sel:[0,0,0] op_sel_hi:[1,0,0]
  v_fma_mix_f32 v201, v128, v193, v185 op_sel:[1,0,0] op_sel_hi:[1,0,0]
  v_fma_mix_f32 v202, v129, v194, v186 op_sel:[0,0,0] op_sel_hi:[1,0,0]
  v_fma_mix_f32 v203, v129, v195, v187 op_sel:[1,0,0] op_sel_hi:[1,0,0]
  s_waitcnt lgkmcnt(4)
  v_fma_mix_f32 v204, v130, v196, v188 op_sel:[0,0,0] op_sel_hi:[1,0,0]
  v_fma_mix_f32 v205, v130, v197, v189 op_sel:[1,0,0] op_sel_hi:[1,0,0]
  ds_read_b128 v[160:163], v233 offset:2368
  ds_read_b128 v[164:167], v233 offset:2384
  v_fma_mix_f32 v206, v131, v198, v190 op_sel:[0,0,0] op_sel_hi:[1,0,0]
  v_fma_mix_f32 v207, v131, v199, v191 op_sel:[1,0,0] op_sel_hi:[1,0,0]
  v_cvt_pk_bf16_f32 v128, v200, v201
  v_cvt_pk_bf16_f32 v129, v202, v203
  ds_read_b128 v[152:155], v233 offset:320
  ds_read_b128 v[156:159], v233 offset:336
  v_cvt_pk_bf16_f32 v130, v204, v205
  v_cvt_pk_bf16_f32 v131, v206, v207
  s_waitcnt vmcnt(25)
  v_fma_mix_f32 v200, v132, v192, v184 op_sel:[0,0,0] op_sel_hi:[1,0,0]
  v_fma_mix_f32 v201, v132, v193, v185 op_sel:[1,0,0] op_sel_hi:[1,0,0]
  v_fma_mix_f32 v202, v133, v194, v186 op_sel:[0,0,0] op_sel_hi:[1,0,0]
  v_fma_mix_f32 v203, v133, v195, v187 op_sel:[1,0,0] op_sel_hi:[1,0,0]
  v_fma_mix_f32 v204, v134, v196, v188 op_sel:[0,0,0] op_sel_hi:[1,0,0]
  v_fma_mix_f32 v205, v134, v197, v189 op_sel:[1,0,0] op_sel_hi:[1,0,0]
  v_fma_mix_f32 v206, v135, v198, v190 op_sel:[0,0,0] op_sel_hi:[1,0,0]
  v_fma_mix_f32 v207, v135, v199, v191 op_sel:[1,0,0] op_sel_hi:[1,0,0]
  v_cvt_pk_bf16_f32 v132, v200, v201
  v_cvt_pk_bf16_f32 v133, v202, v203
  v_cvt_pk_bf16_f32 v134, v204, v205
  v_cvt_pk_bf16_f32 v135, v206, v207
  s_waitcnt vmcnt(24) lgkmcnt(5)
  v_fma_mix_f32 v200, v8, v144, v136 op_sel:[0,0,0] op_sel_hi:[1,0,0]
  v_fma_mix_f32 v201, v8, v145, v137 op_sel:[1,0,0] op_sel_hi:[1,0,0]
  v_fma_mix_f32 v202, v9, v146, v138 op_sel:[0,0,0] op_sel_hi:[1,0,0]
  v_fma_mix_f32 v203, v9, v147, v139 op_sel:[1,0,0] op_sel_hi:[1,0,0]
  s_waitcnt lgkmcnt(4)
  v_fma_mix_f32 v204, v10, v148, v140 op_sel:[0,0,0] op_sel_hi:[1,0,0]
  v_fma_mix_f32 v205, v10, v149, v141 op_sel:[1,0,0] op_sel_hi:[1,0,0]
  ds_read_b128 v[176:179], v233 offset:2432
  ds_read_b128 v[180:183], v233 offset:2448
  v_fma_mix_f32 v206, v11, v150, v142 op_sel:[0,0,0] op_sel_hi:[1,0,0]
  v_fma_mix_f32 v207, v11, v151, v143 op_sel:[1,0,0] op_sel_hi:[1,0,0]
  v_cvt_pk_bf16_f32 v8, v200, v201
  v_cvt_pk_bf16_f32 v9, v202, v203
  ds_read_b128 v[168:171], v233 offset:384
  ds_read_b128 v[172:175], v233 offset:400
  v_cvt_pk_bf16_f32 v10, v204, v205
  v_cvt_pk_bf16_f32 v11, v206, v207
  s_waitcnt vmcnt(23)
  v_fma_mix_f32 v200, v12, v144, v136 op_sel:[0,0,0] op_sel_hi:[1,0,0]
  v_fma_mix_f32 v201, v12, v145, v137 op_sel:[1,0,0] op_sel_hi:[1,0,0]
  v_fma_mix_f32 v202, v13, v146, v138 op_sel:[0,0,0] op_sel_hi:[1,0,0]
  v_fma_mix_f32 v203, v13, v147, v139 op_sel:[1,0,0] op_sel_hi:[1,0,0]
  v_fma_mix_f32 v204, v14, v148, v140 op_sel:[0,0,0] op_sel_hi:[1,0,0]
  v_fma_mix_f32 v205, v14, v149, v141 op_sel:[1,0,0] op_sel_hi:[1,0,0]
  v_fma_mix_f32 v206, v15, v150, v142 op_sel:[0,0,0] op_sel_hi:[1,0,0]
  v_fma_mix_f32 v207, v15, v151, v143 op_sel:[1,0,0] op_sel_hi:[1,0,0]
  v_cvt_pk_bf16_f32 v12, v200, v201
  v_cvt_pk_bf16_f32 v13, v202, v203
  v_cvt_pk_bf16_f32 v14, v204, v205
  v_cvt_pk_bf16_f32 v15, v206, v207
  s_waitcnt vmcnt(22) lgkmcnt(5)
  v_fma_mix_f32 v200, v16, v160, v152 op_sel:[0,0,0] op_sel_hi:[1,0,0]
  v_fma_mix_f32 v201, v16, v161, v153 op_sel:[1,0,0] op_sel_hi:[1,0,0]
  v_fma_mix_f32 v202, v17, v162, v154 op_sel:[0,0,0] op_sel_hi:[1,0,0]
  v_fma_mix_f32 v203, v17, v163, v155 op_sel:[1,0,0] op_sel_hi:[1,0,0]
  s_waitcnt lgkmcnt(4)
  v_fma_mix_f32 v204, v18, v164, v156 op_sel:[0,0,0] op_sel_hi:[1,0,0]
  v_fma_mix_f32 v205, v18, v165, v157 op_sel:[1,0,0] op_sel_hi:[1,0,0]
  ds_read_b128 v[192:195], v233 offset:2496
  ds_read_b128 v[196:199], v233 offset:2512
  v_fma_mix_f32 v206, v19, v166, v158 op_sel:[0,0,0] op_sel_hi:[1,0,0]
  v_fma_mix_f32 v207, v19, v167, v159 op_sel:[1,0,0] op_sel_hi:[1,0,0]
  v_cvt_pk_bf16_f32 v16, v200, v201
  v_cvt_pk_bf16_f32 v17, v202, v203
  ds_read_b128 v[184:187], v233 offset:448
  ds_read_b128 v[188:191], v233 offset:464
  v_cvt_pk_bf16_f32 v18, v204, v205
  v_cvt_pk_bf16_f32 v19, v206, v207
  s_waitcnt vmcnt(21)
  v_fma_mix_f32 v200, v20, v160, v152 op_sel:[0,0,0] op_sel_hi:[1,0,0]
  v_fma_mix_f32 v201, v20, v161, v153 op_sel:[1,0,0] op_sel_hi:[1,0,0]
  v_fma_mix_f32 v202, v21, v162, v154 op_sel:[0,0,0] op_sel_hi:[1,0,0]
  v_fma_mix_f32 v203, v21, v163, v155 op_sel:[1,0,0] op_sel_hi:[1,0,0]
  v_fma_mix_f32 v204, v22, v164, v156 op_sel:[0,0,0] op_sel_hi:[1,0,0]
  v_fma_mix_f32 v205, v22, v165, v157 op_sel:[1,0,0] op_sel_hi:[1,0,0]
  v_fma_mix_f32 v206, v23, v166, v158 op_sel:[0,0,0] op_sel_hi:[1,0,0]
  v_fma_mix_f32 v207, v23, v167, v159 op_sel:[1,0,0] op_sel_hi:[1,0,0]
  v_cvt_pk_bf16_f32 v20, v200, v201
  v_cvt_pk_bf16_f32 v21, v202, v203
  v_cvt_pk_bf16_f32 v22, v204, v205
  v_cvt_pk_bf16_f32 v23, v206, v207
  s_waitcnt vmcnt(20) lgkmcnt(5)
  v_fma_mix_f32 v200, v24, v176, v168 op_sel:[0,0,0] op_sel_hi:[1,0,0]
  v_fma_mix_f32 v201, v24, v177, v169 op_sel:[1,0,0] op_sel_hi:[1,0,0]
  v_fma_mix_f32 v202, v25, v178, v170 op_sel:[0,0,0] op_sel_hi:[1,0,0]
  v_fma_mix_f32 v203, v25, v179, v171 op_sel:[1,0,0] op_sel_hi:[1,0,0]
  s_waitcnt lgkmcnt(4)
  v_fma_mix_f32 v204, v26, v180, v172 op_sel:[0,0,0] op_sel_hi:[1,0,0]
  v_fma_mix_f32 v205, v26, v181, v173 op_sel:[1,0,0] op_sel_hi:[1,0,0]
  v_fma_mix_f32 v206, v27, v182, v174 op_sel:[0,0,0] op_sel_hi:[1,0,0]
  v_fma_mix_f32 v207, v27, v183, v175 op_sel:[1,0,0] op_sel_hi:[1,0,0]
  v_cvt_pk_bf16_f32 v24, v200, v201
  v_cvt_pk_bf16_f32 v25, v202, v203
  v_cvt_pk_bf16_f32 v26, v204, v205
  v_cvt_pk_bf16_f32 v27, v206, v207
  s_waitcnt vmcnt(19)
  v_fma_mix_f32 v200, v28, v176, v168 op_sel:[0,0,0] op_sel_hi:[1,0,0]
  v_fma_mix_f32 v201, v28, v177, v169 op_sel:[1,0,0] op_sel_hi:[1,0,0]
  v_fma_mix_f32 v202, v29, v178, v170 op_sel:[0,0,0] op_sel_hi:[1,0,0]
  v_fma_mix_f32 v203, v29, v179, v171 op_sel:[1,0,0] op_sel_hi:[1,0,0]
  v_fma_mix_f32 v204, v30, v180, v172 op_sel:[0,0,0] op_sel_hi:[1,0,0]
  v_fma_mix_f32 v205, v30, v181, v173 op_sel:[1,0,0] op_sel_hi:[1,0,0]
  v_fma_mix_f32 v206, v31, v182, v174 op_sel:[0,0,0] op_sel_hi:[1,0,0]
  v_fma_mix_f32 v207, v31, v183, v175 op_sel:[1,0,0] op_sel_hi:[1,0,0]
  v_cvt_pk_bf16_f32 v28, v200, v201
  v_cvt_pk_bf16_f32 v29, v202, v203
  v_cvt_pk_bf16_f32 v30, v204, v205
  v_cvt_pk_bf16_f32 v31, v206, v207
  s_waitcnt vmcnt(18) lgkmcnt(1)
  v_fma_mix_f32 v200, v32, v192, v184 op_sel:[0,0,0] op_sel_hi:[1,0,0]
  v_fma_mix_f32 v201, v32, v193, v185 op_sel:[1,0,0] op_sel_hi:[1,0,0]
  v_fma_mix_f32 v202, v33, v194, v186 op_sel:[0,0,0] op_sel_hi:[1,0,0]
  v_fma_mix_f32 v203, v33, v195, v187 op_sel:[1,0,0] op_sel_hi:[1,0,0]
  s_waitcnt lgkmcnt(0)
  v_fma_mix_f32 v204, v34, v196, v188 op_sel:[0,0,0] op_sel_hi:[1,0,0]
  v_fma_mix_f32 v205, v34, v197, v189 op_sel:[1,0,0] op_sel_hi:[1,0,0]
  v_fma_mix_f32 v206, v35, v198, v190 op_sel:[0,0,0] op_sel_hi:[1,0,0]
  v_fma_mix_f32 v207, v35, v199, v191 op_sel:[1,0,0] op_sel_hi:[1,0,0]
  v_cvt_pk_bf16_f32 v32, v200, v201
  v_cvt_pk_bf16_f32 v33, v202, v203
  v_cvt_pk_bf16_f32 v34, v204, v205
  v_cvt_pk_bf16_f32 v35, v206, v207
  s_waitcnt vmcnt(17)
  v_fma_mix_f32 v200, v36, v192, v184 op_sel:[0,0,0] op_sel_hi:[1,0,0]
  v_fma_mix_f32 v201, v36, v193, v185 op_sel:[1,0,0] op_sel_hi:[1,0,0]
  v_fma_mix_f32 v202, v37, v194, v186 op_sel:[0,0,0] op_sel_hi:[1,0,0]
  v_fma_mix_f32 v203, v37, v195, v187 op_sel:[1,0,0] op_sel_hi:[1,0,0]
  v_fma_mix_f32 v204, v38, v196, v188 op_sel:[0,0,0] op_sel_hi:[1,0,0]
  v_fma_mix_f32 v205, v38, v197, v189 op_sel:[1,0,0] op_sel_hi:[1,0,0]
  v_fma_mix_f32 v206, v39, v198, v190 op_sel:[0,0,0] op_sel_hi:[1,0,0]
  v_fma_mix_f32 v207, v39, v199, v191 op_sel:[1,0,0] op_sel_hi:[1,0,0]
  v_cvt_pk_bf16_f32 v36, v200, v201
  v_cvt_pk_bf16_f32 v37, v202, v203
  v_cvt_pk_bf16_f32 v38, v204, v205
  v_cvt_pk_bf16_f32 v39, v206, v207
  s_barrier
  ds_read_b64_tr_b16 a[128:129], v222 offset:0
  ds_read_b64_tr_b16 a[130:131], v222 offset:256
  ds_read_b64_tr_b16 a[132:133], v222 offset:4096
  ds_read_b64_tr_b16 a[134:135], v222 offset:4352
  ds_read_b64_tr_b16 a[136:137], v222 offset:8192
  ds_read_b64_tr_b16 a[138:139], v222 offset:8448
  ds_read_b64_tr_b16 a[140:141], v222 offset:12288
  ds_read_b64_tr_b16 a[142:143], v222 offset:12544
  ds_read_b64_tr_b16 a[144:145], v222 offset:16384
  ds_read_b64_tr_b16 a[146:147], v222 offset:16640
  ds_read_b64_tr_b16 a[148:149], v222 offset:20480
  ds_read_b64_tr_b16 a[150:151], v222 offset:20736
  ds_read_b64_tr_b16 a[152:153], v222 offset:24576
  ds_read_b64_tr_b16 a[154:155], v222 offset:24832
  ds_read_b64_tr_b16 a[156:157], v222 offset:28672
  ds_read_b64_tr_b16 a[158:159], v222 offset:28928
  s_waitcnt lgkmcnt(14)
  v_mfma_f32_32x32x16_bf16 a[0:15], a[128:131], v[104:107], 0
  ds_read_b64_tr_b16 a[160:161], v222 offset:1024
  ds_read_b64_tr_b16 a[162:163], v222 offset:1280
  s_add_u32 m0, s47, 32768
  s_add_u32 s42, s46, 1048576
  buffer_load_dwordx4 v4, s[8:11], s42 offen offset:0 lds
  s_waitcnt lgkmcnt(14)
  v_mfma_f32_32x32x16_bf16 a[0:15], a[132:135], v[112:115], a[0:15]
  ds_read_b64_tr_b16 a[164:165], v222 offset:5120
  ds_read_b64_tr_b16 a[166:167], v222 offset:5376
  ds_read_b128 v[144:147], v233 offset:2560
  ds_read_b128 v[148:151], v233 offset:2576
  ds_read_b128 v[136:139], v233 offset:512
  ds_read_b128 v[140:143], v233 offset:528
  ds_read_b128 v[160:163], v233 offset:2624
  s_waitcnt lgkmcnt(15)
  v_mfma_f32_32x32x16_bf16 a[0:15], a[136:139], v[120:123], a[0:15]
  ds_read_b64_tr_b16 a[168:169], v222 offset:9216
  ds_read_b64_tr_b16 a[170:171], v222 offset:9472
  s_add_u32 m0, s47, 33728
  s_nop 0
  buffer_load_dwordx4 v4, s[8:11], s42 offen offset:64 lds
  ds_read_b128 v[164:167], v233 offset:2640
  ds_read_b128 v[152:155], v233 offset:576
  v_mfma_f32_32x32x16_bf16 a[0:15], a[140:143], v[128:131], a[0:15]
  ds_read_b64_tr_b16 a[172:173], v222 offset:13312
  ds_read_b64_tr_b16 a[174:175], v222 offset:13568
  ds_read_b128 v[156:159], v233 offset:592
  s_waitcnt vmcnt(18)
  v_accvgpr_read_b32 v212, a192
  v_accvgpr_read_b32 v213, a193
  v_accvgpr_read_b32 v214, a194
  v_accvgpr_read_b32 v215, a195
  v_mfma_f32_32x32x16_bf16 a[0:15], a[144:147], v[8:11], a[0:15]
  ds_read_b64_tr_b16 a[176:177], v222 offset:17408
  ds_read_b64_tr_b16 a[178:179], v222 offset:17664
  s_add_u32 m0, s47, 34688
  s_nop 0
  buffer_load_dwordx4 v4, s[8:11], s42 offen offset:128 lds
  s_add_u32 s60, s59, 32768
  buffer_load_dwordx4 a[192:195], v3, s[12:15], s60 offen offset:0
  s_waitcnt lgkmcnt(15)
  v_mfma_f32_32x32x16_bf16 a[0:15], a[148:151], v[16:19], a[0:15]
  ds_read_b64_tr_b16 a[180:181], v222 offset:21504
  ds_read_b64_tr_b16 a[182:183], v222 offset:21760
  s_waitcnt lgkmcnt(13)
  v_fma_mix_f32 v200, v212, v144, v136 op_sel:[0,0,0] op_sel_hi:[1,0,0]
  ds_read_b128 v[176:179], v233 offset:2688
  ds_read_b128 v[180:183], v233 offset:2704
  v_fma_mix_f32 v201, v212, v145, v137 op_sel:[1,0,0] op_sel_hi:[1,0,0]
  v_fma_mix_f32 v202, v213, v146, v138 op_sel:[0,0,0] op_sel_hi:[1,0,0]
  v_mfma_f32_32x32x16_bf16 a[0:15], a[152:155], v[24:27], a[0:15]
  ds_read_b64_tr_b16 a[184:185], v222 offset:25600
  ds_read_b64_tr_b16 a[186:187], v222 offset:25856
  s_add_u32 m0, s47, 35648
  s_nop 0
  buffer_load_dwordx4 v4, s[8:11], s42 offen offset:192 lds
  v_fma_mix_f32 v203, v213, v147, v139 op_sel:[1,0,0] op_sel_hi:[1,0,0]
  s_waitcnt lgkmcnt(15)
  v_fma_mix_f32 v204, v214, v148, v140 op_sel:[0,0,0] op_sel_hi:[1,0,0]
  v_mfma_f32_32x32x16_bf16 a[0:15], a[156:159], v[32:35], a[0:15]
  ds_read_b64_tr_b16 a[188:189], v222 offset:29696
  ds_read_b64_tr_b16 a[190:191], v222 offset:29952
  ds_read_b128 v[168:171], v233 offset:640
  ds_read_b128 v[172:175], v233 offset:656
  v_fma_mix_f32 v205, v214, v149, v141 op_sel:[1,0,0] op_sel_hi:[1,0,0]
  v_fma_mix_f32 v206, v215, v150, v142 op_sel:[0,0,0] op_sel_hi:[1,0,0]
  v_fma_mix_f32 v207, v215, v151, v143 op_sel:[1,0,0] op_sel_hi:[1,0,0]
  v_mfma_f32_32x32x16_bf16 a[16:31], a[128:131], v[108:111], 0
  s_add_u32 m0, s47, 36864
  s_add_u32 s42, s46, 1179648
  buffer_load_dwordx4 v4, s[8:11], s42 offen offset:0 lds
  v_cvt_pk_bf16_f32 v40, v200, v201
  v_cvt_pk_bf16_f32 v41, v202, v203
  v_cvt_pk_bf16_f32 v42, v204, v205
  v_cvt_pk_bf16_f32 v43, v206, v207
  s_waitcnt vmcnt(21)
  v_accvgpr_read_b32 v212, a196
  v_mfma_f32_32x32x16_bf16 a[16:31], a[132:135], v[116:119], a[16:31]
  v_accvgpr_read_b32 v213, a197
  v_accvgpr_read_b32 v214, a198
  v_accvgpr_read_b32 v215, a199
  s_add_u32 s60, s59, 32768
  buffer_load_dwordx4 a[196:199], v3, s[12:15], s60 offen offset:1024
  v_fma_mix_f32 v200, v212, v144, v136 op_sel:[0,0,0] op_sel_hi:[1,0,0]
  v_fma_mix_f32 v201, v212, v145, v137 op_sel:[1,0,0] op_sel_hi:[1,0,0]
  v_mfma_f32_32x32x16_bf16 a[16:31], a[136:139], v[124:127], a[16:31]
  s_add_u32 m0, s47, 37824
  s_nop 0
  buffer_load_dwordx4 v4, s[8:11], s42 offen offset:64 lds
  v_fma_mix_f32 v202, v213, v146, v138 op_sel:[0,0,0] op_sel_hi:[1,0,0]
  v_fma_mix_f32 v203, v213, v147, v139 op_sel:[1,0,0] op_sel_hi:[1,0,0]
  v_fma_mix_f32 v204, v214, v148, v140 op_sel:[0,0,0] op_sel_hi:[1,0,0]
  v_fma_mix_f32 v205, v214, v149, v141 op_sel:[1,0,0] op_sel_hi:[1,0,0]
  v_mfma_f32_32x32x16_bf16 a[16:31], a[140:143], v[132:135], a[16:31]
  v_fma_mix_f32 v206, v215, v150, v142 op_sel:[0,0,0] op_sel_hi:[1,0,0]
  v_fma_mix_f32 v207, v215, v151, v143 op_sel:[1,0,0] op_sel_hi:[1,0,0]
  v_cvt_pk_bf16_f32 v44, v200, v201
  v_cvt_pk_bf16_f32 v45, v202, v203
  v_cvt_pk_bf16_f32 v46, v204, v205
  v_cvt_pk_bf16_f32 v47, v206, v207
  s_waitcnt vmcnt(22)
  v_accvgpr_read_b32 v212, a200
  v_mfma_f32_32x32x16_bf16 a[16:31], a[144:147], v[12:15], a[16:31]
  s_add_u32 m0, s47, 38784
  s_nop 0
  buffer_load_dwordx4 v4, s[8:11], s42 offen offset:128 lds
  v_accvgpr_read_b32 v213, a201
  v_accvgpr_read_b32 v214, a202
  v_accvgpr_read_b32 v215, a203
  v_mfma_f32_32x32x16_bf16 a[16:31], a[148:151], v[20:23], a[16:31]
  s_add_u32 s60, s59, 32768
  buffer_load_dwordx4 a[200:203], v3, s[12:15], s60 offen offset:2048
  s_waitcnt lgkmcnt(15)
  v_fma_mix_f32 v200, v212, v160, v152 op_sel:[0,0,0] op_sel_hi:[1,0,0]
  ds_read_b128 v[192:195], v233 offset:2752
  ds_read_b128 v[196:199], v233 offset:2768
  v_fma_mix_f32 v201, v212, v161, v153 op_sel:[1,0,0] op_sel_hi:[1,0,0]
  v_fma_mix_f32 v202, v213, v162, v154 op_sel:[0,0,0] op_sel_hi:[1,0,0]
  v_mfma_f32_32x32x16_bf16 a[16:31], a[152:155], v[28:31], a[16:31]
  s_add_u32 m0, s47, 39744
  s_nop 0
  buffer_load_dwordx4 v4, s[8:11], s42 offen offset:192 lds
  v_fma_mix_f32 v203, v213, v163, v155 op_sel:[1,0,0] op_sel_hi:[1,0,0]
  s_waitcnt lgkmcnt(14)
  v_fma_mix_f32 v204, v214, v164, v156 op_sel:[0,0,0] op_sel_hi:[1,0,0]
  ds_read_b128 v[184:187], v233 offset:704
  ds_read_b128 v[188:191], v233 offset:720
  v_mfma_f32_32x32x16_bf16 a[16:31], a[156:159], v[36:39], a[16:31]
  v_fma_mix_f32 v205, v214, v165, v157 op_sel:[1,0,0] op_sel_hi:[1,0,0]
  v_fma_mix_f32 v206, v215, v166, v158 op_sel:[0,0,0] op_sel_hi:[1,0,0]
  v_fma_mix_f32 v207, v215, v167, v159 op_sel:[1,0,0] op_sel_hi:[1,0,0]
  v_cvt_pk_bf16_f32 v48, v200, v201
  v_cvt_pk_bf16_f32 v49, v202, v203
  v_cvt_pk_bf16_f32 v50, v204, v205
  v_cvt_pk_bf16_f32 v51, v206, v207
  v_mfma_f32_32x32x16_bf16 a[32:47], a[160:163], v[104:107], 0
  ds_read_b64_tr_b16 a[128:129], v222 offset:2048
  ds_read_b64_tr_b16 a[130:131], v222 offset:2304
  s_waitcnt vmcnt(24)
  v_accvgpr_read_b32 v212, a204
  v_accvgpr_read_b32 v213, a205
  v_accvgpr_read_b32 v214, a206
  v_accvgpr_read_b32 v215, a207
  v_mfma_f32_32x32x16_bf16 a[32:47], a[164:167], v[112:115], a[32:47]
  ds_read_b64_tr_b16 a[132:133], v222 offset:6144
  ds_read_b64_tr_b16 a[134:135], v222 offset:6400
  s_add_u32 s60, s59, 32768
  buffer_load_dwordx4 a[204:207], v3, s[12:15], s60 offen offset:3072
  v_fma_mix_f32 v200, v212, v160, v152 op_sel:[0,0,0] op_sel_hi:[1,0,0]
  v_fma_mix_f32 v201, v212, v161, v153 op_sel:[1,0,0] op_sel_hi:[1,0,0]
  v_fma_mix_f32 v202, v213, v162, v154 op_sel:[0,0,0] op_sel_hi:[1,0,0]
  v_mfma_f32_32x32x16_bf16 a[32:47], a[168:171], v[120:123], a[32:47]
  ds_read_b64_tr_b16 a[136:137], v222 offset:10240
  ds_read_b64_tr_b16 a[138:139], v222 offset:10496
  v_fma_mix_f32 v203, v213, v163, v155 op_sel:[1,0,0] op_sel_hi:[1,0,0]
  v_fma_mix_f32 v204, v214, v164, v156 op_sel:[0,0,0] op_sel_hi:[1,0,0]
  v_fma_mix_f32 v205, v214, v165, v157 op_sel:[1,0,0] op_sel_hi:[1,0,0]
  v_fma_mix_f32 v206, v215, v166, v158 op_sel:[0,0,0] op_sel_hi:[1,0,0]
  v_fma_mix_f32 v207, v215, v167, v159 op_sel:[1,0,0] op_sel_hi:[1,0,0]
  v_mfma_f32_32x32x16_bf16 a[32:47], a[172:175], v[128:131], a[32:47]
  ds_read_b64_tr_b16 a[140:141], v222 offset:14336
  ds_read_b64_tr_b16 a[142:143], v222 offset:14592
  v_cvt_pk_bf16_f32 v52, v200, v201
  v_cvt_pk_bf16_f32 v53, v202, v203
  v_cvt_pk_bf16_f32 v54, v204, v205
  v_cvt_pk_bf16_f32 v55, v206, v207
  s_waitcnt vmcnt(24)
  v_accvgpr_read_b32 v212, a208
  s_waitcnt lgkmcnt(15)
  v_mfma_f32_32x32x16_bf16 a[32:47], a[176:179], v[8:11], a[32:47]
  ds_read_b64_tr_b16 a[144:145], v222 offset:18432
  ds_read_b64_tr_b16 a[146:147], v222 offset:18688
  v_accvgpr_read_b32 v213, a209
  v_accvgpr_read_b32 v214, a210
  v_accvgpr_read_b32 v215, a211
  s_add_u32 s60, s59, 36864
  buffer_load_dwordx4 a[208:211], v3, s[12:15], s60 offen offset:0
  v_mfma_f32_32x32x16_bf16 a[32:47], a[180:183], v[16:19], a[32:47]
  ds_read_b64_tr_b16 a[148:149], v222 offset:22528
  ds_read_b64_tr_b16 a[150:151], v222 offset:22784
  s_waitcnt lgkmcnt(15)
  v_fma_mix_f32 v200, v212, v176, v168 op_sel:[0,0,0] op_sel_hi:[1,0,0]
  ds_read_b128 v[144:147], v233 offset:2816
  ds_read_b128 v[148:151], v233 offset:2832
  v_fma_mix_f32 v201, v212, v177, v169 op_sel:[1,0,0] op_sel_hi:[1,0,0]
  v_fma_mix_f32 v202, v213, v178, v170 op_sel:[0,0,0] op_sel_hi:[1,0,0]
  v_mfma_f32_32x32x16_bf16 a[32:47], a[184:187], v[24:27], a[32:47]
  ds_read_b64_tr_b16 a[152:153], v222 offset:26624
  ds_read_b64_tr_b16 a[154:155], v222 offset:26880
  v_fma_mix_f32 v203, v213, v179, v171 op_sel:[1,0,0] op_sel_hi:[1,0,0]
  v_fma_mix_f32 v204, v214, v180, v172 op_sel:[0,0,0] op_sel_hi:[1,0,0]
  ds_read_b128 v[136:139], v233 offset:768
  ds_read_b128 v[140:143], v233 offset:784
  v_fma_mix_f32 v205, v214, v181, v173 op_sel:[1,0,0] op_sel_hi:[1,0,0]
  v_mfma_f32_32x32x16_bf16 a[32:47], a[188:191], v[32:35], a[32:47]
  ds_read_b64_tr_b16 a[156:157], v222 offset:30720
  ds_read_b64_tr_b16 a[158:159], v222 offset:30976
  v_fma_mix_f32 v206, v215, v182, v174 op_sel:[0,0,0] op_sel_hi:[1,0,0]
  v_fma_mix_f32 v207, v215, v183, v175 op_sel:[1,0,0] op_sel_hi:[1,0,0]
  v_cvt_pk_bf16_f32 v56, v200, v201
  v_cvt_pk_bf16_f32 v57, v202, v203
  v_cvt_pk_bf16_f32 v58, v204, v205
  v_mfma_f32_32x32x16_bf16 a[48:63], a[160:163], v[108:111], 0
  v_cvt_pk_bf16_f32 v59, v206, v207
  s_waitcnt vmcnt(24)
  v_accvgpr_read_b32 v212, a212
  v_accvgpr_read_b32 v213, a213
  v_accvgpr_read_b32 v214, a214
  v_accvgpr_read_b32 v215, a215
  s_add_u32 s60, s59, 36864
  buffer_load_dwordx4 a[212:215], v3, s[12:15], s60 offen offset:1024
  v_mfma_f32_32x32x16_bf16 a[48:63], a[164:167], v[116:119], a[48:63]
  v_fma_mix_f32 v200, v212, v176, v168 op_sel:[0,0,0] op_sel_hi:[1,0,0]
  v_fma_mix_f32 v201, v212, v177, v169 op_sel:[1,0,0] op_sel_hi:[1,0,0]
  v_fma_mix_f32 v202, v213, v178, v170 op_sel:[0,0,0] op_sel_hi:[1,0,0]
  v_fma_mix_f32 v203, v213, v179, v171 op_sel:[1,0,0] op_sel_hi:[1,0,0]
  v_fma_mix_f32 v204, v214, v180, v172 op_sel:[0,0,0] op_sel_hi:[1,0,0]
  v_fma_mix_f32 v205, v214, v181, v173 op_sel:[1,0,0] op_sel_hi:[1,0,0]
  v_fma_mix_f32 v206, v215, v182, v174 op_sel:[0,0,0] op_sel_hi:[1,0,0]
  v_mfma_f32_32x32x16_bf16 a[48:63], a[168:171], v[124:127], a[48:63]
  v_fma_mix_f32 v207, v215, v183, v175 op_sel:[1,0,0] op_sel_hi:[1,0,0]
  v_cvt_pk_bf16_f32 v60, v200, v201
  v_cvt_pk_bf16_f32 v61, v202, v203
  v_cvt_pk_bf16_f32 v62, v204, v205
  v_cvt_pk_bf16_f32 v63, v206, v207
  s_waitcnt vmcnt(24)
  v_accvgpr_read_b32 v212, a216
  v_accvgpr_read_b32 v213, a217
  v_mfma_f32_32x32x16_bf16 a[48:63], a[172:175], v[132:135], a[48:63]
  v_accvgpr_read_b32 v214, a218
  v_accvgpr_read_b32 v215, a219
  s_add_u32 s60, s59, 36864
  buffer_load_dwordx4 a[216:219], v3, s[12:15], s60 offen offset:2048
  s_waitcnt lgkmcnt(15)
  v_fma_mix_f32 v200, v212, v192, v184 op_sel:[0,0,0] op_sel_hi:[1,0,0]
  ds_read_b128 v[160:163], v233 offset:2880
  ds_read_b128 v[164:167], v233 offset:2896
  v_mfma_f32_32x32x16_bf16 a[48:63], a[176:179], v[12:15], a[48:63]
  v_fma_mix_f32 v201, v212, v193, v185 op_sel:[1,0,0] op_sel_hi:[1,0,0]
  v_fma_mix_f32 v202, v213, v194, v186 op_sel:[0,0,0] op_sel_hi:[1,0,0]
  v_fma_mix_f32 v203, v213, v195, v187 op_sel:[1,0,0] op_sel_hi:[1,0,0]
  v_fma_mix_f32 v204, v214, v196, v188 op_sel:[0,0,0] op_sel_hi:[1,0,0]
  ds_read_b128 v[152:155], v233 offset:832
  ds_read_b128 v[156:159], v233 offset:848
  v_fma_mix_f32 v205, v214, v197, v189 op_sel:[1,0,0] op_sel_hi:[1,0,0]
  v_mfma_f32_32x32x16_bf16 a[48:63], a[180:183], v[20:23], a[48:63]
  v_fma_mix_f32 v206, v215, v198, v190 op_sel:[0,0,0] op_sel_hi:[1,0,0]
  v_fma_mix_f32 v207, v215, v199, v191 op_sel:[1,0,0] op_sel_hi:[1,0,0]
  v_cvt_pk_bf16_f32 v64, v200, v201
  v_cvt_pk_bf16_f32 v65, v202, v203
  v_cvt_pk_bf16_f32 v66, v204, v205
  v_cvt_pk_bf16_f32 v67, v206, v207
  s_waitcnt vmcnt(24)
  v_accvgpr_read_b32 v212, a220
  v_mfma_f32_32x32x16_bf16 a[48:63], a[184:187], v[28:31], a[48:63]
  v_accvgpr_read_b32 v213, a221
  v_accvgpr_read_b32 v214, a222
  v_accvgpr_read_b32 v215, a223
  s_add_u32 s60, s59, 36864
  buffer_load_dwordx4 a[220:223], v3, s[12:15], s60 offen offset:3072
  v_fma_mix_f32 v200, v212, v192, v184 op_sel:[0,0,0] op_sel_hi:[1,0,0]
  v_fma_mix_f32 v201, v212, v193, v185 op_sel:[1,0,0] op_sel_hi:[1,0,0]
  v_mfma_f32_32x32x16_bf16 a[48:63], a[188:191], v[36:39], a[48:63]
  v_fma_mix_f32 v202, v213, v194, v186 op_sel:[0,0,0] op_sel_hi:[1,0,0]
  v_fma_mix_f32 v203, v213, v195, v187 op_sel:[1,0,0] op_sel_hi:[1,0,0]
  v_fma_mix_f32 v204, v214, v196, v188 op_sel:[0,0,0] op_sel_hi:[1,0,0]
  v_fma_mix_f32 v205, v214, v197, v189 op_sel:[1,0,0] op_sel_hi:[1,0,0]
  v_fma_mix_f32 v206, v215, v198, v190 op_sel:[0,0,0] op_sel_hi:[1,0,0]
  v_fma_mix_f32 v207, v215, v199, v191 op_sel:[1,0,0] op_sel_hi:[1,0,0]
  v_cvt_pk_bf16_f32 v68, v200, v201
  v_mfma_f32_32x32x16_bf16 a[64:79], a[128:131], v[104:107], 0
  ds_read_b64_tr_b16 a[160:161], v222 offset:3072
  ds_read_b64_tr_b16 a[162:163], v222 offset:3328
  v_cvt_pk_bf16_f32 v69, v202, v203
  v_cvt_pk_bf16_f32 v70, v204, v205
  v_cvt_pk_bf16_f32 v71, v206, v207
  s_waitcnt vmcnt(24)
  v_accvgpr_read_b32 v212, a224
  v_accvgpr_read_b32 v213, a225
  v_mfma_f32_32x32x16_bf16 a[64:79], a[132:135], v[112:115], a[64:79]
  ds_read_b64_tr_b16 a[164:165], v222 offset:7168
  ds_read_b64_tr_b16 a[166:167], v222 offset:7424
  v_accvgpr_read_b32 v214, a226
  v_accvgpr_read_b32 v215, a227
  s_add_u32 s60, s59, 40960
  buffer_load_dwordx4 a[224:227], v3, s[12:15], s60 offen offset:0
  s_waitcnt lgkmcnt(11)
  v_fma_mix_f32 v200, v212, v144, v136 op_sel:[0,0,0] op_sel_hi:[1,0,0]
  v_mfma_f32_32x32x16_bf16 a[64:79], a[136:139], v[120:123], a[64:79]
  ds_read_b64_tr_b16 a[168:169], v222 offset:11264
  ds_read_b64_tr_b16 a[170:171], v222 offset:11520
  ds_read_b128 v[176:179], v233 offset:2944
  ds_read_b128 v[180:183], v233 offset:2960
  v_fma_mix_f32 v201, v212, v145, v137 op_sel:[1,0,0] op_sel_hi:[1,0,0]
  v_fma_mix_f32 v202, v213, v146, v138 op_sel:[0,0,0] op_sel_hi:[1,0,0]
  v_fma_mix_f32 v203, v213, v147, v139 op_sel:[1,0,0] op_sel_hi:[1,0,0]
  v_mfma_f32_32x32x16_bf16 a[64:79], a[140:143], v[128:131], a[64:79]
  ds_read_b64_tr_b16 a[172:173], v222 offset:15360
  ds_read_b64_tr_b16 a[174:175], v222 offset:15616
  s_waitcnt lgkmcnt(15)
  v_fma_mix_f32 v204, v214, v148, v140 op_sel:[0,0,0] op_sel_hi:[1,0,0]
  ds_read_b128 v[168:171], v233 offset:896
  ds_read_b128 v[172:175], v233 offset:912
  v_fma_mix_f32 v205, v214, v149, v141 op_sel:[1,0,0] op_sel_hi:[1,0,0]
  v_fma_mix_f32 v206, v215, v150, v142 op_sel:[0,0,0] op_sel_hi:[1,0,0]
  v_mfma_f32_32x32x16_bf16 a[64:79], a[144:147], v[8:11], a[64:79]
  ds_read_b64_tr_b16 a[176:177], v222 offset:19456
  ds_read_b64_tr_b16 a[178:179], v222 offset:19712
  v_fma_mix_f32 v207, v215, v151, v143 op_sel:[1,0,0] op_sel_hi:[1,0,0]
  v_cvt_pk_bf16_f32 v72, v200, v201
  v_cvt_pk_bf16_f32 v73, v202, v203
  v_cvt_pk_bf16_f32 v74, v204, v205
  v_cvt_pk_bf16_f32 v75, v206, v207
  v_mfma_f32_32x32x16_bf16 a[64:79], a[148:151], v[16:19], a[64:79]
  ds_read_b64_tr_b16 a[180:181], v222 offset:23552
  ds_read_b64_tr_b16 a[182:183], v222 offset:23808
  s_waitcnt vmcnt(24)
  v_accvgpr_read_b32 v212, a228
  v_accvgpr_read_b32 v213, a229
  v_accvgpr_read_b32 v214, a230
  v_accvgpr_read_b32 v215, a231
  v_mfma_f32_32x32x16_bf16 a[64:79], a[152:155], v[24:27], a[64:79]
  ds_read_b64_tr_b16 a[184:185], v222 offset:27648
  ds_read_b64_tr_b16 a[186:187], v222 offset:27904
  s_add_u32 s60, s59, 40960
  buffer_load_dwordx4 a[228:231], v3, s[12:15], s60 offen offset:1024
  v_fma_mix_f32 v200, v212, v144, v136 op_sel:[0,0,0] op_sel_hi:[1,0,0]
  v_fma_mix_f32 v201, v212, v145, v137 op_sel:[1,0,0] op_sel_hi:[1,0,0]
  v_fma_mix_f32 v202, v213, v146, v138 op_sel:[0,0,0] op_sel_hi:[1,0,0]
  s_waitcnt lgkmcnt(15)
  v_mfma_f32_32x32x16_bf16 a[64:79], a[156:159], v[32:35], a[64:79]
  ds_read_b64_tr_b16 a[188:189], v222 offset:31744
  ds_read_b64_tr_b16 a[190:191], v222 offset:32000
  v_fma_mix_f32 v203, v213, v147, v139 op_sel:[1,0,0] op_sel_hi:[1,0,0]
  v_fma_mix_f32 v204, v214, v148, v140 op_sel:[0,0,0] op_sel_hi:[1,0,0]
  v_fma_mix_f32 v205, v214, v149, v141 op_sel:[1,0,0] op_sel_hi:[1,0,0]
  v_fma_mix_f32 v206, v215, v150, v142 op_sel:[0,0,0] op_sel_hi:[1,0,0]
  v_fma_mix_f32 v207, v215, v151, v143 op_sel:[1,0,0] op_sel_hi:[1,0,0]
  v_mfma_f32_32x32x16_bf16 a[80:95], a[128:131], v[108:111], 0
  v_cvt_pk_bf16_f32 v76, v200, v201
  v_cvt_pk_bf16_f32 v77, v202, v203
  v_cvt_pk_bf16_f32 v78, v204, v205
  v_cvt_pk_bf16_f32 v79, v206, v207
  s_waitcnt vmcnt(24)
  v_accvgpr_read_b32 v212, a232
  v_accvgpr_read_b32 v213, a233
  v_accvgpr_read_b32 v214, a234
  v_mfma_f32_32x32x16_bf16 a[80:95], a[132:135], v[116:119], a[80:95]
  v_accvgpr_read_b32 v215, a235
  s_add_u32 s60, s59, 40960
  buffer_load_dwordx4 a[232:235], v3, s[12:15], s60 offen offset:2048
  v_fma_mix_f32 v200, v212, v160, v152 op_sel:[0,0,0] op_sel_hi:[1,0,0]
  ds_read_b128 v[192:195], v233 offset:3008
  ds_read_b128 v[196:199], v233 offset:3024
  v_fma_mix_f32 v201, v212, v161, v153 op_sel:[1,0,0] op_sel_hi:[1,0,0]
  v_mfma_f32_32x32x16_bf16 a[80:95], a[136:139], v[124:127], a[80:95]
  v_fma_mix_f32 v202, v213, v162, v154 op_sel:[0,0,0] op_sel_hi:[1,0,0]
  v_fma_mix_f32 v203, v213, v163, v155 op_sel:[1,0,0] op_sel_hi:[1,0,0]
  v_fma_mix_f32 v204, v214, v164, v156 op_sel:[0,0,0] op_sel_hi:[1,0,0]
  ds_read_b128 v[184:187], v233 offset:960
  ds_read_b128 v[188:191], v233 offset:976
  v_fma_mix_f32 v205, v214, v165, v157 op_sel:[1,0,0] op_sel_hi:[1,0,0]
  v_fma_mix_f32 v206, v215, v166, v158 op_sel:[0,0,0] op_sel_hi:[1,0,0]
  v_mfma_f32_32x32x16_bf16 a[80:95], a[140:143], v[132:135], a[80:95]
  v_fma_mix_f32 v207, v215, v167, v159 op_sel:[1,0,0] op_sel_hi:[1,0,0]
  v_cvt_pk_bf16_f32 v80, v200, v201
  v_cvt_pk_bf16_f32 v81, v202, v203
  v_cvt_pk_bf16_f32 v82, v204, v205
  v_cvt_pk_bf16_f32 v83, v206, v207
  s_waitcnt vmcnt(24)
  v_accvgpr_read_b32 v212, a236
  v_accvgpr_read_b32 v213, a237
  v_mfma_f32_32x32x16_bf16 a[80:95], a[144:147], v[12:15], a[80:95]
  v_accvgpr_read_b32 v214, a238
  v_accvgpr_read_b32 v215, a239
  s_add_u32 s60, s59, 40960
  buffer_load_dwordx4 a[236:239], v3, s[12:15], s60 offen offset:3072
  v_fma_mix_f32 v200, v212, v160, v152 op_sel:[0,0,0] op_sel_hi:[1,0,0]
  v_fma_mix_f32 v201, v212, v161, v153 op_sel:[1,0,0] op_sel_hi:[1,0,0]
  v_fma_mix_f32 v202, v213, v162, v154 op_sel:[0,0,0] op_sel_hi:[1,0,0]
  v_mfma_f32_32x32x16_bf16 a[80:95], a[148:151], v[20:23], a[80:95]
  v_fma_mix_f32 v203, v213, v163, v155 op_sel:[1,0,0] op_sel_hi:[1,0,0]
  v_fma_mix_f32 v204, v214, v164, v156 op_sel:[0,0,0] op_sel_hi:[1,0,0]
  v_fma_mix_f32 v205, v214, v165, v157 op_sel:[1,0,0] op_sel_hi:[1,0,0]
  v_fma_mix_f32 v206, v215, v166, v158 op_sel:[0,0,0] op_sel_hi:[1,0,0]
  v_fma_mix_f32 v207, v215, v167, v159 op_sel:[1,0,0] op_sel_hi:[1,0,0]
  v_cvt_pk_bf16_f32 v84, v200, v201
  v_cvt_pk_bf16_f32 v85, v202, v203
  v_mfma_f32_32x32x16_bf16 a[80:95], a[152:155], v[28:31], a[80:95]
  v_cvt_pk_bf16_f32 v86, v204, v205
  v_cvt_pk_bf16_f32 v87, v206, v207
  s_waitcnt vmcnt(24)
  v_accvgpr_read_b32 v212, a240
  v_accvgpr_read_b32 v213, a241
  v_accvgpr_read_b32 v214, a242
  v_accvgpr_read_b32 v215, a243
  v_mfma_f32_32x32x16_bf16 a[80:95], a[156:159], v[36:39], a[80:95]
  s_add_u32 s60, s59, 45056
  buffer_load_dwordx4 a[240:243], v3, s[12:15], s60 offen offset:0
  s_waitcnt lgkmcnt(13)
  v_fma_mix_f32 v200, v212, v176, v168 op_sel:[0,0,0] op_sel_hi:[1,0,0]
  v_fma_mix_f32 v201, v212, v177, v169 op_sel:[1,0,0] op_sel_hi:[1,0,0]
  v_fma_mix_f32 v202, v213, v178, v170 op_sel:[0,0,0] op_sel_hi:[1,0,0]
  v_fma_mix_f32 v203, v213, v179, v171 op_sel:[1,0,0] op_sel_hi:[1,0,0]
  s_waitcnt lgkmcnt(12)
  v_fma_mix_f32 v204, v214, v180, v172 op_sel:[0,0,0] op_sel_hi:[1,0,0]
  s_waitcnt vmcnt(10)
  s_barrier
  v_mfma_f32_32x32x16_bf16 a[96:111], a[160:163], v[104:107], 0
  ds_read_b64_tr_b16 a[128:129], v222 offset:32768
  ds_read_b64_tr_b16 a[130:131], v222 offset:33024
  v_fma_mix_f32 v205, v214, v181, v173 op_sel:[1,0,0] op_sel_hi:[1,0,0]
  v_fma_mix_f32 v206, v215, v182, v174 op_sel:[0,0,0] op_sel_hi:[1,0,0]
  v_fma_mix_f32 v207, v215, v183, v175 op_sel:[1,0,0] op_sel_hi:[1,0,0]
  v_cvt_pk_bf16_f32 v88, v200, v201
  v_mfma_f32_32x32x16_bf16 a[96:111], a[164:167], v[112:115], a[96:111]
  ds_read_b64_tr_b16 a[132:133], v222 offset:36864
  ds_read_b64_tr_b16 a[134:135], v222 offset:37120
  v_cvt_pk_bf16_f32 v89, v202, v203
  v_cvt_pk_bf16_f32 v90, v204, v205
  v_cvt_pk_bf16_f32 v91, v206, v207
  v_accvgpr_read_b32 v212, a244
  v_accvgpr_read_b32 v213, a245
  v_mfma_f32_32x32x16_bf16 a[96:111], a[168:171], v[120:123], a[96:111]
  ds_read_b64_tr_b16 a[136:137], v222 offset:40960
  ds_read_b64_tr_b16 a[138:139], v222 offset:41216
  v_accvgpr_read_b32 v214, a246
  v_accvgpr_read_b32 v215, a247
  s_add_u32 s60, s59, 45056
  buffer_load_dwordx4 a[244:247], v3, s[12:15], s60 offen offset:1024
  v_fma_mix_f32 v200, v212, v176, v168 op_sel:[0,0,0] op_sel_hi:[1,0,0]
  v_mfma_f32_32x32x16_bf16 a[96:111], a[172:175], v[128:131], a[96:111]
  ds_read_b64_tr_b16 a[140:141], v222 offset:45056
  ds_read_b64_tr_b16 a[142:143], v222 offset:45312
  v_fma_mix_f32 v201, v212, v177, v169 op_sel:[1,0,0] op_sel_hi:[1,0,0]
  v_fma_mix_f32 v202, v213, v178, v170 op_sel:[0,0,0] op_sel_hi:[1,0,0]
  v_fma_mix_f32 v203, v213, v179, v171 op_sel:[1,0,0] op_sel_hi:[1,0,0]
  v_fma_mix_f32 v204, v214, v180, v172 op_sel:[0,0,0] op_sel_hi:[1,0,0]
  v_fma_mix_f32 v205, v214, v181, v173 op_sel:[1,0,0] op_sel_hi:[1,0,0]
  s_waitcnt lgkmcnt(15)
  v_mfma_f32_32x32x16_bf16 a[96:111], a[176:179], v[8:11], a[96:111]
  ds_read_b64_tr_b16 a[144:145], v222 offset:49152
  ds_read_b64_tr_b16 a[146:147], v222 offset:49408
  v_fma_mix_f32 v206, v215, v182, v174 op_sel:[0,0,0] op_sel_hi:[1,0,0]
  v_fma_mix_f32 v207, v215, v183, v175 op_sel:[1,0,0] op_sel_hi:[1,0,0]
  v_cvt_pk_bf16_f32 v92, v200, v201
  v_cvt_pk_bf16_f32 v93, v202, v203
  v_cvt_pk_bf16_f32 v94, v204, v205
  v_mfma_f32_32x32x16_bf16 a[96:111], a[180:183], v[16:19], a[96:111]
  ds_read_b64_tr_b16 a[148:149], v222 offset:53248
  ds_read_b64_tr_b16 a[150:151], v222 offset:53504
  v_cvt_pk_bf16_f32 v95, v206, v207
  v_accvgpr_read_b32 v212, a248
  v_accvgpr_read_b32 v213, a249
  v_accvgpr_read_b32 v214, a250
  v_accvgpr_read_b32 v215, a251
  s_waitcnt lgkmcnt(15)
  v_mfma_f32_32x32x16_bf16 a[96:111], a[184:187], v[24:27], a[96:111]
  ds_read_b64_tr_b16 a[152:153], v222 offset:57344
  ds_read_b64_tr_b16 a[154:155], v222 offset:57600
  s_add_u32 s60, s59, 45056
  buffer_load_dwordx4 a[248:251], v3, s[12:15], s60 offen offset:2048
  s_waitcnt lgkmcnt(15)
  v_fma_mix_f32 v200, v212, v192, v184 op_sel:[0,0,0] op_sel_hi:[1,0,0]
  v_fma_mix_f32 v201, v212, v193, v185 op_sel:[1,0,0] op_sel_hi:[1,0,0]
  v_fma_mix_f32 v202, v213, v194, v186 op_sel:[0,0,0] op_sel_hi:[1,0,0]
  v_mfma_f32_32x32x16_bf16 a[96:111], a[188:191], v[32:35], a[96:111]
  ds_read_b64_tr_b16 a[156:157], v222 offset:61440
  ds_read_b64_tr_b16 a[158:159], v222 offset:61696
  v_fma_mix_f32 v203, v213, v195, v187 op_sel:[1,0,0] op_sel_hi:[1,0,0]
  s_waitcnt lgkmcnt(15)
  v_fma_mix_f32 v204, v214, v196, v188 op_sel:[0,0,0] op_sel_hi:[1,0,0]
  v_fma_mix_f32 v205, v214, v197, v189 op_sel:[1,0,0] op_sel_hi:[1,0,0]
  v_fma_mix_f32 v206, v215, v198, v190 op_sel:[0,0,0] op_sel_hi:[1,0,0]
  v_fma_mix_f32 v207, v215, v199, v191 op_sel:[1,0,0] op_sel_hi:[1,0,0]
  v_mfma_f32_32x32x16_bf16 a[112:127], a[160:163], v[108:111], 0
  v_cvt_pk_bf16_f32 v96, v200, v201
  v_cvt_pk_bf16_f32 v97, v202, v203
  v_cvt_pk_bf16_f32 v98, v204, v205
  v_cvt_pk_bf16_f32 v99, v206, v207
  v_accvgpr_read_b32 v212, a252
  v_accvgpr_read_b32 v213, a253
  v_accvgpr_read_b32 v214, a254
  v_mfma_f32_32x32x16_bf16 a[112:127], a[164:167], v[116:119], a[112:127]
  v_accvgpr_read_b32 v215, a255
  s_add_u32 s60, s59, 45056
  buffer_load_dwordx4 a[252:255], v3, s[12:15], s60 offen offset:3072
  v_fma_mix_f32 v200, v212, v192, v184 op_sel:[0,0,0] op_sel_hi:[1,0,0]
  v_fma_mix_f32 v201, v212, v193, v185 op_sel:[1,0,0] op_sel_hi:[1,0,0]
  v_fma_mix_f32 v202, v213, v194, v186 op_sel:[0,0,0] op_sel_hi:[1,0,0]
  v_fma_mix_f32 v203, v213, v195, v187 op_sel:[1,0,0] op_sel_hi:[1,0,0]
  v_mfma_f32_32x32x16_bf16 a[112:127], a[168:171], v[124:127], a[112:127]
  v_fma_mix_f32 v204, v214, v196, v188 op_sel:[0,0,0] op_sel_hi:[1,0,0]
  v_fma_mix_f32 v205, v214, v197, v189 op_sel:[1,0,0] op_sel_hi:[1,0,0]
  v_fma_mix_f32 v206, v215, v198, v190 op_sel:[0,0,0] op_sel_hi:[1,0,0]
  v_fma_mix_f32 v207, v215, v199, v191 op_sel:[1,0,0] op_sel_hi:[1,0,0]
  v_cvt_pk_bf16_f32 v100, v200, v201
  v_cvt_pk_bf16_f32 v101, v202, v203
  v_cvt_pk_bf16_f32 v102, v204, v205
  v_mfma_f32_32x32x16_bf16 a[112:127], a[172:175], v[132:135], a[112:127]
  v_cvt_pk_bf16_f32 v103, v206, v207
  v_mfma_f32_32x32x16_bf16 a[112:127], a[176:179], v[12:15], a[112:127]
  v_mfma_f32_32x32x16_bf16 a[112:127], a[180:183], v[20:23], a[112:127]
  v_mfma_f32_32x32x16_bf16 a[112:127], a[184:187], v[28:31], a[112:127]
  v_mfma_f32_32x32x16_bf16 a[112:127], a[188:191], v[36:39], a[112:127]
  s_waitcnt lgkmcnt(14)
  v_mfma_f32_32x32x16_bf16 a[0:15], a[128:131], v[40:43], a[0:15]
  ds_read_b64_tr_b16 a[160:161], v222 offset:33792
  ds_read_b64_tr_b16 a[162:163], v222 offset:34048
  s_add_u32 m0, s47, 65536
  s_add_u32 s42, s46, 2097152
  buffer_load_dwordx4 v4, s[8:11], s42 offen offset:0 lds
  s_waitcnt lgkmcnt(14)
  v_mfma_f32_32x32x16_bf16 a[0:15], a[132:135], v[48:51], a[0:15]
  ds_read_b64_tr_b16 a[164:165], v222 offset:37888
  ds_read_b64_tr_b16 a[166:167], v222 offset:38144
  ds_read_b128 v[144:147], v233 offset:3072
  ds_read_b128 v[148:151], v233 offset:3088
  ds_read_b128 v[136:139], v233 offset:1024
  ds_read_b128 v[140:143], v233 offset:1040
  ds_read_b128 v[160:163], v233 offset:3136
  s_waitcnt lgkmcnt(15)
  v_mfma_f32_32x32x16_bf16 a[0:15], a[136:139], v[56:59], a[0:15]
  ds_read_b64_tr_b16 a[168:169], v222 offset:41984
  ds_read_b64_tr_b16 a[170:171], v222 offset:42240
  s_add_u32 m0, s47, 66496
  s_nop 0
  buffer_load_dwordx4 v4, s[8:11], s42 offen offset:64 lds
  ds_read_b128 v[164:167], v233 offset:3152
  ds_read_b128 v[152:155], v233 offset:1088
  v_mfma_f32_32x32x16_bf16 a[0:15], a[140:143], v[64:67], a[0:15]
  ds_read_b64_tr_b16 a[172:173], v222 offset:46080
  ds_read_b64_tr_b16 a[174:175], v222 offset:46336
  ds_read_b128 v[156:159], v233 offset:1104
  v_accvgpr_read_b32 v212, a192
  v_accvgpr_read_b32 v213, a193
  v_accvgpr_read_b32 v214, a194
  v_accvgpr_read_b32 v215, a195
  v_mfma_f32_32x32x16_bf16 a[0:15], a[144:147], v[72:75], a[0:15]
  ds_read_b64_tr_b16 a[176:177], v222 offset:50176
  ds_read_b64_tr_b16 a[178:179], v222 offset:50432
  s_add_u32 m0, s47, 67456
  s_nop 0
  buffer_load_dwordx4 v4, s[8:11], s42 offen offset:128 lds
  s_add_u32 s60, s59, 49152
  buffer_load_dwordx4 a[192:195], v3, s[12:15], s60 offen offset:0
  s_waitcnt lgkmcnt(15)
  v_mfma_f32_32x32x16_bf16 a[0:15], a[148:151], v[80:83], a[0:15]
  ds_read_b64_tr_b16 a[180:181], v222 offset:54272
  ds_read_b64_tr_b16 a[182:183], v222 offset:54528
  s_waitcnt lgkmcnt(13)
  v_fma_mix_f32 v200, v212, v144, v136 op_sel:[0,0,0] op_sel_hi:[1,0,0]
  ds_read_b128 v[176:179], v233 offset:3200
  ds_read_b128 v[180:183], v233 offset:3216
  v_fma_mix_f32 v201, v212, v145, v137 op_sel:[1,0,0] op_sel_hi:[1,0,0]
  v_fma_mix_f32 v202, v213, v146, v138 op_sel:[0,0,0] op_sel_hi:[1,0,0]
  v_mfma_f32_32x32x16_bf16 a[0:15], a[152:155], v[88:91], a[0:15]
  ds_read_b64_tr_b16 a[184:185], v222 offset:58368
  ds_read_b64_tr_b16 a[186:187], v222 offset:58624
  s_add_u32 m0, s47, 68416
  s_nop 0
  buffer_load_dwordx4 v4, s[8:11], s42 offen offset:192 lds
  v_fma_mix_f32 v203, v213, v147, v139 op_sel:[1,0,0] op_sel_hi:[1,0,0]
  s_waitcnt lgkmcnt(15)
  v_fma_mix_f32 v204, v214, v148, v140 op_sel:[0,0,0] op_sel_hi:[1,0,0]
  v_mfma_f32_32x32x16_bf16 a[0:15], a[156:159], v[96:99], a[0:15]
  ds_read_b64_tr_b16 a[188:189], v222 offset:62464
  ds_read_b64_tr_b16 a[190:191], v222 offset:62720
  ds_read_b128 v[168:171], v233 offset:1152
  ds_read_b128 v[172:175], v233 offset:1168
  v_fma_mix_f32 v205, v214, v149, v141 op_sel:[1,0,0] op_sel_hi:[1,0,0]
  v_fma_mix_f32 v206, v215, v150, v142 op_sel:[0,0,0] op_sel_hi:[1,0,0]
  v_fma_mix_f32 v207, v215, v151, v143 op_sel:[1,0,0] op_sel_hi:[1,0,0]
  v_mfma_f32_32x32x16_bf16 a[16:31], a[128:131], v[44:47], a[16:31]
  s_add_u32 m0, s47, 69632
  s_add_u32 s42, s46, 2228224
  buffer_load_dwordx4 v4, s[8:11], s42 offen offset:0 lds
  v_cvt_pk_bf16_f32 v104, v200, v201
  v_cvt_pk_bf16_f32 v105, v202, v203
  v_cvt_pk_bf16_f32 v106, v204, v205
  v_cvt_pk_bf16_f32 v107, v206, v207
  v_accvgpr_read_b32 v212, a196
  v_mfma_f32_32x32x16_bf16 a[16:31], a[132:135], v[52:55], a[16:31]
  v_accvgpr_read_b32 v213, a197
  v_accvgpr_read_b32 v214, a198
  v_accvgpr_read_b32 v215, a199
  s_add_u32 s60, s59, 49152
  buffer_load_dwordx4 a[196:199], v3, s[12:15], s60 offen offset:1024
  v_fma_mix_f32 v200, v212, v144, v136 op_sel:[0,0,0] op_sel_hi:[1,0,0]
  v_fma_mix_f32 v201, v212, v145, v137 op_sel:[1,0,0] op_sel_hi:[1,0,0]
  v_mfma_f32_32x32x16_bf16 a[16:31], a[136:139], v[60:63], a[16:31]
  s_add_u32 m0, s47, 70592
  s_nop 0
  buffer_load_dwordx4 v4, s[8:11], s42 offen offset:64 lds
  v_fma_mix_f32 v202, v213, v146, v138 op_sel:[0,0,0] op_sel_hi:[1,0,0]
  v_fma_mix_f32 v203, v213, v147, v139 op_sel:[1,0,0] op_sel_hi:[1,0,0]
  v_fma_mix_f32 v204, v214, v148, v140 op_sel:[0,0,0] op_sel_hi:[1,0,0]
  v_fma_mix_f32 v205, v214, v149, v141 op_sel:[1,0,0] op_sel_hi:[1,0,0]
  v_mfma_f32_32x32x16_bf16 a[16:31], a[140:143], v[68:71], a[16:31]
  v_fma_mix_f32 v206, v215, v150, v142 op_sel:[0,0,0] op_sel_hi:[1,0,0]
  v_fma_mix_f32 v207, v215, v151, v143 op_sel:[1,0,0] op_sel_hi:[1,0,0]
  v_cvt_pk_bf16_f32 v108, v200, v201
  v_cvt_pk_bf16_f32 v109, v202, v203
  v_cvt_pk_bf16_f32 v110, v204, v205
  v_cvt_pk_bf16_f32 v111, v206, v207
  v_accvgpr_read_b32 v212, a200
  v_mfma_f32_32x32x16_bf16 a[16:31], a[144:147], v[76:79], a[16:31]
  s_add_u32 m0, s47, 71552
  s_nop 0
  buffer_load_dwordx4 v4, s[8:11], s42 offen offset:128 lds
  v_accvgpr_read_b32 v213, a201
  v_accvgpr_read_b32 v214, a202
  v_accvgpr_read_b32 v215, a203
  v_mfma_f32_32x32x16_bf16 a[16:31], a[148:151], v[84:87], a[16:31]
  s_add_u32 s60, s59, 49152
  buffer_load_dwordx4 a[200:203], v3, s[12:15], s60 offen offset:2048
  s_waitcnt lgkmcnt(15)
  v_fma_mix_f32 v200, v212, v160, v152 op_sel:[0,0,0] op_sel_hi:[1,0,0]
  ds_read_b128 v[192:195], v233 offset:3264
  ds_read_b128 v[196:199], v233 offset:3280
  v_fma_mix_f32 v201, v212, v161, v153 op_sel:[1,0,0] op_sel_hi:[1,0,0]
  v_fma_mix_f32 v202, v213, v162, v154 op_sel:[0,0,0] op_sel_hi:[1,0,0]
  v_mfma_f32_32x32x16_bf16 a[16:31], a[152:155], v[92:95], a[16:31]
  s_add_u32 m0, s47, 72512
  s_nop 0
  buffer_load_dwordx4 v4, s[8:11], s42 offen offset:192 lds
  v_fma_mix_f32 v203, v213, v163, v155 op_sel:[1,0,0] op_sel_hi:[1,0,0]
  s_waitcnt lgkmcnt(14)
  v_fma_mix_f32 v204, v214, v164, v156 op_sel:[0,0,0] op_sel_hi:[1,0,0]
  ds_read_b128 v[184:187], v233 offset:1216
  ds_read_b128 v[188:191], v233 offset:1232
  v_mfma_f32_32x32x16_bf16 a[16:31], a[156:159], v[100:103], a[16:31]
  v_fma_mix_f32 v205, v214, v165, v157 op_sel:[1,0,0] op_sel_hi:[1,0,0]
  v_fma_mix_f32 v206, v215, v166, v158 op_sel:[0,0,0] op_sel_hi:[1,0,0]
  v_fma_mix_f32 v207, v215, v167, v159 op_sel:[1,0,0] op_sel_hi:[1,0,0]
  v_cvt_pk_bf16_f32 v112, v200, v201
  v_cvt_pk_bf16_f32 v113, v202, v203
  v_cvt_pk_bf16_f32 v114, v204, v205
  v_cvt_pk_bf16_f32 v115, v206, v207
  v_mfma_f32_32x32x16_bf16 a[32:47], a[160:163], v[40:43], a[32:47]
  ds_read_b64_tr_b16 a[128:129], v222 offset:34816
  ds_read_b64_tr_b16 a[130:131], v222 offset:35072
  s_waitcnt vmcnt(23)
  v_accvgpr_read_b32 v212, a204
  v_accvgpr_read_b32 v213, a205
  v_accvgpr_read_b32 v214, a206
  v_accvgpr_read_b32 v215, a207
  v_mfma_f32_32x32x16_bf16 a[32:47], a[164:167], v[48:51], a[32:47]
  ds_read_b64_tr_b16 a[132:133], v222 offset:38912
  ds_read_b64_tr_b16 a[134:135], v222 offset:39168
  s_add_u32 s60, s59, 49152
  buffer_load_dwordx4 a[204:207], v3, s[12:15], s60 offen offset:3072
  v_fma_mix_f32 v200, v212, v160, v152 op_sel:[0,0,0] op_sel_hi:[1,0,0]
  v_fma_mix_f32 v201, v212, v161, v153 op_sel:[1,0,0] op_sel_hi:[1,0,0]
  v_fma_mix_f32 v202, v213, v162, v154 op_sel:[0,0,0] op_sel_hi:[1,0,0]
  v_mfma_f32_32x32x16_bf16 a[32:47], a[168:171], v[56:59], a[32:47]
  ds_read_b64_tr_b16 a[136:137], v222 offset:43008
  ds_read_b64_tr_b16 a[138:139], v222 offset:43264
  v_fma_mix_f32 v203, v213, v163, v155 op_sel:[1,0,0] op_sel_hi:[1,0,0]
  v_fma_mix_f32 v204, v214, v164, v156 op_sel:[0,0,0] op_sel_hi:[1,0,0]
  v_fma_mix_f32 v205, v214, v165, v157 op_sel:[1,0,0] op_sel_hi:[1,0,0]
  v_fma_mix_f32 v206, v215, v166, v158 op_sel:[0,0,0] op_sel_hi:[1,0,0]
  v_fma_mix_f32 v207, v215, v167, v159 op_sel:[1,0,0] op_sel_hi:[1,0,0]
  v_mfma_f32_32x32x16_bf16 a[32:47], a[172:175], v[64:67], a[32:47]
  ds_read_b64_tr_b16 a[140:141], v222 offset:47104
  ds_read_b64_tr_b16 a[142:143], v222 offset:47360
  v_cvt_pk_bf16_f32 v116, v200, v201
  v_cvt_pk_bf16_f32 v117, v202, v203
  v_cvt_pk_bf16_f32 v118, v204, v205
  v_cvt_pk_bf16_f32 v119, v206, v207
  s_waitcnt vmcnt(23)
  v_accvgpr_read_b32 v212, a208
  s_waitcnt lgkmcnt(15)
  v_mfma_f32_32x32x16_bf16 a[32:47], a[176:179], v[72:75], a[32:47]
  ds_read_b64_tr_b16 a[144:145], v222 offset:51200
  ds_read_b64_tr_b16 a[146:147], v222 offset:51456
  v_accvgpr_read_b32 v213, a209
  v_accvgpr_read_b32 v214, a210
  v_accvgpr_read_b32 v215, a211
  s_add_u32 s60, s59, 53248
  buffer_load_dwordx4 a[208:211], v3, s[12:15], s60 offen offset:0
  v_mfma_f32_32x32x16_bf16 a[32:47], a[180:183], v[80:83], a[32:47]
  ds_read_b64_tr_b16 a[148:149], v222 offset:55296
  ds_read_b64_tr_b16 a[150:151], v222 offset:55552
  s_waitcnt lgkmcnt(15)
  v_fma_mix_f32 v200, v212, v176, v168 op_sel:[0,0,0] op_sel_hi:[1,0,0]
  ds_read_b128 v[144:147], v233 offset:3328
  ds_read_b128 v[148:151], v233 offset:3344
  v_fma_mix_f32 v201, v212, v177, v169 op_sel:[1,0,0] op_sel_hi:[1,0,0]
  v_fma_mix_f32 v202, v213, v178, v170 op_sel:[0,0,0] op_sel_hi:[1,0,0]
  v_mfma_f32_32x32x16_bf16 a[32:47], a[184:187], v[88:91], a[32:47]
  ds_read_b64_tr_b16 a[152:153], v222 offset:59392
  ds_read_b64_tr_b16 a[154:155], v222 offset:59648
  v_fma_mix_f32 v203, v213, v179, v171 op_sel:[1,0,0] op_sel_hi:[1,0,0]
  v_fma_mix_f32 v204, v214, v180, v172 op_sel:[0,0,0] op_sel_hi:[1,0,0]
  ds_read_b128 v[136:139], v233 offset:1280
  ds_read_b128 v[140:143], v233 offset:1296
  v_fma_mix_f32 v205, v214, v181, v173 op_sel:[1,0,0] op_sel_hi:[1,0,0]
  v_mfma_f32_32x32x16_bf16 a[32:47], a[188:191], v[96:99], a[32:47]
  ds_read_b64_tr_b16 a[156:157], v222 offset:63488
  ds_read_b64_tr_b16 a[158:159], v222 offset:63744
  v_fma_mix_f32 v206, v215, v182, v174 op_sel:[0,0,0] op_sel_hi:[1,0,0]
  v_fma_mix_f32 v207, v215, v183, v175 op_sel:[1,0,0] op_sel_hi:[1,0,0]
  v_cvt_pk_bf16_f32 v120, v200, v201
  v_cvt_pk_bf16_f32 v121, v202, v203
  v_cvt_pk_bf16_f32 v122, v204, v205
  v_mfma_f32_32x32x16_bf16 a[48:63], a[160:163], v[44:47], a[48:63]
  v_cvt_pk_bf16_f32 v123, v206, v207
  s_waitcnt vmcnt(23)
  v_accvgpr_read_b32 v212, a212
  v_accvgpr_read_b32 v213, a213
  v_accvgpr_read_b32 v214, a214
  v_accvgpr_read_b32 v215, a215
  s_add_u32 s60, s59, 53248
  buffer_load_dwordx4 a[212:215], v3, s[12:15], s60 offen offset:1024
  v_mfma_f32_32x32x16_bf16 a[48:63], a[164:167], v[52:55], a[48:63]
  v_fma_mix_f32 v200, v212, v176, v168 op_sel:[0,0,0] op_sel_hi:[1,0,0]
  v_fma_mix_f32 v201, v212, v177, v169 op_sel:[1,0,0] op_sel_hi:[1,0,0]
  v_fma_mix_f32 v202, v213, v178, v170 op_sel:[0,0,0] op_sel_hi:[1,0,0]
  v_fma_mix_f32 v203, v213, v179, v171 op_sel:[1,0,0] op_sel_hi:[1,0,0]
  v_fma_mix_f32 v204, v214, v180, v172 op_sel:[0,0,0] op_sel_hi:[1,0,0]
  v_fma_mix_f32 v205, v214, v181, v173 op_sel:[1,0,0] op_sel_hi:[1,0,0]
  v_fma_mix_f32 v206, v215, v182, v174 op_sel:[0,0,0] op_sel_hi:[1,0,0]
  v_mfma_f32_32x32x16_bf16 a[48:63], a[168:171], v[60:63], a[48:63]
  v_fma_mix_f32 v207, v215, v183, v175 op_sel:[1,0,0] op_sel_hi:[1,0,0]
  v_cvt_pk_bf16_f32 v124, v200, v201
  v_cvt_pk_bf16_f32 v125, v202, v203
  v_cvt_pk_bf16_f32 v126, v204, v205
  v_cvt_pk_bf16_f32 v127, v206, v207
  s_waitcnt vmcnt(23)
  v_accvgpr_read_b32 v212, a216
  v_accvgpr_read_b32 v213, a217
  v_mfma_f32_32x32x16_bf16 a[48:63], a[172:175], v[68:71], a[48:63]
  v_accvgpr_read_b32 v214, a218
  v_accvgpr_read_b32 v215, a219
  s_add_u32 s60, s59, 53248
  buffer_load_dwordx4 a[216:219], v3, s[12:15], s60 offen offset:2048
  s_waitcnt lgkmcnt(15)
  v_fma_mix_f32 v200, v212, v192, v184 op_sel:[0,0,0] op_sel_hi:[1,0,0]
  ds_read_b128 v[160:163], v233 offset:3392
  ds_read_b128 v[164:167], v233 offset:3408
  v_mfma_f32_32x32x16_bf16 a[48:63], a[176:179], v[76:79], a[48:63]
  v_fma_mix_f32 v201, v212, v193, v185 op_sel:[1,0,0] op_sel_hi:[1,0,0]
  v_fma_mix_f32 v202, v213, v194, v186 op_sel:[0,0,0] op_sel_hi:[1,0,0]
  v_fma_mix_f32 v203, v213, v195, v187 op_sel:[1,0,0] op_sel_hi:[1,0,0]
  v_fma_mix_f32 v204, v214, v196, v188 op_sel:[0,0,0] op_sel_hi:[1,0,0]
  ds_read_b128 v[152:155], v233 offset:1344
  ds_read_b128 v[156:159], v233 offset:1360
  v_fma_mix_f32 v205, v214, v197, v189 op_sel:[1,0,0] op_sel_hi:[1,0,0]
  v_mfma_f32_32x32x16_bf16 a[48:63], a[180:183], v[84:87], a[48:63]
  v_fma_mix_f32 v206, v215, v198, v190 op_sel:[0,0,0] op_sel_hi:[1,0,0]
  v_fma_mix_f32 v207, v215, v199, v191 op_sel:[1,0,0] op_sel_hi:[1,0,0]
  v_cvt_pk_bf16_f32 v128, v200, v201
  v_cvt_pk_bf16_f32 v129, v202, v203
  v_cvt_pk_bf16_f32 v130, v204, v205
  v_cvt_pk_bf16_f32 v131, v206, v207
  s_waitcnt vmcnt(23)
  v_accvgpr_read_b32 v212, a220
  v_mfma_f32_32x32x16_bf16 a[48:63], a[184:187], v[92:95], a[48:63]
  v_accvgpr_read_b32 v213, a221
  v_accvgpr_read_b32 v214, a222
  v_accvgpr_read_b32 v215, a223
  s_add_u32 s60, s59, 53248
  buffer_load_dwordx4 a[220:223], v3, s[12:15], s60 offen offset:3072
  v_fma_mix_f32 v200, v212, v192, v184 op_sel:[0,0,0] op_sel_hi:[1,0,0]
  v_fma_mix_f32 v201, v212, v193, v185 op_sel:[1,0,0] op_sel_hi:[1,0,0]
  v_mfma_f32_32x32x16_bf16 a[48:63], a[188:191], v[100:103], a[48:63]
  v_fma_mix_f32 v202, v213, v194, v186 op_sel:[0,0,0] op_sel_hi:[1,0,0]
  v_fma_mix_f32 v203, v213, v195, v187 op_sel:[1,0,0] op_sel_hi:[1,0,0]
  v_fma_mix_f32 v204, v214, v196, v188 op_sel:[0,0,0] op_sel_hi:[1,0,0]
  v_fma_mix_f32 v205, v214, v197, v189 op_sel:[1,0,0] op_sel_hi:[1,0,0]
  v_fma_mix_f32 v206, v215, v198, v190 op_sel:[0,0,0] op_sel_hi:[1,0,0]
  v_fma_mix_f32 v207, v215, v199, v191 op_sel:[1,0,0] op_sel_hi:[1,0,0]
  v_cvt_pk_bf16_f32 v132, v200, v201
  v_mfma_f32_32x32x16_bf16 a[64:79], a[128:131], v[40:43], a[64:79]
  ds_read_b64_tr_b16 a[160:161], v222 offset:35840
  ds_read_b64_tr_b16 a[162:163], v222 offset:36096
  v_cvt_pk_bf16_f32 v133, v202, v203
  v_cvt_pk_bf16_f32 v134, v204, v205
  v_cvt_pk_bf16_f32 v135, v206, v207
  s_waitcnt vmcnt(23)
  v_accvgpr_read_b32 v212, a224
  v_accvgpr_read_b32 v213, a225
  v_mfma_f32_32x32x16_bf16 a[64:79], a[132:135], v[48:51], a[64:79]
  ds_read_b64_tr_b16 a[164:165], v222 offset:39936
  ds_read_b64_tr_b16 a[166:167], v222 offset:40192
  v_accvgpr_read_b32 v214, a226
  v_accvgpr_read_b32 v215, a227
  s_add_u32 s60, s59, 57344
  buffer_load_dwordx4 a[224:227], v3, s[12:15], s60 offen offset:0
  s_waitcnt lgkmcnt(11)
  v_fma_mix_f32 v200, v212, v144, v136 op_sel:[0,0,0] op_sel_hi:[1,0,0]
  v_mfma_f32_32x32x16_bf16 a[64:79], a[136:139], v[56:59], a[64:79]
  ds_read_b64_tr_b16 a[168:169], v222 offset:44032
  ds_read_b64_tr_b16 a[170:171], v222 offset:44288
  ds_read_b128 v[176:179], v233 offset:3456
  ds_read_b128 v[180:183], v233 offset:3472
  v_fma_mix_f32 v201, v212, v145, v137 op_sel:[1,0,0] op_sel_hi:[1,0,0]
  v_fma_mix_f32 v202, v213, v146, v138 op_sel:[0,0,0] op_sel_hi:[1,0,0]
  v_fma_mix_f32 v203, v213, v147, v139 op_sel:[1,0,0] op_sel_hi:[1,0,0]
  v_mfma_f32_32x32x16_bf16 a[64:79], a[140:143], v[64:67], a[64:79]
  ds_read_b64_tr_b16 a[172:173], v222 offset:48128
  ds_read_b64_tr_b16 a[174:175], v222 offset:48384
  s_waitcnt lgkmcnt(15)
  v_fma_mix_f32 v204, v214, v148, v140 op_sel:[0,0,0] op_sel_hi:[1,0,0]
  ds_read_b128 v[168:171], v233 offset:1408
  ds_read_b128 v[172:175], v233 offset:1424
  v_fma_mix_f32 v205, v214, v149, v141 op_sel:[1,0,0] op_sel_hi:[1,0,0]
  v_fma_mix_f32 v206, v215, v150, v142 op_sel:[0,0,0] op_sel_hi:[1,0,0]
  v_mfma_f32_32x32x16_bf16 a[64:79], a[144:147], v[72:75], a[64:79]
  ds_read_b64_tr_b16 a[176:177], v222 offset:52224
  ds_read_b64_tr_b16 a[178:179], v222 offset:52480
  v_fma_mix_f32 v207, v215, v151, v143 op_sel:[1,0,0] op_sel_hi:[1,0,0]
  v_cvt_pk_bf16_f32 v8, v200, v201
  v_cvt_pk_bf16_f32 v9, v202, v203
  v_cvt_pk_bf16_f32 v10, v204, v205
  v_cvt_pk_bf16_f32 v11, v206, v207
  v_mfma_f32_32x32x16_bf16 a[64:79], a[148:151], v[80:83], a[64:79]
  ds_read_b64_tr_b16 a[180:181], v222 offset:56320
  ds_read_b64_tr_b16 a[182:183], v222 offset:56576
  s_waitcnt vmcnt(23)
  v_accvgpr_read_b32 v212, a228
  v_accvgpr_read_b32 v213, a229
  v_accvgpr_read_b32 v214, a230
  v_accvgpr_read_b32 v215, a231
  v_mfma_f32_32x32x16_bf16 a[64:79], a[152:155], v[88:91], a[64:79]
  ds_read_b64_tr_b16 a[184:185], v222 offset:60416
  ds_read_b64_tr_b16 a[186:187], v222 offset:60672
  s_add_u32 s60, s59, 57344
  buffer_load_dwordx4 a[228:231], v3, s[12:15], s60 offen offset:1024
  v_fma_mix_f32 v200, v212, v144, v136 op_sel:[0,0,0] op_sel_hi:[1,0,0]
  v_fma_mix_f32 v201, v212, v145, v137 op_sel:[1,0,0] op_sel_hi:[1,0,0]
  v_fma_mix_f32 v202, v213, v146, v138 op_sel:[0,0,0] op_sel_hi:[1,0,0]
  s_waitcnt lgkmcnt(15)
  v_mfma_f32_32x32x16_bf16 a[64:79], a[156:159], v[96:99], a[64:79]
  ds_read_b64_tr_b16 a[188:189], v222 offset:64512
  ds_read_b64_tr_b16 a[190:191], v222 offset:64768
  v_fma_mix_f32 v203, v213, v147, v139 op_sel:[1,0,0] op_sel_hi:[1,0,0]
  v_fma_mix_f32 v204, v214, v148, v140 op_sel:[0,0,0] op_sel_hi:[1,0,0]
  v_fma_mix_f32 v205, v214, v149, v141 op_sel:[1,0,0] op_sel_hi:[1,0,0]
  v_fma_mix_f32 v206, v215, v150, v142 op_sel:[0,0,0] op_sel_hi:[1,0,0]
  v_fma_mix_f32 v207, v215, v151, v143 op_sel:[1,0,0] op_sel_hi:[1,0,0]
  v_mfma_f32_32x32x16_bf16 a[80:95], a[128:131], v[44:47], a[80:95]
  v_cvt_pk_bf16_f32 v12, v200, v201
  v_cvt_pk_bf16_f32 v13, v202, v203
  v_cvt_pk_bf16_f32 v14, v204, v205
  v_cvt_pk_bf16_f32 v15, v206, v207
  s_waitcnt vmcnt(23)
  v_accvgpr_read_b32 v212, a232
  v_accvgpr_read_b32 v213, a233
  v_accvgpr_read_b32 v214, a234
  v_mfma_f32_32x32x16_bf16 a[80:95], a[132:135], v[52:55], a[80:95]
  v_accvgpr_read_b32 v215, a235
  s_add_u32 s60, s59, 57344
  buffer_load_dwordx4 a[232:235], v3, s[12:15], s60 offen offset:2048
  v_fma_mix_f32 v200, v212, v160, v152 op_sel:[0,0,0] op_sel_hi:[1,0,0]
  ds_read_b128 v[192:195], v233 offset:3520
  ds_read_b128 v[196:199], v233 offset:3536
  v_fma_mix_f32 v201, v212, v161, v153 op_sel:[1,0,0] op_sel_hi:[1,0,0]
  v_mfma_f32_32x32x16_bf16 a[80:95], a[136:139], v[60:63], a[80:95]
  v_fma_mix_f32 v202, v213, v162, v154 op_sel:[0,0,0] op_sel_hi:[1,0,0]
  v_fma_mix_f32 v203, v213, v163, v155 op_sel:[1,0,0] op_sel_hi:[1,0,0]
  v_fma_mix_f32 v204, v214, v164, v156 op_sel:[0,0,0] op_sel_hi:[1,0,0]
  ds_read_b128 v[184:187], v233 offset:1472
  ds_read_b128 v[188:191], v233 offset:1488
  v_fma_mix_f32 v205, v214, v165, v157 op_sel:[1,0,0] op_sel_hi:[1,0,0]
  v_fma_mix_f32 v206, v215, v166, v158 op_sel:[0,0,0] op_sel_hi:[1,0,0]
  v_mfma_f32_32x32x16_bf16 a[80:95], a[140:143], v[68:71], a[80:95]
  v_fma_mix_f32 v207, v215, v167, v159 op_sel:[1,0,0] op_sel_hi:[1,0,0]
  v_cvt_pk_bf16_f32 v16, v200, v201
  v_cvt_pk_bf16_f32 v17, v202, v203
  v_cvt_pk_bf16_f32 v18, v204, v205
  v_cvt_pk_bf16_f32 v19, v206, v207
  s_waitcnt vmcnt(23)
  v_accvgpr_read_b32 v212, a236
  v_accvgpr_read_b32 v213, a237
  v_mfma_f32_32x32x16_bf16 a[80:95], a[144:147], v[76:79], a[80:95]
  v_accvgpr_read_b32 v214, a238
  v_accvgpr_read_b32 v215, a239
  s_add_u32 s60, s59, 57344
  buffer_load_dwordx4 a[236:239], v3, s[12:15], s60 offen offset:3072
  v_fma_mix_f32 v200, v212, v160, v152 op_sel:[0,0,0] op_sel_hi:[1,0,0]
  v_fma_mix_f32 v201, v212, v161, v153 op_sel:[1,0,0] op_sel_hi:[1,0,0]
  v_fma_mix_f32 v202, v213, v162, v154 op_sel:[0,0,0] op_sel_hi:[1,0,0]
  v_mfma_f32_32x32x16_bf16 a[80:95], a[148:151], v[84:87], a[80:95]
  v_fma_mix_f32 v203, v213, v163, v155 op_sel:[1,0,0] op_sel_hi:[1,0,0]
  v_fma_mix_f32 v204, v214, v164, v156 op_sel:[0,0,0] op_sel_hi:[1,0,0]
  v_fma_mix_f32 v205, v214, v165, v157 op_sel:[1,0,0] op_sel_hi:[1,0,0]
  v_fma_mix_f32 v206, v215, v166, v158 op_sel:[0,0,0] op_sel_hi:[1,0,0]
  v_fma_mix_f32 v207, v215, v167, v159 op_sel:[1,0,0] op_sel_hi:[1,0,0]
  v_cvt_pk_bf16_f32 v20, v200, v201
  v_cvt_pk_bf16_f32 v21, v202, v203
  v_mfma_f32_32x32x16_bf16 a[80:95], a[152:155], v[92:95], a[80:95]
  v_cvt_pk_bf16_f32 v22, v204, v205
  v_cvt_pk_bf16_f32 v23, v206, v207
  s_waitcnt vmcnt(23)
  v_accvgpr_read_b32 v212, a240
  v_accvgpr_read_b32 v213, a241
  v_accvgpr_read_b32 v214, a242
  v_accvgpr_read_b32 v215, a243
  v_mfma_f32_32x32x16_bf16 a[80:95], a[156:159], v[100:103], a[80:95]
  s_add_u32 s60, s59, 61440
  buffer_load_dwordx4 a[240:243], v3, s[12:15], s60 offen offset:0
  s_waitcnt lgkmcnt(13)
  v_fma_mix_f32 v200, v212, v176, v168 op_sel:[0,0,0] op_sel_hi:[1,0,0]
  v_fma_mix_f32 v201, v212, v177, v169 op_sel:[1,0,0] op_sel_hi:[1,0,0]
  v_fma_mix_f32 v202, v213, v178, v170 op_sel:[0,0,0] op_sel_hi:[1,0,0]
  v_fma_mix_f32 v203, v213, v179, v171 op_sel:[1,0,0] op_sel_hi:[1,0,0]
  s_waitcnt lgkmcnt(12)
  v_fma_mix_f32 v204, v214, v180, v172 op_sel:[0,0,0] op_sel_hi:[1,0,0]
  s_waitcnt vmcnt(10)
  s_barrier
  v_mfma_f32_32x32x16_bf16 a[96:111], a[160:163], v[40:43], a[96:111]
  ds_read_b64_tr_b16 a[128:129], v223 offset:0
  ds_read_b64_tr_b16 a[130:131], v223 offset:256
  v_fma_mix_f32 v205, v214, v181, v173 op_sel:[1,0,0] op_sel_hi:[1,0,0]
  v_fma_mix_f32 v206, v215, v182, v174 op_sel:[0,0,0] op_sel_hi:[1,0,0]
  v_fma_mix_f32 v207, v215, v183, v175 op_sel:[1,0,0] op_sel_hi:[1,0,0]
  v_cvt_pk_bf16_f32 v24, v200, v201
  v_mfma_f32_32x32x16_bf16 a[96:111], a[164:167], v[48:51], a[96:111]
  ds_read_b64_tr_b16 a[132:133], v223 offset:4096
  ds_read_b64_tr_b16 a[134:135], v223 offset:4352
  v_cvt_pk_bf16_f32 v25, v202, v203
  v_cvt_pk_bf16_f32 v26, v204, v205
  v_cvt_pk_bf16_f32 v27, v206, v207
  v_accvgpr_read_b32 v212, a244
  v_accvgpr_read_b32 v213, a245
  v_mfma_f32_32x32x16_bf16 a[96:111], a[168:171], v[56:59], a[96:111]
  ds_read_b64_tr_b16 a[136:137], v223 offset:8192
  ds_read_b64_tr_b16 a[138:139], v223 offset:8448
  v_accvgpr_read_b32 v214, a246
  v_accvgpr_read_b32 v215, a247
  s_add_u32 s60, s59, 61440
  buffer_load_dwordx4 a[244:247], v3, s[12:15], s60 offen offset:1024
  v_fma_mix_f32 v200, v212, v176, v168 op_sel:[0,0,0] op_sel_hi:[1,0,0]
  v_mfma_f32_32x32x16_bf16 a[96:111], a[172:175], v[64:67], a[96:111]
  ds_read_b64_tr_b16 a[140:141], v223 offset:12288
  ds_read_b64_tr_b16 a[142:143], v223 offset:12544
  v_fma_mix_f32 v201, v212, v177, v169 op_sel:[1,0,0] op_sel_hi:[1,0,0]
  v_fma_mix_f32 v202, v213, v178, v170 op_sel:[0,0,0] op_sel_hi:[1,0,0]
  v_fma_mix_f32 v203, v213, v179, v171 op_sel:[1,0,0] op_sel_hi:[1,0,0]
  v_fma_mix_f32 v204, v214, v180, v172 op_sel:[0,0,0] op_sel_hi:[1,0,0]
  v_fma_mix_f32 v205, v214, v181, v173 op_sel:[1,0,0] op_sel_hi:[1,0,0]
  s_waitcnt lgkmcnt(15)
  v_mfma_f32_32x32x16_bf16 a[96:111], a[176:179], v[72:75], a[96:111]
  ds_read_b64_tr_b16 a[144:145], v223 offset:16384
  ds_read_b64_tr_b16 a[146:147], v223 offset:16640
  v_fma_mix_f32 v206, v215, v182, v174 op_sel:[0,0,0] op_sel_hi:[1,0,0]
  v_fma_mix_f32 v207, v215, v183, v175 op_sel:[1,0,0] op_sel_hi:[1,0,0]
  v_cvt_pk_bf16_f32 v28, v200, v201
  v_cvt_pk_bf16_f32 v29, v202, v203
  v_cvt_pk_bf16_f32 v30, v204, v205
  v_mfma_f32_32x32x16_bf16 a[96:111], a[180:183], v[80:83], a[96:111]
  ds_read_b64_tr_b16 a[148:149], v223 offset:20480
  ds_read_b64_tr_b16 a[150:151], v223 offset:20736
  v_cvt_pk_bf16_f32 v31, v206, v207
  v_accvgpr_read_b32 v212, a248
  v_accvgpr_read_b32 v213, a249
  v_accvgpr_read_b32 v214, a250
  v_accvgpr_read_b32 v215, a251
  s_waitcnt lgkmcnt(15)
  v_mfma_f32_32x32x16_bf16 a[96:111], a[184:187], v[88:91], a[96:111]
  ds_read_b64_tr_b16 a[152:153], v223 offset:24576
  ds_read_b64_tr_b16 a[154:155], v223 offset:24832
  s_add_u32 s60, s59, 61440
  buffer_load_dwordx4 a[248:251], v3, s[12:15], s60 offen offset:2048
  s_waitcnt lgkmcnt(15)
  v_fma_mix_f32 v200, v212, v192, v184 op_sel:[0,0,0] op_sel_hi:[1,0,0]
  v_fma_mix_f32 v201, v212, v193, v185 op_sel:[1,0,0] op_sel_hi:[1,0,0]
  v_fma_mix_f32 v202, v213, v194, v186 op_sel:[0,0,0] op_sel_hi:[1,0,0]
  v_mfma_f32_32x32x16_bf16 a[96:111], a[188:191], v[96:99], a[96:111]
  ds_read_b64_tr_b16 a[156:157], v223 offset:28672
  ds_read_b64_tr_b16 a[158:159], v223 offset:28928
  v_fma_mix_f32 v203, v213, v195, v187 op_sel:[1,0,0] op_sel_hi:[1,0,0]
  s_waitcnt lgkmcnt(15)
  v_fma_mix_f32 v204, v214, v196, v188 op_sel:[0,0,0] op_sel_hi:[1,0,0]
  v_fma_mix_f32 v205, v214, v197, v189 op_sel:[1,0,0] op_sel_hi:[1,0,0]
  v_fma_mix_f32 v206, v215, v198, v190 op_sel:[0,0,0] op_sel_hi:[1,0,0]
  v_fma_mix_f32 v207, v215, v199, v191 op_sel:[1,0,0] op_sel_hi:[1,0,0]
  v_mfma_f32_32x32x16_bf16 a[112:127], a[160:163], v[44:47], a[112:127]
  s_add_u32 m0, s62, 0
  s_add_u32 s64, s61, 0
  buffer_load_dwordx4 v220, s[16:19], s64 offen offset:0  lds
  v_cvt_pk_bf16_f32 v32, v200, v201
  v_cvt_pk_bf16_f32 v33, v202, v203
  v_cvt_pk_bf16_f32 v34, v204, v205
  v_cvt_pk_bf16_f32 v35, v206, v207
  v_accvgpr_read_b32 v212, a252
  v_mfma_f32_32x32x16_bf16 a[112:127], a[164:167], v[52:55], a[112:127]
  v_accvgpr_read_b32 v213, a253
  v_accvgpr_read_b32 v214, a254
  v_accvgpr_read_b32 v215, a255
  s_add_u32 s60, s59, 61440
  buffer_load_dwordx4 a[252:255], v3, s[12:15], s60 offen offset:3072
  v_fma_mix_f32 v200, v212, v192, v184 op_sel:[0,0,0] op_sel_hi:[1,0,0]
  v_fma_mix_f32 v201, v212, v193, v185 op_sel:[1,0,0] op_sel_hi:[1,0,0]
  v_mfma_f32_32x32x16_bf16 a[112:127], a[168:171], v[60:63], a[112:127]
  s_add_u32 m0, s62, 1984
  s_nop 0
  buffer_load_dwordx4 v220, s[16:19], s64 offen offset:64  lds
  v_fma_mix_f32 v202, v213, v194, v186 op_sel:[0,0,0] op_sel_hi:[1,0,0]
  v_fma_mix_f32 v203, v213, v195, v187 op_sel:[1,0,0] op_sel_hi:[1,0,0]
  v_fma_mix_f32 v204, v214, v196, v188 op_sel:[0,0,0] op_sel_hi:[1,0,0]
  v_fma_mix_f32 v205, v214, v197, v189 op_sel:[1,0,0] op_sel_hi:[1,0,0]
  v_mfma_f32_32x32x16_bf16 a[112:127], a[172:175], v[68:71], a[112:127]
  v_fma_mix_f32 v206, v215, v198, v190 op_sel:[0,0,0] op_sel_hi:[1,0,0]
  v_fma_mix_f32 v207, v215, v199, v191 op_sel:[1,0,0] op_sel_hi:[1,0,0]
  v_cvt_pk_bf16_f32 v36, v200, v201
  v_cvt_pk_bf16_f32 v37, v202, v203
  v_cvt_pk_bf16_f32 v38, v204, v205
  v_cvt_pk_bf16_f32 v39, v206, v207
  v_mfma_f32_32x32x16_bf16 a[112:127], a[176:179], v[76:79], a[112:127]
  s_add_u32 m0, s62, 3968
  s_nop 0
  buffer_load_dwordx4 v220, s[16:19], s64 offen offset:128  lds
  v_mfma_f32_32x32x16_bf16 a[112:127], a[180:183], v[84:87], a[112:127]
  v_mfma_f32_32x32x16_bf16 a[112:127], a[184:187], v[92:95], a[112:127]
  s_add_u32 m0, s62, 5952
  s_nop 0
  buffer_load_dwordx4 v220, s[16:19], s64 offen offset:192  lds
  v_mfma_f32_32x32x16_bf16 a[112:127], a[188:191], v[100:103], a[112:127]
  s_waitcnt lgkmcnt(14)
  v_mfma_f32_32x32x16_bf16 a[0:15], a[128:131], v[104:107], a[0:15]
  ds_read_b64_tr_b16 a[160:161], v223 offset:1024
  ds_read_b64_tr_b16 a[162:163], v223 offset:1280
  s_add_u32 m0, s47, 98304
  s_add_u32 s42, s46, 3145728
  buffer_load_dwordx4 v4, s[8:11], s42 offen offset:0 lds
  s_waitcnt lgkmcnt(14)
  v_mfma_f32_32x32x16_bf16 a[0:15], a[132:135], v[112:115], a[0:15]
  ds_read_b64_tr_b16 a[164:165], v223 offset:5120
  ds_read_b64_tr_b16 a[166:167], v223 offset:5376
  ds_read_b128 v[144:147], v233 offset:3584
  ds_read_b128 v[148:151], v233 offset:3600
  ds_read_b128 v[136:139], v233 offset:1536
  ds_read_b128 v[140:143], v233 offset:1552
  ds_read_b128 v[160:163], v233 offset:3648
  s_waitcnt lgkmcnt(15)
  v_mfma_f32_32x32x16_bf16 a[0:15], a[136:139], v[120:123], a[0:15]
  ds_read_b64_tr_b16 a[168:169], v223 offset:9216
  ds_read_b64_tr_b16 a[170:171], v223 offset:9472
  s_add_u32 m0, s47, 99264
  s_nop 0
  buffer_load_dwordx4 v4, s[8:11], s42 offen offset:64 lds
  ds_read_b128 v[164:167], v233 offset:3664
  ds_read_b128 v[152:155], v233 offset:1600
  v_mfma_f32_32x32x16_bf16 a[0:15], a[140:143], v[128:131], a[0:15]
  ds_read_b64_tr_b16 a[172:173], v223 offset:13312
  ds_read_b64_tr_b16 a[174:175], v223 offset:13568
  ds_read_b128 v[156:159], v233 offset:1616
  v_accvgpr_read_b32 v212, a192
  v_accvgpr_read_b32 v213, a193
  v_accvgpr_read_b32 v214, a194
  v_accvgpr_read_b32 v215, a195
  v_mfma_f32_32x32x16_bf16 a[0:15], a[144:147], v[8:11], a[0:15]
  ds_read_b64_tr_b16 a[176:177], v223 offset:17408
  ds_read_b64_tr_b16 a[178:179], v223 offset:17664
  s_add_u32 m0, s47, 100224
  s_nop 0
  buffer_load_dwordx4 v4, s[8:11], s42 offen offset:128 lds
  s_waitcnt lgkmcnt(11)
  v_fma_mix_f32 v200, v212, v144, v136 op_sel:[0,0,0] op_sel_hi:[1,0,0]
  v_fma_mix_f32 v201, v212, v145, v137 op_sel:[1,0,0] op_sel_hi:[1,0,0]
  v_mfma_f32_32x32x16_bf16 a[0:15], a[148:151], v[16:19], a[0:15]
  ds_read_b64_tr_b16 a[180:181], v223 offset:21504
  ds_read_b64_tr_b16 a[182:183], v223 offset:21760
  ds_read_b128 v[176:179], v233 offset:3712
  ds_read_b128 v[180:183], v233 offset:3728
  v_fma_mix_f32 v202, v213, v146, v138 op_sel:[0,0,0] op_sel_hi:[1,0,0]
  v_fma_mix_f32 v203, v213, v147, v139 op_sel:[1,0,0] op_sel_hi:[1,0,0]
  s_waitcnt lgkmcnt(14)
  v_fma_mix_f32 v204, v214, v148, v140 op_sel:[0,0,0] op_sel_hi:[1,0,0]
  v_mfma_f32_32x32x16_bf16 a[0:15], a[152:155], v[24:27], a[0:15]
  ds_read_b64_tr_b16 a[184:185], v223 offset:25600
  ds_read_b64_tr_b16 a[186:187], v223 offset:25856
  s_add_u32 m0, s47, 101184
  s_nop 0
  buffer_load_dwordx4 v4, s[8:11], s42 offen offset:192 lds
  v_fma_mix_f32 v205, v214, v149, v141 op_sel:[1,0,0] op_sel_hi:[1,0,0]
  ds_read_b128 v[168:171], v233 offset:1664
  v_mfma_f32_32x32x16_bf16 a[0:15], a[156:159], v[32:35], a[0:15]
  ds_read_b64_tr_b16 a[188:189], v223 offset:29696
  ds_read_b64_tr_b16 a[190:191], v223 offset:29952
  ds_read_b128 v[172:175], v233 offset:1680
  v_fma_mix_f32 v206, v215, v150, v142 op_sel:[0,0,0] op_sel_hi:[1,0,0]
  v_fma_mix_f32 v207, v215, v151, v143 op_sel:[1,0,0] op_sel_hi:[1,0,0]
  v_cvt_pk_bf16_f32 v40, v200, v201
  v_cvt_pk_bf16_f32 v41, v202, v203
  v_mfma_f32_32x32x16_bf16 a[16:31], a[128:131], v[108:111], a[16:31]
  s_add_u32 m0, s47, 102400
  s_add_u32 s42, s46, 3276800
  buffer_load_dwordx4 v4, s[8:11], s42 offen offset:0 lds
  v_cvt_pk_bf16_f32 v42, v204, v205
  v_cvt_pk_bf16_f32 v43, v206, v207
  v_accvgpr_read_b32 v212, a196
  v_accvgpr_read_b32 v213, a197
  v_accvgpr_read_b32 v214, a198
  v_mfma_f32_32x32x16_bf16 a[16:31], a[132:135], v[116:119], a[16:31]
  v_accvgpr_read_b32 v215, a199
  v_fma_mix_f32 v200, v212, v144, v136 op_sel:[0,0,0] op_sel_hi:[1,0,0]
  v_fma_mix_f32 v201, v212, v145, v137 op_sel:[1,0,0] op_sel_hi:[1,0,0]
  v_fma_mix_f32 v202, v213, v146, v138 op_sel:[0,0,0] op_sel_hi:[1,0,0]
  v_fma_mix_f32 v203, v213, v147, v139 op_sel:[1,0,0] op_sel_hi:[1,0,0]
  v_fma_mix_f32 v204, v214, v148, v140 op_sel:[0,0,0] op_sel_hi:[1,0,0]
  v_fma_mix_f32 v205, v214, v149, v141 op_sel:[1,0,0] op_sel_hi:[1,0,0]
  v_mfma_f32_32x32x16_bf16 a[16:31], a[136:139], v[124:127], a[16:31]
  s_add_u32 m0, s47, 103360
  s_nop 0
  buffer_load_dwordx4 v4, s[8:11], s42 offen offset:64 lds
  v_fma_mix_f32 v206, v215, v150, v142 op_sel:[0,0,0] op_sel_hi:[1,0,0]
  v_fma_mix_f32 v207, v215, v151, v143 op_sel:[1,0,0] op_sel_hi:[1,0,0]
  v_cvt_pk_bf16_f32 v44, v200, v201
  v_cvt_pk_bf16_f32 v45, v202, v203
  v_mfma_f32_32x32x16_bf16 a[16:31], a[140:143], v[132:135], a[16:31]
  v_cvt_pk_bf16_f32 v46, v204, v205
  v_cvt_pk_bf16_f32 v47, v206, v207
  v_accvgpr_read_b32 v212, a200
  v_accvgpr_read_b32 v213, a201
  v_accvgpr_read_b32 v214, a202
  v_accvgpr_read_b32 v215, a203
  s_waitcnt lgkmcnt(15)
  v_fma_mix_f32 v200, v212, v160, v152 op_sel:[0,0,0] op_sel_hi:[1,0,0]
  v_mfma_f32_32x32x16_bf16 a[16:31], a[144:147], v[12:15], a[16:31]
  s_add_u32 m0, s47, 104320
  s_nop 0
  buffer_load_dwordx4 v4, s[8:11], s42 offen offset:128 lds
  v_fma_mix_f32 v201, v212, v161, v153 op_sel:[1,0,0] op_sel_hi:[1,0,0]
  ds_read_b128 v[192:195], v233 offset:3776
  ds_read_b128 v[196:199], v233 offset:3792
  v_fma_mix_f32 v202, v213, v162, v154 op_sel:[0,0,0] op_sel_hi:[1,0,0]
  v_mfma_f32_32x32x16_bf16 a[16:31], a[148:151], v[20:23], a[16:31]
  v_fma_mix_f32 v203, v213, v163, v155 op_sel:[1,0,0] op_sel_hi:[1,0,0]
  s_waitcnt lgkmcnt(14)
  v_fma_mix_f32 v204, v214, v164, v156 op_sel:[0,0,0] op_sel_hi:[1,0,0]
  v_fma_mix_f32 v205, v214, v165, v157 op_sel:[1,0,0] op_sel_hi:[1,0,0]
  ds_read_b128 v[184:187], v233 offset:1728
  ds_read_b128 v[188:191], v233 offset:1744
  v_fma_mix_f32 v206, v215, v166, v158 op_sel:[0,0,0] op_sel_hi:[1,0,0]
  v_fma_mix_f32 v207, v215, v167, v159 op_sel:[1,0,0] op_sel_hi:[1,0,0]
  v_mfma_f32_32x32x16_bf16 a[16:31], a[152:155], v[28:31], a[16:31]
  s_add_u32 m0, s47, 105280
  s_nop 0
  buffer_load_dwordx4 v4, s[8:11], s42 offen offset:192 lds
  v_cvt_pk_bf16_f32 v48, v200, v201
  v_cvt_pk_bf16_f32 v49, v202, v203
  v_cvt_pk_bf16_f32 v50, v204, v205
  v_cvt_pk_bf16_f32 v51, v206, v207
  v_mfma_f32_32x32x16_bf16 a[16:31], a[156:159], v[36:39], a[16:31]
  s_waitcnt vmcnt(24)
  v_accvgpr_read_b32 v212, a204
  v_accvgpr_read_b32 v213, a205
  v_accvgpr_read_b32 v214, a206
  v_accvgpr_read_b32 v215, a207
  v_fma_mix_f32 v200, v212, v160, v152 op_sel:[0,0,0] op_sel_hi:[1,0,0]
  v_fma_mix_f32 v201, v212, v161, v153 op_sel:[1,0,0] op_sel_hi:[1,0,0]
  v_fma_mix_f32 v202, v213, v162, v154 op_sel:[0,0,0] op_sel_hi:[1,0,0]
  v_mfma_f32_32x32x16_bf16 a[32:47], a[160:163], v[104:107], a[32:47]
  ds_read_b64_tr_b16 a[128:129], v223 offset:2048
  ds_read_b64_tr_b16 a[130:131], v223 offset:2304
  v_fma_mix_f32 v203, v213, v163, v155 op_sel:[1,0,0] op_sel_hi:[1,0,0]
  v_fma_mix_f32 v204, v214, v164, v156 op_sel:[0,0,0] op_sel_hi:[1,0,0]
  v_fma_mix_f32 v205, v214, v165, v157 op_sel:[1,0,0] op_sel_hi:[1,0,0]
  v_fma_mix_f32 v206, v215, v166, v158 op_sel:[0,0,0] op_sel_hi:[1,0,0]
  v_fma_mix_f32 v207, v215, v167, v159 op_sel:[1,0,0] op_sel_hi:[1,0,0]
  v_mfma_f32_32x32x16_bf16 a[32:47], a[164:167], v[112:115], a[32:47]
  ds_read_b64_tr_b16 a[132:133], v223 offset:6144
  ds_read_b64_tr_b16 a[134:135], v223 offset:6400
  v_cvt_pk_bf16_f32 v52, v200, v201
  v_cvt_pk_bf16_f32 v53, v202, v203
  v_cvt_pk_bf16_f32 v54, v204, v205
  v_cvt_pk_bf16_f32 v55, v206, v207
  s_waitcnt vmcnt(23)
  v_accvgpr_read_b32 v212, a208
  v_mfma_f32_32x32x16_bf16 a[32:47], a[168:171], v[120:123], a[32:47]
  ds_read_b64_tr_b16 a[136:137], v223 offset:10240
  ds_read_b64_tr_b16 a[138:139], v223 offset:10496
  v_accvgpr_read_b32 v213, a209
  v_accvgpr_read_b32 v214, a210
  v_accvgpr_read_b32 v215, a211
  s_waitcnt lgkmcnt(13)
  v_fma_mix_f32 v200, v212, v176, v168 op_sel:[0,0,0] op_sel_hi:[1,0,0]
  v_fma_mix_f32 v201, v212, v177, v169 op_sel:[1,0,0] op_sel_hi:[1,0,0]
  v_mfma_f32_32x32x16_bf16 a[32:47], a[172:175], v[128:131], a[32:47]
  ds_read_b64_tr_b16 a[140:141], v223 offset:14336
  ds_read_b64_tr_b16 a[142:143], v223 offset:14592
  ds_read_b128 v[144:147], v233 offset:3840
  ds_read_b128 v[148:151], v233 offset:3856
  v_fma_mix_f32 v202, v213, v178, v170 op_sel:[0,0,0] op_sel_hi:[1,0,0]
  v_fma_mix_f32 v203, v213, v179, v171 op_sel:[1,0,0] op_sel_hi:[1,0,0]
  s_waitcnt lgkmcnt(14)
  v_fma_mix_f32 v204, v214, v180, v172 op_sel:[0,0,0] op_sel_hi:[1,0,0]
  v_mfma_f32_32x32x16_bf16 a[32:47], a[176:179], v[8:11], a[32:47]
  ds_read_b64_tr_b16 a[144:145], v223 offset:18432
  ds_read_b64_tr_b16 a[146:147], v223 offset:18688
  v_fma_mix_f32 v205, v214, v181, v173 op_sel:[1,0,0] op_sel_hi:[1,0,0]
  ds_read_b128 v[136:139], v233 offset:1792
  ds_read_b128 v[140:143], v233 offset:1808
  v_fma_mix_f32 v206, v215, v182, v174 op_sel:[0,0,0] op_sel_hi:[1,0,0]
  v_fma_mix_f32 v207, v215, v183, v175 op_sel:[1,0,0] op_sel_hi:[1,0,0]
  v_mfma_f32_32x32x16_bf16 a[32:47], a[180:183], v[16:19], a[32:47]
  ds_read_b64_tr_b16 a[148:149], v223 offset:22528
  ds_read_b64_tr_b16 a[150:151], v223 offset:22784
  v_cvt_pk_bf16_f32 v56, v200, v201
  v_cvt_pk_bf16_f32 v57, v202, v203
  v_cvt_pk_bf16_f32 v58, v204, v205
  v_cvt_pk_bf16_f32 v59, v206, v207
  s_waitcnt vmcnt(22)
  v_accvgpr_read_b32 v212, a212
  v_mfma_f32_32x32x16_bf16 a[32:47], a[184:187], v[24:27], a[32:47]
  ds_read_b64_tr_b16 a[152:153], v223 offset:26624
  ds_read_b64_tr_b16 a[154:155], v223 offset:26880
  v_accvgpr_read_b32 v213, a213
  v_accvgpr_read_b32 v214, a214
  v_accvgpr_read_b32 v215, a215
  v_fma_mix_f32 v200, v212, v176, v168 op_sel:[0,0,0] op_sel_hi:[1,0,0]
  v_fma_mix_f32 v201, v212, v177, v169 op_sel:[1,0,0] op_sel_hi:[1,0,0]
  v_mfma_f32_32x32x16_bf16 a[32:47], a[188:191], v[32:35], a[32:47]
  ds_read_b64_tr_b16 a[156:157], v223 offset:30720
  ds_read_b64_tr_b16 a[158:159], v223 offset:30976
  v_fma_mix_f32 v202, v213, v178, v170 op_sel:[0,0,0] op_sel_hi:[1,0,0]
  v_fma_mix_f32 v203, v213, v179, v171 op_sel:[1,0,0] op_sel_hi:[1,0,0]
  v_fma_mix_f32 v204, v214, v180, v172 op_sel:[0,0,0] op_sel_hi:[1,0,0]
  v_fma_mix_f32 v205, v214, v181, v173 op_sel:[1,0,0] op_sel_hi:[1,0,0]
  v_fma_mix_f32 v206, v215, v182, v174 op_sel:[0,0,0] op_sel_hi:[1,0,0]
  v_mfma_f32_32x32x16_bf16 a[48:63], a[160:163], v[108:111], a[48:63]
  v_fma_mix_f32 v207, v215, v183, v175 op_sel:[1,0,0] op_sel_hi:[1,0,0]
  v_cvt_pk_bf16_f32 v60, v200, v201
  v_cvt_pk_bf16_f32 v61, v202, v203
  v_cvt_pk_bf16_f32 v62, v204, v205
  v_cvt_pk_bf16_f32 v63, v206, v207
  s_waitcnt vmcnt(21)
  v_accvgpr_read_b32 v212, a216
  v_accvgpr_read_b32 v213, a217
  v_mfma_f32_32x32x16_bf16 a[48:63], a[164:167], v[116:119], a[48:63]
  v_accvgpr_read_b32 v214, a218
  v_accvgpr_read_b32 v215, a219
  s_waitcnt lgkmcnt(15)
  v_fma_mix_f32 v200, v212, v192, v184 op_sel:[0,0,0] op_sel_hi:[1,0,0]
  v_fma_mix_f32 v201, v212, v193, v185 op_sel:[1,0,0] op_sel_hi:[1,0,0]
  ds_read_b128 v[160:163], v233 offset:3904
  ds_read_b128 v[164:167], v233 offset:3920
  v_fma_mix_f32 v202, v213, v194, v186 op_sel:[0,0,0] op_sel_hi:[1,0,0]
  v_mfma_f32_32x32x16_bf16 a[48:63], a[168:171], v[124:127], a[48:63]
  v_fma_mix_f32 v203, v213, v195, v187 op_sel:[1,0,0] op_sel_hi:[1,0,0]
  v_fma_mix_f32 v204, v214, v196, v188 op_sel:[0,0,0] op_sel_hi:[1,0,0]
  v_fma_mix_f32 v205, v214, v197, v189 op_sel:[1,0,0] op_sel_hi:[1,0,0]
  ds_read_b128 v[152:155], v233 offset:1856
  ds_read_b128 v[156:159], v233 offset:1872
  v_fma_mix_f32 v206, v215, v198, v190 op_sel:[0,0,0] op_sel_hi:[1,0,0]
  v_fma_mix_f32 v207, v215, v199, v191 op_sel:[1,0,0] op_sel_hi:[1,0,0]
  v_mfma_f32_32x32x16_bf16 a[48:63], a[172:175], v[132:135], a[48:63]
  v_cvt_pk_bf16_f32 v64, v200, v201
  v_cvt_pk_bf16_f32 v65, v202, v203
  v_cvt_pk_bf16_f32 v66, v204, v205
  v_cvt_pk_bf16_f32 v67, v206, v207
  s_waitcnt vmcnt(20)
  v_accvgpr_read_b32 v212, a220
  v_accvgpr_read_b32 v213, a221
  v_accvgpr_read_b32 v214, a222
  v_mfma_f32_32x32x16_bf16 a[48:63], a[176:179], v[12:15], a[48:63]
  v_accvgpr_read_b32 v215, a223
  v_fma_mix_f32 v200, v212, v192, v184 op_sel:[0,0,0] op_sel_hi:[1,0,0]
  v_fma_mix_f32 v201, v212, v193, v185 op_sel:[1,0,0] op_sel_hi:[1,0,0]
  v_fma_mix_f32 v202, v213, v194, v186 op_sel:[0,0,0] op_sel_hi:[1,0,0]
  v_fma_mix_f32 v203, v213, v195, v187 op_sel:[1,0,0] op_sel_hi:[1,0,0]
  v_fma_mix_f32 v204, v214, v196, v188 op_sel:[0,0,0] op_sel_hi:[1,0,0]
  v_fma_mix_f32 v205, v214, v197, v189 op_sel:[1,0,0] op_sel_hi:[1,0,0]
  v_mfma_f32_32x32x16_bf16 a[48:63], a[180:183], v[20:23], a[48:63]
  v_fma_mix_f32 v206, v215, v198, v190 op_sel:[0,0,0] op_sel_hi:[1,0,0]
  v_fma_mix_f32 v207, v215, v199, v191 op_sel:[1,0,0] op_sel_hi:[1,0,0]
  v_cvt_pk_bf16_f32 v68, v200, v201
  v_cvt_pk_bf16_f32 v69, v202, v203
  v_cvt_pk_bf16_f32 v70, v204, v205
  v_cvt_pk_bf16_f32 v71, v206, v207
  s_waitcnt vmcnt(19)
  v_accvgpr_read_b32 v212, a224
  v_mfma_f32_32x32x16_bf16 a[48:63], a[184:187], v[28:31], a[48:63]
  v_accvgpr_read_b32 v213, a225
  v_accvgpr_read_b32 v214, a226
  v_accvgpr_read_b32 v215, a227
  s_waitcnt lgkmcnt(11)
  v_fma_mix_f32 v200, v212, v144, v136 op_sel:[0,0,0] op_sel_hi:[1,0,0]
  v_fma_mix_f32 v201, v212, v145, v137 op_sel:[1,0,0] op_sel_hi:[1,0,0]
  ds_read_b128 v[176:179], v233 offset:3968
  ds_read_b128 v[180:183], v233 offset:3984
  v_mfma_f32_32x32x16_bf16 a[48:63], a[188:191], v[36:39], a[48:63]
  v_fma_mix_f32 v202, v213, v146, v138 op_sel:[0,0,0] op_sel_hi:[1,0,0]
  v_fma_mix_f32 v203, v213, v147, v139 op_sel:[1,0,0] op_sel_hi:[1,0,0]
  s_waitcnt lgkmcnt(12)
  v_fma_mix_f32 v204, v214, v148, v140 op_sel:[0,0,0] op_sel_hi:[1,0,0]
  v_fma_mix_f32 v205, v214, v149, v141 op_sel:[1,0,0] op_sel_hi:[1,0,0]
  ds_read_b128 v[168:171], v233 offset:1920
  ds_read_b128 v[172:175], v233 offset:1936
  v_fma_mix_f32 v206, v215, v150, v142 op_sel:[0,0,0] op_sel_hi:[1,0,0]
  v_mfma_f32_32x32x16_bf16 a[64:79], a[128:131], v[104:107], a[64:79]
  ds_read_b64_tr_b16 a[160:161], v223 offset:3072
  ds_read_b64_tr_b16 a[162:163], v223 offset:3328
  v_fma_mix_f32 v207, v215, v151, v143 op_sel:[1,0,0] op_sel_hi:[1,0,0]
  v_cvt_pk_bf16_f32 v72, v200, v201
  v_cvt_pk_bf16_f32 v73, v202, v203
  v_cvt_pk_bf16_f32 v74, v204, v205
  v_cvt_pk_bf16_f32 v75, v206, v207
  v_mfma_f32_32x32x16_bf16 a[64:79], a[132:135], v[112:115], a[64:79]
  ds_read_b64_tr_b16 a[164:165], v223 offset:7168
  ds_read_b64_tr_b16 a[166:167], v223 offset:7424
  s_waitcnt vmcnt(18)
  v_accvgpr_read_b32 v212, a228
  v_accvgpr_read_b32 v213, a229
  v_accvgpr_read_b32 v214, a230
  v_accvgpr_read_b32 v215, a231
  v_fma_mix_f32 v200, v212, v144, v136 op_sel:[0,0,0] op_sel_hi:[1,0,0]
  v_mfma_f32_32x32x16_bf16 a[64:79], a[136:139], v[120:123], a[64:79]
  ds_read_b64_tr_b16 a[168:169], v223 offset:11264
  ds_read_b64_tr_b16 a[170:171], v223 offset:11520
  v_fma_mix_f32 v201, v212, v145, v137 op_sel:[1,0,0] op_sel_hi:[1,0,0]
  v_fma_mix_f32 v202, v213, v146, v138 op_sel:[0,0,0] op_sel_hi:[1,0,0]
  v_fma_mix_f32 v203, v213, v147, v139 op_sel:[1,0,0] op_sel_hi:[1,0,0]
  v_fma_mix_f32 v204, v214, v148, v140 op_sel:[0,0,0] op_sel_hi:[1,0,0]
  v_fma_mix_f32 v205, v214, v149, v141 op_sel:[1,0,0] op_sel_hi:[1,0,0]
  v_mfma_f32_32x32x16_bf16 a[64:79], a[140:143], v[128:131], a[64:79]
  ds_read_b64_tr_b16 a[172:173], v223 offset:15360
  ds_read_b64_tr_b16 a[174:175], v223 offset:15616
  v_fma_mix_f32 v206, v215, v150, v142 op_sel:[0,0,0] op_sel_hi:[1,0,0]
  v_fma_mix_f32 v207, v215, v151, v143 op_sel:[1,0,0] op_sel_hi:[1,0,0]
  v_cvt_pk_bf16_f32 v76, v200, v201
  v_cvt_pk_bf16_f32 v77, v202, v203
  v_cvt_pk_bf16_f32 v78, v204, v205
  v_mfma_f32_32x32x16_bf16 a[64:79], a[144:147], v[8:11], a[64:79]
  ds_read_b64_tr_b16 a[176:177], v223 offset:19456
  ds_read_b64_tr_b16 a[178:179], v223 offset:19712
  v_cvt_pk_bf16_f32 v79, v206, v207
  s_waitcnt vmcnt(17)
  v_accvgpr_read_b32 v212, a232
  v_accvgpr_read_b32 v213, a233
  v_accvgpr_read_b32 v214, a234
  v_accvgpr_read_b32 v215, a235
  s_waitcnt lgkmcnt(15)
  v_mfma_f32_32x32x16_bf16 a[64:79], a[148:151], v[16:19], a[64:79]
  ds_read_b64_tr_b16 a[180:181], v223 offset:23552
  ds_read_b64_tr_b16 a[182:183], v223 offset:23808
  v_fma_mix_f32 v200, v212, v160, v152 op_sel:[0,0,0] op_sel_hi:[1,0,0]
  v_fma_mix_f32 v201, v212, v161, v153 op_sel:[1,0,0] op_sel_hi:[1,0,0]
  ds_read_b128 v[192:195], v233 offset:4032
  ds_read_b128 v[196:199], v233 offset:4048
  v_fma_mix_f32 v202, v213, v162, v154 op_sel:[0,0,0] op_sel_hi:[1,0,0]
  v_mfma_f32_32x32x16_bf16 a[64:79], a[152:155], v[24:27], a[64:79]
  ds_read_b64_tr_b16 a[184:185], v223 offset:27648
  ds_read_b64_tr_b16 a[186:187], v223 offset:27904
  v_fma_mix_f32 v203, v213, v163, v155 op_sel:[1,0,0] op_sel_hi:[1,0,0]
  s_waitcnt lgkmcnt(15)
  v_fma_mix_f32 v204, v214, v164, v156 op_sel:[0,0,0] op_sel_hi:[1,0,0]
  v_fma_mix_f32 v205, v214, v165, v157 op_sel:[1,0,0] op_sel_hi:[1,0,0]
  ds_read_b128 v[184:187], v233 offset:1984
  ds_read_b128 v[188:191], v233 offset:2000
  v_mfma_f32_32x32x16_bf16 a[64:79], a[156:159], v[32:35], a[64:79]
  ds_read_b64_tr_b16 a[188:189], v223 offset:31744
  ds_read_b64_tr_b16 a[190:191], v223 offset:32000
  v_fma_mix_f32 v206, v215, v166, v158 op_sel:[0,0,0] op_sel_hi:[1,0,0]
  v_fma_mix_f32 v207, v215, v167, v159 op_sel:[1,0,0] op_sel_hi:[1,0,0]
  v_cvt_pk_bf16_f32 v80, v200, v201
  v_cvt_pk_bf16_f32 v81, v202, v203
  v_cvt_pk_bf16_f32 v82, v204, v205
  v_mfma_f32_32x32x16_bf16 a[80:95], a[128:131], v[108:111], a[80:95]
  v_cvt_pk_bf16_f32 v83, v206, v207
  s_waitcnt vmcnt(16)
  v_accvgpr_read_b32 v212, a236
  v_accvgpr_read_b32 v213, a237
  v_accvgpr_read_b32 v214, a238
  v_accvgpr_read_b32 v215, a239
  v_fma_mix_f32 v200, v212, v160, v152 op_sel:[0,0,0] op_sel_hi:[1,0,0]
  v_fma_mix_f32 v201, v212, v161, v153 op_sel:[1,0,0] op_sel_hi:[1,0,0]
  v_mfma_f32_32x32x16_bf16 a[80:95], a[132:135], v[116:119], a[80:95]
  v_fma_mix_f32 v202, v213, v162, v154 op_sel:[0,0,0] op_sel_hi:[1,0,0]
  v_fma_mix_f32 v203, v213, v163, v155 op_sel:[1,0,0] op_sel_hi:[1,0,0]
  v_fma_mix_f32 v204, v214, v164, v156 op_sel:[0,0,0] op_sel_hi:[1,0,0]
  v_fma_mix_f32 v205, v214, v165, v157 op_sel:[1,0,0] op_sel_hi:[1,0,0]
  v_fma_mix_f32 v206, v215, v166, v158 op_sel:[0,0,0] op_sel_hi:[1,0,0]
  v_fma_mix_f32 v207, v215, v167, v159 op_sel:[1,0,0] op_sel_hi:[1,0,0]
  v_cvt_pk_bf16_f32 v84, v200, v201
  v_mfma_f32_32x32x16_bf16 a[80:95], a[136:139], v[124:127], a[80:95]
  v_cvt_pk_bf16_f32 v85, v202, v203
  v_cvt_pk_bf16_f32 v86, v204, v205
  v_cvt_pk_bf16_f32 v87, v206, v207
  s_waitcnt vmcnt(15)
  v_accvgpr_read_b32 v212, a240
  v_accvgpr_read_b32 v213, a241
  v_accvgpr_read_b32 v214, a242
  v_accvgpr_read_b32 v215, a243
  v_mfma_f32_32x32x16_bf16 a[80:95], a[140:143], v[132:135], a[80:95]
  v_fma_mix_f32 v200, v212, v176, v168 op_sel:[0,0,0] op_sel_hi:[1,0,0]
  v_fma_mix_f32 v201, v212, v177, v169 op_sel:[1,0,0] op_sel_hi:[1,0,0]
  v_fma_mix_f32 v202, v213, v178, v170 op_sel:[0,0,0] op_sel_hi:[1,0,0]
  v_fma_mix_f32 v203, v213, v179, v171 op_sel:[1,0,0] op_sel_hi:[1,0,0]
  v_fma_mix_f32 v204, v214, v180, v172 op_sel:[0,0,0] op_sel_hi:[1,0,0]
  v_fma_mix_f32 v205, v214, v181, v173 op_sel:[1,0,0] op_sel_hi:[1,0,0]
  v_fma_mix_f32 v206, v215, v182, v174 op_sel:[0,0,0] op_sel_hi:[1,0,0]
  v_mfma_f32_32x32x16_bf16 a[80:95], a[144:147], v[12:15], a[80:95]
  v_fma_mix_f32 v207, v215, v183, v175 op_sel:[1,0,0] op_sel_hi:[1,0,0]
  v_cvt_pk_bf16_f32 v88, v200, v201
  v_cvt_pk_bf16_f32 v89, v202, v203
  v_cvt_pk_bf16_f32 v90, v204, v205
  v_cvt_pk_bf16_f32 v91, v206, v207
  s_waitcnt vmcnt(14)
  v_accvgpr_read_b32 v212, a244
  v_accvgpr_read_b32 v213, a245
  v_mfma_f32_32x32x16_bf16 a[80:95], a[148:151], v[20:23], a[80:95]
  v_accvgpr_read_b32 v214, a246
  v_accvgpr_read_b32 v215, a247
  v_fma_mix_f32 v200, v212, v176, v168 op_sel:[0,0,0] op_sel_hi:[1,0,0]
  v_fma_mix_f32 v201, v212, v177, v169 op_sel:[1,0,0] op_sel_hi:[1,0,0]
  v_fma_mix_f32 v202, v213, v178, v170 op_sel:[0,0,0] op_sel_hi:[1,0,0]
  v_fma_mix_f32 v203, v213, v179, v171 op_sel:[1,0,0] op_sel_hi:[1,0,0]
  v_fma_mix_f32 v204, v214, v180, v172 op_sel:[0,0,0] op_sel_hi:[1,0,0]
  v_mfma_f32_32x32x16_bf16 a[80:95], a[152:155], v[28:31], a[80:95]
  v_fma_mix_f32 v205, v214, v181, v173 op_sel:[1,0,0] op_sel_hi:[1,0,0]
  v_fma_mix_f32 v206, v215, v182, v174 op_sel:[0,0,0] op_sel_hi:[1,0,0]
  v_fma_mix_f32 v207, v215, v183, v175 op_sel:[1,0,0] op_sel_hi:[1,0,0]
  v_cvt_pk_bf16_f32 v92, v200, v201
  v_cvt_pk_bf16_f32 v93, v202, v203
  v_cvt_pk_bf16_f32 v94, v204, v205
  v_cvt_pk_bf16_f32 v95, v206, v207
  v_mfma_f32_32x32x16_bf16 a[80:95], a[156:159], v[36:39], a[80:95]
  s_waitcnt vmcnt(13)
  v_accvgpr_read_b32 v212, a248
  v_accvgpr_read_b32 v213, a249
  v_accvgpr_read_b32 v214, a250
  v_accvgpr_read_b32 v215, a251
  s_waitcnt lgkmcnt(3)
  v_fma_mix_f32 v200, v212, v192, v184 op_sel:[0,0,0] op_sel_hi:[1,0,0]
  v_fma_mix_f32 v201, v212, v193, v185 op_sel:[1,0,0] op_sel_hi:[1,0,0]
  v_fma_mix_f32 v202, v213, v194, v186 op_sel:[0,0,0] op_sel_hi:[1,0,0]
  s_waitcnt vmcnt(0)
  s_barrier
  v_mfma_f32_32x32x16_bf16 a[96:111], a[160:163], v[104:107], a[96:111]
  ds_read_b64_tr_b16 a[128:129], v223 offset:32768
  ds_read_b64_tr_b16 a[130:131], v223 offset:33024
  v_fma_mix_f32 v203, v213, v195, v187 op_sel:[1,0,0] op_sel_hi:[1,0,0]
  s_waitcnt lgkmcnt(4)
  v_fma_mix_f32 v204, v214, v196, v188 op_sel:[0,0,0] op_sel_hi:[1,0,0]
  v_fma_mix_f32 v205, v214, v197, v189 op_sel:[1,0,0] op_sel_hi:[1,0,0]
  v_fma_mix_f32 v206, v215, v198, v190 op_sel:[0,0,0] op_sel_hi:[1,0,0]
  v_mfma_f32_32x32x16_bf16 a[96:111], a[164:167], v[112:115], a[96:111]
  ds_read_b64_tr_b16 a[132:133], v223 offset:36864
  ds_read_b64_tr_b16 a[134:135], v223 offset:37120
  v_fma_mix_f32 v207, v215, v199, v191 op_sel:[1,0,0] op_sel_hi:[1,0,0]
  v_cvt_pk_bf16_f32 v96, v200, v201
  v_cvt_pk_bf16_f32 v97, v202, v203
  v_cvt_pk_bf16_f32 v98, v204, v205
  v_cvt_pk_bf16_f32 v99, v206, v207
  v_mfma_f32_32x32x16_bf16 a[96:111], a[168:171], v[120:123], a[96:111]
  ds_read_b64_tr_b16 a[136:137], v223 offset:40960
  ds_read_b64_tr_b16 a[138:139], v223 offset:41216
  v_accvgpr_read_b32 v212, a252
  v_accvgpr_read_b32 v213, a253
  v_accvgpr_read_b32 v214, a254
  v_accvgpr_read_b32 v215, a255
  v_fma_mix_f32 v200, v212, v192, v184 op_sel:[0,0,0] op_sel_hi:[1,0,0]
  v_mfma_f32_32x32x16_bf16 a[96:111], a[172:175], v[128:131], a[96:111]
  ds_read_b64_tr_b16 a[140:141], v223 offset:45056
  ds_read_b64_tr_b16 a[142:143], v223 offset:45312
  v_fma_mix_f32 v201, v212, v193, v185 op_sel:[1,0,0] op_sel_hi:[1,0,0]
  v_fma_mix_f32 v202, v213, v194, v186 op_sel:[0,0,0] op_sel_hi:[1,0,0]
  v_fma_mix_f32 v203, v213, v195, v187 op_sel:[1,0,0] op_sel_hi:[1,0,0]
  v_fma_mix_f32 v204, v214, v196, v188 op_sel:[0,0,0] op_sel_hi:[1,0,0]
  v_fma_mix_f32 v205, v214, v197, v189 op_sel:[1,0,0] op_sel_hi:[1,0,0]
  v_mfma_f32_32x32x16_bf16 a[96:111], a[176:179], v[8:11], a[96:111]
  ds_read_b64_tr_b16 a[144:145], v223 offset:49152
  ds_read_b64_tr_b16 a[146:147], v223 offset:49408
  v_fma_mix_f32 v206, v215, v198, v190 op_sel:[0,0,0] op_sel_hi:[1,0,0]
  v_fma_mix_f32 v207, v215, v199, v191 op_sel:[1,0,0] op_sel_hi:[1,0,0]
  v_cvt_pk_bf16_f32 v100, v200, v201
  v_cvt_pk_bf16_f32 v101, v202, v203
  v_cvt_pk_bf16_f32 v102, v204, v205
  v_mfma_f32_32x32x16_bf16 a[96:111], a[180:183], v[16:19], a[96:111]
  ds_read_b64_tr_b16 a[148:149], v223 offset:53248
  ds_read_b64_tr_b16 a[150:151], v223 offset:53504
  v_cvt_pk_bf16_f32 v103, v206, v207
  v_mfma_f32_32x32x16_bf16 a[96:111], a[184:187], v[24:27], a[96:111]
  ds_read_b64_tr_b16 a[152:153], v223 offset:57344
  ds_read_b64_tr_b16 a[154:155], v223 offset:57600
  s_waitcnt lgkmcnt(14)
  v_mfma_f32_32x32x16_bf16 a[96:111], a[188:191], v[32:35], a[96:111]
  ds_read_b64_tr_b16 a[156:157], v223 offset:61440
  ds_read_b64_tr_b16 a[158:159], v223 offset:61696
  v_mfma_f32_32x32x16_bf16 a[112:127], a[160:163], v[108:111], a[112:127]
  s_add_u32 m0, s62, 32768
  s_add_u32 s64, s61, 16384
  buffer_load_dwordx4 v220, s[16:19], s64 offen offset:0  lds
  v_mfma_f32_32x32x16_bf16 a[112:127], a[164:167], v[116:119], a[112:127]
  v_mfma_f32_32x32x16_bf16 a[112:127], a[168:171], v[124:127], a[112:127]
  v_mfma_f32_32x32x16_bf16 a[112:127], a[172:175], v[132:135], a[112:127]
  s_add_u32 m0, s62, 34752
  s_nop 0
  buffer_load_dwordx4 v220, s[16:19], s64 offen offset:64  lds
  v_mfma_f32_32x32x16_bf16 a[112:127], a[176:179], v[12:15], a[112:127]
  v_mfma_f32_32x32x16_bf16 a[112:127], a[180:183], v[20:23], a[112:127]
  v_mfma_f32_32x32x16_bf16 a[112:127], a[184:187], v[28:31], a[112:127]
  s_add_u32 m0, s62, 36736
  s_nop 0
  buffer_load_dwordx4 v220, s[16:19], s64 offen offset:128  lds
  v_mfma_f32_32x32x16_bf16 a[112:127], a[188:191], v[36:39], a[112:127]
  s_waitcnt lgkmcnt(14)
  v_mfma_f32_32x32x16_bf16 a[0:15], a[128:131], v[40:43], a[0:15]
  ds_read_b64_tr_b16 a[160:161], v223 offset:33792
  ds_read_b64_tr_b16 a[162:163], v223 offset:34048
  v_mov_b32 v104, 0
  v_mov_b32 v105, 0
  v_mov_b32 v210, 0
  s_waitcnt lgkmcnt(14)
  v_mfma_f32_32x32x16_bf16 a[0:15], a[132:135], v[48:51], a[0:15]
  ds_read_b64_tr_b16 a[164:165], v223 offset:37888
  ds_read_b64_tr_b16 a[166:167], v223 offset:38144
  s_add_u32 m0, s62, 38720
  s_nop 0
  buffer_load_dwordx4 v220, s[16:19], s64 offen offset:192  lds
  v_mov_b32 v106, 0
  v_mov_b32 v107, 0
  v_mov_b32 v211, 0
  s_waitcnt lgkmcnt(14)
  v_mfma_f32_32x32x16_bf16 a[0:15], a[136:139], v[56:59], a[0:15]
  ds_read_b64_tr_b16 a[168:169], v223 offset:41984
  ds_read_b64_tr_b16 a[170:171], v223 offset:42240
  v_mov_b32 v108, 0
  v_mov_b32 v109, 0
  s_waitcnt lgkmcnt(14)
  v_mfma_f32_32x32x16_bf16 a[0:15], a[140:143], v[64:67], a[0:15]
  ds_read_b64_tr_b16 a[172:173], v223 offset:46080
  ds_read_b64_tr_b16 a[174:175], v223 offset:46336
  v_mov_b32 v110, 0
  v_mov_b32 v111, 0
  s_waitcnt lgkmcnt(14)
  v_mfma_f32_32x32x16_bf16 a[0:15], a[144:147], v[72:75], a[0:15]
  ds_read_b64_tr_b16 a[176:177], v223 offset:50176
  ds_read_b64_tr_b16 a[178:179], v223 offset:50432
  s_add_u32 m0, s63, 0
  s_add_u32 s65, s61, 0
  buffer_load_dwordx4 v221, s[20:23], s65 offen offset:0  lds
  v_mov_b32 v112, 0
  v_mov_b32 v113, 0
  s_waitcnt lgkmcnt(14)
  v_mfma_f32_32x32x16_bf16 a[0:15], a[148:151], v[80:83], a[0:15]
  ds_read_b64_tr_b16 a[180:181], v223 offset:54272
  ds_read_b64_tr_b16 a[182:183], v223 offset:54528
  v_mov_b32 v114, 0
  v_mov_b32 v115, 0
  s_waitcnt lgkmcnt(14)
  v_mfma_f32_32x32x16_bf16 a[0:15], a[152:155], v[88:91], a[0:15]
  ds_read_b64_tr_b16 a[184:185], v223 offset:58368
  ds_read_b64_tr_b16 a[186:187], v223 offset:58624
  v_mov_b32 v116, 0
  v_mov_b32 v117, 0
  s_waitcnt lgkmcnt(14)
  v_mfma_f32_32x32x16_bf16 a[0:15], a[156:159], v[96:99], a[0:15]
  ds_read_b64_tr_b16 a[188:189], v223 offset:62464
  ds_read_b64_tr_b16 a[190:191], v223 offset:62720
  s_add_u32 m0, s63, 960
  s_nop 0
  buffer_load_dwordx4 v221, s[20:23], s65 offen offset:64  lds
  v_mov_b32 v118, 0
  v_mov_b32 v119, 0
  v_mfma_f32_32x32x16_bf16 a[16:31], a[128:131], v[44:47], a[16:31]
  v_mov_b32 v120, 0
  v_mov_b32 v121, 0
  v_mfma_f32_32x32x16_bf16 a[16:31], a[132:135], v[52:55], a[16:31]
  v_mov_b32 v122, 0
  v_mov_b32 v123, 0
  v_mfma_f32_32x32x16_bf16 a[16:31], a[136:139], v[60:63], a[16:31]
  s_add_u32 m0, s63, 1920
  s_nop 0
  buffer_load_dwordx4 v221, s[20:23], s65 offen offset:128  lds
  v_mov_b32 v124, 0
  v_mov_b32 v125, 0
  v_accvgpr_read_b32 v200, a0
  v_accvgpr_read_b32 v201, a1
  v_mfma_f32_32x32x16_bf16 a[16:31], a[140:143], v[68:71], a[16:31]
  v_mov_b32 v126, 0
  v_mov_b32 v127, 0
  v_accvgpr_read_b32 v202, a2
  v_accvgpr_read_b32 v203, a3
  v_accvgpr_read_b32 v204, a4
  v_accvgpr_read_b32 v205, a5
  v_accvgpr_read_b32 v206, a6
  v_mfma_f32_32x32x16_bf16 a[16:31], a[144:147], v[76:79], a[16:31]
  v_mov_b32 v128, 0
  v_mov_b32 v129, 0
  v_accvgpr_read_b32 v207, a7
  v_cvt_pk_bf16_f32 v136, v200, v201
  v_cvt_pk_bf16_f32 v137, v202, v203
  v_cvt_pk_bf16_f32 v138, v204, v205
  v_cvt_pk_bf16_f32 v139, v206, v207
  v_mfma_f32_32x32x16_bf16 a[16:31], a[148:151], v[84:87], a[16:31]
  s_add_u32 m0, s63, 2880
  s_nop 0
  buffer_load_dwordx4 v221, s[20:23], s65 offen offset:192  lds
  v_mov_b32 v130, 0
  v_mov_b32 v131, 0
  v_accvgpr_read_b32 v200, a8
  v_accvgpr_read_b32 v201, a9
  v_mfma_f32_32x32x16_bf16 a[16:31], a[152:155], v[92:95], a[16:31]
  v_mov_b32 v132, 0
  v_mov_b32 v133, 0
  v_accvgpr_read_b32 v202, a10
  v_accvgpr_read_b32 v203, a11
  v_accvgpr_read_b32 v204, a12
  v_accvgpr_read_b32 v205, a13
  v_accvgpr_read_b32 v206, a14
  v_mfma_f32_32x32x16_bf16 a[16:31], a[156:159], v[100:103], a[16:31]
  v_mov_b32 v134, 0
  v_mov_b32 v135, 0
  v_accvgpr_read_b32 v207, a15
  v_cvt_pk_bf16_f32 v140, v200, v201
  v_cvt_pk_bf16_f32 v141, v202, v203
  v_cvt_pk_bf16_f32 v142, v204, v205
  v_cvt_pk_bf16_f32 v143, v206, v207
  s_waitcnt lgkmcnt(14)
  v_mfma_f32_32x32x16_bf16 a[32:47], a[160:163], v[40:43], a[32:47]
  ds_read_b64_tr_b16 a[128:129], v223 offset:34816
  ds_read_b64_tr_b16 a[130:131], v223 offset:35072
  s_waitcnt lgkmcnt(14)
  v_mfma_f32_32x32x16_bf16 a[32:47], a[164:167], v[48:51], a[32:47]
  ds_read_b64_tr_b16 a[132:133], v223 offset:38912
  ds_read_b64_tr_b16 a[134:135], v223 offset:39168
  s_waitcnt lgkmcnt(14)
  v_mfma_f32_32x32x16_bf16 a[32:47], a[168:171], v[56:59], a[32:47]
  ds_read_b64_tr_b16 a[136:137], v223 offset:43008
  ds_read_b64_tr_b16 a[138:139], v223 offset:43264
  v_accvgpr_read_b32 v200, a16
  v_accvgpr_read_b32 v201, a17
  v_accvgpr_read_b32 v202, a18
  v_accvgpr_read_b32 v203, a19
  v_accvgpr_read_b32 v204, a20
  s_waitcnt lgkmcnt(14)
  v_mfma_f32_32x32x16_bf16 a[32:47], a[172:175], v[64:67], a[32:47]
  ds_read_b64_tr_b16 a[140:141], v223 offset:47104
  ds_read_b64_tr_b16 a[142:143], v223 offset:47360
  v_accvgpr_read_b32 v205, a21
  v_accvgpr_read_b32 v206, a22
  v_accvgpr_read_b32 v207, a23
  v_cvt_pk_bf16_f32 v168, v200, v201
  v_cvt_pk_bf16_f32 v169, v202, v203
  s_waitcnt lgkmcnt(14)
  v_mfma_f32_32x32x16_bf16 a[32:47], a[176:179], v[72:75], a[32:47]
  ds_read_b64_tr_b16 a[144:145], v223 offset:51200
  ds_read_b64_tr_b16 a[146:147], v223 offset:51456
  v_cvt_pk_bf16_f32 v170, v204, v205
  v_cvt_pk_bf16_f32 v171, v206, v207
  v_accvgpr_read_b32 v200, a24
  v_accvgpr_read_b32 v201, a25
  v_accvgpr_read_b32 v202, a26
  s_waitcnt lgkmcnt(14)
  v_mfma_f32_32x32x16_bf16 a[32:47], a[180:183], v[80:83], a[32:47]
  ds_read_b64_tr_b16 a[148:149], v223 offset:55296
  ds_read_b64_tr_b16 a[150:151], v223 offset:55552
  v_accvgpr_read_b32 v203, a27
  v_accvgpr_read_b32 v204, a28
  v_accvgpr_read_b32 v205, a29
  v_accvgpr_read_b32 v206, a30
  v_accvgpr_read_b32 v207, a31
  s_waitcnt lgkmcnt(14)
  v_mfma_f32_32x32x16_bf16 a[32:47], a[184:187], v[88:91], a[32:47]
  ds_read_b64_tr_b16 a[152:153], v223 offset:59392
  ds_read_b64_tr_b16 a[154:155], v223 offset:59648
  v_cvt_pk_bf16_f32 v172, v200, v201
  v_cvt_pk_bf16_f32 v173, v202, v203
  v_cvt_pk_bf16_f32 v174, v204, v205
  v_cvt_pk_bf16_f32 v175, v206, v207
  s_waitcnt lgkmcnt(14)
  v_mfma_f32_32x32x16_bf16 a[32:47], a[188:191], v[96:99], a[32:47]
  ds_read_b64_tr_b16 a[156:157], v223 offset:63488
  ds_read_b64_tr_b16 a[158:159], v223 offset:63744
  v_mfma_f32_32x32x16_bf16 a[48:63], a[160:163], v[44:47], a[48:63]
  v_mfma_f32_32x32x16_bf16 a[48:63], a[164:167], v[52:55], a[48:63]
  v_mfma_f32_32x32x16_bf16 a[48:63], a[168:171], v[60:63], a[48:63]
  s_nop 6
  v_accvgpr_read_b32 v200, a32
  v_accvgpr_read_b32 v201, a33
  v_accvgpr_read_b32 v202, a34
  v_accvgpr_read_b32 v203, a35
  v_accvgpr_read_b32 v204, a36
  v_accvgpr_read_b32 v205, a37
  v_accvgpr_read_b32 v206, a38
  v_mfma_f32_32x32x16_bf16 a[48:63], a[172:175], v[68:71], a[48:63]
  v_accvgpr_read_b32 v207, a39
  v_cvt_pk_bf16_f32 v144, v200, v201
  v_cvt_pk_bf16_f32 v145, v202, v203
  v_cvt_pk_bf16_f32 v146, v204, v205
  v_cvt_pk_bf16_f32 v147, v206, v207
  v_accvgpr_read_b32 v200, a40
  v_accvgpr_read_b32 v201, a41
  v_mfma_f32_32x32x16_bf16 a[48:63], a[176:179], v[76:79], a[48:63]
  v_accvgpr_read_b32 v202, a42
  v_accvgpr_read_b32 v203, a43
  v_accvgpr_read_b32 v204, a44
  v_accvgpr_read_b32 v205, a45
  v_accvgpr_read_b32 v206, a46
  v_accvgpr_read_b32 v207, a47
  v_cvt_pk_bf16_f32 v148, v200, v201
  v_mfma_f32_32x32x16_bf16 a[48:63], a[180:183], v[84:87], a[48:63]
  v_cvt_pk_bf16_f32 v149, v202, v203
  v_cvt_pk_bf16_f32 v150, v204, v205
  v_cvt_pk_bf16_f32 v151, v206, v207
  v_mfma_f32_32x32x16_bf16 a[48:63], a[184:187], v[92:95], a[48:63]
  v_mfma_f32_32x32x16_bf16 a[48:63], a[188:191], v[100:103], a[48:63]
  s_waitcnt lgkmcnt(14)
  v_mfma_f32_32x32x16_bf16 a[64:79], a[128:131], v[40:43], a[64:79]
  ds_read_b64_tr_b16 a[160:161], v223 offset:35840
  ds_read_b64_tr_b16 a[162:163], v223 offset:36096
  s_waitcnt lgkmcnt(14)
  v_mfma_f32_32x32x16_bf16 a[64:79], a[132:135], v[48:51], a[64:79]
  ds_read_b64_tr_b16 a[164:165], v223 offset:39936
  ds_read_b64_tr_b16 a[166:167], v223 offset:40192
  s_waitcnt lgkmcnt(14)
  v_mfma_f32_32x32x16_bf16 a[64:79], a[136:139], v[56:59], a[64:79]
  ds_read_b64_tr_b16 a[168:169], v223 offset:44032
  ds_read_b64_tr_b16 a[170:171], v223 offset:44288
  v_accvgpr_read_b32 v200, a48
  v_accvgpr_read_b32 v201, a49
  v_accvgpr_read_b32 v202, a50
  v_accvgpr_read_b32 v203, a51
  v_accvgpr_read_b32 v204, a52
  s_waitcnt lgkmcnt(14)
  v_mfma_f32_32x32x16_bf16 a[64:79], a[140:143], v[64:67], a[64:79]
  ds_read_b64_tr_b16 a[172:173], v223 offset:48128
  ds_read_b64_tr_b16 a[174:175], v223 offset:48384
  v_accvgpr_read_b32 v205, a53
  v_accvgpr_read_b32 v206, a54
  v_accvgpr_read_b32 v207, a55
  v_cvt_pk_bf16_f32 v176, v200, v201
  v_cvt_pk_bf16_f32 v177, v202, v203
  s_waitcnt lgkmcnt(14)
  v_mfma_f32_32x32x16_bf16 a[64:79], a[144:147], v[72:75], a[64:79]
  ds_read_b64_tr_b16 a[176:177], v223 offset:52224
  ds_read_b64_tr_b16 a[178:179], v223 offset:52480
  v_cvt_pk_bf16_f32 v178, v204, v205
  v_cvt_pk_bf16_f32 v179, v206, v207
  v_accvgpr_read_b32 v200, a56
  v_accvgpr_read_b32 v201, a57
  v_accvgpr_read_b32 v202, a58
  s_waitcnt lgkmcnt(14)
  v_mfma_f32_32x32x16_bf16 a[64:79], a[148:151], v[80:83], a[64:79]
  ds_read_b64_tr_b16 a[180:181], v223 offset:56320
  ds_read_b64_tr_b16 a[182:183], v223 offset:56576
  v_accvgpr_read_b32 v203, a59
  v_accvgpr_read_b32 v204, a60
  v_accvgpr_read_b32 v205, a61
  v_accvgpr_read_b32 v206, a62
  v_accvgpr_read_b32 v207, a63
  s_waitcnt lgkmcnt(14)
  v_mfma_f32_32x32x16_bf16 a[64:79], a[152:155], v[88:91], a[64:79]
  ds_read_b64_tr_b16 a[184:185], v223 offset:60416
  ds_read_b64_tr_b16 a[186:187], v223 offset:60672
  v_cvt_pk_bf16_f32 v180, v200, v201
  v_cvt_pk_bf16_f32 v181, v202, v203
  v_cvt_pk_bf16_f32 v182, v204, v205
  v_cvt_pk_bf16_f32 v183, v206, v207
  s_waitcnt lgkmcnt(14)
  v_mfma_f32_32x32x16_bf16 a[64:79], a[156:159], v[96:99], a[64:79]
  ds_read_b64_tr_b16 a[188:189], v223 offset:64512
  ds_read_b64_tr_b16 a[190:191], v223 offset:64768
  v_mfma_f32_32x32x16_bf16 a[80:95], a[128:131], v[44:47], a[80:95]
  v_mfma_f32_32x32x16_bf16 a[80:95], a[132:135], v[52:55], a[80:95]
  v_mfma_f32_32x32x16_bf16 a[80:95], a[136:139], v[60:63], a[80:95]
  s_nop 6
  v_accvgpr_read_b32 v200, a64
  v_accvgpr_read_b32 v201, a65
  v_accvgpr_read_b32 v202, a66
  v_accvgpr_read_b32 v203, a67
  v_accvgpr_read_b32 v204, a68
  v_accvgpr_read_b32 v205, a69
  v_accvgpr_read_b32 v206, a70
  v_mfma_f32_32x32x16_bf16 a[80:95], a[140:143], v[68:71], a[80:95]
  v_accvgpr_read_b32 v207, a71
  v_cvt_pk_bf16_f32 v152, v200, v201
  v_cvt_pk_bf16_f32 v153, v202, v203
  v_cvt_pk_bf16_f32 v154, v204, v205
  v_cvt_pk_bf16_f32 v155, v206, v207
  v_accvgpr_read_b32 v200, a72
  v_accvgpr_read_b32 v201, a73
  v_mfma_f32_32x32x16_bf16 a[80:95], a[144:147], v[76:79], a[80:95]
  v_accvgpr_read_b32 v202, a74
  v_accvgpr_read_b32 v203, a75
  v_accvgpr_read_b32 v204, a76
  v_accvgpr_read_b32 v205, a77
  v_accvgpr_read_b32 v206, a78
  v_accvgpr_read_b32 v207, a79
  v_cvt_pk_bf16_f32 v156, v200, v201
  v_mfma_f32_32x32x16_bf16 a[80:95], a[148:151], v[84:87], a[80:95]
  v_cvt_pk_bf16_f32 v157, v202, v203
  v_cvt_pk_bf16_f32 v158, v204, v205
  v_cvt_pk_bf16_f32 v159, v206, v207
  v_mfma_f32_32x32x16_bf16 a[80:95], a[152:155], v[92:95], a[80:95]
  v_mfma_f32_32x32x16_bf16 a[80:95], a[156:159], v[100:103], a[80:95]
  s_barrier
  s_waitcnt lgkmcnt(14)
  v_mfma_f32_32x32x16_bf16 a[96:111], a[160:163], v[40:43], a[96:111]
  ds_read_b128 a[128:131], v226 offset:0
  s_waitcnt lgkmcnt(13)
  v_mfma_f32_32x32x16_bf16 a[96:111], a[164:167], v[48:51], a[96:111]
  ds_read_b128 a[132:135], v228 offset:0
  s_waitcnt lgkmcnt(12)
  v_mfma_f32_32x32x16_bf16 a[96:111], a[168:171], v[56:59], a[96:111]
  ds_read_b128 a[136:139], v226 offset:2048
  s_nop 1
  v_accvgpr_read_b32 v200, a80
  v_accvgpr_read_b32 v201, a81
  v_accvgpr_read_b32 v202, a82
  v_accvgpr_read_b32 v203, a83
  v_accvgpr_read_b32 v204, a84
  v_accvgpr_read_b32 v205, a85
  s_waitcnt lgkmcnt(11)
  v_mfma_f32_32x32x16_bf16 a[96:111], a[172:175], v[64:67], a[96:111]
  ds_read_b128 a[140:143], v228 offset:2048
  v_accvgpr_read_b32 v206, a86
  v_accvgpr_read_b32 v207, a87
  v_cvt_pk_bf16_f32 v184, v200, v201
  v_cvt_pk_bf16_f32 v185, v202, v203
  v_cvt_pk_bf16_f32 v186, v204, v205
  v_cvt_pk_bf16_f32 v187, v206, v207
  s_waitcnt lgkmcnt(10)
  v_mfma_f32_32x32x16_bf16 a[96:111], a[176:179], v[72:75], a[96:111]
  ds_read_b128 a[144:147], v226 offset:4096
  v_accvgpr_read_b32 v200, a88
  v_accvgpr_read_b32 v201, a89
  v_accvgpr_read_b32 v202, a90
  v_accvgpr_read_b32 v203, a91
  v_accvgpr_read_b32 v204, a92
  v_accvgpr_read_b32 v205, a93
  s_waitcnt lgkmcnt(9)
  v_mfma_f32_32x32x16_bf16 a[96:111], a[180:183], v[80:83], a[96:111]
  ds_read_b128 a[148:151], v228 offset:4096
  v_accvgpr_read_b32 v206, a94
  v_accvgpr_read_b32 v207, a95
  v_cvt_pk_bf16_f32 v188, v200, v201
  v_cvt_pk_bf16_f32 v189, v202, v203
  v_cvt_pk_bf16_f32 v190, v204, v205
  v_cvt_pk_bf16_f32 v191, v206, v207
  s_waitcnt lgkmcnt(8)
  v_mfma_f32_32x32x16_bf16 a[96:111], a[184:187], v[88:91], a[96:111]
  ds_read_b128 a[152:155], v226 offset:6144
  s_waitcnt lgkmcnt(7)
  v_mfma_f32_32x32x16_bf16 a[96:111], a[188:191], v[96:99], a[96:111]
  ds_read_b128 a[156:159], v228 offset:6144
  v_mfma_f32_32x32x16_bf16 a[112:127], a[160:163], v[44:47], a[112:127]
  s_add_u32 m0, s62, 65536
  s_add_u32 s64, s61, 32768
  buffer_load_dwordx4 v220, s[16:19], s64 offen offset:0  lds
  v_mfma_f32_32x32x16_bf16 a[112:127], a[164:167], v[52:55], a[112:127]
  v_mfma_f32_32x32x16_bf16 a[112:127], a[168:171], v[60:63], a[112:127]
  s_nop 4
  v_accvgpr_read_b32 v200, a96
  v_accvgpr_read_b32 v201, a97
  v_accvgpr_read_b32 v202, a98
  v_accvgpr_read_b32 v203, a99
  v_accvgpr_read_b32 v204, a100
  v_accvgpr_read_b32 v205, a101
  v_accvgpr_read_b32 v206, a102
  s_add_u32 m0, s62, 67520
  s_nop 0
  buffer_load_dwordx4 v220, s[16:19], s64 offen offset:64  lds
  v_mfma_f32_32x32x16_bf16 a[112:127], a[172:175], v[68:71], a[112:127]
  v_accvgpr_read_b32 v207, a103
  v_cvt_pk_bf16_f32 v160, v200, v201
  v_cvt_pk_bf16_f32 v161, v202, v203
  v_cvt_pk_bf16_f32 v162, v204, v205
  v_cvt_pk_bf16_f32 v163, v206, v207
  v_accvgpr_read_b32 v200, a104
  v_accvgpr_read_b32 v201, a105
  v_mfma_f32_32x32x16_bf16 a[112:127], a[176:179], v[76:79], a[112:127]
  v_accvgpr_read_b32 v202, a106
  v_accvgpr_read_b32 v203, a107
  v_accvgpr_read_b32 v204, a108
  v_accvgpr_read_b32 v205, a109
  v_accvgpr_read_b32 v206, a110
  v_accvgpr_read_b32 v207, a111
  v_cvt_pk_bf16_f32 v164, v200, v201
  s_add_u32 m0, s62, 69504
  s_nop 0
  buffer_load_dwordx4 v220, s[16:19], s64 offen offset:128  lds
  v_mfma_f32_32x32x16_bf16 a[112:127], a[180:183], v[84:87], a[112:127]
  v_cvt_pk_bf16_f32 v165, v202, v203
  v_cvt_pk_bf16_f32 v166, v204, v205
  v_cvt_pk_bf16_f32 v167, v206, v207
  v_mfma_f32_32x32x16_bf16 a[112:127], a[184:187], v[92:95], a[112:127]
  s_add_u32 m0, s62, 71488
  s_nop 0
  buffer_load_dwordx4 v220, s[16:19], s64 offen offset:192  lds
  v_mfma_f32_32x32x16_bf16 a[112:127], a[188:191], v[100:103], a[112:127]
  s_waitcnt lgkmcnt(7)
  v_mfma_f32_32x32x16_bf16 v[8:23], a[128:131], v[136:139], v[104:119]
  ds_read_b128 a[160:163], v226 offset:8192
  s_add_u32 m0, s63, 32768
  s_add_u32 s65, s61, 16384
  buffer_load_dwordx4 v221, s[20:23], s65 offen offset:0  lds
  s_waitcnt lgkmcnt(7)
  v_mfma_f32_32x32x16_bf16 v[8:23], a[132:135], v[140:143], v[8:23]
  s_nop 3
  v_accvgpr_read_b32 v200, a112
  v_accvgpr_read_b32 v201, a113
  v_accvgpr_read_b32 v202, a114
  ds_read_b128 a[164:167], v228 offset:8192
  s_waitcnt lgkmcnt(7)
  v_mfma_f32_32x32x16_bf16 v[8:23], a[136:139], v[144:147], v[8:23]
  v_accvgpr_read_b32 v203, a115
  v_accvgpr_read_b32 v204, a116
  v_accvgpr_read_b32 v205, a117
  v_accvgpr_read_b32 v206, a118
  ds_read_b128 a[168:171], v226 offset:10240
  s_add_u32 m0, s63, 33728
  s_nop 0
  buffer_load_dwordx4 v221, s[20:23], s65 offen offset:64  lds
  s_waitcnt lgkmcnt(7)
  v_mfma_f32_32x32x16_bf16 v[8:23], a[140:143], v[148:151], v[8:23]
  v_accvgpr_read_b32 v207, a119
  v_cvt_pk_bf16_f32 v192, v200, v201
  v_cvt_pk_bf16_f32 v193, v202, v203
  ds_read_b128 a[172:175], v228 offset:10240
  s_waitcnt lgkmcnt(7)
  v_mfma_f32_32x32x16_bf16 v[8:23], a[144:147], v[152:155], v[8:23]
  v_cvt_pk_bf16_f32 v194, v204, v205
  v_cvt_pk_bf16_f32 v195, v206, v207
  v_accvgpr_read_b32 v200, a120
  v_accvgpr_read_b32 v201, a121
  ds_read_b128 a[176:179], v226 offset:12288
  s_add_u32 m0, s63, 34688
  s_nop 0
  buffer_load_dwordx4 v221, s[20:23], s65 offen offset:128  lds
  s_waitcnt lgkmcnt(7)
  v_mfma_f32_32x32x16_bf16 v[8:23], a[148:151], v[156:159], v[8:23]
  v_accvgpr_read_b32 v202, a122
  v_accvgpr_read_b32 v203, a123
  v_accvgpr_read_b32 v204, a124
  ds_read_b128 a[180:183], v228 offset:12288
  s_waitcnt lgkmcnt(7)
  v_mfma_f32_32x32x16_bf16 v[8:23], a[152:155], v[160:163], v[8:23]
  v_accvgpr_read_b32 v205, a125
  v_accvgpr_read_b32 v206, a126
  v_accvgpr_read_b32 v207, a127
  v_cvt_pk_bf16_f32 v196, v200, v201
  ds_read_b128 a[184:187], v226 offset:14336
  s_add_u32 m0, s63, 35648
  s_nop 0
  buffer_load_dwordx4 v221, s[20:23], s65 offen offset:192  lds
  s_waitcnt lgkmcnt(7)
  v_mfma_f32_32x32x16_bf16 v[8:23], a[156:159], v[164:167], v[8:23]
  v_cvt_pk_bf16_f32 v197, v202, v203
  v_cvt_pk_bf16_f32 v198, v204, v205
  v_cvt_pk_bf16_f32 v199, v206, v207
  ds_read_b128 a[188:191], v228 offset:14336
  v_mfma_f32_32x32x16_bf16 v[24:39], a[128:131], v[168:171], v[120:135]
  v_mfma_f32_32x32x16_bf16 v[24:39], a[132:135], v[172:175], v[24:39]
  v_mfma_f32_32x32x16_bf16 v[24:39], a[136:139], v[176:179], v[24:39]
  v_mfma_f32_32x32x16_bf16 v[24:39], a[140:143], v[180:183], v[24:39]
  v_mfma_f32_32x32x16_bf16 v[24:39], a[144:147], v[184:187], v[24:39]
  v_mfma_f32_32x32x16_bf16 v[24:39], a[148:151], v[188:191], v[24:39]
  v_mfma_f32_32x32x16_bf16 v[24:39], a[152:155], v[192:195], v[24:39]
  v_mfma_f32_32x32x16_bf16 v[24:39], a[156:159], v[196:199], v[24:39]
  s_waitcnt lgkmcnt(7)
  v_mfma_f32_32x32x16_bf16 v[40:55], a[160:163], v[136:139], v[104:119]
  v_exp_f32 v200, v8
  v_exp_f32 v201, v9
  v_add_f32 v208, v210, v200
  v_exp_f32 v202, v10
  s_waitcnt lgkmcnt(6)
  v_mfma_f32_32x32x16_bf16 v[40:55], a[164:167], v[140:143], v[40:55]
  v_add_f32 v208, v208, v201
  v_cvt_pk_bf16_f32 v72, v200, v201
  v_exp_f32 v203, v11
  v_add_f32 v208, v208, v202
  v_exp_f32 v204, v12
  s_waitcnt lgkmcnt(5)
  v_mfma_f32_32x32x16_bf16 v[40:55], a[168:171], v[144:147], v[40:55]
  v_add_f32 v208, v208, v203
  v_cvt_pk_bf16_f32 v73, v202, v203
  v_exp_f32 v205, v13
  v_add_f32 v208, v208, v204
  v_exp_f32 v206, v14
  s_waitcnt lgkmcnt(4)
  v_mfma_f32_32x32x16_bf16 v[40:55], a[172:175], v[148:151], v[40:55]
  v_add_f32 v208, v208, v205
  v_cvt_pk_bf16_f32 v74, v204, v205
  v_exp_f32 v207, v15
  v_add_f32 v208, v208, v206
  v_exp_f32 v200, v16
  s_waitcnt lgkmcnt(3)
  v_mfma_f32_32x32x16_bf16 v[40:55], a[176:179], v[152:155], v[40:55]
  v_add_f32 v208, v208, v207
  v_cvt_pk_bf16_f32 v75, v206, v207
  v_exp_f32 v201, v17
  v_add_f32 v208, v208, v200
  v_exp_f32 v202, v18
  s_waitcnt lgkmcnt(2)
  v_mfma_f32_32x32x16_bf16 v[40:55], a[180:183], v[156:159], v[40:55]
  v_add_f32 v208, v208, v201
  v_cvt_pk_bf16_f32 v76, v200, v201
  v_exp_f32 v203, v19
  v_add_f32 v208, v208, v202
  v_exp_f32 v204, v20
  s_waitcnt lgkmcnt(1)
  v_mfma_f32_32x32x16_bf16 v[40:55], a[184:187], v[160:163], v[40:55]
  v_add_f32 v208, v208, v203
  v_cvt_pk_bf16_f32 v77, v202, v203
  v_exp_f32 v205, v21
  v_add_f32 v208, v208, v204
  v_exp_f32 v206, v22
  s_waitcnt lgkmcnt(0)
  v_mfma_f32_32x32x16_bf16 v[40:55], a[188:191], v[164:167], v[40:55]
  v_add_f32 v208, v208, v205
  v_cvt_pk_bf16_f32 v78, v204, v205
  v_exp_f32 v207, v23
  v_add_f32 v208, v208, v206
  v_exp_f32 v200, v24
  s_waitcnt vmcnt(8)
  s_barrier
  v_mfma_f32_32x32x16_bf16 v[56:71], a[160:163], v[168:171], v[120:135]
  v_add_f32 v208, v208, v207
  v_cvt_pk_bf16_f32 v79, v206, v207
  v_exp_f32 v201, v25
  v_add_f32 v209, v211, v200
  v_exp_f32 v202, v26
  ds_read_b128 a[128:131], v226 offset:32768
  v_mfma_f32_32x32x16_bf16 v[56:71], a[164:167], v[172:175], v[56:71]
  v_add_f32 v209, v209, v201
  v_cvt_pk_bf16_f32 v80, v200, v201
  v_exp_f32 v203, v27
  v_add_f32 v209, v209, v202
  v_exp_f32 v204, v28
  ds_read_b128 a[132:135], v228 offset:32768
  v_mfma_f32_32x32x16_bf16 v[56:71], a[168:171], v[176:179], v[56:71]
  v_add_f32 v209, v209, v203
  v_cvt_pk_bf16_f32 v81, v202, v203
  v_exp_f32 v205, v29
  v_add_f32 v209, v209, v204
  v_exp_f32 v206, v30
  ds_read_b128 a[136:139], v226 offset:34816
  s_add_u32 m0, s62, 98304
  s_add_u32 s64, s61, 49152
  buffer_load_dwordx4 v220, s[16:19], s64 offen offset:0  lds
  v_mfma_f32_32x32x16_bf16 v[56:71], a[172:175], v[180:183], v[56:71]
  v_add_f32 v209, v209, v205
  v_cvt_pk_bf16_f32 v82, v204, v205
  v_exp_f32 v207, v31
  v_add_f32 v209, v209, v206
  v_exp_f32 v200, v32
  ds_read_b128 a[140:143], v228 offset:34816
  v_mfma_f32_32x32x16_bf16 v[56:71], a[176:179], v[184:187], v[56:71]
  v_add_f32 v209, v209, v207
  v_cvt_pk_bf16_f32 v83, v206, v207
  v_exp_f32 v201, v33
  v_add_f32 v209, v209, v200
  v_exp_f32 v202, v34
  ds_read_b128 a[144:147], v226 offset:36864
  v_mfma_f32_32x32x16_bf16 v[56:71], a[180:183], v[188:191], v[56:71]
  v_add_f32 v209, v209, v201
  v_cvt_pk_bf16_f32 v84, v200, v201
  v_exp_f32 v203, v35
  v_add_f32 v209, v209, v202
  v_exp_f32 v204, v36
  ds_read_b128 a[148:151], v228 offset:36864
  v_mfma_f32_32x32x16_bf16 v[56:71], a[184:187], v[192:195], v[56:71]
  v_add_f32 v209, v209, v203
  v_cvt_pk_bf16_f32 v85, v202, v203
  v_exp_f32 v205, v37
  v_add_f32 v209, v209, v204
  v_exp_f32 v206, v38
  ds_read_b128 a[152:155], v226 offset:38912
  s_add_u32 m0, s62, 100288
  s_nop 0
  buffer_load_dwordx4 v220, s[16:19], s64 offen offset:64  lds
  v_mfma_f32_32x32x16_bf16 v[56:71], a[188:191], v[196:199], v[56:71]
  v_add_f32 v209, v209, v205
  v_cvt_pk_bf16_f32 v86, v204, v205
  v_exp_f32 v207, v39
  v_add_f32 v209, v209, v206
  v_add_f32 v209, v209, v207
  v_cvt_pk_bf16_f32 v87, v206, v207
  ds_read_b128 a[156:159], v228 offset:38912
  v_cmp_nle_f32 s[68:69], v208, s66
  v_cmp_nle_f32 s[70:71], v209, s66
  s_nop 0
  s_or_b64 s[68:69], s[68:69], s[70:71]
  v_cmp_nge_f32 s[70:71], v208, s67
  s_nop 0
  s_or_b64 s[68:69], s[68:69], s[70:71]
  v_cmp_nge_f32 s[70:71], v209, s67
  s_nop 0
  s_or_b64 s[68:69], s[68:69], s[70:71]
  s_cbranch_scc1 k2_fb2
k2_ret3:
  s_waitcnt lgkmcnt(7)
  s_nop 0
  v_mfma_f32_32x32x16_bf16 v[8:23], a[128:131], v[136:139], v[104:119]
  ds_read_b64_tr_b16 a[160:161], v224 offset:16384
  ds_read_b64_tr_b16 a[162:163], v224 offset:16896
  v_exp_f32 v200, v40
  v_exp_f32 v201, v41
  s_waitcnt lgkmcnt(8)
  v_mfma_f32_32x32x16_bf16 v[8:23], a[132:135], v[140:143], v[8:23]
  ds_read_b64_tr_b16 a[164:165], v224 offset:20480
  ds_read_b64_tr_b16 a[166:167], v224 offset:20992
  v_add_f32 v210, v208, v200
  v_exp_f32 v202, v42
  s_waitcnt lgkmcnt(9)
  v_mfma_f32_32x32x16_bf16 v[8:23], a[136:139], v[144:147], v[8:23]
  ds_read_b64_tr_b16 a[168:169], v224 offset:17408
  ds_read_b64_tr_b16 a[170:171], v224 offset:17920
  v_add_f32 v210, v210, v201
  v_cvt_pk_bf16_f32 v88, v200, v201
  v_exp_f32 v203, v43
  s_add_u32 m0, s62, 102272
  s_nop 0
  buffer_load_dwordx4 v220, s[16:19], s64 offen offset:128  lds
  s_waitcnt lgkmcnt(10)
  v_mfma_f32_32x32x16_bf16 v[8:23], a[140:143], v[148:151], v[8:23]
  ds_read_b64_tr_b16 a[172:173], v224 offset:21504
  ds_read_b64_tr_b16 a[174:175], v224 offset:22016
  v_add_f32 v210, v210, v202
  v_exp_f32 v204, v44
  s_waitcnt lgkmcnt(11)
  v_mfma_f32_32x32x16_bf16 v[8:23], a[144:147], v[152:155], v[8:23]
  ds_read_b64_tr_b16 a[176:177], v224 offset:18432
  ds_read_b64_tr_b16 a[178:179], v224 offset:18944
  v_add_f32 v210, v210, v203
  v_cvt_pk_bf16_f32 v89, v202, v203
  v_exp_f32 v205, v45
  s_waitcnt lgkmcnt(12)
  v_mfma_f32_32x32x16_bf16 v[8:23], a[148:151], v[156:159], v[8:23]
  ds_read_b64_tr_b16 a[180:181], v224 offset:22528
  ds_read_b64_tr_b16 a[182:183], v224 offset:23040
  v_add_f32 v210, v210, v204
  v_exp_f32 v206, v46
  v_add_f32 v210, v210, v205
  s_waitcnt lgkmcnt(13)
  v_mfma_f32_32x32x16_bf16 v[8:23], a[152:155], v[160:163], v[8:23]
  ds_read_b64_tr_b16 a[184:185], v224 offset:19456
  ds_read_b64_tr_b16 a[186:187], v224 offset:19968
  v_cvt_pk_bf16_f32 v90, v204, v205
  v_exp_f32 v207, v47
  s_add_u32 m0, s62, 104256
  s_nop 0
  buffer_load_dwordx4 v220, s[16:19], s64 offen offset:192  lds
  s_waitcnt lgkmcnt(14)
  v_mfma_f32_32x32x16_bf16 v[8:23], a[156:159], v[164:167], v[8:23]
  ds_read_b64_tr_b16 a[188:189], v224 offset:23552
  ds_read_b64_tr_b16 a[190:191], v224 offset:24064
  v_add_f32 v210, v210, v206
  v_exp_f32 v200, v48
  v_add_f32 v210, v210, v207
  v_mfma_f32_32x32x16_bf16 v[24:39], a[128:131], v[168:171], v[120:135]
  v_cvt_pk_bf16_f32 v91, v206, v207
  v_exp_f32 v201, v49
  v_add_f32 v210, v210, v200
  v_mfma_f32_32x32x16_bf16 v[24:39], a[132:135], v[172:175], v[24:39]
  v_exp_f32 v202, v50
  v_add_f32 v210, v210, v201
  v_mfma_f32_32x32x16_bf16 v[24:39], a[136:139], v[176:179], v[24:39]
  v_cvt_pk_bf16_f32 v92, v200, v201
  v_exp_f32 v203, v51
  v_add_f32 v210, v210, v202
  s_add_u32 m0, s63, 65536
  s_add_u32 s65, s61, 32768
  buffer_load_dwordx4 v221, s[20:23], s65 offen offset:0  lds
  v_mfma_f32_32x32x16_bf16 v[24:39], a[140:143], v[180:183], v[24:39]
  v_exp_f32 v204, v52
  v_add_f32 v210, v210, v203
  v_mfma_f32_32x32x16_bf16 v[24:39], a[144:147], v[184:187], v[24:39]
  v_cvt_pk_bf16_f32 v93, v202, v203
  v_exp_f32 v205, v53
  v_add_f32 v210, v210, v204
  v_mfma_f32_32x32x16_bf16 v[24:39], a[148:151], v[188:191], v[24:39]
  v_exp_f32 v206, v54
  v_add_f32 v210, v210, v205
  v_cvt_pk_bf16_f32 v94, v204, v205
  v_mfma_f32_32x32x16_bf16 v[24:39], a[152:155], v[192:195], v[24:39]
  v_exp_f32 v207, v55
  v_add_f32 v210, v210, v206
  s_add_u32 m0, s63, 66496
  s_nop 0
  buffer_load_dwordx4 v221, s[20:23], s65 offen offset:64  lds
  v_mfma_f32_32x32x16_bf16 v[24:39], a[156:159], v[196:199], v[24:39]
  v_exp_f32 v200, v56
  v_add_f32 v210, v210, v207
  v_cvt_pk_bf16_f32 v95, v206, v207
  s_waitcnt lgkmcnt(14)
  v_mfma_f32_32x32x16_bf16 a[0:15], a[160:163], v[72:75], 0
  ds_read_b128 a[128:131], v226 offset:40960
  v_exp_f32 v201, v57
  v_add_f32 v211, v209, v200
  s_waitcnt lgkmcnt(13)
  v_mfma_f32_32x32x16_bf16 a[0:15], a[164:167], v[76:79], a[0:15]
  v_exp_f32 v202, v58
  v_add_f32 v211, v211, v201
  v_cvt_pk_bf16_f32 v96, v200, v201
  v_mfma_f32_32x32x16_bf16 a[16:31], a[160:163], v[80:83], 0
  ds_read_b128 a[132:135], v228 offset:40960
  v_exp_f32 v203, v59
  v_add_f32 v211, v211, v202
  s_add_u32 m0, s63, 67456
  s_nop 0
  buffer_load_dwordx4 v221, s[20:23], s65 offen offset:128  lds
  v_mfma_f32_32x32x16_bf16 a[16:31], a[164:167], v[84:87], a[16:31]
  v_exp_f32 v204, v60
  v_add_f32 v211, v211, v203
  v_cvt_pk_bf16_f32 v97, v202, v203
  s_waitcnt lgkmcnt(12)
  v_mfma_f32_32x32x16_bf16 a[32:47], a[168:171], v[72:75], 0
  ds_read_b128 a[136:139], v226 offset:43008
  v_exp_f32 v205, v61
  v_add_f32 v211, v211, v204
  s_waitcnt lgkmcnt(11)
  v_mfma_f32_32x32x16_bf16 a[32:47], a[172:175], v[76:79], a[32:47]
  v_exp_f32 v206, v62
  v_add_f32 v211, v211, v205
  v_cvt_pk_bf16_f32 v98, v204, v205
  v_mfma_f32_32x32x16_bf16 a[48:63], a[168:171], v[80:83], 0
  ds_read_b128 a[140:143], v228 offset:43008
  v_exp_f32 v207, v63
  v_add_f32 v211, v211, v206
  v_exp_f32 v200, v64
  s_add_u32 m0, s63, 68416
  s_nop 0
  buffer_load_dwordx4 v221, s[20:23], s65 offen offset:192  lds
  v_mfma_f32_32x32x16_bf16 a[48:63], a[172:175], v[84:87], a[48:63]
  v_add_f32 v211, v211, v207
  v_cvt_pk_bf16_f32 v99, v206, v207
  s_waitcnt lgkmcnt(10)
  v_mfma_f32_32x32x16_bf16 a[64:79], a[176:179], v[72:75], 0
  ds_read_b128 a[144:147], v226 offset:45056
  v_exp_f32 v201, v65
  v_add_f32 v211, v211, v200
  v_exp_f32 v202, v66
  s_waitcnt lgkmcnt(9)
  v_mfma_f32_32x32x16_bf16 a[64:79], a[180:183], v[76:79], a[64:79]
  v_add_f32 v211, v211, v201
  v_cvt_pk_bf16_f32 v100, v200, v201
  v_mfma_f32_32x32x16_bf16 a[80:95], a[176:179], v[80:83], 0
  ds_read_b128 a[148:151], v228 offset:45056
  v_exp_f32 v203, v67
  v_add_f32 v211, v211, v202
  v_exp_f32 v204, v68
  v_mfma_f32_32x32x16_bf16 a[80:95], a[180:183], v[84:87], a[80:95]
  v_add_f32 v211, v211, v203
  v_cvt_pk_bf16_f32 v101, v202, v203
  v_exp_f32 v205, v69
  s_waitcnt lgkmcnt(8)
  v_mfma_f32_32x32x16_bf16 a[96:111], a[184:187], v[72:75], 0
  ds_read_b128 a[152:155], v226 offset:47104
  v_add_f32 v211, v211, v204
  v_exp_f32 v206, v70
  s_waitcnt lgkmcnt(7)
  v_mfma_f32_32x32x16_bf16 a[96:111], a[188:191], v[76:79], a[96:111]
  v_add_f32 v211, v211, v205
  v_cvt_pk_bf16_f32 v102, v204, v205
  v_exp_f32 v207, v71
  v_mfma_f32_32x32x16_bf16 a[112:127], a[184:187], v[80:83], 0
  ds_read_b128 a[156:159], v228 offset:47104
  v_add_f32 v211, v211, v206
  v_add_f32 v211, v211, v207
  v_cvt_pk_bf16_f32 v103, v206, v207
  v_cmp_nle_f32 s[68:69], v210, s66
  v_cmp_nle_f32 s[70:71], v211, s66
  v_mfma_f32_32x32x16_bf16 a[112:127], a[188:191], v[84:87], a[112:127]
  s_or_b64 s[68:69], s[68:69], s[70:71]
  s_cbranch_scc1 k2_fb4
k2_ret5:
  s_waitcnt lgkmcnt(7)
  s_nop 0
  v_mfma_f32_32x32x16_bf16 v[40:55], a[128:131], v[136:139], v[104:119]
  ds_read_b64_tr_b16 a[160:161], v224 offset:24576
  ds_read_b64_tr_b16 a[162:163], v224 offset:25088
  v_exp_f32 v200, v8
  v_exp_f32 v201, v9
  s_waitcnt lgkmcnt(8)
  v_mfma_f32_32x32x16_bf16 v[40:55], a[132:135], v[140:143], v[40:55]
  ds_read_b64_tr_b16 a[164:165], v224 offset:28672
  ds_read_b64_tr_b16 a[166:167], v224 offset:29184
  v_add_f32 v208, v210, v200
  v_exp_f32 v202, v10
  s_waitcnt lgkmcnt(9)
  v_mfma_f32_32x32x16_bf16 v[40:55], a[136:139], v[144:147], v[40:55]
  ds_read_b64_tr_b16 a[168:169], v224 offset:25600
  ds_read_b64_tr_b16 a[170:171], v224 offset:26112
  v_add_f32 v208, v208, v201
  v_cvt_pk_bf16_f32 v72, v200, v201
  v_exp_f32 v203, v11
  s_waitcnt lgkmcnt(10)
  v_mfma_f32_32x32x16_bf16 v[40:55], a[140:143], v[148:151], v[40:55]
  ds_read_b64_tr_b16 a[172:173], v224 offset:29696
  ds_read_b64_tr_b16 a[174:175], v224 offset:30208
  v_add_f32 v208, v208, v202
  v_exp_f32 v204, v12
  s_waitcnt lgkmcnt(11)
  v_mfma_f32_32x32x16_bf16 v[40:55], a[144:147], v[152:155], v[40:55]
  ds_read_b64_tr_b16 a[176:177], v224 offset:26624
  ds_read_b64_tr_b16 a[178:179], v224 offset:27136
  v_add_f32 v208, v208, v203
  v_cvt_pk_bf16_f32 v73, v202, v203
  v_exp_f32 v205, v13
  s_waitcnt lgkmcnt(12)
  v_mfma_f32_32x32x16_bf16 v[40:55], a[148:151], v[156:159], v[40:55]
  ds_read_b64_tr_b16 a[180:181], v224 offset:30720
  ds_read_b64_tr_b16 a[182:183], v224 offset:31232
  v_add_f32 v208, v208, v204
  v_exp_f32 v206, v14
  v_add_f32 v208, v208, v205
  s_waitcnt lgkmcnt(13)
  v_mfma_f32_32x32x16_bf16 v[40:55], a[152:155], v[160:163], v[40:55]
  ds_read_b64_tr_b16 a[184:185], v224 offset:27648
  ds_read_b64_tr_b16 a[186:187], v224 offset:28160
  v_cvt_pk_bf16_f32 v74, v204, v205
  v_exp_f32 v207, v15
  s_waitcnt lgkmcnt(14)
  v_mfma_f32_32x32x16_bf16 v[40:55], a[156:159], v[164:167], v[40:55]
  ds_read_b64_tr_b16 a[188:189], v224 offset:31744
  ds_read_b64_tr_b16 a[190:191], v224 offset:32256
  v_add_f32 v208, v208, v206
  v_exp_f32 v200, v16
  v_add_f32 v208, v208, v207
  v_mfma_f32_32x32x16_bf16 v[56:71], a[128:131], v[168:171], v[120:135]
  v_cvt_pk_bf16_f32 v75, v206, v207
  v_exp_f32 v201, v17
  v_add_f32 v208, v208, v200
  v_mfma_f32_32x32x16_bf16 v[56:71], a[132:135], v[172:175], v[56:71]
  v_exp_f32 v202, v18
  v_add_f32 v208, v208, v201
  v_mfma_f32_32x32x16_bf16 v[56:71], a[136:139], v[176:179], v[56:71]
  v_cvt_pk_bf16_f32 v76, v200, v201
  v_exp_f32 v203, v19
  v_add_f32 v208, v208, v202
  v_mfma_f32_32x32x16_bf16 v[56:71], a[140:143], v[180:183], v[56:71]
  v_exp_f32 v204, v20
  v_add_f32 v208, v208, v203
  v_mfma_f32_32x32x16_bf16 v[56:71], a[144:147], v[184:187], v[56:71]
  v_cvt_pk_bf16_f32 v77, v202, v203
  v_exp_f32 v205, v21
  v_add_f32 v208, v208, v204
  v_mfma_f32_32x32x16_bf16 v[56:71], a[148:151], v[188:191], v[56:71]
  v_exp_f32 v206, v22
  v_add_f32 v208, v208, v205
  v_cvt_pk_bf16_f32 v78, v204, v205
  v_mfma_f32_32x32x16_bf16 v[56:71], a[152:155], v[192:195], v[56:71]
  v_exp_f32 v207, v23
  v_add_f32 v208, v208, v206
  v_mfma_f32_32x32x16_bf16 v[56:71], a[156:159], v[196:199], v[56:71]
  v_exp_f32 v200, v24
  v_add_f32 v208, v208, v207
  v_cvt_pk_bf16_f32 v79, v206, v207
  s_waitcnt vmcnt(8)
  s_barrier
  s_waitcnt lgkmcnt(14)
  v_mfma_f32_32x32x16_bf16 a[0:15], a[160:163], v[88:91], a[0:15]
  ds_read_b128 a[128:131], v227 offset:0
  v_exp_f32 v201, v25
  v_add_f32 v209, v211, v200
  s_waitcnt lgkmcnt(13)
  v_mfma_f32_32x32x16_bf16 a[0:15], a[164:167], v[92:95], a[0:15]
  v_exp_f32 v202, v26
  v_add_f32 v209, v209, v201
  v_cvt_pk_bf16_f32 v80, v200, v201
  s_add_u32 m0, s62, 0
  s_add_u32 s64, s61, 65536
  buffer_load_dwordx4 v220, s[16:19], s64 offen offset:0  lds
  v_mfma_f32_32x32x16_bf16 a[16:31], a[160:163], v[96:99], a[16:31]
  ds_read_b128 a[132:135], v229 offset:0
  v_exp_f32 v203, v27
  v_add_f32 v209, v209, v202
  v_mfma_f32_32x32x16_bf16 a[16:31], a[164:167], v[100:103], a[16:31]
  v_exp_f32 v204, v28
  v_add_f32 v209, v209, v203
  v_cvt_pk_bf16_f32 v81, v202, v203
  s_waitcnt lgkmcnt(12)
  v_mfma_f32_32x32x16_bf16 a[32:47], a[168:171], v[88:91], a[32:47]
  ds_read_b128 a[136:139], v227 offset:2048
  v_exp_f32 v205, v29
  v_add_f32 v209, v209, v204
  s_waitcnt lgkmcnt(11)
  v_mfma_f32_32x32x16_bf16 a[32:47], a[172:175], v[92:95], a[32:47]
  v_exp_f32 v206, v30
  v_add_f32 v209, v209, v205
  v_cvt_pk_bf16_f32 v82, v204, v205
  v_mfma_f32_32x32x16_bf16 a[48:63], a[168:171], v[96:99], a[48:63]
  ds_read_b128 a[140:143], v229 offset:2048
  v_exp_f32 v207, v31
  v_add_f32 v209, v209, v206
  v_exp_f32 v200, v32
  s_add_u32 m0, s62, 1984
  s_nop 0
  buffer_load_dwordx4 v220, s[16:19], s64 offen offset:64  lds
  v_mfma_f32_32x32x16_bf16 a[48:63], a[172:175], v[100:103], a[48:63]
  v_add_f32 v209, v209, v207
  v_cvt_pk_bf16_f32 v83, v206, v207
  s_waitcnt lgkmcnt(10)
  v_mfma_f32_32x32x16_bf16 a[64:79], a[176:179], v[88:91], a[64:79]
  ds_read_b128 a[144:147], v227 offset:4096
  v_exp_f32 v201, v33
  v_add_f32 v209, v209, v200
  v_exp_f32 v202, v34
  s_waitcnt lgkmcnt(9)
  v_mfma_f32_32x32x16_bf16 a[64:79], a[180:183], v[92:95], a[64:79]
  v_add_f32 v209, v209, v201
  v_cvt_pk_bf16_f32 v84, v200, v201
  v_mfma_f32_32x32x16_bf16 a[80:95], a[176:179], v[96:99], a[80:95]
  ds_read_b128 a[148:151], v229 offset:4096
  v_exp_f32 v203, v35
  v_add_f32 v209, v209, v202
  v_exp_f32 v204, v36
  v_mfma_f32_32x32x16_bf16 a[80:95], a[180:183], v[100:103], a[80:95]
  v_add_f32 v209, v209, v203
  v_cvt_pk_bf16_f32 v85, v202, v203
  v_exp_f32 v205, v37
  s_add_u32 m0, s62, 3968
  s_nop 0
  buffer_load_dwordx4 v220, s[16:19], s64 offen offset:128  lds
  s_waitcnt lgkmcnt(8)
  v_mfma_f32_32x32x16_bf16 a[96:111], a[184:187], v[88:91], a[96:111]
  ds_read_b128 a[152:155], v227 offset:6144
  v_add_f32 v209, v209, v204
  v_exp_f32 v206, v38
  s_waitcnt lgkmcnt(7)
  v_mfma_f32_32x32x16_bf16 a[96:111], a[188:191], v[92:95], a[96:111]
  v_add_f32 v209, v209, v205
  v_cvt_pk_bf16_f32 v86, v204, v205
  v_exp_f32 v207, v39
  v_mfma_f32_32x32x16_bf16 a[112:127], a[184:187], v[96:99], a[112:127]
  ds_read_b128 a[156:159], v229 offset:6144
  v_add_f32 v209, v209, v206
  v_add_f32 v209, v209, v207
  v_cvt_pk_bf16_f32 v87, v206, v207
  v_cmp_nle_f32 s[68:69], v208, s66
  v_cmp_nle_f32 s[70:71], v209, s66
  v_mfma_f32_32x32x16_bf16 a[112:127], a[188:191], v[100:103], a[112:127]
  s_or_b64 s[68:69], s[68:69], s[70:71]
  s_cbranch_scc1 k2_fb6
k2_ret7:
  s_waitcnt lgkmcnt(7)
  s_nop 0
  v_mfma_f32_32x32x16_bf16 v[8:23], a[128:131], v[136:139], v[104:119]
  ds_read_b64_tr_b16 a[160:161], v224 offset:49152
  ds_read_b64_tr_b16 a[162:163], v224 offset:49664
  v_exp_f32 v200, v40
  v_exp_f32 v201, v41
  s_add_u32 m0, s62, 5952
  s_nop 0
  buffer_load_dwordx4 v220, s[16:19], s64 offen offset:192  lds
  s_waitcnt lgkmcnt(8)
  v_mfma_f32_32x32x16_bf16 v[8:23], a[132:135], v[140:143], v[8:23]
  ds_read_b64_tr_b16 a[164:165], v224 offset:53248
  ds_read_b64_tr_b16 a[166:167], v224 offset:53760
  v_add_f32 v210, v208, v200
  v_exp_f32 v202, v42
  s_waitcnt lgkmcnt(9)
  v_mfma_f32_32x32x16_bf16 v[8:23], a[136:139], v[144:147], v[8:23]
  ds_read_b64_tr_b16 a[168:169], v224 offset:50176
  ds_read_b64_tr_b16 a[170:171], v224 offset:50688
  v_add_f32 v210, v210, v201
  v_cvt_pk_bf16_f32 v88, v200, v201
  v_exp_f32 v203, v43
  s_waitcnt lgkmcnt(10)
  v_mfma_f32_32x32x16_bf16 v[8:23], a[140:143], v[148:151], v[8:23]
  ds_read_b64_tr_b16 a[172:173], v224 offset:54272
  ds_read_b64_tr_b16 a[174:175], v224 offset:54784
  v_add_f32 v210, v210, v202
  v_exp_f32 v204, v44
  s_waitcnt lgkmcnt(11)
  v_mfma_f32_32x32x16_bf16 v[8:23], a[144:147], v[152:155], v[8:23]
  ds_read_b64_tr_b16 a[176:177], v224 offset:51200
  ds_read_b64_tr_b16 a[178:179], v224 offset:51712
  v_add_f32 v210, v210, v203
  v_cvt_pk_bf16_f32 v89, v202, v203
  v_exp_f32 v205, v45
  s_waitcnt lgkmcnt(12)
  v_mfma_f32_32x32x16_bf16 v[8:23], a[148:151], v[156:159], v[8:23]
  ds_read_b64_tr_b16 a[180:181], v224 offset:55296
  ds_read_b64_tr_b16 a[182:183], v224 offset:55808
  v_add_f32 v210, v210, v204
  v_exp_f32 v206, v46
  v_add_f32 v210, v210, v205
  s_add_u32 m0, s63, 98304
  s_add_u32 s65, s61, 49152
  buffer_load_dwordx4 v221, s[20:23], s65 offen offset:0  lds
  s_waitcnt lgkmcnt(13)
  v_mfma_f32_32x32x16_bf16 v[8:23], a[152:155], v[160:163], v[8:23]
  ds_read_b64_tr_b16 a[184:185], v224 offset:52224
  ds_read_b64_tr_b16 a[186:187], v224 offset:52736
  v_cvt_pk_bf16_f32 v90, v204, v205
  v_exp_f32 v207, v47
  s_waitcnt lgkmcnt(14)
  v_mfma_f32_32x32x16_bf16 v[8:23], a[156:159], v[164:167], v[8:23]
  ds_read_b64_tr_b16 a[188:189], v224 offset:56320
  ds_read_b64_tr_b16 a[190:191], v224 offset:56832
  v_add_f32 v210, v210, v206
  v_exp_f32 v200, v48
  v_add_f32 v210, v210, v207
  v_mfma_f32_32x32x16_bf16 v[24:39], a[128:131], v[168:171], v[120:135]
  v_cvt_pk_bf16_f32 v91, v206, v207
  v_exp_f32 v201, v49
  v_add_f32 v210, v210, v200
  v_mfma_f32_32x32x16_bf16 v[24:39], a[132:135], v[172:175], v[24:39]
  v_exp_f32 v202, v50
  v_add_f32 v210, v210, v201
  v_mfma_f32_32x32x16_bf16 v[24:39], a[136:139], v[176:179], v[24:39]
  v_cvt_pk_bf16_f32 v92, v200, v201
  v_exp_f32 v203, v51
  v_add_f32 v210, v210, v202
  s_add_u32 m0, s63, 99264
  s_nop 0
  buffer_load_dwordx4 v221, s[20:23], s65 offen offset:64  lds
  v_mfma_f32_32x32x16_bf16 v[24:39], a[140:143], v[180:183], v[24:39]
  v_exp_f32 v204, v52
  v_add_f32 v210, v210, v203
  v_mfma_f32_32x32x16_bf16 v[24:39], a[144:147], v[184:187], v[24:39]
  v_cvt_pk_bf16_f32 v93, v202, v203
  v_exp_f32 v205, v53
  v_add_f32 v210, v210, v204
  v_mfma_f32_32x32x16_bf16 v[24:39], a[148:151], v[188:191], v[24:39]
  v_exp_f32 v206, v54
  v_add_f32 v210, v210, v205
  v_cvt_pk_bf16_f32 v94, v204, v205
  v_mfma_f32_32x32x16_bf16 v[24:39], a[152:155], v[192:195], v[24:39]
  v_exp_f32 v207, v55
  v_add_f32 v210, v210, v206
  v_mfma_f32_32x32x16_bf16 v[24:39], a[156:159], v[196:199], v[24:39]
  v_exp_f32 v200, v56
  v_add_f32 v210, v210, v207
  v_cvt_pk_bf16_f32 v95, v206, v207
  s_add_u32 m0, s63, 100224
  s_nop 0
  buffer_load_dwordx4 v221, s[20:23], s65 offen offset:128  lds
  s_waitcnt lgkmcnt(14)
  v_mfma_f32_32x32x16_bf16 a[0:15], a[160:163], v[72:75], a[0:15]
  ds_read_b128 a[128:131], v227 offset:8192
  v_exp_f32 v201, v57
  v_add_f32 v211, v209, v200
  s_waitcnt lgkmcnt(13)
  v_mfma_f32_32x32x16_bf16 a[0:15], a[164:167], v[76:79], a[0:15]
  v_exp_f32 v202, v58
  v_add_f32 v211, v211, v201
  v_cvt_pk_bf16_f32 v96, v200, v201
  v_mfma_f32_32x32x16_bf16 a[16:31], a[160:163], v[80:83], a[16:31]
  ds_read_b128 a[132:135], v229 offset:8192
  v_exp_f32 v203, v59
  v_add_f32 v211, v211, v202
  v_mfma_f32_32x32x16_bf16 a[16:31], a[164:167], v[84:87], a[16:31]
  v_exp_f32 v204, v60
  v_add_f32 v211, v211, v203
  v_cvt_pk_bf16_f32 v97, v202, v203
  s_waitcnt lgkmcnt(12)
  v_mfma_f32_32x32x16_bf16 a[32:47], a[168:171], v[72:75], a[32:47]
  ds_read_b128 a[136:139], v227 offset:10240
  v_exp_f32 v205, v61
  v_add_f32 v211, v211, v204
  s_add_u32 m0, s63, 101184
  s_nop 0
  buffer_load_dwordx4 v221, s[20:23], s65 offen offset:192  lds
  s_waitcnt lgkmcnt(11)
  v_mfma_f32_32x32x16_bf16 a[32:47], a[172:175], v[76:79], a[32:47]
  v_exp_f32 v206, v62
  v_add_f32 v211, v211, v205
  v_cvt_pk_bf16_f32 v98, v204, v205
  v_mfma_f32_32x32x16_bf16 a[48:63], a[168:171], v[80:83], a[48:63]
  ds_read_b128 a[140:143], v229 offset:10240
  v_exp_f32 v207, v63
  v_add_f32 v211, v211, v206
  v_exp_f32 v200, v64
  v_mfma_f32_32x32x16_bf16 a[48:63], a[172:175], v[84:87], a[48:63]
  v_add_f32 v211, v211, v207
  v_cvt_pk_bf16_f32 v99, v206, v207
  s_waitcnt lgkmcnt(10)
  v_mfma_f32_32x32x16_bf16 a[64:79], a[176:179], v[72:75], a[64:79]
  ds_read_b128 a[144:147], v227 offset:12288
  v_exp_f32 v201, v65
  v_add_f32 v211, v211, v200
  v_exp_f32 v202, v66
  s_waitcnt lgkmcnt(9)
  v_mfma_f32_32x32x16_bf16 a[64:79], a[180:183], v[76:79], a[64:79]
  v_add_f32 v211, v211, v201
  v_cvt_pk_bf16_f32 v100, v200, v201
  v_mfma_f32_32x32x16_bf16 a[80:95], a[176:179], v[80:83], a[80:95]
  ds_read_b128 a[148:151], v229 offset:12288
  v_exp_f32 v203, v67
  v_add_f32 v211, v211, v202
  v_exp_f32 v204, v68
  v_mfma_f32_32x32x16_bf16 a[80:95], a[180:183], v[84:87], a[80:95]
  v_add_f32 v211, v211, v203
  v_cvt_pk_bf16_f32 v101, v202, v203
  v_exp_f32 v205, v69
  s_waitcnt lgkmcnt(8)
  v_mfma_f32_32x32x16_bf16 a[96:111], a[184:187], v[72:75], a[96:111]
  ds_read_b128 a[152:155], v227 offset:14336
  v_add_f32 v211, v211, v204
  v_exp_f32 v206, v70
  s_waitcnt lgkmcnt(7)
  v_mfma_f32_32x32x16_bf16 a[96:111], a[188:191], v[76:79], a[96:111]
  v_add_f32 v211, v211, v205
  v_cvt_pk_bf16_f32 v102, v204, v205
  v_exp_f32 v207, v71
  v_mfma_f32_32x32x16_bf16 a[112:127], a[184:187], v[80:83], a[112:127]
  ds_read_b128 a[156:159], v229 offset:14336
  v_add_f32 v211, v211, v206
  v_add_f32 v211, v211, v207
  v_cvt_pk_bf16_f32 v103, v206, v207
  v_cmp_nle_f32 s[68:69], v210, s66
  v_cmp_nle_f32 s[70:71], v211, s66
  v_mfma_f32_32x32x16_bf16 a[112:127], a[188:191], v[84:87], a[112:127]
  s_or_b64 s[68:69], s[68:69], s[70:71]
  s_cbranch_scc1 k2_fb8
k2_ret9:
  s_waitcnt lgkmcnt(7)
  s_nop 0
  v_mfma_f32_32x32x16_bf16 v[40:55], a[128:131], v[136:139], v[104:119]
  ds_read_b64_tr_b16 a[160:161], v224 offset:57344
  ds_read_b64_tr_b16 a[162:163], v224 offset:57856
  v_exp_f32 v200, v8
  v_exp_f32 v201, v9
  s_waitcnt lgkmcnt(8)
  v_mfma_f32_32x32x16_bf16 v[40:55], a[132:135], v[140:143], v[40:55]
  ds_read_b64_tr_b16 a[164:165], v224 offset:61440
  ds_read_b64_tr_b16 a[166:167], v224 offset:61952
  v_add_f32 v208, v210, v200
  v_exp_f32 v202, v10
  s_waitcnt lgkmcnt(9)
  v_mfma_f32_32x32x16_bf16 v[40:55], a[136:139], v[144:147], v[40:55]
  ds_read_b64_tr_b16 a[168:169], v224 offset:58368
  ds_read_b64_tr_b16 a[170:171], v224 offset:58880
  v_add_f32 v208, v208, v201
  v_cvt_pk_bf16_f32 v72, v200, v201
  v_exp_f32 v203, v11
  s_waitcnt lgkmcnt(10)
  v_mfma_f32_32x32x16_bf16 v[40:55], a[140:143], v[148:151], v[40:55]
  ds_read_b64_tr_b16 a[172:173], v224 offset:62464
  ds_read_b64_tr_b16 a[174:175], v224 offset:62976
  v_add_f32 v208, v208, v202
  v_exp_f32 v204, v12
  s_waitcnt lgkmcnt(11)
  v_mfma_f32_32x32x16_bf16 v[40:55], a[144:147], v[152:155], v[40:55]
  ds_read_b64_tr_b16 a[176:177], v224 offset:59392
  ds_read_b64_tr_b16 a[178:179], v224 offset:59904
  v_add_f32 v208, v208, v203
  v_cvt_pk_bf16_f32 v73, v202, v203
  v_exp_f32 v205, v13
  s_waitcnt lgkmcnt(12)
  v_mfma_f32_32x32x16_bf16 v[40:55], a[148:151], v[156:159], v[40:55]
  ds_read_b64_tr_b16 a[180:181], v224 offset:63488
  ds_read_b64_tr_b16 a[182:183], v224 offset:64000
  v_add_f32 v208, v208, v204
  v_exp_f32 v206, v14
  v_add_f32 v208, v208, v205
  s_waitcnt lgkmcnt(13)
  v_mfma_f32_32x32x16_bf16 v[40:55], a[152:155], v[160:163], v[40:55]
  ds_read_b64_tr_b16 a[184:185], v224 offset:60416
  ds_read_b64_tr_b16 a[186:187], v224 offset:60928
  v_cvt_pk_bf16_f32 v74, v204, v205
  v_exp_f32 v207, v15
  s_waitcnt lgkmcnt(14)
  v_mfma_f32_32x32x16_bf16 v[40:55], a[156:159], v[164:167], v[40:55]
  ds_read_b64_tr_b16 a[188:189], v224 offset:64512
  ds_read_b64_tr_b16 a[190:191], v224 offset:65024
  v_add_f32 v208, v208, v206
  v_exp_f32 v200, v16
  v_add_f32 v208, v208, v207
  v_mfma_f32_32x32x16_bf16 v[56:71], a[128:131], v[168:171], v[120:135]
  v_cvt_pk_bf16_f32 v75, v206, v207
  v_exp_f32 v201, v17
  v_add_f32 v208, v208, v200
  v_mfma_f32_32x32x16_bf16 v[56:71], a[132:135], v[172:175], v[56:71]
  v_exp_f32 v202, v18
  v_add_f32 v208, v208, v201
  v_mfma_f32_32x32x16_bf16 v[56:71], a[136:139], v[176:179], v[56:71]
  v_cvt_pk_bf16_f32 v76, v200, v201
  v_exp_f32 v203, v19
  v_add_f32 v208, v208, v202
  v_mfma_f32_32x32x16_bf16 v[56:71], a[140:143], v[180:183], v[56:71]
  v_exp_f32 v204, v20
  v_add_f32 v208, v208, v203
  v_mfma_f32_32x32x16_bf16 v[56:71], a[144:147], v[184:187], v[56:71]
  v_cvt_pk_bf16_f32 v77, v202, v203
  v_exp_f32 v205, v21
  v_add_f32 v208, v208, v204
  v_mfma_f32_32x32x16_bf16 v[56:71], a[148:151], v[188:191], v[56:71]
  v_exp_f32 v206, v22
  v_add_f32 v208, v208, v205
  v_cvt_pk_bf16_f32 v78, v204, v205
  v_mfma_f32_32x32x16_bf16 v[56:71], a[152:155], v[192:195], v[56:71]
  v_exp_f32 v207, v23
  v_add_f32 v208, v208, v206
  v_mfma_f32_32x32x16_bf16 v[56:71], a[156:159], v[196:199], v[56:71]
  v_exp_f32 v200, v24
  v_add_f32 v208, v208, v207
  v_cvt_pk_bf16_f32 v79, v206, v207
  s_waitcnt vmcnt(8)
  s_barrier
  s_waitcnt lgkmcnt(14)
  v_mfma_f32_32x32x16_bf16 a[0:15], a[160:163], v[88:91], a[0:15]
  ds_read_b128 a[128:131], v227 offset:32768
  v_exp_f32 v201, v25
  v_add_f32 v209, v211, v200
  s_waitcnt lgkmcnt(13)
  v_mfma_f32_32x32x16_bf16 a[0:15], a[164:167], v[92:95], a[0:15]
  v_exp_f32 v202, v26
  v_add_f32 v209, v209, v201
  v_cvt_pk_bf16_f32 v80, v200, v201
  s_add_u32 m0, s62, 32768
  s_add_u32 s64, s61, 81920
  buffer_load_dwordx4 v220, s[16:19], s64 offen offset:0  lds
  v_mfma_f32_32x32x16_bf16 a[16:31], a[160:163], v[96:99], a[16:31]
  ds_read_b128 a[132:135], v229 offset:32768
  v_exp_f32 v203, v27
  v_add_f32 v209, v209, v202
  v_mfma_f32_32x32x16_bf16 a[16:31], a[164:167], v[100:103], a[16:31]
  v_exp_f32 v204, v28
  v_add_f32 v209, v209, v203
  v_cvt_pk_bf16_f32 v81, v202, v203
  s_waitcnt lgkmcnt(12)
  v_mfma_f32_32x32x16_bf16 a[32:47], a[168:171], v[88:91], a[32:47]
  ds_read_b128 a[136:139], v227 offset:34816
  v_exp_f32 v205, v29
  v_add_f32 v209, v209, v204
  s_waitcnt lgkmcnt(11)
  v_mfma_f32_32x32x16_bf16 a[32:47], a[172:175], v[92:95], a[32:47]
  v_exp_f32 v206, v30
  v_add_f32 v209, v209, v205
  v_cvt_pk_bf16_f32 v82, v204, v205
  v_mfma_f32_32x32x16_bf16 a[48:63], a[168:171], v[96:99], a[48:63]
  ds_read_b128 a[140:143], v229 offset:34816
  v_exp_f32 v207, v31
  v_add_f32 v209, v209, v206
  v_exp_f32 v200, v32
  s_add_u32 m0, s62, 34752
  s_nop 0
  buffer_load_dwordx4 v220, s[16:19], s64 offen offset:64  lds
  v_mfma_f32_32x32x16_bf16 a[48:63], a[172:175], v[100:103], a[48:63]
  v_add_f32 v209, v209, v207
  v_cvt_pk_bf16_f32 v83, v206, v207
  s_waitcnt lgkmcnt(10)
  v_mfma_f32_32x32x16_bf16 a[64:79], a[176:179], v[88:91], a[64:79]
  ds_read_b128 a[144:147], v227 offset:36864
  v_exp_f32 v201, v33
  v_add_f32 v209, v209, v200
  v_exp_f32 v202, v34
  s_waitcnt lgkmcnt(9)
  v_mfma_f32_32x32x16_bf16 a[64:79], a[180:183], v[92:95], a[64:79]
  v_add_f32 v209, v209, v201
  v_cvt_pk_bf16_f32 v84, v200, v201
  v_mfma_f32_32x32x16_bf16 a[80:95], a[176:179], v[96:99], a[80:95]
  ds_read_b128 a[148:151], v229 offset:36864
  v_exp_f32 v203, v35
  v_add_f32 v209, v209, v202
  v_exp_f32 v204, v36
  v_mfma_f32_32x32x16_bf16 a[80:95], a[180:183], v[100:103], a[80:95]
  v_add_f32 v209, v209, v203
  v_cvt_pk_bf16_f32 v85, v202, v203
  v_exp_f32 v205, v37
  s_add_u32 m0, s62, 36736
  s_nop 0
  buffer_load_dwordx4 v220, s[16:19], s64 offen offset:128  lds
  s_waitcnt lgkmcnt(8)
  v_mfma_f32_32x32x16_bf16 a[96:111], a[184:187], v[88:91], a[96:111]
  ds_read_b128 a[152:155], v227 offset:38912
  v_add_f32 v209, v209, v204
  v_exp_f32 v206, v38
  s_waitcnt lgkmcnt(7)
  v_mfma_f32_32x32x16_bf16 a[96:111], a[188:191], v[92:95], a[96:111]
  v_add_f32 v209, v209, v205
  v_cvt_pk_bf16_f32 v86, v204, v205
  v_exp_f32 v207, v39
  v_mfma_f32_32x32x16_bf16 a[112:127], a[184:187], v[96:99], a[112:127]
  ds_read_b128 a[156:159], v229 offset:38912
  v_add_f32 v209, v209, v206
  v_add_f32 v209, v209, v207
  v_cvt_pk_bf16_f32 v87, v206, v207
  v_cmp_nle_f32 s[68:69], v208, s66
  v_cmp_nle_f32 s[70:71], v209, s66
  v_mfma_f32_32x32x16_bf16 a[112:127], a[188:191], v[100:103], a[112:127]
  s_or_b64 s[68:69], s[68:69], s[70:71]
  s_cbranch_scc1 k2_fb10
k2_ret11:
  s_waitcnt lgkmcnt(7)
  s_nop 0
  v_mfma_f32_32x32x16_bf16 v[8:23], a[128:131], v[136:139], v[104:119]
  ds_read_b64_tr_b16 a[160:161], v225 offset:16384
  ds_read_b64_tr_b16 a[162:163], v225 offset:16896
  v_exp_f32 v200, v40
  v_exp_f32 v201, v41
  s_add_u32 m0, s62, 38720
  s_nop 0
  buffer_load_dwordx4 v220, s[16:19], s64 offen offset:192  lds
  s_waitcnt lgkmcnt(8)
  v_mfma_f32_32x32x16_bf16 v[8:23], a[132:135], v[140:143], v[8:23]
  ds_read_b64_tr_b16 a[164:165], v225 offset:20480
  ds_read_b64_tr_b16 a[166:167], v225 offset:20992
  v_add_f32 v210, v208, v200
  v_exp_f32 v202, v42
  s_waitcnt lgkmcnt(9)
  v_mfma_f32_32x32x16_bf16 v[8:23], a[136:139], v[144:147], v[8:23]
  ds_read_b64_tr_b16 a[168:169], v225 offset:17408
  ds_read_b64_tr_b16 a[170:171], v225 offset:17920
  v_add_f32 v210, v210, v201
  v_cvt_pk_bf16_f32 v88, v200, v201
  v_exp_f32 v203, v43
  s_waitcnt lgkmcnt(10)
  v_mfma_f32_32x32x16_bf16 v[8:23], a[140:143], v[148:151], v[8:23]
  ds_read_b64_tr_b16 a[172:173], v225 offset:21504
  ds_read_b64_tr_b16 a[174:175], v225 offset:22016
  v_add_f32 v210, v210, v202
  v_exp_f32 v204, v44
  s_waitcnt lgkmcnt(11)
  v_mfma_f32_32x32x16_bf16 v[8:23], a[144:147], v[152:155], v[8:23]
  ds_read_b64_tr_b16 a[176:177], v225 offset:18432
  ds_read_b64_tr_b16 a[178:179], v225 offset:18944
  v_add_f32 v210, v210, v203
  v_cvt_pk_bf16_f32 v89, v202, v203
  v_exp_f32 v205, v45
  s_waitcnt lgkmcnt(12)
  v_mfma_f32_32x32x16_bf16 v[8:23], a[148:151], v[156:159], v[8:23]
  ds_read_b64_tr_b16 a[180:181], v225 offset:22528
  ds_read_b64_tr_b16 a[182:183], v225 offset:23040
  v_add_f32 v210, v210, v204
  v_exp_f32 v206, v46
  v_add_f32 v210, v210, v205
  s_add_u32 m0, s63, 0
  s_add_u32 s65, s61, 65536
  buffer_load_dwordx4 v221, s[20:23], s65 offen offset:0  lds
  s_waitcnt lgkmcnt(13)
  v_mfma_f32_32x32x16_bf16 v[8:23], a[152:155], v[160:163], v[8:23]
  ds_read_b64_tr_b16 a[184:185], v225 offset:19456
  ds_read_b64_tr_b16 a[186:187], v225 offset:19968
  v_cvt_pk_bf16_f32 v90, v204, v205
  v_exp_f32 v207, v47
  s_waitcnt lgkmcnt(14)
  v_mfma_f32_32x32x16_bf16 v[8:23], a[156:159], v[164:167], v[8:23]
  ds_read_b64_tr_b16 a[188:189], v225 offset:23552
  ds_read_b64_tr_b16 a[190:191], v225 offset:24064
  v_add_f32 v210, v210, v206
  v_exp_f32 v200, v48
  v_add_f32 v210, v210, v207
  v_mfma_f32_32x32x16_bf16 v[24:39], a[128:131], v[168:171], v[120:135]
  v_cvt_pk_bf16_f32 v91, v206, v207
  v_exp_f32 v201, v49
  v_add_f32 v210, v210, v200
  v_mfma_f32_32x32x16_bf16 v[24:39], a[132:135], v[172:175], v[24:39]
  v_exp_f32 v202, v50
  v_add_f32 v210, v210, v201
  v_mfma_f32_32x32x16_bf16 v[24:39], a[136:139], v[176:179], v[24:39]
  v_cvt_pk_bf16_f32 v92, v200, v201
  v_exp_f32 v203, v51
  v_add_f32 v210, v210, v202
  s_add_u32 m0, s63, 960
  s_nop 0
  buffer_load_dwordx4 v221, s[20:23], s65 offen offset:64  lds
  v_mfma_f32_32x32x16_bf16 v[24:39], a[140:143], v[180:183], v[24:39]
  v_exp_f32 v204, v52
  v_add_f32 v210, v210, v203
  v_mfma_f32_32x32x16_bf16 v[24:39], a[144:147], v[184:187], v[24:39]
  v_cvt_pk_bf16_f32 v93, v202, v203
  v_exp_f32 v205, v53
  v_add_f32 v210, v210, v204
  v_mfma_f32_32x32x16_bf16 v[24:39], a[148:151], v[188:191], v[24:39]
  v_exp_f32 v206, v54
  v_add_f32 v210, v210, v205
  v_cvt_pk_bf16_f32 v94, v204, v205
  v_mfma_f32_32x32x16_bf16 v[24:39], a[152:155], v[192:195], v[24:39]
  v_exp_f32 v207, v55
  v_add_f32 v210, v210, v206
  v_mfma_f32_32x32x16_bf16 v[24:39], a[156:159], v[196:199], v[24:39]
  v_exp_f32 v200, v56
  v_add_f32 v210, v210, v207
  v_cvt_pk_bf16_f32 v95, v206, v207
  s_add_u32 m0, s63, 1920
  s_nop 0
  buffer_load_dwordx4 v221, s[20:23], s65 offen offset:128  lds
  s_waitcnt lgkmcnt(14)
  v_mfma_f32_32x32x16_bf16 a[0:15], a[160:163], v[72:75], a[0:15]
  ds_read_b128 a[128:131], v227 offset:40960
  v_exp_f32 v201, v57
  v_add_f32 v211, v209, v200
  s_waitcnt lgkmcnt(13)
  v_mfma_f32_32x32x16_bf16 a[0:15], a[164:167], v[76:79], a[0:15]
  v_exp_f32 v202, v58
  v_add_f32 v211, v211, v201
  v_cvt_pk_bf16_f32 v96, v200, v201
  v_mfma_f32_32x32x16_bf16 a[16:31], a[160:163], v[80:83], a[16:31]
  ds_read_b128 a[132:135], v229 offset:40960
  v_exp_f32 v203, v59
  v_add_f32 v211, v211, v202
  v_mfma_f32_32x32x16_bf16 a[16:31], a[164:167], v[84:87], a[16:31]
  v_exp_f32 v204, v60
  v_add_f32 v211, v211, v203
  v_cvt_pk_bf16_f32 v97, v202, v203
  s_waitcnt lgkmcnt(12)
  v_mfma_f32_32x32x16_bf16 a[32:47], a[168:171], v[72:75], a[32:47]
  ds_read_b128 a[136:139], v227 offset:43008
  v_exp_f32 v205, v61
  v_add_f32 v211, v211, v204
  s_add_u32 m0, s63, 2880
  s_nop 0
  buffer_load_dwordx4 v221, s[20:23], s65 offen offset:192  lds
  s_waitcnt lgkmcnt(11)
  v_mfma_f32_32x32x16_bf16 a[32:47], a[172:175], v[76:79], a[32:47]
  v_exp_f32 v206, v62
  v_add_f32 v211, v211, v205
  v_cvt_pk_bf16_f32 v98, v204, v205
  v_mfma_f32_32x32x16_bf16 a[48:63], a[168:171], v[80:83], a[48:63]
  ds_read_b128 a[140:143], v229 offset:43008
  v_exp_f32 v207, v63
  v_add_f32 v211, v211, v206
  v_exp_f32 v200, v64
  v_mfma_f32_32x32x16_bf16 a[48:63], a[172:175], v[84:87], a[48:63]
  v_add_f32 v211, v211, v207
  v_cvt_pk_bf16_f32 v99, v206, v207
  s_waitcnt lgkmcnt(10)
  v_mfma_f32_32x32x16_bf16 a[64:79], a[176:179], v[72:75], a[64:79]
  ds_read_b128 a[144:147], v227 offset:45056
  v_exp_f32 v201, v65
  v_add_f32 v211, v211, v200
  v_exp_f32 v202, v66
  s_waitcnt lgkmcnt(9)
  v_mfma_f32_32x32x16_bf16 a[64:79], a[180:183], v[76:79], a[64:79]
  v_add_f32 v211, v211, v201
  v_cvt_pk_bf16_f32 v100, v200, v201
  v_mfma_f32_32x32x16_bf16 a[80:95], a[176:179], v[80:83], a[80:95]
  ds_read_b128 a[148:151], v229 offset:45056
  v_exp_f32 v203, v67
  v_add_f32 v211, v211, v202
  v_exp_f32 v204, v68
  v_mfma_f32_32x32x16_bf16 a[80:95], a[180:183], v[84:87], a[80:95]
  v_add_f32 v211, v211, v203
  v_cvt_pk_bf16_f32 v101, v202, v203
  v_exp_f32 v205, v69
  s_waitcnt lgkmcnt(8)
  v_mfma_f32_32x32x16_bf16 a[96:111], a[184:187], v[72:75], a[96:111]
  ds_read_b128 a[152:155], v227 offset:47104
  v_add_f32 v211, v211, v204
  v_exp_f32 v206, v70
  s_waitcnt lgkmcnt(7)
  v_mfma_f32_32x32x16_bf16 a[96:111], a[188:191], v[76:79], a[96:111]
  v_add_f32 v211, v211, v205
  v_cvt_pk_bf16_f32 v102, v204, v205
  v_exp_f32 v207, v71
  v_mfma_f32_32x32x16_bf16 a[112:127], a[184:187], v[80:83], a[112:127]
  ds_read_b128 a[156:159], v229 offset:47104
  v_add_f32 v211, v211, v206
  v_add_f32 v211, v211, v207
  v_cvt_pk_bf16_f32 v103, v206, v207
  v_cmp_nle_f32 s[68:69], v210, s66
  v_cmp_nle_f32 s[70:71], v211, s66
  v_mfma_f32_32x32x16_bf16 a[112:127], a[188:191], v[84:87], a[112:127]
  s_or_b64 s[68:69], s[68:69], s[70:71]
  s_cbranch_scc1 k2_fb12
k2_ret13:
  s_waitcnt lgkmcnt(7)
  s_nop 0
  v_mfma_f32_32x32x16_bf16 v[40:55], a[128:131], v[136:139], v[104:119]
  ds_read_b64_tr_b16 a[160:161], v225 offset:24576
  ds_read_b64_tr_b16 a[162:163], v225 offset:25088
  v_exp_f32 v200, v8
  v_exp_f32 v201, v9
  s_waitcnt lgkmcnt(8)
  v_mfma_f32_32x32x16_bf16 v[40:55], a[132:135], v[140:143], v[40:55]
  ds_read_b64_tr_b16 a[164:165], v225 offset:28672
  ds_read_b64_tr_b16 a[166:167], v225 offset:29184
  v_add_f32 v208, v210, v200
  v_exp_f32 v202, v10
  s_waitcnt lgkmcnt(9)
  v_mfma_f32_32x32x16_bf16 v[40:55], a[136:139], v[144:147], v[40:55]
  ds_read_b64_tr_b16 a[168:169], v225 offset:25600
  ds_read_b64_tr_b16 a[170:171], v225 offset:26112
  v_add_f32 v208, v208, v201
  v_cvt_pk_bf16_f32 v72, v200, v201
  v_exp_f32 v203, v11
  s_waitcnt lgkmcnt(10)
  v_mfma_f32_32x32x16_bf16 v[40:55], a[140:143], v[148:151], v[40:55]
  ds_read_b64_tr_b16 a[172:173], v225 offset:29696
  ds_read_b64_tr_b16 a[174:175], v225 offset:30208
  v_add_f32 v208, v208, v202
  v_exp_f32 v204, v12
  s_waitcnt lgkmcnt(11)
  v_mfma_f32_32x32x16_bf16 v[40:55], a[144:147], v[152:155], v[40:55]
  ds_read_b64_tr_b16 a[176:177], v225 offset:26624
  ds_read_b64_tr_b16 a[178:179], v225 offset:27136
  v_add_f32 v208, v208, v203
  v_cvt_pk_bf16_f32 v73, v202, v203
  v_exp_f32 v205, v13
  s_waitcnt lgkmcnt(12)
  v_mfma_f32_32x32x16_bf16 v[40:55], a[148:151], v[156:159], v[40:55]
  ds_read_b64_tr_b16 a[180:181], v225 offset:30720
  ds_read_b64_tr_b16 a[182:183], v225 offset:31232
  v_add_f32 v208, v208, v204
  v_exp_f32 v206, v14
  v_add_f32 v208, v208, v205
  s_waitcnt lgkmcnt(13)
  v_mfma_f32_32x32x16_bf16 v[40:55], a[152:155], v[160:163], v[40:55]
  ds_read_b64_tr_b16 a[184:185], v225 offset:27648
  ds_read_b64_tr_b16 a[186:187], v225 offset:28160
  v_cvt_pk_bf16_f32 v74, v204, v205
  v_exp_f32 v207, v15
  s_waitcnt lgkmcnt(14)
  v_mfma_f32_32x32x16_bf16 v[40:55], a[156:159], v[164:167], v[40:55]
  ds_read_b64_tr_b16 a[188:189], v225 offset:31744
  ds_read_b64_tr_b16 a[190:191], v225 offset:32256
  v_add_f32 v208, v208, v206
  v_exp_f32 v200, v16
  v_add_f32 v208, v208, v207
  v_mfma_f32_32x32x16_bf16 v[56:71], a[128:131], v[168:171], v[120:135]
  v_cvt_pk_bf16_f32 v75, v206, v207
  v_exp_f32 v201, v17
  v_add_f32 v208, v208, v200
  v_mfma_f32_32x32x16_bf16 v[56:71], a[132:135], v[172:175], v[56:71]
  v_exp_f32 v202, v18
  v_add_f32 v208, v208, v201
  v_mfma_f32_32x32x16_bf16 v[56:71], a[136:139], v[176:179], v[56:71]
  v_cvt_pk_bf16_f32 v76, v200, v201
  v_exp_f32 v203, v19
  v_add_f32 v208, v208, v202
  v_mfma_f32_32x32x16_bf16 v[56:71], a[140:143], v[180:183], v[56:71]
  v_exp_f32 v204, v20
  v_add_f32 v208, v208, v203
  v_mfma_f32_32x32x16_bf16 v[56:71], a[144:147], v[184:187], v[56:71]
  v_cvt_pk_bf16_f32 v77, v202, v203
  v_exp_f32 v205, v21
  v_add_f32 v208, v208, v204
  v_mfma_f32_32x32x16_bf16 v[56:71], a[148:151], v[188:191], v[56:71]
  v_exp_f32 v206, v22
  v_add_f32 v208, v208, v205
  v_cvt_pk_bf16_f32 v78, v204, v205
  v_mfma_f32_32x32x16_bf16 v[56:71], a[152:155], v[192:195], v[56:71]
  v_exp_f32 v207, v23
  v_add_f32 v208, v208, v206
  v_mfma_f32_32x32x16_bf16 v[56:71], a[156:159], v[196:199], v[56:71]
  v_exp_f32 v200, v24
  v_add_f32 v208, v208, v207
  v_cvt_pk_bf16_f32 v79, v206, v207
  s_waitcnt vmcnt(8)
  s_barrier
  s_waitcnt lgkmcnt(14)
  v_mfma_f32_32x32x16_bf16 a[0:15], a[160:163], v[88:91], a[0:15]
  ds_read_b128 a[128:131], v226 offset:0
  v_exp_f32 v201, v25
  v_add_f32 v209, v211, v200
  s_waitcnt lgkmcnt(13)
  v_mfma_f32_32x32x16_bf16 a[0:15], a[164:167], v[92:95], a[0:15]
  v_exp_f32 v202, v26
  v_add_f32 v209, v209, v201
  v_cvt_pk_bf16_f32 v80, v200, v201
  s_add_u32 m0, s62, 65536
  s_add_u32 s64, s61, 98304
  buffer_load_dwordx4 v220, s[16:19], s64 offen offset:0  lds
  v_mfma_f32_32x32x16_bf16 a[16:31], a[160:163], v[96:99], a[16:31]
  ds_read_b128 a[132:135], v228 offset:0
  v_exp_f32 v203, v27
  v_add_f32 v209, v209, v202
  v_mfma_f32_32x32x16_bf16 a[16:31], a[164:167], v[100:103], a[16:31]
  v_exp_f32 v204, v28
  v_add_f32 v209, v209, v203
  v_cvt_pk_bf16_f32 v81, v202, v203
  s_waitcnt lgkmcnt(12)
  v_mfma_f32_32x32x16_bf16 a[32:47], a[168:171], v[88:91], a[32:47]
  ds_read_b128 a[136:139], v226 offset:2048
  v_exp_f32 v205, v29
  v_add_f32 v209, v209, v204
  s_waitcnt lgkmcnt(11)
  v_mfma_f32_32x32x16_bf16 a[32:47], a[172:175], v[92:95], a[32:47]
  v_exp_f32 v206, v30
  v_add_f32 v209, v209, v205
  v_cvt_pk_bf16_f32 v82, v204, v205
  v_mfma_f32_32x32x16_bf16 a[48:63], a[168:171], v[96:99], a[48:63]
  ds_read_b128 a[140:143], v228 offset:2048
  v_exp_f32 v207, v31
  v_add_f32 v209, v209, v206
  v_exp_f32 v200, v32
  s_add_u32 m0, s62, 67520
  s_nop 0
  buffer_load_dwordx4 v220, s[16:19], s64 offen offset:64  lds
  v_mfma_f32_32x32x16_bf16 a[48:63], a[172:175], v[100:103], a[48:63]
  v_add_f32 v209, v209, v207
  v_cvt_pk_bf16_f32 v83, v206, v207
  s_waitcnt lgkmcnt(10)
  v_mfma_f32_32x32x16_bf16 a[64:79], a[176:179], v[88:91], a[64:79]
  ds_read_b128 a[144:147], v226 offset:4096
  v_exp_f32 v201, v33
  v_add_f32 v209, v209, v200
  v_exp_f32 v202, v34
  s_waitcnt lgkmcnt(9)
  v_mfma_f32_32x32x16_bf16 a[64:79], a[180:183], v[92:95], a[64:79]
  v_add_f32 v209, v209, v201
  v_cvt_pk_bf16_f32 v84, v200, v201
  v_mfma_f32_32x32x16_bf16 a[80:95], a[176:179], v[96:99], a[80:95]
  ds_read_b128 a[148:151], v228 offset:4096
  v_exp_f32 v203, v35
  v_add_f32 v209, v209, v202
  v_exp_f32 v204, v36
  v_mfma_f32_32x32x16_bf16 a[80:95], a[180:183], v[100:103], a[80:95]
  v_add_f32 v209, v209, v203
  v_cvt_pk_bf16_f32 v85, v202, v203
  v_exp_f32 v205, v37
  s_add_u32 m0, s62, 69504
  s_nop 0
  buffer_load_dwordx4 v220, s[16:19], s64 offen offset:128  lds
  s_waitcnt lgkmcnt(8)
  v_mfma_f32_32x32x16_bf16 a[96:111], a[184:187], v[88:91], a[96:111]
  ds_read_b128 a[152:155], v226 offset:6144
  v_add_f32 v209, v209, v204
  v_exp_f32 v206, v38
  s_waitcnt lgkmcnt(7)
  v_mfma_f32_32x32x16_bf16 a[96:111], a[188:191], v[92:95], a[96:111]
  v_add_f32 v209, v209, v205
  v_cvt_pk_bf16_f32 v86, v204, v205
  v_exp_f32 v207, v39
  v_mfma_f32_32x32x16_bf16 a[112:127], a[184:187], v[96:99], a[112:127]
  ds_read_b128 a[156:159], v228 offset:6144
  v_add_f32 v209, v209, v206
  v_add_f32 v209, v209, v207
  v_cvt_pk_bf16_f32 v87, v206, v207
  v_cmp_nle_f32 s[68:69], v208, s66
  v_cmp_nle_f32 s[70:71], v209, s66
  v_mfma_f32_32x32x16_bf16 a[112:127], a[188:191], v[100:103], a[112:127]
  s_or_b64 s[68:69], s[68:69], s[70:71]
  s_cbranch_scc1 k2_fb14
k2_ret15:
  s_waitcnt lgkmcnt(7)
  s_nop 0
  v_mfma_f32_32x32x16_bf16 v[8:23], a[128:131], v[136:139], v[104:119]
  ds_read_b64_tr_b16 a[160:161], v225 offset:49152
  ds_read_b64_tr_b16 a[162:163], v225 offset:49664
  v_exp_f32 v200, v40
  v_exp_f32 v201, v41
  s_add_u32 m0, s62, 71488
  s_nop 0
  buffer_load_dwordx4 v220, s[16:19], s64 offen offset:192  lds
  s_waitcnt lgkmcnt(8)
  v_mfma_f32_32x32x16_bf16 v[8:23], a[132:135], v[140:143], v[8:23]
  ds_read_b64_tr_b16 a[164:165], v225 offset:53248
  ds_read_b64_tr_b16 a[166:167], v225 offset:53760
  v_add_f32 v210, v208, v200
  v_exp_f32 v202, v42
  s_waitcnt lgkmcnt(9)
  v_mfma_f32_32x32x16_bf16 v[8:23], a[136:139], v[144:147], v[8:23]
  ds_read_b64_tr_b16 a[168:169], v225 offset:50176
  ds_read_b64_tr_b16 a[170:171], v225 offset:50688
  v_add_f32 v210, v210, v201
  v_cvt_pk_bf16_f32 v88, v200, v201
  v_exp_f32 v203, v43
  s_waitcnt lgkmcnt(10)
  v_mfma_f32_32x32x16_bf16 v[8:23], a[140:143], v[148:151], v[8:23]
  ds_read_b64_tr_b16 a[172:173], v225 offset:54272
  ds_read_b64_tr_b16 a[174:175], v225 offset:54784
  v_add_f32 v210, v210, v202
  v_exp_f32 v204, v44
  s_waitcnt lgkmcnt(11)
  v_mfma_f32_32x32x16_bf16 v[8:23], a[144:147], v[152:155], v[8:23]
  ds_read_b64_tr_b16 a[176:177], v225 offset:51200
  ds_read_b64_tr_b16 a[178:179], v225 offset:51712
  v_add_f32 v210, v210, v203
  v_cvt_pk_bf16_f32 v89, v202, v203
  v_exp_f32 v205, v45
  s_waitcnt lgkmcnt(12)
  v_mfma_f32_32x32x16_bf16 v[8:23], a[148:151], v[156:159], v[8:23]
  ds_read_b64_tr_b16 a[180:181], v225 offset:55296
  ds_read_b64_tr_b16 a[182:183], v225 offset:55808
  v_add_f32 v210, v210, v204
  v_exp_f32 v206, v46
  v_add_f32 v210, v210, v205
  s_add_u32 m0, s63, 32768
  s_add_u32 s65, s61, 81920
  buffer_load_dwordx4 v221, s[20:23], s65 offen offset:0  lds
  s_waitcnt lgkmcnt(13)
  v_mfma_f32_32x32x16_bf16 v[8:23], a[152:155], v[160:163], v[8:23]
  ds_read_b64_tr_b16 a[184:185], v225 offset:52224
  ds_read_b64_tr_b16 a[186:187], v225 offset:52736
  v_cvt_pk_bf16_f32 v90, v204, v205
  v_exp_f32 v207, v47
  s_waitcnt lgkmcnt(14)
  v_mfma_f32_32x32x16_bf16 v[8:23], a[156:159], v[164:167], v[8:23]
  ds_read_b64_tr_b16 a[188:189], v225 offset:56320
  ds_read_b64_tr_b16 a[190:191], v225 offset:56832
  v_add_f32 v210, v210, v206
  v_exp_f32 v200, v48
  v_add_f32 v210, v210, v207
  v_mfma_f32_32x32x16_bf16 v[24:39], a[128:131], v[168:171], v[120:135]
  v_cvt_pk_bf16_f32 v91, v206, v207
  v_exp_f32 v201, v49
  v_add_f32 v210, v210, v200
  v_mfma_f32_32x32x16_bf16 v[24:39], a[132:135], v[172:175], v[24:39]
  v_exp_f32 v202, v50
  v_add_f32 v210, v210, v201
  v_mfma_f32_32x32x16_bf16 v[24:39], a[136:139], v[176:179], v[24:39]
  v_cvt_pk_bf16_f32 v92, v200, v201
  v_exp_f32 v203, v51
  v_add_f32 v210, v210, v202
  s_add_u32 m0, s63, 33728
  s_nop 0
  buffer_load_dwordx4 v221, s[20:23], s65 offen offset:64  lds
  v_mfma_f32_32x32x16_bf16 v[24:39], a[140:143], v[180:183], v[24:39]
  v_exp_f32 v204, v52
  v_add_f32 v210, v210, v203
  v_mfma_f32_32x32x16_bf16 v[24:39], a[144:147], v[184:187], v[24:39]
  v_cvt_pk_bf16_f32 v93, v202, v203
  v_exp_f32 v205, v53
  v_add_f32 v210, v210, v204
  v_mfma_f32_32x32x16_bf16 v[24:39], a[148:151], v[188:191], v[24:39]
  v_exp_f32 v206, v54
  v_add_f32 v210, v210, v205
  v_cvt_pk_bf16_f32 v94, v204, v205
  v_mfma_f32_32x32x16_bf16 v[24:39], a[152:155], v[192:195], v[24:39]
  v_exp_f32 v207, v55
  v_add_f32 v210, v210, v206
  v_mfma_f32_32x32x16_bf16 v[24:39], a[156:159], v[196:199], v[24:39]
  v_exp_f32 v200, v56
  v_add_f32 v210, v210, v207
  v_cvt_pk_bf16_f32 v95, v206, v207
  s_add_u32 m0, s63, 34688
  s_nop 0
  buffer_load_dwordx4 v221, s[20:23], s65 offen offset:128  lds
  s_waitcnt lgkmcnt(14)
  v_mfma_f32_32x32x16_bf16 a[0:15], a[160:163], v[72:75], a[0:15]
  ds_read_b128 a[128:131], v226 offset:8192
  v_exp_f32 v201, v57
  v_add_f32 v211, v209, v200
  s_waitcnt lgkmcnt(13)
  v_mfma_f32_32x32x16_bf16 a[0:15], a[164:167], v[76:79], a[0:15]
  v_exp_f32 v202, v58
  v_add_f32 v211, v211, v201
  v_cvt_pk_bf16_f32 v96, v200, v201
  v_mfma_f32_32x32x16_bf16 a[16:31], a[160:163], v[80:83], a[16:31]
  ds_read_b128 a[132:135], v228 offset:8192
  v_exp_f32 v203, v59
  v_add_f32 v211, v211, v202
  v_mfma_f32_32x32x16_bf16 a[16:31], a[164:167], v[84:87], a[16:31]
  v_exp_f32 v204, v60
  v_add_f32 v211, v211, v203
  v_cvt_pk_bf16_f32 v97, v202, v203
  s_waitcnt lgkmcnt(12)
  v_mfma_f32_32x32x16_bf16 a[32:47], a[168:171], v[72:75], a[32:47]
  ds_read_b128 a[136:139], v226 offset:10240
  v_exp_f32 v205, v61
  v_add_f32 v211, v211, v204
  s_add_u32 m0, s63, 35648
  s_nop 0
  buffer_load_dwordx4 v221, s[20:23], s65 offen offset:192  lds
  s_waitcnt lgkmcnt(11)
  v_mfma_f32_32x32x16_bf16 a[32:47], a[172:175], v[76:79], a[32:47]
  v_exp_f32 v206, v62
  v_add_f32 v211, v211, v205
  v_cvt_pk_bf16_f32 v98, v204, v205
  v_mfma_f32_32x32x16_bf16 a[48:63], a[168:171], v[80:83], a[48:63]
  ds_read_b128 a[140:143], v228 offset:10240
  v_exp_f32 v207, v63
  v_add_f32 v211, v211, v206
  v_exp_f32 v200, v64
  v_mfma_f32_32x32x16_bf16 a[48:63], a[172:175], v[84:87], a[48:63]
  v_add_f32 v211, v211, v207
  v_cvt_pk_bf16_f32 v99, v206, v207
  s_waitcnt lgkmcnt(10)
  v_mfma_f32_32x32x16_bf16 a[64:79], a[176:179], v[72:75], a[64:79]
  ds_read_b128 a[144:147], v226 offset:12288
  v_exp_f32 v201, v65
  v_add_f32 v211, v211, v200
  v_exp_f32 v202, v66
  s_waitcnt lgkmcnt(9)
  v_mfma_f32_32x32x16_bf16 a[64:79], a[180:183], v[76:79], a[64:79]
  v_add_f32 v211, v211, v201
  v_cvt_pk_bf16_f32 v100, v200, v201
  v_mfma_f32_32x32x16_bf16 a[80:95], a[176:179], v[80:83], a[80:95]
  ds_read_b128 a[148:151], v228 offset:12288
  v_exp_f32 v203, v67
  v_add_f32 v211, v211, v202
  v_exp_f32 v204, v68
  v_mfma_f32_32x32x16_bf16 a[80:95], a[180:183], v[84:87], a[80:95]
  v_add_f32 v211, v211, v203
  v_cvt_pk_bf16_f32 v101, v202, v203
  v_exp_f32 v205, v69
  s_waitcnt lgkmcnt(8)
  v_mfma_f32_32x32x16_bf16 a[96:111], a[184:187], v[72:75], a[96:111]
  ds_read_b128 a[152:155], v226 offset:14336
  v_add_f32 v211, v211, v204
  v_exp_f32 v206, v70
  s_waitcnt lgkmcnt(7)
  v_mfma_f32_32x32x16_bf16 a[96:111], a[188:191], v[76:79], a[96:111]
  v_add_f32 v211, v211, v205
  v_cvt_pk_bf16_f32 v102, v204, v205
  v_exp_f32 v207, v71
  v_mfma_f32_32x32x16_bf16 a[112:127], a[184:187], v[80:83], a[112:127]
  ds_read_b128 a[156:159], v228 offset:14336
  v_add_f32 v211, v211, v206
  v_add_f32 v211, v211, v207
  v_cvt_pk_bf16_f32 v103, v206, v207
  v_cmp_nle_f32 s[68:69], v210, s66
  v_cmp_nle_f32 s[70:71], v211, s66
  v_mfma_f32_32x32x16_bf16 a[112:127], a[188:191], v[84:87], a[112:127]
  s_or_b64 s[68:69], s[68:69], s[70:71]
  s_cbranch_scc1 k2_fb16
k2_ret17:
  s_waitcnt lgkmcnt(7)
  s_nop 0
  v_mfma_f32_32x32x16_bf16 v[40:55], a[128:131], v[136:139], v[104:119]
  ds_read_b64_tr_b16 a[160:161], v225 offset:57344
  ds_read_b64_tr_b16 a[162:163], v225 offset:57856
  v_exp_f32 v200, v8
  v_exp_f32 v201, v9
  s_waitcnt lgkmcnt(8)
  v_mfma_f32_32x32x16_bf16 v[40:55], a[132:135], v[140:143], v[40:55]
  ds_read_b64_tr_b16 a[164:165], v225 offset:61440
  ds_read_b64_tr_b16 a[166:167], v225 offset:61952
  v_add_f32 v208, v210, v200
  v_exp_f32 v202, v10
  s_waitcnt lgkmcnt(9)
  v_mfma_f32_32x32x16_bf16 v[40:55], a[136:139], v[144:147], v[40:55]
  ds_read_b64_tr_b16 a[168:169], v225 offset:58368
  ds_read_b64_tr_b16 a[170:171], v225 offset:58880
  v_add_f32 v208, v208, v201
  v_cvt_pk_bf16_f32 v72, v200, v201
  v_exp_f32 v203, v11
  s_waitcnt lgkmcnt(10)
  v_mfma_f32_32x32x16_bf16 v[40:55], a[140:143], v[148:151], v[40:55]
  ds_read_b64_tr_b16 a[172:173], v225 offset:62464
  ds_read_b64_tr_b16 a[174:175], v225 offset:62976
  v_add_f32 v208, v208, v202
  v_exp_f32 v204, v12
  s_waitcnt lgkmcnt(11)
  v_mfma_f32_32x32x16_bf16 v[40:55], a[144:147], v[152:155], v[40:55]
  ds_read_b64_tr_b16 a[176:177], v225 offset:59392
  ds_read_b64_tr_b16 a[178:179], v225 offset:59904
  v_add_f32 v208, v208, v203
  v_cvt_pk_bf16_f32 v73, v202, v203
  v_exp_f32 v205, v13
  s_waitcnt lgkmcnt(12)
  v_mfma_f32_32x32x16_bf16 v[40:55], a[148:151], v[156:159], v[40:55]
  ds_read_b64_tr_b16 a[180:181], v225 offset:63488
  ds_read_b64_tr_b16 a[182:183], v225 offset:64000
  v_add_f32 v208, v208, v204
  v_exp_f32 v206, v14
  v_add_f32 v208, v208, v205
  s_waitcnt lgkmcnt(13)
  v_mfma_f32_32x32x16_bf16 v[40:55], a[152:155], v[160:163], v[40:55]
  ds_read_b64_tr_b16 a[184:185], v225 offset:60416
  ds_read_b64_tr_b16 a[186:187], v225 offset:60928
  v_cvt_pk_bf16_f32 v74, v204, v205
  v_exp_f32 v207, v15
  s_waitcnt lgkmcnt(14)
  v_mfma_f32_32x32x16_bf16 v[40:55], a[156:159], v[164:167], v[40:55]
  ds_read_b64_tr_b16 a[188:189], v225 offset:64512
  ds_read_b64_tr_b16 a[190:191], v225 offset:65024
  v_add_f32 v208, v208, v206
  v_exp_f32 v200, v16
  v_add_f32 v208, v208, v207
  v_mfma_f32_32x32x16_bf16 v[56:71], a[128:131], v[168:171], v[120:135]
  v_cvt_pk_bf16_f32 v75, v206, v207
  v_exp_f32 v201, v17
  v_add_f32 v208, v208, v200
  v_mfma_f32_32x32x16_bf16 v[56:71], a[132:135], v[172:175], v[56:71]
  v_exp_f32 v202, v18
  v_add_f32 v208, v208, v201
  v_mfma_f32_32x32x16_bf16 v[56:71], a[136:139], v[176:179], v[56:71]
  v_cvt_pk_bf16_f32 v76, v200, v201
  v_exp_f32 v203, v19
  v_add_f32 v208, v208, v202
  v_mfma_f32_32x32x16_bf16 v[56:71], a[140:143], v[180:183], v[56:71]
  v_exp_f32 v204, v20
  v_add_f32 v208, v208, v203
  v_mfma_f32_32x32x16_bf16 v[56:71], a[144:147], v[184:187], v[56:71]
  v_cvt_pk_bf16_f32 v77, v202, v203
  v_exp_f32 v205, v21
  v_add_f32 v208, v208, v204
  v_mfma_f32_32x32x16_bf16 v[56:71], a[148:151], v[188:191], v[56:71]
  v_exp_f32 v206, v22
  v_add_f32 v208, v208, v205
  v_cvt_pk_bf16_f32 v78, v204, v205
  v_mfma_f32_32x32x16_bf16 v[56:71], a[152:155], v[192:195], v[56:71]
  v_exp_f32 v207, v23
  v_add_f32 v208, v208, v206
  v_mfma_f32_32x32x16_bf16 v[56:71], a[156:159], v[196:199], v[56:71]
  v_exp_f32 v200, v24
  v_add_f32 v208, v208, v207
  v_cvt_pk_bf16_f32 v79, v206, v207
  s_waitcnt vmcnt(8)
  s_barrier
  s_waitcnt lgkmcnt(14)
  v_mfma_f32_32x32x16_bf16 a[0:15], a[160:163], v[88:91], a[0:15]
  ds_read_b128 a[128:131], v226 offset:32768
  v_exp_f32 v201, v25
  v_add_f32 v209, v211, v200
  s_waitcnt lgkmcnt(13)
  v_mfma_f32_32x32x16_bf16 a[0:15], a[164:167], v[92:95], a[0:15]
  v_exp_f32 v202, v26
  v_add_f32 v209, v209, v201
  v_cvt_pk_bf16_f32 v80, v200, v201
  s_add_u32 m0, s62, 98304
  s_add_u32 s64, s61, 114688
  buffer_load_dwordx4 v220, s[16:19], s64 offen offset:0  lds
  v_mfma_f32_32x32x16_bf16 a[16:31], a[160:163], v[96:99], a[16:31]
  ds_read_b128 a[132:135], v228 offset:32768
  v_exp_f32 v203, v27
  v_add_f32 v209, v209, v202
  v_mfma_f32_32x32x16_bf16 a[16:31], a[164:167], v[100:103], a[16:31]
  v_exp_f32 v204, v28
  v_add_f32 v209, v209, v203
  v_cvt_pk_bf16_f32 v81, v202, v203
  s_waitcnt lgkmcnt(12)
  v_mfma_f32_32x32x16_bf16 a[32:47], a[168:171], v[88:91], a[32:47]
  ds_read_b128 a[136:139], v226 offset:34816
  v_exp_f32 v205, v29
  v_add_f32 v209, v209, v204
  s_waitcnt lgkmcnt(11)
  v_mfma_f32_32x32x16_bf16 a[32:47], a[172:175], v[92:95], a[32:47]
  v_exp_f32 v206, v30
  v_add_f32 v209, v209, v205
  v_cvt_pk_bf16_f32 v82, v204, v205
  v_mfma_f32_32x32x16_bf16 a[48:63], a[168:171], v[96:99], a[48:63]
  ds_read_b128 a[140:143], v228 offset:34816
  v_exp_f32 v207, v31
  v_add_f32 v209, v209, v206
  v_exp_f32 v200, v32
  s_add_u32 m0, s62, 100288
  s_nop 0
  buffer_load_dwordx4 v220, s[16:19], s64 offen offset:64  lds
  v_mfma_f32_32x32x16_bf16 a[48:63], a[172:175], v[100:103], a[48:63]
  v_add_f32 v209, v209, v207
  v_cvt_pk_bf16_f32 v83, v206, v207
  s_waitcnt lgkmcnt(10)
  v_mfma_f32_32x32x16_bf16 a[64:79], a[176:179], v[88:91], a[64:79]
  ds_read_b128 a[144:147], v226 offset:36864
  v_exp_f32 v201, v33
  v_add_f32 v209, v209, v200
  v_exp_f32 v202, v34
  s_waitcnt lgkmcnt(9)
  v_mfma_f32_32x32x16_bf16 a[64:79], a[180:183], v[92:95], a[64:79]
  v_add_f32 v209, v209, v201
  v_cvt_pk_bf16_f32 v84, v200, v201
  v_mfma_f32_32x32x16_bf16 a[80:95], a[176:179], v[96:99], a[80:95]
  ds_read_b128 a[148:151], v228 offset:36864
  v_exp_f32 v203, v35
  v_add_f32 v209, v209, v202
  v_exp_f32 v204, v36
  v_mfma_f32_32x32x16_bf16 a[80:95], a[180:183], v[100:103], a[80:95]
  v_add_f32 v209, v209, v203
  v_cvt_pk_bf16_f32 v85, v202, v203
  v_exp_f32 v205, v37
  s_add_u32 m0, s62, 102272
  s_nop 0
  buffer_load_dwordx4 v220, s[16:19], s64 offen offset:128  lds
  s_waitcnt lgkmcnt(8)
  v_mfma_f32_32x32x16_bf16 a[96:111], a[184:187], v[88:91], a[96:111]
  ds_read_b128 a[152:155], v226 offset:38912
  v_add_f32 v209, v209, v204
  v_exp_f32 v206, v38
  s_waitcnt lgkmcnt(7)
  v_mfma_f32_32x32x16_bf16 a[96:111], a[188:191], v[92:95], a[96:111]
  v_add_f32 v209, v209, v205
  v_cvt_pk_bf16_f32 v86, v204, v205
  v_exp_f32 v207, v39
  v_mfma_f32_32x32x16_bf16 a[112:127], a[184:187], v[96:99], a[112:127]
  ds_read_b128 a[156:159], v228 offset:38912
  v_add_f32 v209, v209, v206
  v_add_f32 v209, v209, v207
  v_cvt_pk_bf16_f32 v87, v206, v207
  v_cmp_nle_f32 s[68:69], v208, s66
  v_cmp_nle_f32 s[70:71], v209, s66
  v_mfma_f32_32x32x16_bf16 a[112:127], a[188:191], v[100:103], a[112:127]
  s_or_b64 s[68:69], s[68:69], s[70:71]
  s_cbranch_scc1 k2_fb18
k2_ret19:
  s_waitcnt lgkmcnt(7)
  s_nop 0
  v_mfma_f32_32x32x16_bf16 v[8:23], a[128:131], v[136:139], v[104:119]
  ds_read_b64_tr_b16 a[160:161], v224 offset:16384
  ds_read_b64_tr_b16 a[162:163], v224 offset:16896
  v_exp_f32 v200, v40
  v_exp_f32 v201, v41
  s_add_u32 m0, s62, 104256
  s_nop 0
  buffer_load_dwordx4 v220, s[16:19], s64 offen offset:192  lds
  s_waitcnt lgkmcnt(8)
  v_mfma_f32_32x32x16_bf16 v[8:23], a[132:135], v[140:143], v[8:23]
  ds_read_b64_tr_b16 a[164:165], v224 offset:20480
  ds_read_b64_tr_b16 a[166:167], v224 offset:20992
  v_add_f32 v210, v208, v200
  v_exp_f32 v202, v42
  s_waitcnt lgkmcnt(9)
  v_mfma_f32_32x32x16_bf16 v[8:23], a[136:139], v[144:147], v[8:23]
  ds_read_b64_tr_b16 a[168:169], v224 offset:17408
  ds_read_b64_tr_b16 a[170:171], v224 offset:17920
  v_add_f32 v210, v210, v201
  v_cvt_pk_bf16_f32 v88, v200, v201
  v_exp_f32 v203, v43
  v_and_b32 v215, 15, v1
  s_waitcnt lgkmcnt(10)
  v_mfma_f32_32x32x16_bf16 v[8:23], a[140:143], v[148:151], v[8:23]
  ds_read_b64_tr_b16 a[172:173], v224 offset:21504
  ds_read_b64_tr_b16 a[174:175], v224 offset:22016
  v_add_f32 v210, v210, v202
  v_exp_f32 v204, v44
  v_min_u32 v215, 10, v215
  s_waitcnt lgkmcnt(11)
  v_mfma_f32_32x32x16_bf16 v[8:23], a[144:147], v[152:155], v[8:23]
  ds_read_b64_tr_b16 a[176:177], v224 offset:18432
  ds_read_b64_tr_b16 a[178:179], v224 offset:18944
  v_add_f32 v210, v210, v203
  v_cvt_pk_bf16_f32 v89, v202, v203
  v_exp_f32 v205, v45
  v_lshlrev_b32 v215, 6, v215
  s_waitcnt lgkmcnt(12)
  v_mfma_f32_32x32x16_bf16 v[8:23], a[148:151], v[156:159], v[8:23]
  ds_read_b64_tr_b16 a[180:181], v224 offset:22528
  ds_read_b64_tr_b16 a[182:183], v224 offset:23040
  v_add_f32 v210, v210, v204
  v_exp_f32 v206, v46
  v_add_f32 v210, v210, v205
  s_add_u32 m0, s63, 65536
  s_add_u32 s65, s61, 98304
  buffer_load_dwordx4 v221, s[20:23], s65 offen offset:0  lds
  v_lshrrev_b32 v216, 4, v1
  s_waitcnt lgkmcnt(13)
  v_mfma_f32_32x32x16_bf16 v[8:23], a[152:155], v[160:163], v[8:23]
  ds_read_b64_tr_b16 a[184:185], v224 offset:19456
  ds_read_b64_tr_b16 a[186:187], v224 offset:19968
  v_cvt_pk_bf16_f32 v90, v204, v205
  v_exp_f32 v207, v47
  v_mul_u32_u24 v216, 2752, v216
  s_waitcnt lgkmcnt(14)
  v_mfma_f32_32x32x16_bf16 v[8:23], a[156:159], v[164:167], v[8:23]
  ds_read_b64_tr_b16 a[188:189], v224 offset:23552
  ds_read_b64_tr_b16 a[190:191], v224 offset:24064
  v_add_f32 v210, v210, v206
  v_exp_f32 v200, v48
  v_add_f32 v210, v210, v207
  v_add_u32 v216, v216, v215
  v_mfma_f32_32x32x16_bf16 v[24:39], a[128:131], v[168:171], v[120:135]
  v_cvt_pk_bf16_f32 v91, v206, v207
  v_exp_f32 v201, v49
  v_add_f32 v210, v210, v200
  buffer_load_dword a196, v216, s[32:35], s44 offen
  v_mfma_f32_32x32x16_bf16 v[24:39], a[132:135], v[172:175], v[24:39]
  v_exp_f32 v202, v50
  v_add_f32 v210, v210, v201
  v_mfma_f32_32x32x16_bf16 v[24:39], a[136:139], v[176:179], v[24:39]
  v_cvt_pk_bf16_f32 v92, v200, v201
  v_exp_f32 v203, v51
  v_add_f32 v210, v210, v202
  s_add_u32 m0, s63, 66496
  s_nop 0
  buffer_load_dwordx4 v221, s[20:23], s65 offen offset:64  lds
  v_mfma_f32_32x32x16_bf16 v[24:39], a[140:143], v[180:183], v[24:39]
  v_exp_f32 v204, v52
  v_add_f32 v210, v210, v203
  v_mfma_f32_32x32x16_bf16 v[24:39], a[144:147], v[184:187], v[24:39]
  v_cvt_pk_bf16_f32 v93, v202, v203
  v_exp_f32 v205, v53
  v_add_f32 v210, v210, v204
  v_mfma_f32_32x32x16_bf16 v[24:39], a[148:151], v[188:191], v[24:39]
  v_exp_f32 v206, v54
  v_add_f32 v210, v210, v205
  v_cvt_pk_bf16_f32 v94, v204, v205
  v_mfma_f32_32x32x16_bf16 v[24:39], a[152:155], v[192:195], v[24:39]
  v_exp_f32 v207, v55
  v_add_f32 v210, v210, v206
  v_mfma_f32_32x32x16_bf16 v[24:39], a[156:159], v[196:199], v[24:39]
  v_exp_f32 v200, v56
  v_add_f32 v210, v210, v207
  v_cvt_pk_bf16_f32 v95, v206, v207
  s_add_u32 m0, s63, 67456
  s_nop 0
  buffer_load_dwordx4 v221, s[20:23], s65 offen offset:128  lds
  s_waitcnt lgkmcnt(14)
  v_mfma_f32_32x32x16_bf16 a[0:15], a[160:163], v[72:75], a[0:15]
  ds_read_b128 a[128:131], v226 offset:40960
  v_exp_f32 v201, v57
  v_add_f32 v211, v209, v200
  s_waitcnt lgkmcnt(13)
  v_mfma_f32_32x32x16_bf16 a[0:15], a[164:167], v[76:79], a[0:15]
  v_exp_f32 v202, v58
  v_add_f32 v211, v211, v201
  v_cvt_pk_bf16_f32 v96, v200, v201
  v_mfma_f32_32x32x16_bf16 a[16:31], a[160:163], v[80:83], a[16:31]
  ds_read_b128 a[132:135], v228 offset:40960
  v_exp_f32 v203, v59
  v_add_f32 v211, v211, v202
  v_mfma_f32_32x32x16_bf16 a[16:31], a[164:167], v[84:87], a[16:31]
  v_exp_f32 v204, v60
  v_add_f32 v211, v211, v203
  v_cvt_pk_bf16_f32 v97, v202, v203
  s_waitcnt lgkmcnt(12)
  v_mfma_f32_32x32x16_bf16 a[32:47], a[168:171], v[72:75], a[32:47]
  ds_read_b128 a[136:139], v226 offset:43008
  v_exp_f32 v205, v61
  v_add_f32 v211, v211, v204
  s_add_u32 m0, s63, 68416
  s_nop 0
  buffer_load_dwordx4 v221, s[20:23], s65 offen offset:192  lds
  s_waitcnt lgkmcnt(11)
  v_mfma_f32_32x32x16_bf16 a[32:47], a[172:175], v[76:79], a[32:47]
  v_exp_f32 v206, v62
  v_add_f32 v211, v211, v205
  v_cvt_pk_bf16_f32 v98, v204, v205
  v_mfma_f32_32x32x16_bf16 a[48:63], a[168:171], v[80:83], a[48:63]
  ds_read_b128 a[140:143], v228 offset:43008
  v_exp_f32 v207, v63
  v_add_f32 v211, v211, v206
  v_exp_f32 v200, v64
  v_mfma_f32_32x32x16_bf16 a[48:63], a[172:175], v[84:87], a[48:63]
  v_add_f32 v211, v211, v207
  v_cvt_pk_bf16_f32 v99, v206, v207
  s_waitcnt lgkmcnt(10)
  v_mfma_f32_32x32x16_bf16 a[64:79], a[176:179], v[72:75], a[64:79]
  ds_read_b128 a[144:147], v226 offset:45056
  v_exp_f32 v201, v65
  v_add_f32 v211, v211, v200
  v_exp_f32 v202, v66
  s_waitcnt lgkmcnt(9)
  v_mfma_f32_32x32x16_bf16 a[64:79], a[180:183], v[76:79], a[64:79]
  v_add_f32 v211, v211, v201
  v_cvt_pk_bf16_f32 v100, v200, v201
  v_mfma_f32_32x32x16_bf16 a[80:95], a[176:179], v[80:83], a[80:95]
  ds_read_b128 a[148:151], v228 offset:45056
  v_exp_f32 v203, v67
  v_add_f32 v211, v211, v202
  v_exp_f32 v204, v68
  v_mfma_f32_32x32x16_bf16 a[80:95], a[180:183], v[84:87], a[80:95]
  v_add_f32 v211, v211, v203
  v_cvt_pk_bf16_f32 v101, v202, v203
  v_exp_f32 v205, v69
  s_waitcnt lgkmcnt(8)
  v_mfma_f32_32x32x16_bf16 a[96:111], a[184:187], v[72:75], a[96:111]
  ds_read_b128 a[152:155], v226 offset:47104
  v_add_f32 v211, v211, v204
  v_exp_f32 v206, v70
  s_waitcnt lgkmcnt(7)
  v_mfma_f32_32x32x16_bf16 a[96:111], a[188:191], v[76:79], a[96:111]
  v_add_f32 v211, v211, v205
  v_cvt_pk_bf16_f32 v102, v204, v205
  v_exp_f32 v207, v71
  v_mfma_f32_32x32x16_bf16 a[112:127], a[184:187], v[80:83], a[112:127]
  ds_read_b128 a[156:159], v228 offset:47104
  v_add_f32 v211, v211, v206
  v_add_f32 v211, v211, v207
  v_cvt_pk_bf16_f32 v103, v206, v207
  v_cmp_nle_f32 s[68:69], v210, s66
  v_cmp_nle_f32 s[70:71], v211, s66
  v_mfma_f32_32x32x16_bf16 a[112:127], a[188:191], v[84:87], a[112:127]
  s_or_b64 s[68:69], s[68:69], s[70:71]
  s_cbranch_scc1 k2_fb20
k2_ret21:
  s_waitcnt lgkmcnt(7)
  s_nop 0
  v_mfma_f32_32x32x16_bf16 v[40:55], a[128:131], v[136:139], v[104:119]
  ds_read_b64_tr_b16 a[160:161], v224 offset:24576
  ds_read_b64_tr_b16 a[162:163], v224 offset:25088
  v_exp_f32 v200, v8
  v_exp_f32 v201, v9
  s_waitcnt lgkmcnt(8)
  v_mfma_f32_32x32x16_bf16 v[40:55], a[132:135], v[140:143], v[40:55]
  ds_read_b64_tr_b16 a[164:165], v224 offset:28672
  ds_read_b64_tr_b16 a[166:167], v224 offset:29184
  v_add_f32 v208, v210, v200
  v_exp_f32 v202, v10
  s_waitcnt lgkmcnt(9)
  v_mfma_f32_32x32x16_bf16 v[40:55], a[136:139], v[144:147], v[40:55]
  ds_read_b64_tr_b16 a[168:169], v224 offset:25600
  ds_read_b64_tr_b16 a[170:171], v224 offset:26112
  v_add_f32 v208, v208, v201
  v_cvt_pk_bf16_f32 v72, v200, v201
  v_exp_f32 v203, v11
  s_waitcnt lgkmcnt(10)
  v_mfma_f32_32x32x16_bf16 v[40:55], a[140:143], v[148:151], v[40:55]
  ds_read_b64_tr_b16 a[172:173], v224 offset:29696
  ds_read_b64_tr_b16 a[174:175], v224 offset:30208
  v_add_f32 v208, v208, v202
  v_exp_f32 v204, v12
  s_waitcnt lgkmcnt(11)
  v_mfma_f32_32x32x16_bf16 v[40:55], a[144:147], v[152:155], v[40:55]
  ds_read_b64_tr_b16 a[176:177], v224 offset:26624
  ds_read_b64_tr_b16 a[178:179], v224 offset:27136
  v_add_f32 v208, v208, v203
  v_cvt_pk_bf16_f32 v73, v202, v203
  v_exp_f32 v205, v13
  s_waitcnt lgkmcnt(12)
  v_mfma_f32_32x32x16_bf16 v[40:55], a[148:151], v[156:159], v[40:55]
  ds_read_b64_tr_b16 a[180:181], v224 offset:30720
  ds_read_b64_tr_b16 a[182:183], v224 offset:31232
  v_add_f32 v208, v208, v204
  v_exp_f32 v206, v14
  v_add_f32 v208, v208, v205
  s_waitcnt lgkmcnt(13)
  v_mfma_f32_32x32x16_bf16 v[40:55], a[152:155], v[160:163], v[40:55]
  ds_read_b64_tr_b16 a[184:185], v224 offset:27648
  ds_read_b64_tr_b16 a[186:187], v224 offset:28160
  v_cvt_pk_bf16_f32 v74, v204, v205
  v_exp_f32 v207, v15
  s_waitcnt lgkmcnt(14)
  v_mfma_f32_32x32x16_bf16 v[40:55], a[156:159], v[164:167], v[40:55]
  ds_read_b64_tr_b16 a[188:189], v224 offset:31744
  ds_read_b64_tr_b16 a[190:191], v224 offset:32256
  v_add_f32 v208, v208, v206
  v_exp_f32 v200, v16
  v_add_f32 v208, v208, v207
  v_mfma_f32_32x32x16_bf16 v[56:71], a[128:131], v[168:171], v[120:135]
  v_cvt_pk_bf16_f32 v75, v206, v207
  v_exp_f32 v201, v17
  v_add_f32 v208, v208, v200
  v_mfma_f32_32x32x16_bf16 v[56:71], a[132:135], v[172:175], v[56:71]
  v_exp_f32 v202, v18
  v_add_f32 v208, v208, v201
  v_mfma_f32_32x32x16_bf16 v[56:71], a[136:139], v[176:179], v[56:71]
  v_cvt_pk_bf16_f32 v76, v200, v201
  v_exp_f32 v203, v19
  v_add_f32 v208, v208, v202
  v_mfma_f32_32x32x16_bf16 v[56:71], a[140:143], v[180:183], v[56:71]
  v_exp_f32 v204, v20
  v_add_f32 v208, v208, v203
  v_mfma_f32_32x32x16_bf16 v[56:71], a[144:147], v[184:187], v[56:71]
  v_cvt_pk_bf16_f32 v77, v202, v203
  v_exp_f32 v205, v21
  v_add_f32 v208, v208, v204
  v_mfma_f32_32x32x16_bf16 v[56:71], a[148:151], v[188:191], v[56:71]
  v_exp_f32 v206, v22
  v_add_f32 v208, v208, v205
  v_cvt_pk_bf16_f32 v78, v204, v205
  v_mfma_f32_32x32x16_bf16 v[56:71], a[152:155], v[192:195], v[56:71]
  v_exp_f32 v207, v23
  v_add_f32 v208, v208, v206
  v_mfma_f32_32x32x16_bf16 v[56:71], a[156:159], v[196:199], v[56:71]
  v_exp_f32 v200, v24
  v_add_f32 v208, v208, v207
  v_cvt_pk_bf16_f32 v79, v206, v207
  s_waitcnt vmcnt(9)
  s_barrier
  s_waitcnt lgkmcnt(14)
  v_mfma_f32_32x32x16_bf16 a[0:15], a[160:163], v[88:91], a[0:15]
  ds_read_b128 a[128:131], v227 offset:0
  v_exp_f32 v201, v25
  v_add_f32 v209, v211, v200
  s_waitcnt lgkmcnt(13)
  v_mfma_f32_32x32x16_bf16 a[0:15], a[164:167], v[92:95], a[0:15]
  v_exp_f32 v202, v26
  v_add_f32 v209, v209, v201
  v_cvt_pk_bf16_f32 v80, v200, v201
  s_add_u32 m0, s63, 98304
  s_add_u32 s65, s61, 114688
  buffer_load_dwordx4 v221, s[20:23], s65 offen offset:0  lds
  v_mfma_f32_32x32x16_bf16 a[16:31], a[160:163], v[96:99], a[16:31]
  ds_read_b128 a[132:135], v229 offset:0
  v_exp_f32 v203, v27
  v_add_f32 v209, v209, v202
  v_mfma_f32_32x32x16_bf16 a[16:31], a[164:167], v[100:103], a[16:31]
  v_exp_f32 v204, v28
  v_add_f32 v209, v209, v203
  v_cvt_pk_bf16_f32 v81, v202, v203
  s_waitcnt lgkmcnt(12)
  v_mfma_f32_32x32x16_bf16 a[32:47], a[168:171], v[88:91], a[32:47]
  ds_read_b128 a[136:139], v227 offset:2048
  v_exp_f32 v205, v29
  v_add_f32 v209, v209, v204
  s_waitcnt lgkmcnt(11)
  v_mfma_f32_32x32x16_bf16 a[32:47], a[172:175], v[92:95], a[32:47]
  v_exp_f32 v206, v30
  v_add_f32 v209, v209, v205
  v_cvt_pk_bf16_f32 v82, v204, v205
  v_mfma_f32_32x32x16_bf16 a[48:63], a[168:171], v[96:99], a[48:63]
  ds_read_b128 a[140:143], v229 offset:2048
  v_exp_f32 v207, v31
  v_add_f32 v209, v209, v206
  v_exp_f32 v200, v32
  s_add_u32 m0, s63, 99264
  s_nop 0
  buffer_load_dwordx4 v221, s[20:23], s65 offen offset:64  lds
  v_mfma_f32_32x32x16_bf16 a[48:63], a[172:175], v[100:103], a[48:63]
  v_add_f32 v209, v209, v207
  v_cvt_pk_bf16_f32 v83, v206, v207
  s_waitcnt lgkmcnt(10)
  v_mfma_f32_32x32x16_bf16 a[64:79], a[176:179], v[88:91], a[64:79]
  ds_read_b128 a[144:147], v227 offset:4096
  v_exp_f32 v201, v33
  v_add_f32 v209, v209, v200
  v_exp_f32 v202, v34
  s_waitcnt lgkmcnt(9)
  v_mfma_f32_32x32x16_bf16 a[64:79], a[180:183], v[92:95], a[64:79]
  v_add_f32 v209, v209, v201
  v_cvt_pk_bf16_f32 v84, v200, v201
  v_mfma_f32_32x32x16_bf16 a[80:95], a[176:179], v[96:99], a[80:95]
  ds_read_b128 a[148:151], v229 offset:4096
  v_exp_f32 v203, v35
  v_add_f32 v209, v209, v202
  v_exp_f32 v204, v36
  v_mfma_f32_32x32x16_bf16 a[80:95], a[180:183], v[100:103], a[80:95]
  v_add_f32 v209, v209, v203
  v_cvt_pk_bf16_f32 v85, v202, v203
  v_exp_f32 v205, v37
  s_add_u32 m0, s63, 100224
  s_nop 0
  buffer_load_dwordx4 v221, s[20:23], s65 offen offset:128  lds
  s_waitcnt lgkmcnt(8)
  v_mfma_f32_32x32x16_bf16 a[96:111], a[184:187], v[88:91], a[96:111]
  ds_read_b128 a[152:155], v227 offset:6144
  v_add_f32 v209, v209, v204
  v_exp_f32 v206, v38
  s_waitcnt lgkmcnt(7)
  v_mfma_f32_32x32x16_bf16 a[96:111], a[188:191], v[92:95], a[96:111]
  v_add_f32 v209, v209, v205
  v_cvt_pk_bf16_f32 v86, v204, v205
  v_exp_f32 v207, v39
  v_mfma_f32_32x32x16_bf16 a[112:127], a[184:187], v[96:99], a[112:127]
  ds_read_b128 a[156:159], v229 offset:6144
  v_add_f32 v209, v209, v206
  v_add_f32 v209, v209, v207
  v_cvt_pk_bf16_f32 v87, v206, v207
  v_cmp_nle_f32 s[68:69], v208, s66
  v_cmp_nle_f32 s[70:71], v209, s66
  v_mfma_f32_32x32x16_bf16 a[112:127], a[188:191], v[100:103], a[112:127]
  s_or_b64 s[68:69], s[68:69], s[70:71]
  s_cbranch_scc1 k2_fb22
k2_ret23:
  s_waitcnt lgkmcnt(7)
  s_nop 0
  v_mfma_f32_32x32x16_bf16 v[8:23], a[128:131], v[136:139], v[104:119]
  ds_read_b64_tr_b16 a[160:161], v224 offset:49152
  ds_read_b64_tr_b16 a[162:163], v224 offset:49664
  v_exp_f32 v200, v40
  v_exp_f32 v201, v41
  s_add_u32 m0, s63, 101184
  s_nop 0
  buffer_load_dwordx4 v221, s[20:23], s65 offen offset:192  lds
  v_lshlrev_b32 v4, 10, v5
  s_waitcnt lgkmcnt(8)
  v_mfma_f32_32x32x16_bf16 v[8:23], a[132:135], v[140:143], v[8:23]
  ds_read_b64_tr_b16 a[164:165], v224 offset:53248
  ds_read_b64_tr_b16 a[166:167], v224 offset:53760
  v_add_f32 v210, v208, v200
  v_exp_f32 v202, v42
  v_lshl_add_u32 v4, v6, 7, v4
  s_waitcnt lgkmcnt(9)
  v_mfma_f32_32x32x16_bf16 v[8:23], a[136:139], v[144:147], v[8:23]
  ds_read_b64_tr_b16 a[168:169], v224 offset:50176
  ds_read_b64_tr_b16 a[170:171], v224 offset:50688
  v_add_f32 v210, v210, v201
  v_cvt_pk_bf16_f32 v88, v200, v201
  v_exp_f32 v203, v43
  s_waitcnt lgkmcnt(10)
  v_mfma_f32_32x32x16_bf16 v[8:23], a[140:143], v[148:151], v[8:23]
  ds_read_b64_tr_b16 a[172:173], v224 offset:54272
  ds_read_b64_tr_b16 a[174:175], v224 offset:54784
  v_add_f32 v210, v210, v202
  v_exp_f32 v204, v44
  s_waitcnt lgkmcnt(11)
  v_mfma_f32_32x32x16_bf16 v[8:23], a[144:147], v[152:155], v[8:23]
  ds_read_b64_tr_b16 a[176:177], v224 offset:51200
  ds_read_b64_tr_b16 a[178:179], v224 offset:51712
  v_add_f32 v210, v210, v203
  v_cvt_pk_bf16_f32 v89, v202, v203
  v_exp_f32 v205, v45
  s_waitcnt lgkmcnt(12)
  v_mfma_f32_32x32x16_bf16 v[8:23], a[148:151], v[156:159], v[8:23]
  ds_read_b64_tr_b16 a[180:181], v224 offset:55296
  ds_read_b64_tr_b16 a[182:183], v224 offset:55808
  v_add_f32 v210, v210, v204
  v_exp_f32 v206, v46
  v_add_f32 v210, v210, v205
  buffer_load_dword a192, v4, s[28:31], s43 offen
  s_waitcnt lgkmcnt(13)
  v_mfma_f32_32x32x16_bf16 v[8:23], a[152:155], v[160:163], v[8:23]
  ds_read_b64_tr_b16 a[184:185], v224 offset:52224
  ds_read_b64_tr_b16 a[186:187], v224 offset:52736
  v_cvt_pk_bf16_f32 v90, v204, v205
  v_exp_f32 v207, v47
  s_waitcnt lgkmcnt(14)
  v_mfma_f32_32x32x16_bf16 v[8:23], a[156:159], v[164:167], v[8:23]
  ds_read_b64_tr_b16 a[188:189], v224 offset:56320
  ds_read_b64_tr_b16 a[190:191], v224 offset:56832
  v_add_f32 v210, v210, v206
  v_exp_f32 v200, v48
  v_add_f32 v210, v210, v207
  v_mfma_f32_32x32x16_bf16 v[24:39], a[128:131], v[168:171], v[120:135]
  v_cvt_pk_bf16_f32 v91, v206, v207
  v_exp_f32 v201, v49
  v_add_f32 v210, v210, v200
  v_mfma_f32_32x32x16_bf16 v[24:39], a[132:135], v[172:175], v[24:39]
  v_exp_f32 v202, v50
  v_add_f32 v210, v210, v201
  s_add_u32 s43, s43, 16384
  buffer_load_dword a193, v4, s[28:31], s43 offen
  v_mfma_f32_32x32x16_bf16 v[24:39], a[136:139], v[176:179], v[24:39]
  v_cvt_pk_bf16_f32 v92, v200, v201
  v_exp_f32 v203, v51
  v_add_f32 v210, v210, v202
  v_mfma_f32_32x32x16_bf16 v[24:39], a[140:143], v[180:183], v[24:39]
  v_exp_f32 v204, v52
  v_add_f32 v210, v210, v203
  v_mfma_f32_32x32x16_bf16 v[24:39], a[144:147], v[184:187], v[24:39]
  v_cvt_pk_bf16_f32 v93, v202, v203
  v_exp_f32 v205, v53
  v_add_f32 v210, v210, v204
  v_mfma_f32_32x32x16_bf16 v[24:39], a[148:151], v[188:191], v[24:39]
  v_exp_f32 v206, v54
  v_add_f32 v210, v210, v205
  v_cvt_pk_bf16_f32 v94, v204, v205
  v_mfma_f32_32x32x16_bf16 v[24:39], a[152:155], v[192:195], v[24:39]
  v_exp_f32 v207, v55
  v_add_f32 v210, v210, v206
  v_mfma_f32_32x32x16_bf16 v[24:39], a[156:159], v[196:199], v[24:39]
  v_exp_f32 v200, v56
  v_add_f32 v210, v210, v207
  v_cvt_pk_bf16_f32 v95, v206, v207
  s_waitcnt lgkmcnt(14)
  v_mfma_f32_32x32x16_bf16 a[0:15], a[160:163], v[72:75], a[0:15]
  ds_read_b128 a[128:131], v227 offset:8192
  v_exp_f32 v201, v57
  v_add_f32 v211, v209, v200
  s_waitcnt lgkmcnt(13)
  v_mfma_f32_32x32x16_bf16 a[0:15], a[164:167], v[76:79], a[0:15]
  v_exp_f32 v202, v58
  v_add_f32 v211, v211, v201
  v_cvt_pk_bf16_f32 v96, v200, v201
  v_mfma_f32_32x32x16_bf16 a[16:31], a[160:163], v[80:83], a[16:31]
  ds_read_b128 a[132:135], v229 offset:8192
  v_exp_f32 v203, v59
  v_add_f32 v211, v211, v202
  v_mfma_f32_32x32x16_bf16 a[16:31], a[164:167], v[84:87], a[16:31]
  v_exp_f32 v204, v60
  v_add_f32 v211, v211, v203
  v_cvt_pk_bf16_f32 v97, v202, v203
  s_waitcnt lgkmcnt(12)
  v_mfma_f32_32x32x16_bf16 a[32:47], a[168:171], v[72:75], a[32:47]
  ds_read_b128 a[136:139], v227 offset:10240
  v_exp_f32 v205, v61
  v_add_f32 v211, v211, v204
  s_waitcnt lgkmcnt(11)
  v_mfma_f32_32x32x16_bf16 a[32:47], a[172:175], v[76:79], a[32:47]
  v_exp_f32 v206, v62
  v_add_f32 v211, v211, v205
  v_cvt_pk_bf16_f32 v98, v204, v205
  v_mfma_f32_32x32x16_bf16 a[48:63], a[168:171], v[80:83], a[48:63]
  ds_read_b128 a[140:143], v229 offset:10240
  v_exp_f32 v207, v63
  v_add_f32 v211, v211, v206
  v_exp_f32 v200, v64
  v_mfma_f32_32x32x16_bf16 a[48:63], a[172:175], v[84:87], a[48:63]
  v_add_f32 v211, v211, v207
  v_cvt_pk_bf16_f32 v99, v206, v207
  s_waitcnt lgkmcnt(10)
  v_mfma_f32_32x32x16_bf16 a[64:79], a[176:179], v[72:75], a[64:79]
  ds_read_b128 a[144:147], v227 offset:12288
  v_exp_f32 v201, v65
  v_add_f32 v211, v211, v200
  v_exp_f32 v202, v66
  s_waitcnt lgkmcnt(9)
  v_mfma_f32_32x32x16_bf16 a[64:79], a[180:183], v[76:79], a[64:79]
  v_add_f32 v211, v211, v201
  v_cvt_pk_bf16_f32 v100, v200, v201
  v_mfma_f32_32x32x16_bf16 a[80:95], a[176:179], v[80:83], a[80:95]
  ds_read_b128 a[148:151], v229 offset:12288
  v_exp_f32 v203, v67
  v_add_f32 v211, v211, v202
  v_exp_f32 v204, v68
  v_mfma_f32_32x32x16_bf16 a[80:95], a[180:183], v[84:87], a[80:95]
  v_add_f32 v211, v211, v203
  v_cvt_pk_bf16_f32 v101, v202, v203
  v_exp_f32 v205, v69
  s_waitcnt lgkmcnt(8)
  v_mfma_f32_32x32x16_bf16 a[96:111], a[184:187], v[72:75], a[96:111]
  ds_read_b128 a[152:155], v227 offset:14336
  v_add_f32 v211, v211, v204
  v_exp_f32 v206, v70
  s_waitcnt lgkmcnt(7)
  v_mfma_f32_32x32x16_bf16 a[96:111], a[188:191], v[76:79], a[96:111]
  v_add_f32 v211, v211, v205
  v_cvt_pk_bf16_f32 v102, v204, v205
  v_exp_f32 v207, v71
  v_mfma_f32_32x32x16_bf16 a[112:127], a[184:187], v[80:83], a[112:127]
  ds_read_b128 a[156:159], v229 offset:14336
  v_add_f32 v211, v211, v206
  v_add_f32 v211, v211, v207
  v_cvt_pk_bf16_f32 v103, v206, v207
  v_cmp_nle_f32 s[68:69], v210, s66
  v_cmp_nle_f32 s[70:71], v211, s66
  v_mfma_f32_32x32x16_bf16 a[112:127], a[188:191], v[84:87], a[112:127]
  s_or_b64 s[68:69], s[68:69], s[70:71]
  s_cbranch_scc1 k2_fb24
k2_ret25:
  s_waitcnt lgkmcnt(7)
  s_nop 0
  v_mfma_f32_32x32x16_bf16 v[40:55], a[128:131], v[136:139], v[104:119]
  ds_read_b64_tr_b16 a[160:161], v224 offset:57344
  ds_read_b64_tr_b16 a[162:163], v224 offset:57856
  v_exp_f32 v200, v8
  v_exp_f32 v201, v9
  s_waitcnt lgkmcnt(8)
  v_mfma_f32_32x32x16_bf16 v[40:55], a[132:135], v[140:143], v[40:55]
  ds_read_b64_tr_b16 a[164:165], v224 offset:61440
  ds_read_b64_tr_b16 a[166:167], v224 offset:61952
  v_add_f32 v208, v210, v200
  v_exp_f32 v202, v10
  s_waitcnt lgkmcnt(9)
  v_mfma_f32_32x32x16_bf16 v[40:55], a[136:139], v[144:147], v[40:55]
  ds_read_b64_tr_b16 a[168:169], v224 offset:58368
  ds_read_b64_tr_b16 a[170:171], v224 offset:58880
  v_add_f32 v208, v208, v201
  v_cvt_pk_bf16_f32 v72, v200, v201
  v_exp_f32 v203, v11
  s_waitcnt lgkmcnt(10)
  v_mfma_f32_32x32x16_bf16 v[40:55], a[140:143], v[148:151], v[40:55]
  ds_read_b64_tr_b16 a[172:173], v224 offset:62464
  ds_read_b64_tr_b16 a[174:175], v224 offset:62976
  v_add_f32 v208, v208, v202
  v_exp_f32 v204, v12
  s_waitcnt lgkmcnt(11)
  v_mfma_f32_32x32x16_bf16 v[40:55], a[144:147], v[152:155], v[40:55]
  ds_read_b64_tr_b16 a[176:177], v224 offset:59392
  ds_read_b64_tr_b16 a[178:179], v224 offset:59904
  v_add_f32 v208, v208, v203
  v_cvt_pk_bf16_f32 v73, v202, v203
  v_exp_f32 v205, v13
  s_waitcnt lgkmcnt(12)
  v_mfma_f32_32x32x16_bf16 v[40:55], a[148:151], v[156:159], v[40:55]
  ds_read_b64_tr_b16 a[180:181], v224 offset:63488
  ds_read_b64_tr_b16 a[182:183], v224 offset:64000
  v_add_f32 v208, v208, v204
  v_exp_f32 v206, v14
  v_add_f32 v208, v208, v205
  s_waitcnt lgkmcnt(13)
  v_mfma_f32_32x32x16_bf16 v[40:55], a[152:155], v[160:163], v[40:55]
  ds_read_b64_tr_b16 a[184:185], v224 offset:60416
  ds_read_b64_tr_b16 a[186:187], v224 offset:60928
  v_cvt_pk_bf16_f32 v74, v204, v205
  v_exp_f32 v207, v15
  s_waitcnt lgkmcnt(14)
  v_mfma_f32_32x32x16_bf16 v[40:55], a[156:159], v[164:167], v[40:55]
  ds_read_b64_tr_b16 a[188:189], v224 offset:64512
  ds_read_b64_tr_b16 a[190:191], v224 offset:65024
  v_add_f32 v208, v208, v206
  v_exp_f32 v200, v16
  v_add_f32 v208, v208, v207
  v_mfma_f32_32x32x16_bf16 v[56:71], a[128:131], v[168:171], v[120:135]
  v_cvt_pk_bf16_f32 v75, v206, v207
  v_exp_f32 v201, v17
  v_add_f32 v208, v208, v200
  v_mfma_f32_32x32x16_bf16 v[56:71], a[132:135], v[172:175], v[56:71]
  v_exp_f32 v202, v18
  v_add_f32 v208, v208, v201
  v_mfma_f32_32x32x16_bf16 v[56:71], a[136:139], v[176:179], v[56:71]
  v_cvt_pk_bf16_f32 v76, v200, v201
  v_exp_f32 v203, v19
  v_add_f32 v208, v208, v202
  v_mfma_f32_32x32x16_bf16 v[56:71], a[140:143], v[180:183], v[56:71]
  v_exp_f32 v204, v20
  v_add_f32 v208, v208, v203
  v_mfma_f32_32x32x16_bf16 v[56:71], a[144:147], v[184:187], v[56:71]
  v_cvt_pk_bf16_f32 v77, v202, v203
  v_exp_f32 v205, v21
  v_add_f32 v208, v208, v204
  v_mfma_f32_32x32x16_bf16 v[56:71], a[148:151], v[188:191], v[56:71]
  v_exp_f32 v206, v22
  v_add_f32 v208, v208, v205
  v_cvt_pk_bf16_f32 v78, v204, v205
  v_mfma_f32_32x32x16_bf16 v[56:71], a[152:155], v[192:195], v[56:71]
  v_exp_f32 v207, v23
  v_add_f32 v208, v208, v206
  v_mfma_f32_32x32x16_bf16 v[56:71], a[156:159], v[196:199], v[56:71]
  v_exp_f32 v200, v24
  v_add_f32 v208, v208, v207
  v_cvt_pk_bf16_f32 v79, v206, v207
  s_waitcnt vmcnt(6)
  s_barrier
  s_waitcnt lgkmcnt(14)
  v_mfma_f32_32x32x16_bf16 a[0:15], a[160:163], v[88:91], a[0:15]
  ds_read_b128 a[128:131], v227 offset:32768
  v_exp_f32 v201, v25
  v_add_f32 v209, v211, v200
  s_waitcnt lgkmcnt(13)
  v_mfma_f32_32x32x16_bf16 a[0:15], a[164:167], v[92:95], a[0:15]
  v_exp_f32 v202, v26
  v_add_f32 v209, v209, v201
  v_cvt_pk_bf16_f32 v80, v200, v201
  v_mfma_f32_32x32x16_bf16 a[16:31], a[160:163], v[96:99], a[16:31]
  ds_read_b128 a[132:135], v229 offset:32768
  v_exp_f32 v203, v27
  v_add_f32 v209, v209, v202
  v_mfma_f32_32x32x16_bf16 a[16:31], a[164:167], v[100:103], a[16:31]
  v_exp_f32 v204, v28
  v_add_f32 v209, v209, v203
  v_cvt_pk_bf16_f32 v81, v202, v203
  s_waitcnt lgkmcnt(12)
  v_mfma_f32_32x32x16_bf16 a[32:47], a[168:171], v[88:91], a[32:47]
  ds_read_b128 a[136:139], v227 offset:34816
  v_exp_f32 v205, v29
  v_add_f32 v209, v209, v204
  s_waitcnt lgkmcnt(11)
  v_mfma_f32_32x32x16_bf16 a[32:47], a[172:175], v[92:95], a[32:47]
  v_exp_f32 v206, v30
  v_add_f32 v209, v209, v205
  v_cvt_pk_bf16_f32 v82, v204, v205
  v_mfma_f32_32x32x16_bf16 a[48:63], a[168:171], v[96:99], a[48:63]
  ds_read_b128 a[140:143], v229 offset:34816
  v_exp_f32 v207, v31
  v_add_f32 v209, v209, v206
  v_exp_f32 v200, v32
  v_mfma_f32_32x32x16_bf16 a[48:63], a[172:175], v[100:103], a[48:63]
  v_add_f32 v209, v209, v207
  v_cvt_pk_bf16_f32 v83, v206, v207
  s_waitcnt lgkmcnt(10)
  v_mfma_f32_32x32x16_bf16 a[64:79], a[176:179], v[88:91], a[64:79]
  ds_read_b128 a[144:147], v227 offset:36864
  v_exp_f32 v201, v33
  v_add_f32 v209, v209, v200
  v_exp_f32 v202, v34
  s_waitcnt lgkmcnt(9)
  v_mfma_f32_32x32x16_bf16 a[64:79], a[180:183], v[92:95], a[64:79]
  v_add_f32 v209, v209, v201
  v_cvt_pk_bf16_f32 v84, v200, v201
  v_mfma_f32_32x32x16_bf16 a[80:95], a[176:179], v[96:99], a[80:95]
  ds_read_b128 a[148:151], v229 offset:36864
  v_exp_f32 v203, v35
  v_add_f32 v209, v209, v202
  v_exp_f32 v204, v36
  v_mfma_f32_32x32x16_bf16 a[80:95], a[180:183], v[100:103], a[80:95]
  v_add_f32 v209, v209, v203
  v_cvt_pk_bf16_f32 v85, v202, v203
  v_exp_f32 v205, v37
  s_waitcnt lgkmcnt(8)
  v_mfma_f32_32x32x16_bf16 a[96:111], a[184:187], v[88:91], a[96:111]
  ds_read_b128 a[152:155], v227 offset:38912
  v_add_f32 v209, v209, v204
  v_exp_f32 v206, v38
  s_waitcnt lgkmcnt(7)
  v_mfma_f32_32x32x16_bf16 a[96:111], a[188:191], v[92:95], a[96:111]
  v_add_f32 v209, v209, v205
  v_cvt_pk_bf16_f32 v86, v204, v205
  v_exp_f32 v207, v39
  v_mfma_f32_32x32x16_bf16 a[112:127], a[184:187], v[96:99], a[112:127]
  ds_read_b128 a[156:159], v229 offset:38912
  v_add_f32 v209, v209, v206
  v_add_f32 v209, v209, v207
  v_cvt_pk_bf16_f32 v87, v206, v207
  v_cmp_nle_f32 s[68:69], v208, s66
  v_cmp_nle_f32 s[70:71], v209, s66
  v_mfma_f32_32x32x16_bf16 a[112:127], a[188:191], v[100:103], a[112:127]
  s_or_b64 s[68:69], s[68:69], s[70:71]
  s_cbranch_scc1 k2_fb26
k2_ret27:
  s_waitcnt lgkmcnt(7)
  s_nop 0
  v_mfma_f32_32x32x16_bf16 v[8:23], a[128:131], v[136:139], v[104:119]
  ds_read_b64_tr_b16 a[160:161], v225 offset:16384
  ds_read_b64_tr_b16 a[162:163], v225 offset:16896
  v_exp_f32 v200, v40
  v_exp_f32 v201, v41
  s_waitcnt lgkmcnt(8)
  v_mfma_f32_32x32x16_bf16 v[8:23], a[132:135], v[140:143], v[8:23]
  ds_read_b64_tr_b16 a[164:165], v225 offset:20480
  ds_read_b64_tr_b16 a[166:167], v225 offset:20992
  v_add_f32 v210, v208, v200
  v_exp_f32 v202, v42
  s_waitcnt lgkmcnt(9)
  v_mfma_f32_32x32x16_bf16 v[8:23], a[136:139], v[144:147], v[8:23]
  ds_read_b64_tr_b16 a[168:169], v225 offset:17408
  ds_read_b64_tr_b16 a[170:171], v225 offset:17920
  v_add_f32 v210, v210, v201
  v_cvt_pk_bf16_f32 v88, v200, v201
  v_exp_f32 v203, v43
  s_waitcnt lgkmcnt(10)
  v_mfma_f32_32x32x16_bf16 v[8:23], a[140:143], v[148:151], v[8:23]
  ds_read_b64_tr_b16 a[172:173], v225 offset:21504
  ds_read_b64_tr_b16 a[174:175], v225 offset:22016
  v_add_f32 v210, v210, v202
  v_exp_f32 v204, v44
  s_waitcnt lgkmcnt(11)
  v_mfma_f32_32x32x16_bf16 v[8:23], a[144:147], v[152:155], v[8:23]
  ds_read_b64_tr_b16 a[176:177], v225 offset:18432
  ds_read_b64_tr_b16 a[178:179], v225 offset:18944
  v_add_f32 v210, v210, v203
  v_cvt_pk_bf16_f32 v89, v202, v203
  v_exp_f32 v205, v45
  s_waitcnt lgkmcnt(12)
  v_mfma_f32_32x32x16_bf16 v[8:23], a[148:151], v[156:159], v[8:23]
  ds_read_b64_tr_b16 a[180:181], v225 offset:22528
  ds_read_b64_tr_b16 a[182:183], v225 offset:23040
  v_add_f32 v210, v210, v204
  v_exp_f32 v206, v46
  v_add_f32 v210, v210, v205
  s_waitcnt lgkmcnt(13)
  v_mfma_f32_32x32x16_bf16 v[8:23], a[152:155], v[160:163], v[8:23]
  ds_read_b64_tr_b16 a[184:185], v225 offset:19456
  ds_read_b64_tr_b16 a[186:187], v225 offset:19968
  v_cvt_pk_bf16_f32 v90, v204, v205
  v_exp_f32 v207, v47
  s_waitcnt lgkmcnt(14)
  v_mfma_f32_32x32x16_bf16 v[8:23], a[156:159], v[164:167], v[8:23]
  ds_read_b64_tr_b16 a[188:189], v225 offset:23552
  ds_read_b64_tr_b16 a[190:191], v225 offset:24064
  v_add_f32 v210, v210, v206
  v_exp_f32 v200, v48
  v_add_f32 v210, v210, v207
  v_mfma_f32_32x32x16_bf16 v[24:39], a[128:131], v[168:171], v[120:135]
  v_cvt_pk_bf16_f32 v91, v206, v207
  v_exp_f32 v201, v49
  v_add_f32 v210, v210, v200
  v_mfma_f32_32x32x16_bf16 v[24:39], a[132:135], v[172:175], v[24:39]
  v_exp_f32 v202, v50
  v_add_f32 v210, v210, v201
  v_mfma_f32_32x32x16_bf16 v[24:39], a[136:139], v[176:179], v[24:39]
  v_cvt_pk_bf16_f32 v92, v200, v201
  v_exp_f32 v203, v51
  v_add_f32 v210, v210, v202
  v_mfma_f32_32x32x16_bf16 v[24:39], a[140:143], v[180:183], v[24:39]
  v_exp_f32 v204, v52
  v_add_f32 v210, v210, v203
  v_mfma_f32_32x32x16_bf16 v[24:39], a[144:147], v[184:187], v[24:39]
  v_cvt_pk_bf16_f32 v93, v202, v203
  v_exp_f32 v205, v53
  v_add_f32 v210, v210, v204
  v_mfma_f32_32x32x16_bf16 v[24:39], a[148:151], v[188:191], v[24:39]
  v_exp_f32 v206, v54
  v_add_f32 v210, v210, v205
  v_cvt_pk_bf16_f32 v94, v204, v205
  v_mfma_f32_32x32x16_bf16 v[24:39], a[152:155], v[192:195], v[24:39]
  v_exp_f32 v207, v55
  v_add_f32 v210, v210, v206
  v_mfma_f32_32x32x16_bf16 v[24:39], a[156:159], v[196:199], v[24:39]
  v_exp_f32 v200, v56
  v_add_f32 v210, v210, v207
  v_cvt_pk_bf16_f32 v95, v206, v207
  s_waitcnt lgkmcnt(14)
  v_mfma_f32_32x32x16_bf16 a[0:15], a[160:163], v[72:75], a[0:15]
  ds_read_b128 a[128:131], v227 offset:40960
  v_exp_f32 v201, v57
  v_add_f32 v211, v209, v200
  s_waitcnt lgkmcnt(13)
  v_mfma_f32_32x32x16_bf16 a[0:15], a[164:167], v[76:79], a[0:15]
  v_exp_f32 v202, v58
  v_add_f32 v211, v211, v201
  v_cvt_pk_bf16_f32 v96, v200, v201
  v_mfma_f32_32x32x16_bf16 a[16:31], a[160:163], v[80:83], a[16:31]
  ds_read_b128 a[132:135], v229 offset:40960
  v_exp_f32 v203, v59
  v_add_f32 v211, v211, v202
  v_mfma_f32_32x32x16_bf16 a[16:31], a[164:167], v[84:87], a[16:31]
  v_exp_f32 v204, v60
  v_add_f32 v211, v211, v203
  v_cvt_pk_bf16_f32 v97, v202, v203
  s_waitcnt lgkmcnt(12)
  v_mfma_f32_32x32x16_bf16 a[32:47], a[168:171], v[72:75], a[32:47]
  ds_read_b128 a[136:139], v227 offset:43008
  v_exp_f32 v205, v61
  v_add_f32 v211, v211, v204
  s_waitcnt lgkmcnt(11)
  v_mfma_f32_32x32x16_bf16 a[32:47], a[172:175], v[76:79], a[32:47]
  v_exp_f32 v206, v62
  v_add_f32 v211, v211, v205
  v_cvt_pk_bf16_f32 v98, v204, v205
  v_mfma_f32_32x32x16_bf16 a[48:63], a[168:171], v[80:83], a[48:63]
  ds_read_b128 a[140:143], v229 offset:43008
  v_exp_f32 v207, v63
  v_add_f32 v211, v211, v206
  v_exp_f32 v200, v64
  v_mfma_f32_32x32x16_bf16 a[48:63], a[172:175], v[84:87], a[48:63]
  v_add_f32 v211, v211, v207
  v_cvt_pk_bf16_f32 v99, v206, v207
  s_waitcnt lgkmcnt(10)
  v_mfma_f32_32x32x16_bf16 a[64:79], a[176:179], v[72:75], a[64:79]
  ds_read_b128 a[144:147], v227 offset:45056
  v_exp_f32 v201, v65
  v_add_f32 v211, v211, v200
  v_exp_f32 v202, v66
  s_waitcnt lgkmcnt(9)
  v_mfma_f32_32x32x16_bf16 a[64:79], a[180:183], v[76:79], a[64:79]
  v_add_f32 v211, v211, v201
  v_cvt_pk_bf16_f32 v100, v200, v201
  v_mfma_f32_32x32x16_bf16 a[80:95], a[176:179], v[80:83], a[80:95]
  ds_read_b128 a[148:151], v229 offset:45056
  v_exp_f32 v203, v67
  v_add_f32 v211, v211, v202
  v_exp_f32 v204, v68
  v_mfma_f32_32x32x16_bf16 a[80:95], a[180:183], v[84:87], a[80:95]
  v_add_f32 v211, v211, v203
  v_cvt_pk_bf16_f32 v101, v202, v203
  v_exp_f32 v205, v69
  s_waitcnt lgkmcnt(8)
  v_mfma_f32_32x32x16_bf16 a[96:111], a[184:187], v[72:75], a[96:111]
  ds_read_b128 a[152:155], v227 offset:47104
  v_add_f32 v211, v211, v204
  v_exp_f32 v206, v70
  s_waitcnt lgkmcnt(7)
  v_mfma_f32_32x32x16_bf16 a[96:111], a[188:191], v[76:79], a[96:111]
  v_add_f32 v211, v211, v205
  v_cvt_pk_bf16_f32 v102, v204, v205
  v_exp_f32 v207, v71
  v_mfma_f32_32x32x16_bf16 a[112:127], a[184:187], v[80:83], a[112:127]
  ds_read_b128 a[156:159], v229 offset:47104
  v_add_f32 v211, v211, v206
  v_add_f32 v211, v211, v207
  v_cvt_pk_bf16_f32 v103, v206, v207
  v_cmp_nle_f32 s[68:69], v210, s66
  v_cmp_nle_f32 s[70:71], v211, s66
  v_mfma_f32_32x32x16_bf16 a[112:127], a[188:191], v[84:87], a[112:127]
  s_or_b64 s[68:69], s[68:69], s[70:71]
  s_cbranch_scc1 k2_fb28
k2_ret29:
  s_waitcnt lgkmcnt(7)
  s_nop 0
  v_mfma_f32_32x32x16_bf16 v[40:55], a[128:131], v[136:139], v[104:119]
  ds_read_b64_tr_b16 a[160:161], v225 offset:24576
  ds_read_b64_tr_b16 a[162:163], v225 offset:25088
  v_exp_f32 v200, v8
  v_exp_f32 v201, v9
  s_waitcnt lgkmcnt(8)
  v_mfma_f32_32x32x16_bf16 v[40:55], a[132:135], v[140:143], v[40:55]
  ds_read_b64_tr_b16 a[164:165], v225 offset:28672
  ds_read_b64_tr_b16 a[166:167], v225 offset:29184
  v_add_f32 v208, v210, v200
  v_exp_f32 v202, v10
  s_waitcnt lgkmcnt(9)
  v_mfma_f32_32x32x16_bf16 v[40:55], a[136:139], v[144:147], v[40:55]
  ds_read_b64_tr_b16 a[168:169], v225 offset:25600
  ds_read_b64_tr_b16 a[170:171], v225 offset:26112
  v_add_f32 v208, v208, v201
  v_cvt_pk_bf16_f32 v72, v200, v201
  v_exp_f32 v203, v11
  s_waitcnt lgkmcnt(10)
  v_mfma_f32_32x32x16_bf16 v[40:55], a[140:143], v[148:151], v[40:55]
  ds_read_b64_tr_b16 a[172:173], v225 offset:29696
  ds_read_b64_tr_b16 a[174:175], v225 offset:30208
  v_add_f32 v208, v208, v202
  v_exp_f32 v204, v12
  s_waitcnt lgkmcnt(11)
  v_mfma_f32_32x32x16_bf16 v[40:55], a[144:147], v[152:155], v[40:55]
  ds_read_b64_tr_b16 a[176:177], v225 offset:26624
  ds_read_b64_tr_b16 a[178:179], v225 offset:27136
  v_add_f32 v208, v208, v203
  v_cvt_pk_bf16_f32 v73, v202, v203
  v_exp_f32 v205, v13
  s_waitcnt lgkmcnt(12)
  v_mfma_f32_32x32x16_bf16 v[40:55], a[148:151], v[156:159], v[40:55]
  ds_read_b64_tr_b16 a[180:181], v225 offset:30720
  ds_read_b64_tr_b16 a[182:183], v225 offset:31232
  v_add_f32 v208, v208, v204
  v_exp_f32 v206, v14
  v_add_f32 v208, v208, v205
  s_waitcnt lgkmcnt(13)
  v_mfma_f32_32x32x16_bf16 v[40:55], a[152:155], v[160:163], v[40:55]
  ds_read_b64_tr_b16 a[184:185], v225 offset:27648
  ds_read_b64_tr_b16 a[186:187], v225 offset:28160
  v_cvt_pk_bf16_f32 v74, v204, v205
  v_exp_f32 v207, v15
  s_waitcnt lgkmcnt(14)
  v_mfma_f32_32x32x16_bf16 v[40:55], a[156:159], v[164:167], v[40:55]
  ds_read_b64_tr_b16 a[188:189], v225 offset:31744
  ds_read_b64_tr_b16 a[190:191], v225 offset:32256
  v_add_f32 v208, v208, v206
  v_exp_f32 v200, v16
  v_add_f32 v208, v208, v207
  v_mfma_f32_32x32x16_bf16 v[56:71], a[128:131], v[168:171], v[120:135]
  v_cvt_pk_bf16_f32 v75, v206, v207
  v_exp_f32 v201, v17
  v_add_f32 v208, v208, v200
  v_mfma_f32_32x32x16_bf16 v[56:71], a[132:135], v[172:175], v[56:71]
  v_exp_f32 v202, v18
  v_add_f32 v208, v208, v201
  v_mfma_f32_32x32x16_bf16 v[56:71], a[136:139], v[176:179], v[56:71]
  v_cvt_pk_bf16_f32 v76, v200, v201
  v_exp_f32 v203, v19
  v_add_f32 v208, v208, v202
  v_mfma_f32_32x32x16_bf16 v[56:71], a[140:143], v[180:183], v[56:71]
  v_exp_f32 v204, v20
  v_add_f32 v208, v208, v203
  v_mfma_f32_32x32x16_bf16 v[56:71], a[144:147], v[184:187], v[56:71]
  v_cvt_pk_bf16_f32 v77, v202, v203
  v_exp_f32 v205, v21
  v_add_f32 v208, v208, v204
  v_mfma_f32_32x32x16_bf16 v[56:71], a[148:151], v[188:191], v[56:71]
  v_exp_f32 v206, v22
  v_add_f32 v208, v208, v205
  v_cvt_pk_bf16_f32 v78, v204, v205
  v_mfma_f32_32x32x16_bf16 v[56:71], a[152:155], v[192:195], v[56:71]
  v_exp_f32 v207, v23
  v_add_f32 v208, v208, v206
  v_mfma_f32_32x32x16_bf16 v[56:71], a[156:159], v[196:199], v[56:71]
  v_exp_f32 v200, v24
  v_add_f32 v208, v208, v207
  v_cvt_pk_bf16_f32 v79, v206, v207
  s_waitcnt vmcnt(2)
  s_barrier
  s_waitcnt lgkmcnt(14)
  v_mfma_f32_32x32x16_bf16 a[0:15], a[160:163], v[88:91], a[0:15]
  ds_read_b64_tr_b16 a[128:129], v225 offset:49152
  ds_read_b64_tr_b16 a[130:131], v225 offset:49664
  v_exp_f32 v201, v25
  v_add_f32 v209, v211, v200
  s_waitcnt lgkmcnt(14)
  v_mfma_f32_32x32x16_bf16 a[0:15], a[164:167], v[92:95], a[0:15]
  ds_read_b64_tr_b16 a[132:133], v225 offset:53248
  ds_read_b64_tr_b16 a[134:135], v225 offset:53760
  v_exp_f32 v202, v26
  v_add_f32 v209, v209, v201
  v_cvt_pk_bf16_f32 v80, v200, v201
  v_mfma_f32_32x32x16_bf16 a[16:31], a[160:163], v[96:99], a[16:31]
  ds_read_b64_tr_b16 a[136:137], v225 offset:50176
  ds_read_b64_tr_b16 a[138:139], v225 offset:50688
  v_exp_f32 v203, v27
  v_add_f32 v209, v209, v202
  v_mfma_f32_32x32x16_bf16 a[16:31], a[164:167], v[100:103], a[16:31]
  ds_read_b64_tr_b16 a[140:141], v225 offset:54272
  ds_read_b64_tr_b16 a[142:143], v225 offset:54784
  v_exp_f32 v204, v28
  v_add_f32 v209, v209, v203
  v_cvt_pk_bf16_f32 v81, v202, v203
  s_waitcnt lgkmcnt(15)
  v_mfma_f32_32x32x16_bf16 a[32:47], a[168:171], v[88:91], a[32:47]
  ds_read_b64_tr_b16 a[144:145], v225 offset:51200
  ds_read_b64_tr_b16 a[146:147], v225 offset:51712
  v_exp_f32 v205, v29
  v_add_f32 v209, v209, v204
  v_mfma_f32_32x32x16_bf16 a[32:47], a[172:175], v[92:95], a[32:47]
  ds_read_b64_tr_b16 a[148:149], v225 offset:55296
  ds_read_b64_tr_b16 a[150:151], v225 offset:55808
  v_exp_f32 v206, v30
  v_add_f32 v209, v209, v205
  v_cvt_pk_bf16_f32 v82, v204, v205
  v_mfma_f32_32x32x16_bf16 a[48:63], a[168:171], v[96:99], a[48:63]
  ds_read_b64_tr_b16 a[152:153], v225 offset:52224
  ds_read_b64_tr_b16 a[154:155], v225 offset:52736
  v_exp_f32 v207, v31
  v_add_f32 v209, v209, v206
  v_exp_f32 v200, v32
  v_mfma_f32_32x32x16_bf16 a[48:63], a[172:175], v[100:103], a[48:63]
  ds_read_b64_tr_b16 a[156:157], v225 offset:56320
  ds_read_b64_tr_b16 a[158:159], v225 offset:56832
  v_add_f32 v209, v209, v207
  v_cvt_pk_bf16_f32 v83, v206, v207
  s_waitcnt lgkmcnt(15)
  v_mfma_f32_32x32x16_bf16 a[64:79], a[176:179], v[88:91], a[64:79]
  v_exp_f32 v201, v33
  v_add_f32 v209, v209, v200
  v_exp_f32 v202, v34
  v_mfma_f32_32x32x16_bf16 a[64:79], a[180:183], v[92:95], a[64:79]
  v_add_f32 v209, v209, v201
  v_cvt_pk_bf16_f32 v84, v200, v201
  v_mfma_f32_32x32x16_bf16 a[80:95], a[176:179], v[96:99], a[80:95]
  v_exp_f32 v203, v35
  v_add_f32 v209, v209, v202
  v_exp_f32 v204, v36
  v_mfma_f32_32x32x16_bf16 a[80:95], a[180:183], v[100:103], a[80:95]
  v_add_f32 v209, v209, v203
  v_cvt_pk_bf16_f32 v85, v202, v203
  v_exp_f32 v205, v37
  v_mfma_f32_32x32x16_bf16 a[96:111], a[184:187], v[88:91], a[96:111]
  v_add_f32 v209, v209, v204
  v_exp_f32 v206, v38
  v_mfma_f32_32x32x16_bf16 a[96:111], a[188:191], v[92:95], a[96:111]
  v_add_f32 v209, v209, v205
  v_cvt_pk_bf16_f32 v86, v204, v205
  v_exp_f32 v207, v39
  v_mfma_f32_32x32x16_bf16 a[112:127], a[184:187], v[96:99], a[112:127]
  v_add_f32 v209, v209, v206
  v_add_f32 v209, v209, v207
  v_cvt_pk_bf16_f32 v87, v206, v207
  v_cmp_nle_f32 s[68:69], v208, s66
  v_cmp_nle_f32 s[70:71], v209, s66
  v_mfma_f32_32x32x16_bf16 a[112:127], a[188:191], v[100:103], a[112:127]
  s_or_b64 s[68:69], s[68:69], s[70:71]
  s_cbranch_scc1 k2_fb30
k2_ret31:
  s_waitcnt lgkmcnt(14)
  s_nop 0
  v_mfma_f32_32x32x16_bf16 a[0:15], a[128:131], v[72:75], a[0:15]
  ds_read_b64_tr_b16 a[160:161], v225 offset:57344
  ds_read_b64_tr_b16 a[162:163], v225 offset:57856
  v_exp_f32 v200, v40
  v_exp_f32 v201, v41
  v_add_f32 v210, v208, v200
  v_exp_f32 v202, v42
  s_waitcnt lgkmcnt(14)
  v_mfma_f32_32x32x16_bf16 a[0:15], a[132:135], v[76:79], a[0:15]
  ds_read_b64_tr_b16 a[164:165], v225 offset:61440
  ds_read_b64_tr_b16 a[166:167], v225 offset:61952
  v_add_f32 v210, v210, v201
  v_cvt_pk_bf16_f32 v88, v200, v201
  v_exp_f32 v203, v43
  v_add_f32 v210, v210, v202
  v_exp_f32 v204, v44
  v_mfma_f32_32x32x16_bf16 a[16:31], a[128:131], v[80:83], a[16:31]
  ds_read_b64_tr_b16 a[168:169], v225 offset:58368
  ds_read_b64_tr_b16 a[170:171], v225 offset:58880
  v_add_f32 v210, v210, v203
  v_cvt_pk_bf16_f32 v89, v202, v203
  v_exp_f32 v205, v45
  v_add_f32 v210, v210, v204
  v_exp_f32 v206, v46
  v_mfma_f32_32x32x16_bf16 a[16:31], a[132:135], v[84:87], a[16:31]
  ds_read_b64_tr_b16 a[172:173], v225 offset:62464
  ds_read_b64_tr_b16 a[174:175], v225 offset:62976
  v_add_f32 v210, v210, v205
  v_cvt_pk_bf16_f32 v90, v204, v205
  v_exp_f32 v207, v47
  v_add_f32 v210, v210, v206
  v_exp_f32 v200, v48
  s_waitcnt lgkmcnt(15)
  v_mfma_f32_32x32x16_bf16 a[32:47], a[136:139], v[72:75], a[32:47]
  ds_read_b64_tr_b16 a[176:177], v225 offset:59392
  ds_read_b64_tr_b16 a[178:179], v225 offset:59904
  v_add_f32 v210, v210, v207
  v_cvt_pk_bf16_f32 v91, v206, v207
  v_exp_f32 v201, v49
  v_add_f32 v210, v210, v200
  v_exp_f32 v202, v50
  v_mfma_f32_32x32x16_bf16 a[32:47], a[140:143], v[76:79], a[32:47]
  ds_read_b64_tr_b16 a[180:181], v225 offset:63488
  ds_read_b64_tr_b16 a[182:183], v225 offset:64000
  v_add_f32 v210, v210, v201
  v_cvt_pk_bf16_f32 v92, v200, v201
  v_exp_f32 v203, v51
  v_add_f32 v210, v210, v202
  v_exp_f32 v204, v52
  v_mfma_f32_32x32x16_bf16 a[48:63], a[136:139], v[80:83], a[48:63]
  ds_read_b64_tr_b16 a[184:185], v225 offset:60416
  ds_read_b64_tr_b16 a[186:187], v225 offset:60928
  v_add_f32 v210, v210, v203
  v_cvt_pk_bf16_f32 v93, v202, v203
  v_exp_f32 v205, v53
  v_add_f32 v210, v210, v204
  v_exp_f32 v206, v54
  v_mfma_f32_32x32x16_bf16 a[48:63], a[140:143], v[84:87], a[48:63]
  ds_read_b64_tr_b16 a[188:189], v225 offset:64512
  ds_read_b64_tr_b16 a[190:191], v225 offset:65024
  v_add_f32 v210, v210, v205
  v_cvt_pk_bf16_f32 v94, v204, v205
  v_exp_f32 v207, v55
  v_add_f32 v210, v210, v206
  v_exp_f32 v200, v56
  s_waitcnt lgkmcnt(15)
  v_mfma_f32_32x32x16_bf16 a[64:79], a[144:147], v[72:75], a[64:79]
  v_add_f32 v210, v210, v207
  v_cvt_pk_bf16_f32 v95, v206, v207
  v_exp_f32 v201, v57
  v_add_f32 v211, v209, v200
  v_exp_f32 v202, v58
  v_mfma_f32_32x32x16_bf16 a[64:79], a[148:151], v[76:79], a[64:79]
  v_add_f32 v211, v211, v201
  v_cvt_pk_bf16_f32 v96, v200, v201
  v_exp_f32 v203, v59
  v_add_f32 v211, v211, v202
  v_exp_f32 v204, v60
  v_mfma_f32_32x32x16_bf16 a[80:95], a[144:147], v[80:83], a[80:95]
  v_add_f32 v211, v211, v203
  v_cvt_pk_bf16_f32 v97, v202, v203
  v_exp_f32 v205, v61
  v_add_f32 v211, v211, v204
  v_exp_f32 v206, v62
  v_mfma_f32_32x32x16_bf16 a[80:95], a[148:151], v[84:87], a[80:95]
  v_add_f32 v211, v211, v205
  v_cvt_pk_bf16_f32 v98, v204, v205
  v_exp_f32 v207, v63
  v_add_f32 v211, v211, v206
  v_exp_f32 v200, v64
  v_mfma_f32_32x32x16_bf16 a[96:111], a[152:155], v[72:75], a[96:111]
  v_add_f32 v211, v211, v207
  v_cvt_pk_bf16_f32 v99, v206, v207
  v_exp_f32 v201, v65
  v_add_f32 v211, v211, v200
  v_exp_f32 v202, v66
  v_mfma_f32_32x32x16_bf16 a[96:111], a[156:159], v[76:79], a[96:111]
  v_add_f32 v211, v211, v201
  v_cvt_pk_bf16_f32 v100, v200, v201
  v_exp_f32 v203, v67
  v_add_f32 v211, v211, v202
  v_exp_f32 v204, v68
  v_mfma_f32_32x32x16_bf16 a[112:127], a[152:155], v[80:83], a[112:127]
  v_add_f32 v211, v211, v203
  v_cvt_pk_bf16_f32 v101, v202, v203
  v_exp_f32 v205, v69
  v_add_f32 v211, v211, v204
  v_exp_f32 v206, v70
  v_mfma_f32_32x32x16_bf16 a[112:127], a[156:159], v[84:87], a[112:127]
  v_add_f32 v211, v211, v205
  v_cvt_pk_bf16_f32 v102, v204, v205
  v_exp_f32 v207, v71
  v_add_f32 v211, v211, v206
  v_add_f32 v211, v211, v207
  v_cvt_pk_bf16_f32 v103, v206, v207
  v_cmp_nle_f32 s[68:69], v210, s66
  v_cmp_nle_f32 s[70:71], v211, s66
  s_nop 0
  s_or_b64 s[68:69], s[68:69], s[70:71]
  s_cbranch_scc1 k2_fb32
k2_ret33:
  s_waitcnt lgkmcnt(14)
  s_nop 0
  v_mfma_f32_32x32x16_bf16 a[0:15], a[160:163], v[88:91], a[0:15]
  v_mov_b32 v214, v210
  s_nop 1
  v_permlane32_swap_b32 v210, v214
  v_add_f32 v210, v210, v214
  v_rcp_f32 v212, v210
  v_mov_b32 v215, v211
  s_nop 1
  v_permlane32_swap_b32 v211, v215
  s_waitcnt lgkmcnt(12)
  v_mfma_f32_32x32x16_bf16 a[0:15], a[164:167], v[92:95], a[0:15]
  v_add_f32 v211, v211, v215
  v_rcp_f32 v213, v211
  s_lshl_b32 s72, s40, 19
  s_lshl_b32 s41, s39, 14
  s_add_u32 s72, s72, s41
  v_mfma_f32_32x32x16_bf16 a[16:31], a[160:163], v[96:99], a[16:31]
  v_mfma_f32_32x32x16_bf16 a[16:31], a[164:167], v[100:103], a[16:31]
  s_waitcnt lgkmcnt(10)
  v_mfma_f32_32x32x16_bf16 a[32:47], a[168:171], v[88:91], a[32:47]
  s_waitcnt lgkmcnt(8)
  v_mfma_f32_32x32x16_bf16 a[32:47], a[172:175], v[92:95], a[32:47]
  s_nop 0
  v_accvgpr_read_b32 v8, a0
  v_accvgpr_read_b32 v9, a1
  v_accvgpr_read_b32 v10, a2
  v_accvgpr_read_b32 v11, a3
  v_accvgpr_read_b32 v12, a4
  v_accvgpr_read_b32 v13, a5
  v_accvgpr_read_b32 v14, a6
  v_mfma_f32_32x32x16_bf16 a[48:63], a[168:171], v[96:99], a[48:63]
  v_accvgpr_read_b32 v15, a7
  v_accvgpr_read_b32 v16, a8
  v_accvgpr_read_b32 v17, a9
  v_accvgpr_read_b32 v18, a10
  v_accvgpr_read_b32 v19, a11
  v_accvgpr_read_b32 v20, a12
  v_accvgpr_read_b32 v21, a13
  v_accvgpr_read_b32 v22, a14
  v_mfma_f32_32x32x16_bf16 a[48:63], a[172:175], v[100:103], a[48:63]
  v_accvgpr_read_b32 v23, a15
  v_mul_f32 v8, v8, v212
  v_mul_f32 v9, v9, v212
  v_mul_f32 v10, v10, v212
  v_mul_f32 v11, v11, v212
  v_mul_f32 v12, v12, v212
  v_mul_f32 v13, v13, v212
  s_waitcnt lgkmcnt(6)
  v_mfma_f32_32x32x16_bf16 a[64:79], a[176:179], v[88:91], a[64:79]
  v_mul_f32 v14, v14, v212
  v_mul_f32 v15, v15, v212
  v_mul_f32 v16, v16, v212
  v_mul_f32 v17, v17, v212
  v_mul_f32 v18, v18, v212
  v_mul_f32 v19, v19, v212
  v_mul_f32 v20, v20, v212
  v_mul_f32 v21, v21, v212
  s_waitcnt lgkmcnt(4)
  v_mfma_f32_32x32x16_bf16 a[64:79], a[180:183], v[92:95], a[64:79]
  v_mul_f32 v22, v22, v212
  v_mul_f32 v23, v23, v212
  v_cvt_pk_bf16_f32 v8, v8, v9
  v_cvt_pk_bf16_f32 v9, v10, v11
  v_cvt_pk_bf16_f32 v10, v12, v13
  v_cvt_pk_bf16_f32 v11, v14, v15
  v_mfma_f32_32x32x16_bf16 a[80:95], a[176:179], v[96:99], a[80:95]
  s_add_u32 s41, s72, 0
  buffer_store_dwordx4 v[8:11], v3, s[24:27], s41 offen offset:0 sc1
  v_cvt_pk_bf16_f32 v16, v16, v17
  v_cvt_pk_bf16_f32 v17, v18, v19
  v_cvt_pk_bf16_f32 v18, v20, v21
  v_cvt_pk_bf16_f32 v19, v22, v23
  s_add_u32 s41, s72, 2048
  buffer_store_dwordx4 v[16:19], v3, s[24:27], s41 offen offset:0 sc1
  v_mfma_f32_32x32x16_bf16 a[80:95], a[180:183], v[100:103], a[80:95]
  v_accvgpr_read_b32 v24, a16
  v_accvgpr_read_b32 v25, a17
  v_accvgpr_read_b32 v26, a18
  v_accvgpr_read_b32 v27, a19
  v_accvgpr_read_b32 v28, a20
  v_accvgpr_read_b32 v29, a21
  s_waitcnt lgkmcnt(2)
  v_mfma_f32_32x32x16_bf16 a[96:111], a[184:187], v[88:91], a[96:111]
  v_accvgpr_read_b32 v30, a22
  v_accvgpr_read_b32 v31, a23
  v_accvgpr_read_b32 v32, a24
  v_accvgpr_read_b32 v33, a25
  v_accvgpr_read_b32 v34, a26
  v_accvgpr_read_b32 v35, a27
  s_waitcnt lgkmcnt(0)
  v_mfma_f32_32x32x16_bf16 a[96:111], a[188:191], v[92:95], a[96:111]
  v_accvgpr_read_b32 v36, a28
  v_accvgpr_read_b32 v37, a29
  v_accvgpr_read_b32 v38, a30
  v_accvgpr_read_b32 v39, a31
  v_mul_f32 v24, v24, v213
  v_mul_f32 v25, v25, v213
  v_mfma_f32_32x32x16_bf16 a[112:127], a[184:187], v[96:99], a[112:127]
  v_mul_f32 v26, v26, v213
  v_mul_f32 v27, v27, v213
  v_mul_f32 v28, v28, v213
  v_mul_f32 v29, v29, v213
  v_mul_f32 v30, v30, v213
  v_mul_f32 v31, v31, v213
  v_mfma_f32_32x32x16_bf16 a[112:127], a[188:191], v[100:103], a[112:127]
  v_mul_f32 v32, v32, v213
  v_mul_f32 v33, v33, v213
  v_mul_f32 v34, v34, v213
  v_mul_f32 v35, v35, v213
  v_mul_f32 v36, v36, v213
  v_mul_f32 v37, v37, v213
  v_mul_f32 v38, v38, v213
  v_mul_f32 v39, v39, v213
  v_cvt_pk_bf16_f32 v24, v24, v25
  v_cvt_pk_bf16_f32 v25, v26, v27
  v_cvt_pk_bf16_f32 v26, v28, v29
  v_cvt_pk_bf16_f32 v27, v30, v31
  s_add_u32 s41, s72, 0
  buffer_store_dwordx4 v[24:27], v3, s[24:27], s41 offen offset:1024 sc1
  v_cvt_pk_bf16_f32 v32, v32, v33
  v_cvt_pk_bf16_f32 v33, v34, v35
  v_cvt_pk_bf16_f32 v34, v36, v37
  v_cvt_pk_bf16_f32 v35, v38, v39
  s_add_u32 s41, s72, 2048
  buffer_store_dwordx4 v[32:35], v3, s[24:27], s41 offen offset:1024 sc1
  v_accvgpr_read_b32 v40, a32
  v_accvgpr_read_b32 v41, a33
  v_accvgpr_read_b32 v42, a34
  v_accvgpr_read_b32 v43, a35
  v_accvgpr_read_b32 v44, a36
  v_accvgpr_read_b32 v45, a37
  v_accvgpr_read_b32 v46, a38
  v_accvgpr_read_b32 v47, a39
  v_accvgpr_read_b32 v48, a40
  v_accvgpr_read_b32 v49, a41
  v_accvgpr_read_b32 v50, a42
  v_accvgpr_read_b32 v51, a43
  v_accvgpr_read_b32 v52, a44
  v_accvgpr_read_b32 v53, a45
  v_accvgpr_read_b32 v54, a46
  v_accvgpr_read_b32 v55, a47
  v_mul_f32 v40, v40, v212
  v_mul_f32 v41, v41, v212
  v_mul_f32 v42, v42, v212
  v_mul_f32 v43, v43, v212
  v_mul_f32 v44, v44, v212
  v_mul_f32 v45, v45, v212
  v_mul_f32 v46, v46, v212
  v_mul_f32 v47, v47, v212
  v_mul_f32 v48, v48, v212
  v_mul_f32 v49, v49, v212
  v_mul_f32 v50, v50, v212
  v_mul_f32 v51, v51, v212
  v_mul_f32 v52, v52, v212
  v_mul_f32 v53, v53, v212
  v_mul_f32 v54, v54, v212
  v_mul_f32 v55, v55, v212
  v_cvt_pk_bf16_f32 v40, v40, v41
  v_cvt_pk_bf16_f32 v41, v42, v43
  v_cvt_pk_bf16_f32 v42, v44, v45
  v_cvt_pk_bf16_f32 v43, v46, v47
  s_add_u32 s41, s72, 4096
  buffer_store_dwordx4 v[40:43], v3, s[24:27], s41 offen offset:0 sc1
  v_cvt_pk_bf16_f32 v48, v48, v49
  v_cvt_pk_bf16_f32 v49, v50, v51
  v_cvt_pk_bf16_f32 v50, v52, v53
  v_cvt_pk_bf16_f32 v51, v54, v55
  s_add_u32 s41, s72, 6144
  buffer_store_dwordx4 v[48:51], v3, s[24:27], s41 offen offset:0 sc1
  v_accvgpr_read_b32 v56, a48
  v_accvgpr_read_b32 v57, a49
  v_accvgpr_read_b32 v58, a50
  v_accvgpr_read_b32 v59, a51
  v_accvgpr_read_b32 v60, a52
  v_accvgpr_read_b32 v61, a53
  v_accvgpr_read_b32 v62, a54
  v_accvgpr_read_b32 v63, a55
  v_accvgpr_read_b32 v64, a56
  v_accvgpr_read_b32 v65, a57
  v_accvgpr_read_b32 v66, a58
  v_accvgpr_read_b32 v67, a59
  v_accvgpr_read_b32 v68, a60
  v_accvgpr_read_b32 v69, a61
  v_accvgpr_read_b32 v70, a62
  v_accvgpr_read_b32 v71, a63
  v_mul_f32 v56, v56, v213
  v_mul_f32 v57, v57, v213
  v_mul_f32 v58, v58, v213
  v_mul_f32 v59, v59, v213
  v_mul_f32 v60, v60, v213
  v_mul_f32 v61, v61, v213
  v_mul_f32 v62, v62, v213
  v_mul_f32 v63, v63, v213
  v_mul_f32 v64, v64, v213
  v_mul_f32 v65, v65, v213
  v_mul_f32 v66, v66, v213
  v_mul_f32 v67, v67, v213
  v_mul_f32 v68, v68, v213
  v_mul_f32 v69, v69, v213
  v_mul_f32 v70, v70, v213
  v_mul_f32 v71, v71, v213
  v_cvt_pk_bf16_f32 v56, v56, v57
  v_cvt_pk_bf16_f32 v57, v58, v59
  v_cvt_pk_bf16_f32 v58, v60, v61
  v_cvt_pk_bf16_f32 v59, v62, v63
  s_add_u32 s41, s72, 4096
  buffer_store_dwordx4 v[56:59], v3, s[24:27], s41 offen offset:1024 sc1
  v_cvt_pk_bf16_f32 v64, v64, v65
  v_cvt_pk_bf16_f32 v65, v66, v67
  v_cvt_pk_bf16_f32 v66, v68, v69
  v_cvt_pk_bf16_f32 v67, v70, v71
  s_add_u32 s41, s72, 6144
  buffer_store_dwordx4 v[64:67], v3, s[24:27], s41 offen offset:1024 sc1
  v_accvgpr_read_b32 v8, a64
  v_accvgpr_read_b32 v9, a65
  v_accvgpr_read_b32 v10, a66
  v_accvgpr_read_b32 v11, a67
  v_accvgpr_read_b32 v12, a68
  v_accvgpr_read_b32 v13, a69
  v_accvgpr_read_b32 v14, a70
  v_accvgpr_read_b32 v15, a71
  v_accvgpr_read_b32 v16, a72
  v_accvgpr_read_b32 v17, a73
  v_accvgpr_read_b32 v18, a74
  v_accvgpr_read_b32 v19, a75
  v_accvgpr_read_b32 v20, a76
  v_accvgpr_read_b32 v21, a77
  v_accvgpr_read_b32 v22, a78
  v_accvgpr_read_b32 v23, a79
  v_mul_f32 v8, v8, v212
  v_mul_f32 v9, v9, v212
  v_mul_f32 v10, v10, v212
  v_mul_f32 v11, v11, v212
  v_mul_f32 v12, v12, v212
  v_mul_f32 v13, v13, v212
  v_mul_f32 v14, v14, v212
  v_mul_f32 v15, v15, v212
  v_mul_f32 v16, v16, v212
  v_mul_f32 v17, v17, v212
  v_mul_f32 v18, v18, v212
  v_mul_f32 v19, v19, v212
  v_mul_f32 v20, v20, v212
  v_mul_f32 v21, v21, v212
  v_mul_f32 v22, v22, v212
  v_mul_f32 v23, v23, v212
  v_cvt_pk_bf16_f32 v8, v8, v9
  v_cvt_pk_bf16_f32 v9, v10, v11
  v_cvt_pk_bf16_f32 v10, v12, v13
  v_cvt_pk_bf16_f32 v11, v14, v15
  s_add_u32 s41, s72, 8192
  buffer_store_dwordx4 v[8:11], v3, s[24:27], s41 offen offset:0 sc1
  v_cvt_pk_bf16_f32 v16, v16, v17
  v_cvt_pk_bf16_f32 v17, v18, v19
  v_cvt_pk_bf16_f32 v18, v20, v21
  v_cvt_pk_bf16_f32 v19, v22, v23
  s_add_u32 s41, s72, 10240
  buffer_store_dwordx4 v[16:19], v3, s[24:27], s41 offen offset:0 sc1
  v_accvgpr_read_b32 v24, a80
  v_accvgpr_read_b32 v25, a81
  v_accvgpr_read_b32 v26, a82
  v_accvgpr_read_b32 v27, a83
  v_accvgpr_read_b32 v28, a84
  v_accvgpr_read_b32 v29, a85
  v_accvgpr_read_b32 v30, a86
  v_accvgpr_read_b32 v31, a87
  v_accvgpr_read_b32 v32, a88
  v_accvgpr_read_b32 v33, a89
  v_accvgpr_read_b32 v34, a90
  v_accvgpr_read_b32 v35, a91
  v_accvgpr_read_b32 v36, a92
  v_accvgpr_read_b32 v37, a93
  v_accvgpr_read_b32 v38, a94
  v_accvgpr_read_b32 v39, a95
  v_mul_f32 v24, v24, v213
  v_mul_f32 v25, v25, v213
  v_mul_f32 v26, v26, v213
  v_mul_f32 v27, v27, v213
  v_mul_f32 v28, v28, v213
  v_mul_f32 v29, v29, v213
  v_mul_f32 v30, v30, v213
  v_mul_f32 v31, v31, v213
  v_mul_f32 v32, v32, v213
  v_mul_f32 v33, v33, v213
  v_mul_f32 v34, v34, v213
  v_mul_f32 v35, v35, v213
  v_mul_f32 v36, v36, v213
  v_mul_f32 v37, v37, v213
  v_mul_f32 v38, v38, v213
  v_mul_f32 v39, v39, v213
  v_cvt_pk_bf16_f32 v24, v24, v25
  v_cvt_pk_bf16_f32 v25, v26, v27
  v_cvt_pk_bf16_f32 v26, v28, v29
  v_cvt_pk_bf16_f32 v27, v30, v31
  s_add_u32 s41, s72, 8192
  buffer_store_dwordx4 v[24:27], v3, s[24:27], s41 offen offset:1024 sc1
  v_cvt_pk_bf16_f32 v32, v32, v33
  v_cvt_pk_bf16_f32 v33, v34, v35
  v_cvt_pk_bf16_f32 v34, v36, v37
  v_cvt_pk_bf16_f32 v35, v38, v39
  s_add_u32 s41, s72, 10240
  buffer_store_dwordx4 v[32:35], v3, s[24:27], s41 offen offset:1024 sc1
  v_accvgpr_read_b32 v40, a96
  v_accvgpr_read_b32 v41, a97
  v_accvgpr_read_b32 v42, a98
  v_accvgpr_read_b32 v43, a99
  v_accvgpr_read_b32 v44, a100
  v_accvgpr_read_b32 v45, a101
  v_accvgpr_read_b32 v46, a102
  v_accvgpr_read_b32 v47, a103
  v_accvgpr_read_b32 v48, a104
  v_accvgpr_read_b32 v49, a105
  v_accvgpr_read_b32 v50, a106
  v_accvgpr_read_b32 v51, a107
  v_accvgpr_read_b32 v52, a108
  v_accvgpr_read_b32 v53, a109
  v_accvgpr_read_b32 v54, a110
  v_accvgpr_read_b32 v55, a111
  v_mul_f32 v40, v40, v212
  v_mul_f32 v41, v41, v212
  v_mul_f32 v42, v42, v212
  v_mul_f32 v43, v43, v212
  v_mul_f32 v44, v44, v212
  v_mul_f32 v45, v45, v212
  v_mul_f32 v46, v46, v212
  v_mul_f32 v47, v47, v212
  v_mul_f32 v48, v48, v212
  v_mul_f32 v49, v49, v212
  v_mul_f32 v50, v50, v212
  v_mul_f32 v51, v51, v212
  v_mul_f32 v52, v52, v212
  v_mul_f32 v53, v53, v212
  v_mul_f32 v54, v54, v212
  v_mul_f32 v55, v55, v212
  v_cvt_pk_bf16_f32 v40, v40, v41
  v_cvt_pk_bf16_f32 v41, v42, v43
  v_cvt_pk_bf16_f32 v42, v44, v45
  v_cvt_pk_bf16_f32 v43, v46, v47
  s_add_u32 s41, s72, 12288
  buffer_store_dwordx4 v[40:43], v3, s[24:27], s41 offen offset:0 sc1
  v_cvt_pk_bf16_f32 v48, v48, v49
  v_cvt_pk_bf16_f32 v49, v50, v51
  v_cvt_pk_bf16_f32 v50, v52, v53
  v_cvt_pk_bf16_f32 v51, v54, v55
  s_add_u32 s41, s72, 14336
  buffer_store_dwordx4 v[48:51], v3, s[24:27], s41 offen offset:0 sc1
  v_accvgpr_read_b32 v56, a112
  v_accvgpr_read_b32 v57, a113
  v_accvgpr_read_b32 v58, a114
  v_accvgpr_read_b32 v59, a115
  v_accvgpr_read_b32 v60, a116
  v_accvgpr_read_b32 v61, a117
  v_accvgpr_read_b32 v62, a118
  v_accvgpr_read_b32 v63, a119
  v_accvgpr_read_b32 v64, a120
  v_accvgpr_read_b32 v65, a121
  v_accvgpr_read_b32 v66, a122
  v_accvgpr_read_b32 v67, a123
  v_accvgpr_read_b32 v68, a124
  v_accvgpr_read_b32 v69, a125
  v_accvgpr_read_b32 v70, a126
  v_accvgpr_read_b32 v71, a127
  v_mul_f32 v56, v56, v213
  v_mul_f32 v57, v57, v213
  v_mul_f32 v58, v58, v213
  v_mul_f32 v59, v59, v213
  v_mul_f32 v60, v60, v213
  v_mul_f32 v61, v61, v213
  v_mul_f32 v62, v62, v213
  v_mul_f32 v63, v63, v213
  v_mul_f32 v64, v64, v213
  v_mul_f32 v65, v65, v213
  v_mul_f32 v66, v66, v213
  v_mul_f32 v67, v67, v213
  v_mul_f32 v68, v68, v213
  v_mul_f32 v69, v69, v213
  v_mul_f32 v70, v70, v213
  v_mul_f32 v71, v71, v213
  v_cvt_pk_bf16_f32 v56, v56, v57
  v_cvt_pk_bf16_f32 v57, v58, v59
  v_cvt_pk_bf16_f32 v58, v60, v61
  v_cvt_pk_bf16_f32 v59, v62, v63
  s_add_u32 s41, s72, 12288
  buffer_store_dwordx4 v[56:59], v3, s[24:27], s41 offen offset:1024 sc1
  v_cvt_pk_bf16_f32 v64, v64, v65
  v_cvt_pk_bf16_f32 v65, v66, v67
  v_cvt_pk_bf16_f32 v66, v68, v69
  v_cvt_pk_bf16_f32 v67, v70, v71
  s_add_u32 s41, s72, 14336
  buffer_store_dwordx4 v[64:67], v3, s[24:27], s41 offen offset:1024 sc1
  s_endpgm
k2_fb2:
  v_max3_f32 v212, v8, v9, v10
  v_max3_f32 v212, v212, v11, v12
  v_max3_f32 v212, v212, v13, v14
  v_max3_f32 v212, v212, v15, v16
  v_max3_f32 v212, v212, v17, v18
  v_max3_f32 v212, v212, v19, v20
  v_max3_f32 v212, v212, v21, v22
  v_max_f32 v212, v212, v23
  v_mov_b32 v213, v212
  s_nop 1
  v_permlane32_swap_b32 v212, v213
  v_max_f32 v212, v212, v213
  v_sub_f32 v104, v104, v212
  v_sub_f32 v105, v105, v212
  v_sub_f32 v106, v106, v212
  v_sub_f32 v107, v107, v212
  v_sub_f32 v108, v108, v212
  v_sub_f32 v109, v109, v212
  v_sub_f32 v110, v110, v212
  v_sub_f32 v111, v111, v212
  v_sub_f32 v112, v112, v212
  v_sub_f32 v113, v113, v212
  v_sub_f32 v114, v114, v212
  v_sub_f32 v115, v115, v212
  v_sub_f32 v116, v116, v212
  v_sub_f32 v117, v117, v212
  v_sub_f32 v118, v118, v212
  v_sub_f32 v119, v119, v212
  v_sub_f32 v8, v8, v212
  v_sub_f32 v9, v9, v212
  v_sub_f32 v10, v10, v212
  v_sub_f32 v11, v11, v212
  v_sub_f32 v12, v12, v212
  v_sub_f32 v13, v13, v212
  v_sub_f32 v14, v14, v212
  v_sub_f32 v15, v15, v212
  v_sub_f32 v16, v16, v212
  v_sub_f32 v17, v17, v212
  v_sub_f32 v18, v18, v212
  v_sub_f32 v19, v19, v212
  v_sub_f32 v20, v20, v212
  v_sub_f32 v21, v21, v212
  v_sub_f32 v22, v22, v212
  v_sub_f32 v23, v23, v212
  v_sub_f32 v40, v40, v212
  v_sub_f32 v41, v41, v212
  v_sub_f32 v42, v42, v212
  v_sub_f32 v43, v43, v212
  v_sub_f32 v44, v44, v212
  v_sub_f32 v45, v45, v212
  v_sub_f32 v46, v46, v212
  v_sub_f32 v47, v47, v212
  v_sub_f32 v48, v48, v212
  v_sub_f32 v49, v49, v212
  v_sub_f32 v50, v50, v212
  v_sub_f32 v51, v51, v212
  v_sub_f32 v52, v52, v212
  v_sub_f32 v53, v53, v212
  v_sub_f32 v54, v54, v212
  v_sub_f32 v55, v55, v212
  v_max3_f32 v212, v24, v25, v26
  v_max3_f32 v212, v212, v27, v28
  v_max3_f32 v212, v212, v29, v30
  v_max3_f32 v212, v212, v31, v32
  v_max3_f32 v212, v212, v33, v34
  v_max3_f32 v212, v212, v35, v36
  v_max3_f32 v212, v212, v37, v38
  v_max_f32 v212, v212, v39
  v_mov_b32 v213, v212
  s_nop 1
  v_permlane32_swap_b32 v212, v213
  v_max_f32 v212, v212, v213
  v_sub_f32 v120, v120, v212
  v_sub_f32 v121, v121, v212
  v_sub_f32 v122, v122, v212
  v_sub_f32 v123, v123, v212
  v_sub_f32 v124, v124, v212
  v_sub_f32 v125, v125, v212
  v_sub_f32 v126, v126, v212
  v_sub_f32 v127, v127, v212
  v_sub_f32 v128, v128, v212
  v_sub_f32 v129, v129, v212
  v_sub_f32 v130, v130, v212
  v_sub_f32 v131, v131, v212
  v_sub_f32 v132, v132, v212
  v_sub_f32 v133, v133, v212
  v_sub_f32 v134, v134, v212
  v_sub_f32 v135, v135, v212
  v_sub_f32 v24, v24, v212
  v_sub_f32 v25, v25, v212
  v_sub_f32 v26, v26, v212
  v_sub_f32 v27, v27, v212
  v_sub_f32 v28, v28, v212
  v_sub_f32 v29, v29, v212
  v_sub_f32 v30, v30, v212
  v_sub_f32 v31, v31, v212
  v_sub_f32 v32, v32, v212
  v_sub_f32 v33, v33, v212
  v_sub_f32 v34, v34, v212
  v_sub_f32 v35, v35, v212
  v_sub_f32 v36, v36, v212
  v_sub_f32 v37, v37, v212
  v_sub_f32 v38, v38, v212
  v_sub_f32 v39, v39, v212
  v_sub_f32 v56, v56, v212
  v_sub_f32 v57, v57, v212
  v_sub_f32 v58, v58, v212
  v_sub_f32 v59, v59, v212
  v_sub_f32 v60, v60, v212
  v_sub_f32 v61, v61, v212
  v_sub_f32 v62, v62, v212
  v_sub_f32 v63, v63, v212
  v_sub_f32 v64, v64, v212
  v_sub_f32 v65, v65, v212
  v_sub_f32 v66, v66, v212
  v_sub_f32 v67, v67, v212
  v_sub_f32 v68, v68, v212
  v_sub_f32 v69, v69, v212
  v_sub_f32 v70, v70, v212
  v_sub_f32 v71, v71, v212
  v_exp_f32 v200, v8
  v_exp_f32 v201, v9
  v_add_f32 v208, v210, v200
  v_exp_f32 v202, v10
  v_add_f32 v208, v208, v201
  v_cvt_pk_bf16_f32 v72, v200, v201
  v_exp_f32 v203, v11
  v_add_f32 v208, v208, v202
  v_exp_f32 v204, v12
  v_add_f32 v208, v208, v203
  v_cvt_pk_bf16_f32 v73, v202, v203
  v_exp_f32 v205, v13
  v_add_f32 v208, v208, v204
  v_exp_f32 v206, v14
  v_add_f32 v208, v208, v205
  v_cvt_pk_bf16_f32 v74, v204, v205
  v_exp_f32 v207, v15
  v_add_f32 v208, v208, v206
  v_exp_f32 v200, v16
  v_add_f32 v208, v208, v207
  v_cvt_pk_bf16_f32 v75, v206, v207
  v_exp_f32 v201, v17
  v_add_f32 v208, v208, v200
  v_exp_f32 v202, v18
  v_add_f32 v208, v208, v201
  v_cvt_pk_bf16_f32 v76, v200, v201
  v_exp_f32 v203, v19
  v_add_f32 v208, v208, v202
  v_exp_f32 v204, v20
  v_add_f32 v208, v208, v203
  v_cvt_pk_bf16_f32 v77, v202, v203
  v_exp_f32 v205, v21
  v_add_f32 v208, v208, v204
  v_exp_f32 v206, v22
  v_add_f32 v208, v208, v205
  v_cvt_pk_bf16_f32 v78, v204, v205
  v_exp_f32 v207, v23
  v_add_f32 v208, v208, v206
  v_exp_f32 v200, v24
  v_add_f32 v208, v208, v207
  v_cvt_pk_bf16_f32 v79, v206, v207
  v_exp_f32 v201, v25
  v_add_f32 v209, v211, v200
  v_exp_f32 v202, v26
  v_add_f32 v209, v209, v201
  v_cvt_pk_bf16_f32 v80, v200, v201
  v_exp_f32 v203, v27
  v_add_f32 v209, v209, v202
  v_exp_f32 v204, v28
  v_add_f32 v209, v209, v203
  v_cvt_pk_bf16_f32 v81, v202, v203
  v_exp_f32 v205, v29
  v_add_f32 v209, v209, v204
  v_exp_f32 v206, v30
  v_add_f32 v209, v209, v205
  v_cvt_pk_bf16_f32 v82, v204, v205
  v_exp_f32 v207, v31
  v_add_f32 v209, v209, v206
  v_exp_f32 v200, v32
  v_add_f32 v209, v209, v207
  v_cvt_pk_bf16_f32 v83, v206, v207
  v_exp_f32 v201, v33
  v_add_f32 v209, v209, v200
  v_exp_f32 v202, v34
  v_add_f32 v209, v209, v201
  v_cvt_pk_bf16_f32 v84, v200, v201
  v_exp_f32 v203, v35
  v_add_f32 v209, v209, v202
  v_exp_f32 v204, v36
  v_add_f32 v209, v209, v203
  v_cvt_pk_bf16_f32 v85, v202, v203
  v_exp_f32 v205, v37
  v_add_f32 v209, v209, v204
  v_exp_f32 v206, v38
  v_add_f32 v209, v209, v205
  v_cvt_pk_bf16_f32 v86, v204, v205
  v_exp_f32 v207, v39
  v_add_f32 v209, v209, v206
  v_add_f32 v209, v209, v207
  v_cvt_pk_bf16_f32 v87, v206, v207
  s_branch k2_ret3
k2_fb4:
  v_max3_f32 v212, v40, v41, v42
  v_max3_f32 v212, v212, v43, v44
  v_max3_f32 v212, v212, v45, v46
  v_max3_f32 v212, v212, v47, v48
  v_max3_f32 v212, v212, v49, v50
  v_max3_f32 v212, v212, v51, v52
  v_max3_f32 v212, v212, v53, v54
  v_max_f32 v212, v212, v55
  v_mov_b32 v213, v212
  s_nop 1
  v_permlane32_swap_b32 v212, v213
  v_max_f32 v212, v212, v213
  v_max_f32 v212, 0, v212
  v_sub_f32 v104, v104, v212
  v_sub_f32 v105, v105, v212
  v_sub_f32 v106, v106, v212
  v_sub_f32 v107, v107, v212
  v_sub_f32 v108, v108, v212
  v_sub_f32 v109, v109, v212
  v_sub_f32 v110, v110, v212
  v_sub_f32 v111, v111, v212
  v_sub_f32 v112, v112, v212
  v_sub_f32 v113, v113, v212
  v_sub_f32 v114, v114, v212
  v_sub_f32 v115, v115, v212
  v_sub_f32 v116, v116, v212
  v_sub_f32 v117, v117, v212
  v_sub_f32 v118, v118, v212
  v_sub_f32 v119, v119, v212
  v_sub_f32 v40, v40, v212
  v_sub_f32 v41, v41, v212
  v_sub_f32 v42, v42, v212
  v_sub_f32 v43, v43, v212
  v_sub_f32 v44, v44, v212
  v_sub_f32 v45, v45, v212
  v_sub_f32 v46, v46, v212
  v_sub_f32 v47, v47, v212
  v_sub_f32 v48, v48, v212
  v_sub_f32 v49, v49, v212
  v_sub_f32 v50, v50, v212
  v_sub_f32 v51, v51, v212
  v_sub_f32 v52, v52, v212
  v_sub_f32 v53, v53, v212
  v_sub_f32 v54, v54, v212
  v_sub_f32 v55, v55, v212
  v_sub_f32 v8, v8, v212
  v_sub_f32 v9, v9, v212
  v_sub_f32 v10, v10, v212
  v_sub_f32 v11, v11, v212
  v_sub_f32 v12, v12, v212
  v_sub_f32 v13, v13, v212
  v_sub_f32 v14, v14, v212
  v_sub_f32 v15, v15, v212
  v_sub_f32 v16, v16, v212
  v_sub_f32 v17, v17, v212
  v_sub_f32 v18, v18, v212
  v_sub_f32 v19, v19, v212
  v_sub_f32 v20, v20, v212
  v_sub_f32 v21, v21, v212
  v_sub_f32 v22, v22, v212
  v_sub_f32 v23, v23, v212
  v_sub_f32 v214, 0, v212
  v_exp_f32 v214, v214
  s_nop 0
  v_mul_f32 v208, v208, v214
  v_accvgpr_read_b32 v213, a0
  v_mul_f32 v213, v213, v214
  v_accvgpr_write_b32 a0, v213
  v_accvgpr_read_b32 v213, a1
  v_mul_f32 v213, v213, v214
  v_accvgpr_write_b32 a1, v213
  v_accvgpr_read_b32 v213, a2
  v_mul_f32 v213, v213, v214
  v_accvgpr_write_b32 a2, v213
  v_accvgpr_read_b32 v213, a3
  v_mul_f32 v213, v213, v214
  v_accvgpr_write_b32 a3, v213
  v_accvgpr_read_b32 v213, a4
  v_mul_f32 v213, v213, v214
  v_accvgpr_write_b32 a4, v213
  v_accvgpr_read_b32 v213, a5
  v_mul_f32 v213, v213, v214
  v_accvgpr_write_b32 a5, v213
  v_accvgpr_read_b32 v213, a6
  v_mul_f32 v213, v213, v214
  v_accvgpr_write_b32 a6, v213
  v_accvgpr_read_b32 v213, a7
  v_mul_f32 v213, v213, v214
  v_accvgpr_write_b32 a7, v213
  v_accvgpr_read_b32 v213, a8
  v_mul_f32 v213, v213, v214
  v_accvgpr_write_b32 a8, v213
  v_accvgpr_read_b32 v213, a9
  v_mul_f32 v213, v213, v214
  v_accvgpr_write_b32 a9, v213
  v_accvgpr_read_b32 v213, a10
  v_mul_f32 v213, v213, v214
  v_accvgpr_write_b32 a10, v213
  v_accvgpr_read_b32 v213, a11
  v_mul_f32 v213, v213, v214
  v_accvgpr_write_b32 a11, v213
  v_accvgpr_read_b32 v213, a12
  v_mul_f32 v213, v213, v214
  v_accvgpr_write_b32 a12, v213
  v_accvgpr_read_b32 v213, a13
  v_mul_f32 v213, v213, v214
  v_accvgpr_write_b32 a13, v213
  v_accvgpr_read_b32 v213, a14
  v_mul_f32 v213, v213, v214
  v_accvgpr_write_b32 a14, v213
  v_accvgpr_read_b32 v213, a15
  v_mul_f32 v213, v213, v214
  v_accvgpr_write_b32 a15, v213
  v_accvgpr_read_b32 v213, a32
  v_mul_f32 v213, v213, v214
  v_accvgpr_write_b32 a32, v213
  v_accvgpr_read_b32 v213, a33
  v_mul_f32 v213, v213, v214
  v_accvgpr_write_b32 a33, v213
  v_accvgpr_read_b32 v213, a34
  v_mul_f32 v213, v213, v214
  v_accvgpr_write_b32 a34, v213
  v_accvgpr_read_b32 v213, a35
  v_mul_f32 v213, v213, v214
  v_accvgpr_write_b32 a35, v213
  v_accvgpr_read_b32 v213, a36
  v_mul_f32 v213, v213, v214
  v_accvgpr_write_b32 a36, v213
  v_accvgpr_read_b32 v213, a37
  v_mul_f32 v213, v213, v214
  v_accvgpr_write_b32 a37, v213
  v_accvgpr_read_b32 v213, a38
  v_mul_f32 v213, v213, v214
  v_accvgpr_write_b32 a38, v213
  v_accvgpr_read_b32 v213, a39
  v_mul_f32 v213, v213, v214
  v_accvgpr_write_b32 a39, v213
  v_accvgpr_read_b32 v213, a40
  v_mul_f32 v213, v213, v214
  v_accvgpr_write_b32 a40, v213
  v_accvgpr_read_b32 v213, a41
  v_mul_f32 v213, v213, v214
  v_accvgpr_write_b32 a41, v213
  v_accvgpr_read_b32 v213, a42
  v_mul_f32 v213, v213, v214
  v_accvgpr_write_b32 a42, v213
  v_accvgpr_read_b32 v213, a43
  v_mul_f32 v213, v213, v214
  v_accvgpr_write_b32 a43, v213
  v_accvgpr_read_b32 v213, a44
  v_mul_f32 v213, v213, v214
  v_accvgpr_write_b32 a44, v213
  v_accvgpr_read_b32 v213, a45
  v_mul_f32 v213, v213, v214
  v_accvgpr_write_b32 a45, v213
  v_accvgpr_read_b32 v213, a46
  v_mul_f32 v213, v213, v214
  v_accvgpr_write_b32 a46, v213
  v_accvgpr_read_b32 v213, a47
  v_mul_f32 v213, v213, v214
  v_accvgpr_write_b32 a47, v213
  v_accvgpr_read_b32 v213, a64
  v_mul_f32 v213, v213, v214
  v_accvgpr_write_b32 a64, v213
  v_accvgpr_read_b32 v213, a65
  v_mul_f32 v213, v213, v214
  v_accvgpr_write_b32 a65, v213
  v_accvgpr_read_b32 v213, a66
  v_mul_f32 v213, v213, v214
  v_accvgpr_write_b32 a66, v213
  v_accvgpr_read_b32 v213, a67
  v_mul_f32 v213, v213, v214
  v_accvgpr_write_b32 a67, v213
  v_accvgpr_read_b32 v213, a68
  v_mul_f32 v213, v213, v214
  v_accvgpr_write_b32 a68, v213
  v_accvgpr_read_b32 v213, a69
  v_mul_f32 v213, v213, v214
  v_accvgpr_write_b32 a69, v213
  v_accvgpr_read_b32 v213, a70
  v_mul_f32 v213, v213, v214
  v_accvgpr_write_b32 a70, v213
  v_accvgpr_read_b32 v213, a71
  v_mul_f32 v213, v213, v214
  v_accvgpr_write_b32 a71, v213
  v_accvgpr_read_b32 v213, a72
  v_mul_f32 v213, v213, v214
  v_accvgpr_write_b32 a72, v213
  v_accvgpr_read_b32 v213, a73
  v_mul_f32 v213, v213, v214
  v_accvgpr_write_b32 a73, v213
  v_accvgpr_read_b32 v213, a74
  v_mul_f32 v213, v213, v214
  v_accvgpr_write_b32 a74, v213
  v_accvgpr_read_b32 v213, a75
  v_mul_f32 v213, v213, v214
  v_accvgpr_write_b32 a75, v213
  v_accvgpr_read_b32 v213, a76
  v_mul_f32 v213, v213, v214
  v_accvgpr_write_b32 a76, v213
  v_accvgpr_read_b32 v213, a77
  v_mul_f32 v213, v213, v214
  v_accvgpr_write_b32 a77, v213
  v_accvgpr_read_b32 v213, a78
  v_mul_f32 v213, v213, v214
  v_accvgpr_write_b32 a78, v213
  v_accvgpr_read_b32 v213, a79
  v_mul_f32 v213, v213, v214
  v_accvgpr_write_b32 a79, v213
  v_accvgpr_read_b32 v213, a96
  v_mul_f32 v213, v213, v214
  v_accvgpr_write_b32 a96, v213
  v_accvgpr_read_b32 v213, a97
  v_mul_f32 v213, v213, v214
  v_accvgpr_write_b32 a97, v213
  v_accvgpr_read_b32 v213, a98
  v_mul_f32 v213, v213, v214
  v_accvgpr_write_b32 a98, v213
  v_accvgpr_read_b32 v213, a99
  v_mul_f32 v213, v213, v214
  v_accvgpr_write_b32 a99, v213
  v_accvgpr_read_b32 v213, a100
  v_mul_f32 v213, v213, v214
  v_accvgpr_write_b32 a100, v213
  v_accvgpr_read_b32 v213, a101
  v_mul_f32 v213, v213, v214
  v_accvgpr_write_b32 a101, v213
  v_accvgpr_read_b32 v213, a102
  v_mul_f32 v213, v213, v214
  v_accvgpr_write_b32 a102, v213
  v_accvgpr_read_b32 v213, a103
  v_mul_f32 v213, v213, v214
  v_accvgpr_write_b32 a103, v213
  v_accvgpr_read_b32 v213, a104
  v_mul_f32 v213, v213, v214
  v_accvgpr_write_b32 a104, v213
  v_accvgpr_read_b32 v213, a105
  v_mul_f32 v213, v213, v214
  v_accvgpr_write_b32 a105, v213
  v_accvgpr_read_b32 v213, a106
  v_mul_f32 v213, v213, v214
  v_accvgpr_write_b32 a106, v213
  v_accvgpr_read_b32 v213, a107
  v_mul_f32 v213, v213, v214
  v_accvgpr_write_b32 a107, v213
  v_accvgpr_read_b32 v213, a108
  v_mul_f32 v213, v213, v214
  v_accvgpr_write_b32 a108, v213
  v_accvgpr_read_b32 v213, a109
  v_mul_f32 v213, v213, v214
  v_accvgpr_write_b32 a109, v213
  v_accvgpr_read_b32 v213, a110
  v_mul_f32 v213, v213, v214
  v_accvgpr_write_b32 a110, v213
  v_accvgpr_read_b32 v213, a111
  v_mul_f32 v213, v213, v214
  v_accvgpr_write_b32 a111, v213
  v_max3_f32 v212, v56, v57, v58
  v_max3_f32 v212, v212, v59, v60
  v_max3_f32 v212, v212, v61, v62
  v_max3_f32 v212, v212, v63, v64
  v_max3_f32 v212, v212, v65, v66
  v_max3_f32 v212, v212, v67, v68
  v_max3_f32 v212, v212, v69, v70
  v_max_f32 v212, v212, v71
  v_mov_b32 v213, v212
  s_nop 1
  v_permlane32_swap_b32 v212, v213
  v_max_f32 v212, v212, v213
  v_max_f32 v212, 0, v212
  v_sub_f32 v120, v120, v212
  v_sub_f32 v121, v121, v212
  v_sub_f32 v122, v122, v212
  v_sub_f32 v123, v123, v212
  v_sub_f32 v124, v124, v212
  v_sub_f32 v125, v125, v212
  v_sub_f32 v126, v126, v212
  v_sub_f32 v127, v127, v212
  v_sub_f32 v128, v128, v212
  v_sub_f32 v129, v129, v212
  v_sub_f32 v130, v130, v212
  v_sub_f32 v131, v131, v212
  v_sub_f32 v132, v132, v212
  v_sub_f32 v133, v133, v212
  v_sub_f32 v134, v134, v212
  v_sub_f32 v135, v135, v212
  v_sub_f32 v56, v56, v212
  v_sub_f32 v57, v57, v212
  v_sub_f32 v58, v58, v212
  v_sub_f32 v59, v59, v212
  v_sub_f32 v60, v60, v212
  v_sub_f32 v61, v61, v212
  v_sub_f32 v62, v62, v212
  v_sub_f32 v63, v63, v212
  v_sub_f32 v64, v64, v212
  v_sub_f32 v65, v65, v212
  v_sub_f32 v66, v66, v212
  v_sub_f32 v67, v67, v212
  v_sub_f32 v68, v68, v212
  v_sub_f32 v69, v69, v212
  v_sub_f32 v70, v70, v212
  v_sub_f32 v71, v71, v212
  v_sub_f32 v24, v24, v212
  v_sub_f32 v25, v25, v212
  v_sub_f32 v26, v26, v212
  v_sub_f32 v27, v27, v212
  v_sub_f32 v28, v28, v212
  v_sub_f32 v29, v29, v212
  v_sub_f32 v30, v30, v212
  v_sub_f32 v31, v31, v212
  v_sub_f32 v32, v32, v212
  v_sub_f32 v33, v33, v212
  v_sub_f32 v34, v34, v212
  v_sub_f32 v35, v35, v212
  v_sub_f32 v36, v36, v212
  v_sub_f32 v37, v37, v212
  v_sub_f32 v38, v38, v212
  v_sub_f32 v39, v39, v212
  v_sub_f32 v214, 0, v212
  v_exp_f32 v214, v214
  s_nop 0
  v_mul_f32 v209, v209, v214
  v_accvgpr_read_b32 v213, a16
  v_mul_f32 v213, v213, v214
  v_accvgpr_write_b32 a16, v213
  v_accvgpr_read_b32 v213, a17
  v_mul_f32 v213, v213, v214
  v_accvgpr_write_b32 a17, v213
  v_accvgpr_read_b32 v213, a18
  v_mul_f32 v213, v213, v214
  v_accvgpr_write_b32 a18, v213
  v_accvgpr_read_b32 v213, a19
  v_mul_f32 v213, v213, v214
  v_accvgpr_write_b32 a19, v213
  v_accvgpr_read_b32 v213, a20
  v_mul_f32 v213, v213, v214
  v_accvgpr_write_b32 a20, v213
  v_accvgpr_read_b32 v213, a21
  v_mul_f32 v213, v213, v214
  v_accvgpr_write_b32 a21, v213
  v_accvgpr_read_b32 v213, a22
  v_mul_f32 v213, v213, v214
  v_accvgpr_write_b32 a22, v213
  v_accvgpr_read_b32 v213, a23
  v_mul_f32 v213, v213, v214
  v_accvgpr_write_b32 a23, v213
  v_accvgpr_read_b32 v213, a24
  v_mul_f32 v213, v213, v214
  v_accvgpr_write_b32 a24, v213
  v_accvgpr_read_b32 v213, a25
  v_mul_f32 v213, v213, v214
  v_accvgpr_write_b32 a25, v213
  v_accvgpr_read_b32 v213, a26
  v_mul_f32 v213, v213, v214
  v_accvgpr_write_b32 a26, v213
  v_accvgpr_read_b32 v213, a27
  v_mul_f32 v213, v213, v214
  v_accvgpr_write_b32 a27, v213
  v_accvgpr_read_b32 v213, a28
  v_mul_f32 v213, v213, v214
  v_accvgpr_write_b32 a28, v213
  v_accvgpr_read_b32 v213, a29
  v_mul_f32 v213, v213, v214
  v_accvgpr_write_b32 a29, v213
  v_accvgpr_read_b32 v213, a30
  v_mul_f32 v213, v213, v214
  v_accvgpr_write_b32 a30, v213
  v_accvgpr_read_b32 v213, a31
  v_mul_f32 v213, v213, v214
  v_accvgpr_write_b32 a31, v213
  v_accvgpr_read_b32 v213, a48
  v_mul_f32 v213, v213, v214
  v_accvgpr_write_b32 a48, v213
  v_accvgpr_read_b32 v213, a49
  v_mul_f32 v213, v213, v214
  v_accvgpr_write_b32 a49, v213
  v_accvgpr_read_b32 v213, a50
  v_mul_f32 v213, v213, v214
  v_accvgpr_write_b32 a50, v213
  v_accvgpr_read_b32 v213, a51
  v_mul_f32 v213, v213, v214
  v_accvgpr_write_b32 a51, v213
  v_accvgpr_read_b32 v213, a52
  v_mul_f32 v213, v213, v214
  v_accvgpr_write_b32 a52, v213
  v_accvgpr_read_b32 v213, a53
  v_mul_f32 v213, v213, v214
  v_accvgpr_write_b32 a53, v213
  v_accvgpr_read_b32 v213, a54
  v_mul_f32 v213, v213, v214
  v_accvgpr_write_b32 a54, v213
  v_accvgpr_read_b32 v213, a55
  v_mul_f32 v213, v213, v214
  v_accvgpr_write_b32 a55, v213
  v_accvgpr_read_b32 v213, a56
  v_mul_f32 v213, v213, v214
  v_accvgpr_write_b32 a56, v213
  v_accvgpr_read_b32 v213, a57
  v_mul_f32 v213, v213, v214
  v_accvgpr_write_b32 a57, v213
  v_accvgpr_read_b32 v213, a58
  v_mul_f32 v213, v213, v214
  v_accvgpr_write_b32 a58, v213
  v_accvgpr_read_b32 v213, a59
  v_mul_f32 v213, v213, v214
  v_accvgpr_write_b32 a59, v213
  v_accvgpr_read_b32 v213, a60
  v_mul_f32 v213, v213, v214
  v_accvgpr_write_b32 a60, v213
  v_accvgpr_read_b32 v213, a61
  v_mul_f32 v213, v213, v214
  v_accvgpr_write_b32 a61, v213
  v_accvgpr_read_b32 v213, a62
  v_mul_f32 v213, v213, v214
  v_accvgpr_write_b32 a62, v213
  v_accvgpr_read_b32 v213, a63
  v_mul_f32 v213, v213, v214
  v_accvgpr_write_b32 a63, v213
  v_accvgpr_read_b32 v213, a80
  v_mul_f32 v213, v213, v214
  v_accvgpr_write_b32 a80, v213
  v_accvgpr_read_b32 v213, a81
  v_mul_f32 v213, v213, v214
  v_accvgpr_write_b32 a81, v213
  v_accvgpr_read_b32 v213, a82
  v_mul_f32 v213, v213, v214
  v_accvgpr_write_b32 a82, v213
  v_accvgpr_read_b32 v213, a83
  v_mul_f32 v213, v213, v214
  v_accvgpr_write_b32 a83, v213
  v_accvgpr_read_b32 v213, a84
  v_mul_f32 v213, v213, v214
  v_accvgpr_write_b32 a84, v213
  v_accvgpr_read_b32 v213, a85
  v_mul_f32 v213, v213, v214
  v_accvgpr_write_b32 a85, v213
  v_accvgpr_read_b32 v213, a86
  v_mul_f32 v213, v213, v214
  v_accvgpr_write_b32 a86, v213
  v_accvgpr_read_b32 v213, a87
  v_mul_f32 v213, v213, v214
  v_accvgpr_write_b32 a87, v213
  v_accvgpr_read_b32 v213, a88
  v_mul_f32 v213, v213, v214
  v_accvgpr_write_b32 a88, v213
  v_accvgpr_read_b32 v213, a89
  v_mul_f32 v213, v213, v214
  v_accvgpr_write_b32 a89, v213
  v_accvgpr_read_b32 v213, a90
  v_mul_f32 v213, v213, v214
  v_accvgpr_write_b32 a90, v213
  v_accvgpr_read_b32 v213, a91
  v_mul_f32 v213, v213, v214
  v_accvgpr_write_b32 a91, v213
  v_accvgpr_read_b32 v213, a92
  v_mul_f32 v213, v213, v214
  v_accvgpr_write_b32 a92, v213
  v_accvgpr_read_b32 v213, a93
  v_mul_f32 v213, v213, v214
  v_accvgpr_write_b32 a93, v213
  v_accvgpr_read_b32 v213, a94
  v_mul_f32 v213, v213, v214
  v_accvgpr_write_b32 a94, v213
  v_accvgpr_read_b32 v213, a95
  v_mul_f32 v213, v213, v214
  v_accvgpr_write_b32 a95, v213
  v_accvgpr_read_b32 v213, a112
  v_mul_f32 v213, v213, v214
  v_accvgpr_write_b32 a112, v213
  v_accvgpr_read_b32 v213, a113
  v_mul_f32 v213, v213, v214
  v_accvgpr_write_b32 a113, v213
  v_accvgpr_read_b32 v213, a114
  v_mul_f32 v213, v213, v214
  v_accvgpr_write_b32 a114, v213
  v_accvgpr_read_b32 v213, a115
  v_mul_f32 v213, v213, v214
  v_accvgpr_write_b32 a115, v213
  v_accvgpr_read_b32 v213, a116
  v_mul_f32 v213, v213, v214
  v_accvgpr_write_b32 a116, v213
  v_accvgpr_read_b32 v213, a117
  v_mul_f32 v213, v213, v214
  v_accvgpr_write_b32 a117, v213
  v_accvgpr_read_b32 v213, a118
  v_mul_f32 v213, v213, v214
  v_accvgpr_write_b32 a118, v213
  v_accvgpr_read_b32 v213, a119
  v_mul_f32 v213, v213, v214
  v_accvgpr_write_b32 a119, v213
  v_accvgpr_read_b32 v213, a120
  v_mul_f32 v213, v213, v214
  v_accvgpr_write_b32 a120, v213
  v_accvgpr_read_b32 v213, a121
  v_mul_f32 v213, v213, v214
  v_accvgpr_write_b32 a121, v213
  v_accvgpr_read_b32 v213, a122
  v_mul_f32 v213, v213, v214
  v_accvgpr_write_b32 a122, v213
  v_accvgpr_read_b32 v213, a123
  v_mul_f32 v213, v213, v214
  v_accvgpr_write_b32 a123, v213
  v_accvgpr_read_b32 v213, a124
  v_mul_f32 v213, v213, v214
  v_accvgpr_write_b32 a124, v213
  v_accvgpr_read_b32 v213, a125
  v_mul_f32 v213, v213, v214
  v_accvgpr_write_b32 a125, v213
  v_accvgpr_read_b32 v213, a126
  v_mul_f32 v213, v213, v214
  v_accvgpr_write_b32 a126, v213
  v_accvgpr_read_b32 v213, a127
  v_mul_f32 v213, v213, v214
  v_accvgpr_write_b32 a127, v213
  v_exp_f32 v200, v40
  v_exp_f32 v201, v41
  v_add_f32 v210, v208, v200
  v_exp_f32 v202, v42
  v_add_f32 v210, v210, v201
  v_cvt_pk_bf16_f32 v88, v200, v201
  v_exp_f32 v203, v43
  v_add_f32 v210, v210, v202
  v_exp_f32 v204, v44
  v_add_f32 v210, v210, v203
  v_cvt_pk_bf16_f32 v89, v202, v203
  v_exp_f32 v205, v45
  v_add_f32 v210, v210, v204
  v_exp_f32 v206, v46
  v_add_f32 v210, v210, v205
  v_cvt_pk_bf16_f32 v90, v204, v205
  v_exp_f32 v207, v47
  v_add_f32 v210, v210, v206
  v_exp_f32 v200, v48
  v_add_f32 v210, v210, v207
  v_cvt_pk_bf16_f32 v91, v206, v207
  v_exp_f32 v201, v49
  v_add_f32 v210, v210, v200
  v_exp_f32 v202, v50
  v_add_f32 v210, v210, v201
  v_cvt_pk_bf16_f32 v92, v200, v201
  v_exp_f32 v203, v51
  v_add_f32 v210, v210, v202
  v_exp_f32 v204, v52
  v_add_f32 v210, v210, v203
  v_cvt_pk_bf16_f32 v93, v202, v203
  v_exp_f32 v205, v53
  v_add_f32 v210, v210, v204
  v_exp_f32 v206, v54
  v_add_f32 v210, v210, v205
  v_cvt_pk_bf16_f32 v94, v204, v205
  v_exp_f32 v207, v55
  v_add_f32 v210, v210, v206
  v_exp_f32 v200, v56
  v_add_f32 v210, v210, v207
  v_cvt_pk_bf16_f32 v95, v206, v207
  v_exp_f32 v201, v57
  v_add_f32 v211, v209, v200
  v_exp_f32 v202, v58
  v_add_f32 v211, v211, v201
  v_cvt_pk_bf16_f32 v96, v200, v201
  v_exp_f32 v203, v59
  v_add_f32 v211, v211, v202
  v_exp_f32 v204, v60
  v_add_f32 v211, v211, v203
  v_cvt_pk_bf16_f32 v97, v202, v203
  v_exp_f32 v205, v61
  v_add_f32 v211, v211, v204
  v_exp_f32 v206, v62
  v_add_f32 v211, v211, v205
  v_cvt_pk_bf16_f32 v98, v204, v205
  v_exp_f32 v207, v63
  v_add_f32 v211, v211, v206
  v_exp_f32 v200, v64
  v_add_f32 v211, v211, v207
  v_cvt_pk_bf16_f32 v99, v206, v207
  v_exp_f32 v201, v65
  v_add_f32 v211, v211, v200
  v_exp_f32 v202, v66
  v_add_f32 v211, v211, v201
  v_cvt_pk_bf16_f32 v100, v200, v201
  v_exp_f32 v203, v67
  v_add_f32 v211, v211, v202
  v_exp_f32 v204, v68
  v_add_f32 v211, v211, v203
  v_cvt_pk_bf16_f32 v101, v202, v203
  v_exp_f32 v205, v69
  v_add_f32 v211, v211, v204
  v_exp_f32 v206, v70
  v_add_f32 v211, v211, v205
  v_cvt_pk_bf16_f32 v102, v204, v205
  v_exp_f32 v207, v71
  v_add_f32 v211, v211, v206
  v_add_f32 v211, v211, v207
  v_cvt_pk_bf16_f32 v103, v206, v207
  s_branch k2_ret5
k2_fb6:
  v_max3_f32 v212, v8, v9, v10
  v_max3_f32 v212, v212, v11, v12
  v_max3_f32 v212, v212, v13, v14
  v_max3_f32 v212, v212, v15, v16
  v_max3_f32 v212, v212, v17, v18
  v_max3_f32 v212, v212, v19, v20
  v_max3_f32 v212, v212, v21, v22
  v_max_f32 v212, v212, v23
  v_mov_b32 v213, v212
  s_nop 1
  v_permlane32_swap_b32 v212, v213
  v_max_f32 v212, v212, v213
  v_max_f32 v212, 0, v212
  v_sub_f32 v104, v104, v212
  v_sub_f32 v105, v105, v212
  v_sub_f32 v106, v106, v212
  v_sub_f32 v107, v107, v212
  v_sub_f32 v108, v108, v212
  v_sub_f32 v109, v109, v212
  v_sub_f32 v110, v110, v212
  v_sub_f32 v111, v111, v212
  v_sub_f32 v112, v112, v212
  v_sub_f32 v113, v113, v212
  v_sub_f32 v114, v114, v212
  v_sub_f32 v115, v115, v212
  v_sub_f32 v116, v116, v212
  v_sub_f32 v117, v117, v212
  v_sub_f32 v118, v118, v212
  v_sub_f32 v119, v119, v212
  v_sub_f32 v8, v8, v212
  v_sub_f32 v9, v9, v212
  v_sub_f32 v10, v10, v212
  v_sub_f32 v11, v11, v212
  v_sub_f32 v12, v12, v212
  v_sub_f32 v13, v13, v212
  v_sub_f32 v14, v14, v212
  v_sub_f32 v15, v15, v212
  v_sub_f32 v16, v16, v212
  v_sub_f32 v17, v17, v212
  v_sub_f32 v18, v18, v212
  v_sub_f32 v19, v19, v212
  v_sub_f32 v20, v20, v212
  v_sub_f32 v21, v21, v212
  v_sub_f32 v22, v22, v212
  v_sub_f32 v23, v23, v212
  v_sub_f32 v40, v40, v212
  v_sub_f32 v41, v41, v212
  v_sub_f32 v42, v42, v212
  v_sub_f32 v43, v43, v212
  v_sub_f32 v44, v44, v212
  v_sub_f32 v45, v45, v212
  v_sub_f32 v46, v46, v212
  v_sub_f32 v47, v47, v212
  v_sub_f32 v48, v48, v212
  v_sub_f32 v49, v49, v212
  v_sub_f32 v50, v50, v212
  v_sub_f32 v51, v51, v212
  v_sub_f32 v52, v52, v212
  v_sub_f32 v53, v53, v212
  v_sub_f32 v54, v54, v212
  v_sub_f32 v55, v55, v212
  v_sub_f32 v214, 0, v212
  v_exp_f32 v214, v214
  s_nop 0
  v_mul_f32 v210, v210, v214
  v_accvgpr_read_b32 v213, a0
  v_mul_f32 v213, v213, v214
  v_accvgpr_write_b32 a0, v213
  v_accvgpr_read_b32 v213, a1
  v_mul_f32 v213, v213, v214
  v_accvgpr_write_b32 a1, v213
  v_accvgpr_read_b32 v213, a2
  v_mul_f32 v213, v213, v214
  v_accvgpr_write_b32 a2, v213
  v_accvgpr_read_b32 v213, a3
  v_mul_f32 v213, v213, v214
  v_accvgpr_write_b32 a3, v213
  v_accvgpr_read_b32 v213, a4
  v_mul_f32 v213, v213, v214
  v_accvgpr_write_b32 a4, v213
  v_accvgpr_read_b32 v213, a5
  v_mul_f32 v213, v213, v214
  v_accvgpr_write_b32 a5, v213
  v_accvgpr_read_b32 v213, a6
  v_mul_f32 v213, v213, v214
  v_accvgpr_write_b32 a6, v213
  v_accvgpr_read_b32 v213, a7
  v_mul_f32 v213, v213, v214
  v_accvgpr_write_b32 a7, v213
  v_accvgpr_read_b32 v213, a8
  v_mul_f32 v213, v213, v214
  v_accvgpr_write_b32 a8, v213
  v_accvgpr_read_b32 v213, a9
  v_mul_f32 v213, v213, v214
  v_accvgpr_write_b32 a9, v213
  v_accvgpr_read_b32 v213, a10
  v_mul_f32 v213, v213, v214
  v_accvgpr_write_b32 a10, v213
  v_accvgpr_read_b32 v213, a11
  v_mul_f32 v213, v213, v214
  v_accvgpr_write_b32 a11, v213
  v_accvgpr_read_b32 v213, a12
  v_mul_f32 v213, v213, v214
  v_accvgpr_write_b32 a12, v213
  v_accvgpr_read_b32 v213, a13
  v_mul_f32 v213, v213, v214
  v_accvgpr_write_b32 a13, v213
  v_accvgpr_read_b32 v213, a14
  v_mul_f32 v213, v213, v214
  v_accvgpr_write_b32 a14, v213
  v_accvgpr_read_b32 v213, a15
  v_mul_f32 v213, v213, v214
  v_accvgpr_write_b32 a15, v213
  v_accvgpr_read_b32 v213, a32
  v_mul_f32 v213, v213, v214
  v_accvgpr_write_b32 a32, v213
  v_accvgpr_read_b32 v213, a33
  v_mul_f32 v213, v213, v214
  v_accvgpr_write_b32 a33, v213
  v_accvgpr_read_b32 v213, a34
  v_mul_f32 v213, v213, v214
  v_accvgpr_write_b32 a34, v213
  v_accvgpr_read_b32 v213, a35
  v_mul_f32 v213, v213, v214
  v_accvgpr_write_b32 a35, v213
  v_accvgpr_read_b32 v213, a36
  v_mul_f32 v213, v213, v214
  v_accvgpr_write_b32 a36, v213
  v_accvgpr_read_b32 v213, a37
  v_mul_f32 v213, v213, v214
  v_accvgpr_write_b32 a37, v213
  v_accvgpr_read_b32 v213, a38
  v_mul_f32 v213, v213, v214
  v_accvgpr_write_b32 a38, v213
  v_accvgpr_read_b32 v213, a39
  v_mul_f32 v213, v213, v214
  v_accvgpr_write_b32 a39, v213
  v_accvgpr_read_b32 v213, a40
  v_mul_f32 v213, v213, v214
  v_accvgpr_write_b32 a40, v213
  v_accvgpr_read_b32 v213, a41
  v_mul_f32 v213, v213, v214
  v_accvgpr_write_b32 a41, v213
  v_accvgpr_read_b32 v213, a42
  v_mul_f32 v213, v213, v214
  v_accvgpr_write_b32 a42, v213
  v_accvgpr_read_b32 v213, a43
  v_mul_f32 v213, v213, v214
  v_accvgpr_write_b32 a43, v213
  v_accvgpr_read_b32 v213, a44
  v_mul_f32 v213, v213, v214
  v_accvgpr_write_b32 a44, v213
  v_accvgpr_read_b32 v213, a45
  v_mul_f32 v213, v213, v214
  v_accvgpr_write_b32 a45, v213
  v_accvgpr_read_b32 v213, a46
  v_mul_f32 v213, v213, v214
  v_accvgpr_write_b32 a46, v213
  v_accvgpr_read_b32 v213, a47
  v_mul_f32 v213, v213, v214
  v_accvgpr_write_b32 a47, v213
  v_accvgpr_read_b32 v213, a64
  v_mul_f32 v213, v213, v214
  v_accvgpr_write_b32 a64, v213
  v_accvgpr_read_b32 v213, a65
  v_mul_f32 v213, v213, v214
  v_accvgpr_write_b32 a65, v213
  v_accvgpr_read_b32 v213, a66
  v_mul_f32 v213, v213, v214
  v_accvgpr_write_b32 a66, v213
  v_accvgpr_read_b32 v213, a67
  v_mul_f32 v213, v213, v214
  v_accvgpr_write_b32 a67, v213
  v_accvgpr_read_b32 v213, a68
  v_mul_f32 v213, v213, v214
  v_accvgpr_write_b32 a68, v213
  v_accvgpr_read_b32 v213, a69
  v_mul_f32 v213, v213, v214
  v_accvgpr_write_b32 a69, v213
  v_accvgpr_read_b32 v213, a70
  v_mul_f32 v213, v213, v214
  v_accvgpr_write_b32 a70, v213
  v_accvgpr_read_b32 v213, a71
  v_mul_f32 v213, v213, v214
  v_accvgpr_write_b32 a71, v213
  v_accvgpr_read_b32 v213, a72
  v_mul_f32 v213, v213, v214
  v_accvgpr_write_b32 a72, v213
  v_accvgpr_read_b32 v213, a73
  v_mul_f32 v213, v213, v214
  v_accvgpr_write_b32 a73, v213
  v_accvgpr_read_b32 v213, a74
  v_mul_f32 v213, v213, v214
  v_accvgpr_write_b32 a74, v213
  v_accvgpr_read_b32 v213, a75
  v_mul_f32 v213, v213, v214
  v_accvgpr_write_b32 a75, v213
  v_accvgpr_read_b32 v213, a76
  v_mul_f32 v213, v213, v214
  v_accvgpr_write_b32 a76, v213
  v_accvgpr_read_b32 v213, a77
  v_mul_f32 v213, v213, v214
  v_accvgpr_write_b32 a77, v213
  v_accvgpr_read_b32 v213, a78
  v_mul_f32 v213, v213, v214
  v_accvgpr_write_b32 a78, v213
  v_accvgpr_read_b32 v213, a79
  v_mul_f32 v213, v213, v214
  v_accvgpr_write_b32 a79, v213
  v_accvgpr_read_b32 v213, a96
  v_mul_f32 v213, v213, v214
  v_accvgpr_write_b32 a96, v213
  v_accvgpr_read_b32 v213, a97
  v_mul_f32 v213, v213, v214
  v_accvgpr_write_b32 a97, v213
  v_accvgpr_read_b32 v213, a98
  v_mul_f32 v213, v213, v214
  v_accvgpr_write_b32 a98, v213
  v_accvgpr_read_b32 v213, a99
  v_mul_f32 v213, v213, v214
  v_accvgpr_write_b32 a99, v213
  v_accvgpr_read_b32 v213, a100
  v_mul_f32 v213, v213, v214
  v_accvgpr_write_b32 a100, v213
  v_accvgpr_read_b32 v213, a101
  v_mul_f32 v213, v213, v214
  v_accvgpr_write_b32 a101, v213
  v_accvgpr_read_b32 v213, a102
  v_mul_f32 v213, v213, v214
  v_accvgpr_write_b32 a102, v213
  v_accvgpr_read_b32 v213, a103
  v_mul_f32 v213, v213, v214
  v_accvgpr_write_b32 a103, v213
  v_accvgpr_read_b32 v213, a104
  v_mul_f32 v213, v213, v214
  v_accvgpr_write_b32 a104, v213
  v_accvgpr_read_b32 v213, a105
  v_mul_f32 v213, v213, v214
  v_accvgpr_write_b32 a105, v213
  v_accvgpr_read_b32 v213, a106
  v_mul_f32 v213, v213, v214
  v_accvgpr_write_b32 a106, v213
  v_accvgpr_read_b32 v213, a107
  v_mul_f32 v213, v213, v214
  v_accvgpr_write_b32 a107, v213
  v_accvgpr_read_b32 v213, a108
  v_mul_f32 v213, v213, v214
  v_accvgpr_write_b32 a108, v213
  v_accvgpr_read_b32 v213, a109
  v_mul_f32 v213, v213, v214
  v_accvgpr_write_b32 a109, v213
  v_accvgpr_read_b32 v213, a110
  v_mul_f32 v213, v213, v214
  v_accvgpr_write_b32 a110, v213
  v_accvgpr_read_b32 v213, a111
  v_mul_f32 v213, v213, v214
  v_accvgpr_write_b32 a111, v213
  v_max3_f32 v212, v24, v25, v26
  v_max3_f32 v212, v212, v27, v28
  v_max3_f32 v212, v212, v29, v30
  v_max3_f32 v212, v212, v31, v32
  v_max3_f32 v212, v212, v33, v34
  v_max3_f32 v212, v212, v35, v36
  v_max3_f32 v212, v212, v37, v38
  v_max_f32 v212, v212, v39
  v_mov_b32 v213, v212
  s_nop 1
  v_permlane32_swap_b32 v212, v213
  v_max_f32 v212, v212, v213
  v_max_f32 v212, 0, v212
  v_sub_f32 v120, v120, v212
  v_sub_f32 v121, v121, v212
  v_sub_f32 v122, v122, v212
  v_sub_f32 v123, v123, v212
  v_sub_f32 v124, v124, v212
  v_sub_f32 v125, v125, v212
  v_sub_f32 v126, v126, v212
  v_sub_f32 v127, v127, v212
  v_sub_f32 v128, v128, v212
  v_sub_f32 v129, v129, v212
  v_sub_f32 v130, v130, v212
  v_sub_f32 v131, v131, v212
  v_sub_f32 v132, v132, v212
  v_sub_f32 v133, v133, v212
  v_sub_f32 v134, v134, v212
  v_sub_f32 v135, v135, v212
  v_sub_f32 v24, v24, v212
  v_sub_f32 v25, v25, v212
  v_sub_f32 v26, v26, v212
  v_sub_f32 v27, v27, v212
  v_sub_f32 v28, v28, v212
  v_sub_f32 v29, v29, v212
  v_sub_f32 v30, v30, v212
  v_sub_f32 v31, v31, v212
  v_sub_f32 v32, v32, v212
  v_sub_f32 v33, v33, v212
  v_sub_f32 v34, v34, v212
  v_sub_f32 v35, v35, v212
  v_sub_f32 v36, v36, v212
  v_sub_f32 v37, v37, v212
  v_sub_f32 v38, v38, v212
  v_sub_f32 v39, v39, v212
  v_sub_f32 v56, v56, v212
  v_sub_f32 v57, v57, v212
  v_sub_f32 v58, v58, v212
  v_sub_f32 v59, v59, v212
  v_sub_f32 v60, v60, v212
  v_sub_f32 v61, v61, v212
  v_sub_f32 v62, v62, v212
  v_sub_f32 v63, v63, v212
  v_sub_f32 v64, v64, v212
  v_sub_f32 v65, v65, v212
  v_sub_f32 v66, v66, v212
  v_sub_f32 v67, v67, v212
  v_sub_f32 v68, v68, v212
  v_sub_f32 v69, v69, v212
  v_sub_f32 v70, v70, v212
  v_sub_f32 v71, v71, v212
  v_sub_f32 v214, 0, v212
  v_exp_f32 v214, v214
  s_nop 0
  v_mul_f32 v211, v211, v214
  v_accvgpr_read_b32 v213, a16
  v_mul_f32 v213, v213, v214
  v_accvgpr_write_b32 a16, v213
  v_accvgpr_read_b32 v213, a17
  v_mul_f32 v213, v213, v214
  v_accvgpr_write_b32 a17, v213
  v_accvgpr_read_b32 v213, a18
  v_mul_f32 v213, v213, v214
  v_accvgpr_write_b32 a18, v213
  v_accvgpr_read_b32 v213, a19
  v_mul_f32 v213, v213, v214
  v_accvgpr_write_b32 a19, v213
  v_accvgpr_read_b32 v213, a20
  v_mul_f32 v213, v213, v214
  v_accvgpr_write_b32 a20, v213
  v_accvgpr_read_b32 v213, a21
  v_mul_f32 v213, v213, v214
  v_accvgpr_write_b32 a21, v213
  v_accvgpr_read_b32 v213, a22
  v_mul_f32 v213, v213, v214
  v_accvgpr_write_b32 a22, v213
  v_accvgpr_read_b32 v213, a23
  v_mul_f32 v213, v213, v214
  v_accvgpr_write_b32 a23, v213
  v_accvgpr_read_b32 v213, a24
  v_mul_f32 v213, v213, v214
  v_accvgpr_write_b32 a24, v213
  v_accvgpr_read_b32 v213, a25
  v_mul_f32 v213, v213, v214
  v_accvgpr_write_b32 a25, v213
  v_accvgpr_read_b32 v213, a26
  v_mul_f32 v213, v213, v214
  v_accvgpr_write_b32 a26, v213
  v_accvgpr_read_b32 v213, a27
  v_mul_f32 v213, v213, v214
  v_accvgpr_write_b32 a27, v213
  v_accvgpr_read_b32 v213, a28
  v_mul_f32 v213, v213, v214
  v_accvgpr_write_b32 a28, v213
  v_accvgpr_read_b32 v213, a29
  v_mul_f32 v213, v213, v214
  v_accvgpr_write_b32 a29, v213
  v_accvgpr_read_b32 v213, a30
  v_mul_f32 v213, v213, v214
  v_accvgpr_write_b32 a30, v213
  v_accvgpr_read_b32 v213, a31
  v_mul_f32 v213, v213, v214
  v_accvgpr_write_b32 a31, v213
  v_accvgpr_read_b32 v213, a48
  v_mul_f32 v213, v213, v214
  v_accvgpr_write_b32 a48, v213
  v_accvgpr_read_b32 v213, a49
  v_mul_f32 v213, v213, v214
  v_accvgpr_write_b32 a49, v213
  v_accvgpr_read_b32 v213, a50
  v_mul_f32 v213, v213, v214
  v_accvgpr_write_b32 a50, v213
  v_accvgpr_read_b32 v213, a51
  v_mul_f32 v213, v213, v214
  v_accvgpr_write_b32 a51, v213
  v_accvgpr_read_b32 v213, a52
  v_mul_f32 v213, v213, v214
  v_accvgpr_write_b32 a52, v213
  v_accvgpr_read_b32 v213, a53
  v_mul_f32 v213, v213, v214
  v_accvgpr_write_b32 a53, v213
  v_accvgpr_read_b32 v213, a54
  v_mul_f32 v213, v213, v214
  v_accvgpr_write_b32 a54, v213
  v_accvgpr_read_b32 v213, a55
  v_mul_f32 v213, v213, v214
  v_accvgpr_write_b32 a55, v213
  v_accvgpr_read_b32 v213, a56
  v_mul_f32 v213, v213, v214
  v_accvgpr_write_b32 a56, v213
  v_accvgpr_read_b32 v213, a57
  v_mul_f32 v213, v213, v214
  v_accvgpr_write_b32 a57, v213
  v_accvgpr_read_b32 v213, a58
  v_mul_f32 v213, v213, v214
  v_accvgpr_write_b32 a58, v213
  v_accvgpr_read_b32 v213, a59
  v_mul_f32 v213, v213, v214
  v_accvgpr_write_b32 a59, v213
  v_accvgpr_read_b32 v213, a60
  v_mul_f32 v213, v213, v214
  v_accvgpr_write_b32 a60, v213
  v_accvgpr_read_b32 v213, a61
  v_mul_f32 v213, v213, v214
  v_accvgpr_write_b32 a61, v213
  v_accvgpr_read_b32 v213, a62
  v_mul_f32 v213, v213, v214
  v_accvgpr_write_b32 a62, v213
  v_accvgpr_read_b32 v213, a63
  v_mul_f32 v213, v213, v214
  v_accvgpr_write_b32 a63, v213
  v_accvgpr_read_b32 v213, a80
  v_mul_f32 v213, v213, v214
  v_accvgpr_write_b32 a80, v213
  v_accvgpr_read_b32 v213, a81
  v_mul_f32 v213, v213, v214
  v_accvgpr_write_b32 a81, v213
  v_accvgpr_read_b32 v213, a82
  v_mul_f32 v213, v213, v214
  v_accvgpr_write_b32 a82, v213
  v_accvgpr_read_b32 v213, a83
  v_mul_f32 v213, v213, v214
  v_accvgpr_write_b32 a83, v213
  v_accvgpr_read_b32 v213, a84
  v_mul_f32 v213, v213, v214
  v_accvgpr_write_b32 a84, v213
  v_accvgpr_read_b32 v213, a85
  v_mul_f32 v213, v213, v214
  v_accvgpr_write_b32 a85, v213
  v_accvgpr_read_b32 v213, a86
  v_mul_f32 v213, v213, v214
  v_accvgpr_write_b32 a86, v213
  v_accvgpr_read_b32 v213, a87
  v_mul_f32 v213, v213, v214
  v_accvgpr_write_b32 a87, v213
  v_accvgpr_read_b32 v213, a88
  v_mul_f32 v213, v213, v214
  v_accvgpr_write_b32 a88, v213
  v_accvgpr_read_b32 v213, a89
  v_mul_f32 v213, v213, v214
  v_accvgpr_write_b32 a89, v213
  v_accvgpr_read_b32 v213, a90
  v_mul_f32 v213, v213, v214
  v_accvgpr_write_b32 a90, v213
  v_accvgpr_read_b32 v213, a91
  v_mul_f32 v213, v213, v214
  v_accvgpr_write_b32 a91, v213
  v_accvgpr_read_b32 v213, a92
  v_mul_f32 v213, v213, v214
  v_accvgpr_write_b32 a92, v213
  v_accvgpr_read_b32 v213, a93
  v_mul_f32 v213, v213, v214
  v_accvgpr_write_b32 a93, v213
  v_accvgpr_read_b32 v213, a94
  v_mul_f32 v213, v213, v214
  v_accvgpr_write_b32 a94, v213
  v_accvgpr_read_b32 v213, a95
  v_mul_f32 v213, v213, v214
  v_accvgpr_write_b32 a95, v213
  v_accvgpr_read_b32 v213, a112
  v_mul_f32 v213, v213, v214
  v_accvgpr_write_b32 a112, v213
  v_accvgpr_read_b32 v213, a113
  v_mul_f32 v213, v213, v214
  v_accvgpr_write_b32 a113, v213
  v_accvgpr_read_b32 v213, a114
  v_mul_f32 v213, v213, v214
  v_accvgpr_write_b32 a114, v213
  v_accvgpr_read_b32 v213, a115
  v_mul_f32 v213, v213, v214
  v_accvgpr_write_b32 a115, v213
  v_accvgpr_read_b32 v213, a116
  v_mul_f32 v213, v213, v214
  v_accvgpr_write_b32 a116, v213
  v_accvgpr_read_b32 v213, a117
  v_mul_f32 v213, v213, v214
  v_accvgpr_write_b32 a117, v213
  v_accvgpr_read_b32 v213, a118
  v_mul_f32 v213, v213, v214
  v_accvgpr_write_b32 a118, v213
  v_accvgpr_read_b32 v213, a119
  v_mul_f32 v213, v213, v214
  v_accvgpr_write_b32 a119, v213
  v_accvgpr_read_b32 v213, a120
  v_mul_f32 v213, v213, v214
  v_accvgpr_write_b32 a120, v213
  v_accvgpr_read_b32 v213, a121
  v_mul_f32 v213, v213, v214
  v_accvgpr_write_b32 a121, v213
  v_accvgpr_read_b32 v213, a122
  v_mul_f32 v213, v213, v214
  v_accvgpr_write_b32 a122, v213
  v_accvgpr_read_b32 v213, a123
  v_mul_f32 v213, v213, v214
  v_accvgpr_write_b32 a123, v213
  v_accvgpr_read_b32 v213, a124
  v_mul_f32 v213, v213, v214
  v_accvgpr_write_b32 a124, v213
  v_accvgpr_read_b32 v213, a125
  v_mul_f32 v213, v213, v214
  v_accvgpr_write_b32 a125, v213
  v_accvgpr_read_b32 v213, a126
  v_mul_f32 v213, v213, v214
  v_accvgpr_write_b32 a126, v213
  v_accvgpr_read_b32 v213, a127
  v_mul_f32 v213, v213, v214
  v_accvgpr_write_b32 a127, v213
  v_exp_f32 v200, v8
  v_exp_f32 v201, v9
  v_add_f32 v208, v210, v200
  v_exp_f32 v202, v10
  v_add_f32 v208, v208, v201
  v_cvt_pk_bf16_f32 v72, v200, v201
  v_exp_f32 v203, v11
  v_add_f32 v208, v208, v202
  v_exp_f32 v204, v12
  v_add_f32 v208, v208, v203
  v_cvt_pk_bf16_f32 v73, v202, v203
  v_exp_f32 v205, v13
  v_add_f32 v208, v208, v204
  v_exp_f32 v206, v14
  v_add_f32 v208, v208, v205
  v_cvt_pk_bf16_f32 v74, v204, v205
  v_exp_f32 v207, v15
  v_add_f32 v208, v208, v206
  v_exp_f32 v200, v16
  v_add_f32 v208, v208, v207
  v_cvt_pk_bf16_f32 v75, v206, v207
  v_exp_f32 v201, v17
  v_add_f32 v208, v208, v200
  v_exp_f32 v202, v18
  v_add_f32 v208, v208, v201
  v_cvt_pk_bf16_f32 v76, v200, v201
  v_exp_f32 v203, v19
  v_add_f32 v208, v208, v202
  v_exp_f32 v204, v20
  v_add_f32 v208, v208, v203
  v_cvt_pk_bf16_f32 v77, v202, v203
  v_exp_f32 v205, v21
  v_add_f32 v208, v208, v204
  v_exp_f32 v206, v22
  v_add_f32 v208, v208, v205
  v_cvt_pk_bf16_f32 v78, v204, v205
  v_exp_f32 v207, v23
  v_add_f32 v208, v208, v206
  v_exp_f32 v200, v24
  v_add_f32 v208, v208, v207
  v_cvt_pk_bf16_f32 v79, v206, v207
  v_exp_f32 v201, v25
  v_add_f32 v209, v211, v200
  v_exp_f32 v202, v26
  v_add_f32 v209, v209, v201
  v_cvt_pk_bf16_f32 v80, v200, v201
  v_exp_f32 v203, v27
  v_add_f32 v209, v209, v202
  v_exp_f32 v204, v28
  v_add_f32 v209, v209, v203
  v_cvt_pk_bf16_f32 v81, v202, v203
  v_exp_f32 v205, v29
  v_add_f32 v209, v209, v204
  v_exp_f32 v206, v30
  v_add_f32 v209, v209, v205
  v_cvt_pk_bf16_f32 v82, v204, v205
  v_exp_f32 v207, v31
  v_add_f32 v209, v209, v206
  v_exp_f32 v200, v32
  v_add_f32 v209, v209, v207
  v_cvt_pk_bf16_f32 v83, v206, v207
  v_exp_f32 v201, v33
  v_add_f32 v209, v209, v200
  v_exp_f32 v202, v34
  v_add_f32 v209, v209, v201
  v_cvt_pk_bf16_f32 v84, v200, v201
  v_exp_f32 v203, v35
  v_add_f32 v209, v209, v202
  v_exp_f32 v204, v36
  v_add_f32 v209, v209, v203
  v_cvt_pk_bf16_f32 v85, v202, v203
  v_exp_f32 v205, v37
  v_add_f32 v209, v209, v204
  v_exp_f32 v206, v38
  v_add_f32 v209, v209, v205
  v_cvt_pk_bf16_f32 v86, v204, v205
  v_exp_f32 v207, v39
  v_add_f32 v209, v209, v206
  v_add_f32 v209, v209, v207
  v_cvt_pk_bf16_f32 v87, v206, v207
  s_branch k2_ret7
k2_fb8:
  v_max3_f32 v212, v40, v41, v42
  v_max3_f32 v212, v212, v43, v44
  v_max3_f32 v212, v212, v45, v46
  v_max3_f32 v212, v212, v47, v48
  v_max3_f32 v212, v212, v49, v50
  v_max3_f32 v212, v212, v51, v52
  v_max3_f32 v212, v212, v53, v54
  v_max_f32 v212, v212, v55
  v_mov_b32 v213, v212
  s_nop 1
  v_permlane32_swap_b32 v212, v213
  v_max_f32 v212, v212, v213
  v_max_f32 v212, 0, v212
  v_sub_f32 v104, v104, v212
  v_sub_f32 v105, v105, v212
  v_sub_f32 v106, v106, v212
  v_sub_f32 v107, v107, v212
  v_sub_f32 v108, v108, v212
  v_sub_f32 v109, v109, v212
  v_sub_f32 v110, v110, v212
  v_sub_f32 v111, v111, v212
  v_sub_f32 v112, v112, v212
  v_sub_f32 v113, v113, v212
  v_sub_f32 v114, v114, v212
  v_sub_f32 v115, v115, v212
  v_sub_f32 v116, v116, v212
  v_sub_f32 v117, v117, v212
  v_sub_f32 v118, v118, v212
  v_sub_f32 v119, v119, v212
  v_sub_f32 v40, v40, v212
  v_sub_f32 v41, v41, v212
  v_sub_f32 v42, v42, v212
  v_sub_f32 v43, v43, v212
  v_sub_f32 v44, v44, v212
  v_sub_f32 v45, v45, v212
  v_sub_f32 v46, v46, v212
  v_sub_f32 v47, v47, v212
  v_sub_f32 v48, v48, v212
  v_sub_f32 v49, v49, v212
  v_sub_f32 v50, v50, v212
  v_sub_f32 v51, v51, v212
  v_sub_f32 v52, v52, v212
  v_sub_f32 v53, v53, v212
  v_sub_f32 v54, v54, v212
  v_sub_f32 v55, v55, v212
  v_sub_f32 v8, v8, v212
  v_sub_f32 v9, v9, v212
  v_sub_f32 v10, v10, v212
  v_sub_f32 v11, v11, v212
  v_sub_f32 v12, v12, v212
  v_sub_f32 v13, v13, v212
  v_sub_f32 v14, v14, v212
  v_sub_f32 v15, v15, v212
  v_sub_f32 v16, v16, v212
  v_sub_f32 v17, v17, v212
  v_sub_f32 v18, v18, v212
  v_sub_f32 v19, v19, v212
  v_sub_f32 v20, v20, v212
  v_sub_f32 v21, v21, v212
  v_sub_f32 v22, v22, v212
  v_sub_f32 v23, v23, v212
  v_sub_f32 v214, 0, v212
  v_exp_f32 v214, v214
  s_nop 0
  v_mul_f32 v208, v208, v214
  v_accvgpr_read_b32 v213, a0
  v_mul_f32 v213, v213, v214
  v_accvgpr_write_b32 a0, v213
  v_accvgpr_read_b32 v213, a1
  v_mul_f32 v213, v213, v214
  v_accvgpr_write_b32 a1, v213
  v_accvgpr_read_b32 v213, a2
  v_mul_f32 v213, v213, v214
  v_accvgpr_write_b32 a2, v213
  v_accvgpr_read_b32 v213, a3
  v_mul_f32 v213, v213, v214
  v_accvgpr_write_b32 a3, v213
  v_accvgpr_read_b32 v213, a4
  v_mul_f32 v213, v213, v214
  v_accvgpr_write_b32 a4, v213
  v_accvgpr_read_b32 v213, a5
  v_mul_f32 v213, v213, v214
  v_accvgpr_write_b32 a5, v213
  v_accvgpr_read_b32 v213, a6
  v_mul_f32 v213, v213, v214
  v_accvgpr_write_b32 a6, v213
  v_accvgpr_read_b32 v213, a7
  v_mul_f32 v213, v213, v214
  v_accvgpr_write_b32 a7, v213
  v_accvgpr_read_b32 v213, a8
  v_mul_f32 v213, v213, v214
  v_accvgpr_write_b32 a8, v213
  v_accvgpr_read_b32 v213, a9
  v_mul_f32 v213, v213, v214
  v_accvgpr_write_b32 a9, v213
  v_accvgpr_read_b32 v213, a10
  v_mul_f32 v213, v213, v214
  v_accvgpr_write_b32 a10, v213
  v_accvgpr_read_b32 v213, a11
  v_mul_f32 v213, v213, v214
  v_accvgpr_write_b32 a11, v213
  v_accvgpr_read_b32 v213, a12
  v_mul_f32 v213, v213, v214
  v_accvgpr_write_b32 a12, v213
  v_accvgpr_read_b32 v213, a13
  v_mul_f32 v213, v213, v214
  v_accvgpr_write_b32 a13, v213
  v_accvgpr_read_b32 v213, a14
  v_mul_f32 v213, v213, v214
  v_accvgpr_write_b32 a14, v213
  v_accvgpr_read_b32 v213, a15
  v_mul_f32 v213, v213, v214
  v_accvgpr_write_b32 a15, v213
  v_accvgpr_read_b32 v213, a32
  v_mul_f32 v213, v213, v214
  v_accvgpr_write_b32 a32, v213
  v_accvgpr_read_b32 v213, a33
  v_mul_f32 v213, v213, v214
  v_accvgpr_write_b32 a33, v213
  v_accvgpr_read_b32 v213, a34
  v_mul_f32 v213, v213, v214
  v_accvgpr_write_b32 a34, v213
  v_accvgpr_read_b32 v213, a35
  v_mul_f32 v213, v213, v214
  v_accvgpr_write_b32 a35, v213
  v_accvgpr_read_b32 v213, a36
  v_mul_f32 v213, v213, v214
  v_accvgpr_write_b32 a36, v213
  v_accvgpr_read_b32 v213, a37
  v_mul_f32 v213, v213, v214
  v_accvgpr_write_b32 a37, v213
  v_accvgpr_read_b32 v213, a38
  v_mul_f32 v213, v213, v214
  v_accvgpr_write_b32 a38, v213
  v_accvgpr_read_b32 v213, a39
  v_mul_f32 v213, v213, v214
  v_accvgpr_write_b32 a39, v213
  v_accvgpr_read_b32 v213, a40
  v_mul_f32 v213, v213, v214
  v_accvgpr_write_b32 a40, v213
  v_accvgpr_read_b32 v213, a41
  v_mul_f32 v213, v213, v214
  v_accvgpr_write_b32 a41, v213
  v_accvgpr_read_b32 v213, a42
  v_mul_f32 v213, v213, v214
  v_accvgpr_write_b32 a42, v213
  v_accvgpr_read_b32 v213, a43
  v_mul_f32 v213, v213, v214
  v_accvgpr_write_b32 a43, v213
  v_accvgpr_read_b32 v213, a44
  v_mul_f32 v213, v213, v214
  v_accvgpr_write_b32 a44, v213
  v_accvgpr_read_b32 v213, a45
  v_mul_f32 v213, v213, v214
  v_accvgpr_write_b32 a45, v213
  v_accvgpr_read_b32 v213, a46
  v_mul_f32 v213, v213, v214
  v_accvgpr_write_b32 a46, v213
  v_accvgpr_read_b32 v213, a47
  v_mul_f32 v213, v213, v214
  v_accvgpr_write_b32 a47, v213
  v_accvgpr_read_b32 v213, a64
  v_mul_f32 v213, v213, v214
  v_accvgpr_write_b32 a64, v213
  v_accvgpr_read_b32 v213, a65
  v_mul_f32 v213, v213, v214
  v_accvgpr_write_b32 a65, v213
  v_accvgpr_read_b32 v213, a66
  v_mul_f32 v213, v213, v214
  v_accvgpr_write_b32 a66, v213
  v_accvgpr_read_b32 v213, a67
  v_mul_f32 v213, v213, v214
  v_accvgpr_write_b32 a67, v213
  v_accvgpr_read_b32 v213, a68
  v_mul_f32 v213, v213, v214
  v_accvgpr_write_b32 a68, v213
  v_accvgpr_read_b32 v213, a69
  v_mul_f32 v213, v213, v214
  v_accvgpr_write_b32 a69, v213
  v_accvgpr_read_b32 v213, a70
  v_mul_f32 v213, v213, v214
  v_accvgpr_write_b32 a70, v213
  v_accvgpr_read_b32 v213, a71
  v_mul_f32 v213, v213, v214
  v_accvgpr_write_b32 a71, v213
  v_accvgpr_read_b32 v213, a72
  v_mul_f32 v213, v213, v214
  v_accvgpr_write_b32 a72, v213
  v_accvgpr_read_b32 v213, a73
  v_mul_f32 v213, v213, v214
  v_accvgpr_write_b32 a73, v213
  v_accvgpr_read_b32 v213, a74
  v_mul_f32 v213, v213, v214
  v_accvgpr_write_b32 a74, v213
  v_accvgpr_read_b32 v213, a75
  v_mul_f32 v213, v213, v214
  v_accvgpr_write_b32 a75, v213
  v_accvgpr_read_b32 v213, a76
  v_mul_f32 v213, v213, v214
  v_accvgpr_write_b32 a76, v213
  v_accvgpr_read_b32 v213, a77
  v_mul_f32 v213, v213, v214
  v_accvgpr_write_b32 a77, v213
  v_accvgpr_read_b32 v213, a78
  v_mul_f32 v213, v213, v214
  v_accvgpr_write_b32 a78, v213
  v_accvgpr_read_b32 v213, a79
  v_mul_f32 v213, v213, v214
  v_accvgpr_write_b32 a79, v213
  v_accvgpr_read_b32 v213, a96
  v_mul_f32 v213, v213, v214
  v_accvgpr_write_b32 a96, v213
  v_accvgpr_read_b32 v213, a97
  v_mul_f32 v213, v213, v214
  v_accvgpr_write_b32 a97, v213
  v_accvgpr_read_b32 v213, a98
  v_mul_f32 v213, v213, v214
  v_accvgpr_write_b32 a98, v213
  v_accvgpr_read_b32 v213, a99
  v_mul_f32 v213, v213, v214
  v_accvgpr_write_b32 a99, v213
  v_accvgpr_read_b32 v213, a100
  v_mul_f32 v213, v213, v214
  v_accvgpr_write_b32 a100, v213
  v_accvgpr_read_b32 v213, a101
  v_mul_f32 v213, v213, v214
  v_accvgpr_write_b32 a101, v213
  v_accvgpr_read_b32 v213, a102
  v_mul_f32 v213, v213, v214
  v_accvgpr_write_b32 a102, v213
  v_accvgpr_read_b32 v213, a103
  v_mul_f32 v213, v213, v214
  v_accvgpr_write_b32 a103, v213
  v_accvgpr_read_b32 v213, a104
  v_mul_f32 v213, v213, v214
  v_accvgpr_write_b32 a104, v213
  v_accvgpr_read_b32 v213, a105
  v_mul_f32 v213, v213, v214
  v_accvgpr_write_b32 a105, v213
  v_accvgpr_read_b32 v213, a106
  v_mul_f32 v213, v213, v214
  v_accvgpr_write_b32 a106, v213
  v_accvgpr_read_b32 v213, a107
  v_mul_f32 v213, v213, v214
  v_accvgpr_write_b32 a107, v213
  v_accvgpr_read_b32 v213, a108
  v_mul_f32 v213, v213, v214
  v_accvgpr_write_b32 a108, v213
  v_accvgpr_read_b32 v213, a109
  v_mul_f32 v213, v213, v214
  v_accvgpr_write_b32 a109, v213
  v_accvgpr_read_b32 v213, a110
  v_mul_f32 v213, v213, v214
  v_accvgpr_write_b32 a110, v213
  v_accvgpr_read_b32 v213, a111
  v_mul_f32 v213, v213, v214
  v_accvgpr_write_b32 a111, v213
  v_max3_f32 v212, v56, v57, v58
  v_max3_f32 v212, v212, v59, v60
  v_max3_f32 v212, v212, v61, v62
  v_max3_f32 v212, v212, v63, v64
  v_max3_f32 v212, v212, v65, v66
  v_max3_f32 v212, v212, v67, v68
  v_max3_f32 v212, v212, v69, v70
  v_max_f32 v212, v212, v71
  v_mov_b32 v213, v212
  s_nop 1
  v_permlane32_swap_b32 v212, v213
  v_max_f32 v212, v212, v213
  v_max_f32 v212, 0, v212
  v_sub_f32 v120, v120, v212
  v_sub_f32 v121, v121, v212
  v_sub_f32 v122, v122, v212
  v_sub_f32 v123, v123, v212
  v_sub_f32 v124, v124, v212
  v_sub_f32 v125, v125, v212
  v_sub_f32 v126, v126, v212
  v_sub_f32 v127, v127, v212
  v_sub_f32 v128, v128, v212
  v_sub_f32 v129, v129, v212
  v_sub_f32 v130, v130, v212
  v_sub_f32 v131, v131, v212
  v_sub_f32 v132, v132, v212
  v_sub_f32 v133, v133, v212
  v_sub_f32 v134, v134, v212
  v_sub_f32 v135, v135, v212
  v_sub_f32 v56, v56, v212
  v_sub_f32 v57, v57, v212
  v_sub_f32 v58, v58, v212
  v_sub_f32 v59, v59, v212
  v_sub_f32 v60, v60, v212
  v_sub_f32 v61, v61, v212
  v_sub_f32 v62, v62, v212
  v_sub_f32 v63, v63, v212
  v_sub_f32 v64, v64, v212
  v_sub_f32 v65, v65, v212
  v_sub_f32 v66, v66, v212
  v_sub_f32 v67, v67, v212
  v_sub_f32 v68, v68, v212
  v_sub_f32 v69, v69, v212
  v_sub_f32 v70, v70, v212
  v_sub_f32 v71, v71, v212
  v_sub_f32 v24, v24, v212
  v_sub_f32 v25, v25, v212
  v_sub_f32 v26, v26, v212
  v_sub_f32 v27, v27, v212
  v_sub_f32 v28, v28, v212
  v_sub_f32 v29, v29, v212
  v_sub_f32 v30, v30, v212
  v_sub_f32 v31, v31, v212
  v_sub_f32 v32, v32, v212
  v_sub_f32 v33, v33, v212
  v_sub_f32 v34, v34, v212
  v_sub_f32 v35, v35, v212
  v_sub_f32 v36, v36, v212
  v_sub_f32 v37, v37, v212
  v_sub_f32 v38, v38, v212
  v_sub_f32 v39, v39, v212
  v_sub_f32 v214, 0, v212
  v_exp_f32 v214, v214
  s_nop 0
  v_mul_f32 v209, v209, v214
  v_accvgpr_read_b32 v213, a16
  v_mul_f32 v213, v213, v214
  v_accvgpr_write_b32 a16, v213
  v_accvgpr_read_b32 v213, a17
  v_mul_f32 v213, v213, v214
  v_accvgpr_write_b32 a17, v213
  v_accvgpr_read_b32 v213, a18
  v_mul_f32 v213, v213, v214
  v_accvgpr_write_b32 a18, v213
  v_accvgpr_read_b32 v213, a19
  v_mul_f32 v213, v213, v214
  v_accvgpr_write_b32 a19, v213
  v_accvgpr_read_b32 v213, a20
  v_mul_f32 v213, v213, v214
  v_accvgpr_write_b32 a20, v213
  v_accvgpr_read_b32 v213, a21
  v_mul_f32 v213, v213, v214
  v_accvgpr_write_b32 a21, v213
  v_accvgpr_read_b32 v213, a22
  v_mul_f32 v213, v213, v214
  v_accvgpr_write_b32 a22, v213
  v_accvgpr_read_b32 v213, a23
  v_mul_f32 v213, v213, v214
  v_accvgpr_write_b32 a23, v213
  v_accvgpr_read_b32 v213, a24
  v_mul_f32 v213, v213, v214
  v_accvgpr_write_b32 a24, v213
  v_accvgpr_read_b32 v213, a25
  v_mul_f32 v213, v213, v214
  v_accvgpr_write_b32 a25, v213
  v_accvgpr_read_b32 v213, a26
  v_mul_f32 v213, v213, v214
  v_accvgpr_write_b32 a26, v213
  v_accvgpr_read_b32 v213, a27
  v_mul_f32 v213, v213, v214
  v_accvgpr_write_b32 a27, v213
  v_accvgpr_read_b32 v213, a28
  v_mul_f32 v213, v213, v214
  v_accvgpr_write_b32 a28, v213
  v_accvgpr_read_b32 v213, a29
  v_mul_f32 v213, v213, v214
  v_accvgpr_write_b32 a29, v213
  v_accvgpr_read_b32 v213, a30
  v_mul_f32 v213, v213, v214
  v_accvgpr_write_b32 a30, v213
  v_accvgpr_read_b32 v213, a31
  v_mul_f32 v213, v213, v214
  v_accvgpr_write_b32 a31, v213
  v_accvgpr_read_b32 v213, a48
  v_mul_f32 v213, v213, v214
  v_accvgpr_write_b32 a48, v213
  v_accvgpr_read_b32 v213, a49
  v_mul_f32 v213, v213, v214
  v_accvgpr_write_b32 a49, v213
  v_accvgpr_read_b32 v213, a50
  v_mul_f32 v213, v213, v214
  v_accvgpr_write_b32 a50, v213
  v_accvgpr_read_b32 v213, a51
  v_mul_f32 v213, v213, v214
  v_accvgpr_write_b32 a51, v213
  v_accvgpr_read_b32 v213, a52
  v_mul_f32 v213, v213, v214
  v_accvgpr_write_b32 a52, v213
  v_accvgpr_read_b32 v213, a53
  v_mul_f32 v213, v213, v214
  v_accvgpr_write_b32 a53, v213
  v_accvgpr_read_b32 v213, a54
  v_mul_f32 v213, v213, v214
  v_accvgpr_write_b32 a54, v213
  v_accvgpr_read_b32 v213, a55
  v_mul_f32 v213, v213, v214
  v_accvgpr_write_b32 a55, v213
  v_accvgpr_read_b32 v213, a56
  v_mul_f32 v213, v213, v214
  v_accvgpr_write_b32 a56, v213
  v_accvgpr_read_b32 v213, a57
  v_mul_f32 v213, v213, v214
  v_accvgpr_write_b32 a57, v213
  v_accvgpr_read_b32 v213, a58
  v_mul_f32 v213, v213, v214
  v_accvgpr_write_b32 a58, v213
  v_accvgpr_read_b32 v213, a59
  v_mul_f32 v213, v213, v214
  v_accvgpr_write_b32 a59, v213
  v_accvgpr_read_b32 v213, a60
  v_mul_f32 v213, v213, v214
  v_accvgpr_write_b32 a60, v213
  v_accvgpr_read_b32 v213, a61
  v_mul_f32 v213, v213, v214
  v_accvgpr_write_b32 a61, v213
  v_accvgpr_read_b32 v213, a62
  v_mul_f32 v213, v213, v214
  v_accvgpr_write_b32 a62, v213
  v_accvgpr_read_b32 v213, a63
  v_mul_f32 v213, v213, v214
  v_accvgpr_write_b32 a63, v213
  v_accvgpr_read_b32 v213, a80
  v_mul_f32 v213, v213, v214
  v_accvgpr_write_b32 a80, v213
  v_accvgpr_read_b32 v213, a81
  v_mul_f32 v213, v213, v214
  v_accvgpr_write_b32 a81, v213
  v_accvgpr_read_b32 v213, a82
  v_mul_f32 v213, v213, v214
  v_accvgpr_write_b32 a82, v213
  v_accvgpr_read_b32 v213, a83
  v_mul_f32 v213, v213, v214
  v_accvgpr_write_b32 a83, v213
  v_accvgpr_read_b32 v213, a84
  v_mul_f32 v213, v213, v214
  v_accvgpr_write_b32 a84, v213
  v_accvgpr_read_b32 v213, a85
  v_mul_f32 v213, v213, v214
  v_accvgpr_write_b32 a85, v213
  v_accvgpr_read_b32 v213, a86
  v_mul_f32 v213, v213, v214
  v_accvgpr_write_b32 a86, v213
  v_accvgpr_read_b32 v213, a87
  v_mul_f32 v213, v213, v214
  v_accvgpr_write_b32 a87, v213
  v_accvgpr_read_b32 v213, a88
  v_mul_f32 v213, v213, v214
  v_accvgpr_write_b32 a88, v213
  v_accvgpr_read_b32 v213, a89
  v_mul_f32 v213, v213, v214
  v_accvgpr_write_b32 a89, v213
  v_accvgpr_read_b32 v213, a90
  v_mul_f32 v213, v213, v214
  v_accvgpr_write_b32 a90, v213
  v_accvgpr_read_b32 v213, a91
  v_mul_f32 v213, v213, v214
  v_accvgpr_write_b32 a91, v213
  v_accvgpr_read_b32 v213, a92
  v_mul_f32 v213, v213, v214
  v_accvgpr_write_b32 a92, v213
  v_accvgpr_read_b32 v213, a93
  v_mul_f32 v213, v213, v214
  v_accvgpr_write_b32 a93, v213
  v_accvgpr_read_b32 v213, a94
  v_mul_f32 v213, v213, v214
  v_accvgpr_write_b32 a94, v213
  v_accvgpr_read_b32 v213, a95
  v_mul_f32 v213, v213, v214
  v_accvgpr_write_b32 a95, v213
  v_accvgpr_read_b32 v213, a112
  v_mul_f32 v213, v213, v214
  v_accvgpr_write_b32 a112, v213
  v_accvgpr_read_b32 v213, a113
  v_mul_f32 v213, v213, v214
  v_accvgpr_write_b32 a113, v213
  v_accvgpr_read_b32 v213, a114
  v_mul_f32 v213, v213, v214
  v_accvgpr_write_b32 a114, v213
  v_accvgpr_read_b32 v213, a115
  v_mul_f32 v213, v213, v214
  v_accvgpr_write_b32 a115, v213
  v_accvgpr_read_b32 v213, a116
  v_mul_f32 v213, v213, v214
  v_accvgpr_write_b32 a116, v213
  v_accvgpr_read_b32 v213, a117
  v_mul_f32 v213, v213, v214
  v_accvgpr_write_b32 a117, v213
  v_accvgpr_read_b32 v213, a118
  v_mul_f32 v213, v213, v214
  v_accvgpr_write_b32 a118, v213
  v_accvgpr_read_b32 v213, a119
  v_mul_f32 v213, v213, v214
  v_accvgpr_write_b32 a119, v213
  v_accvgpr_read_b32 v213, a120
  v_mul_f32 v213, v213, v214
  v_accvgpr_write_b32 a120, v213
  v_accvgpr_read_b32 v213, a121
  v_mul_f32 v213, v213, v214
  v_accvgpr_write_b32 a121, v213
  v_accvgpr_read_b32 v213, a122
  v_mul_f32 v213, v213, v214
  v_accvgpr_write_b32 a122, v213
  v_accvgpr_read_b32 v213, a123
  v_mul_f32 v213, v213, v214
  v_accvgpr_write_b32 a123, v213
  v_accvgpr_read_b32 v213, a124
  v_mul_f32 v213, v213, v214
  v_accvgpr_write_b32 a124, v213
  v_accvgpr_read_b32 v213, a125
  v_mul_f32 v213, v213, v214
  v_accvgpr_write_b32 a125, v213
  v_accvgpr_read_b32 v213, a126
  v_mul_f32 v213, v213, v214
  v_accvgpr_write_b32 a126, v213
  v_accvgpr_read_b32 v213, a127
  v_mul_f32 v213, v213, v214
  v_accvgpr_write_b32 a127, v213
  v_exp_f32 v200, v40
  v_exp_f32 v201, v41
  v_add_f32 v210, v208, v200
  v_exp_f32 v202, v42
  v_add_f32 v210, v210, v201
  v_cvt_pk_bf16_f32 v88, v200, v201
  v_exp_f32 v203, v43
  v_add_f32 v210, v210, v202
  v_exp_f32 v204, v44
  v_add_f32 v210, v210, v203
  v_cvt_pk_bf16_f32 v89, v202, v203
  v_exp_f32 v205, v45
  v_add_f32 v210, v210, v204
  v_exp_f32 v206, v46
  v_add_f32 v210, v210, v205
  v_cvt_pk_bf16_f32 v90, v204, v205
  v_exp_f32 v207, v47
  v_add_f32 v210, v210, v206
  v_exp_f32 v200, v48
  v_add_f32 v210, v210, v207
  v_cvt_pk_bf16_f32 v91, v206, v207
  v_exp_f32 v201, v49
  v_add_f32 v210, v210, v200
  v_exp_f32 v202, v50
  v_add_f32 v210, v210, v201
  v_cvt_pk_bf16_f32 v92, v200, v201
  v_exp_f32 v203, v51
  v_add_f32 v210, v210, v202
  v_exp_f32 v204, v52
  v_add_f32 v210, v210, v203
  v_cvt_pk_bf16_f32 v93, v202, v203
  v_exp_f32 v205, v53
  v_add_f32 v210, v210, v204
  v_exp_f32 v206, v54
  v_add_f32 v210, v210, v205
  v_cvt_pk_bf16_f32 v94, v204, v205
  v_exp_f32 v207, v55
  v_add_f32 v210, v210, v206
  v_exp_f32 v200, v56
  v_add_f32 v210, v210, v207
  v_cvt_pk_bf16_f32 v95, v206, v207
  v_exp_f32 v201, v57
  v_add_f32 v211, v209, v200
  v_exp_f32 v202, v58
  v_add_f32 v211, v211, v201
  v_cvt_pk_bf16_f32 v96, v200, v201
  v_exp_f32 v203, v59
  v_add_f32 v211, v211, v202
  v_exp_f32 v204, v60
  v_add_f32 v211, v211, v203
  v_cvt_pk_bf16_f32 v97, v202, v203
  v_exp_f32 v205, v61
  v_add_f32 v211, v211, v204
  v_exp_f32 v206, v62
  v_add_f32 v211, v211, v205
  v_cvt_pk_bf16_f32 v98, v204, v205
  v_exp_f32 v207, v63
  v_add_f32 v211, v211, v206
  v_exp_f32 v200, v64
  v_add_f32 v211, v211, v207
  v_cvt_pk_bf16_f32 v99, v206, v207
  v_exp_f32 v201, v65
  v_add_f32 v211, v211, v200
  v_exp_f32 v202, v66
  v_add_f32 v211, v211, v201
  v_cvt_pk_bf16_f32 v100, v200, v201
  v_exp_f32 v203, v67
  v_add_f32 v211, v211, v202
  v_exp_f32 v204, v68
  v_add_f32 v211, v211, v203
  v_cvt_pk_bf16_f32 v101, v202, v203
  v_exp_f32 v205, v69
  v_add_f32 v211, v211, v204
  v_exp_f32 v206, v70
  v_add_f32 v211, v211, v205
  v_cvt_pk_bf16_f32 v102, v204, v205
  v_exp_f32 v207, v71
  v_add_f32 v211, v211, v206
  v_add_f32 v211, v211, v207
  v_cvt_pk_bf16_f32 v103, v206, v207
  s_branch k2_ret9
k2_fb10:
  v_max3_f32 v212, v8, v9, v10
  v_max3_f32 v212, v212, v11, v12
  v_max3_f32 v212, v212, v13, v14
  v_max3_f32 v212, v212, v15, v16
  v_max3_f32 v212, v212, v17, v18
  v_max3_f32 v212, v212, v19, v20
  v_max3_f32 v212, v212, v21, v22
  v_max_f32 v212, v212, v23
  v_mov_b32 v213, v212
  s_nop 1
  v_permlane32_swap_b32 v212, v213
  v_max_f32 v212, v212, v213
  v_max_f32 v212, 0, v212
  v_sub_f32 v104, v104, v212
  v_sub_f32 v105, v105, v212
  v_sub_f32 v106, v106, v212
  v_sub_f32 v107, v107, v212
  v_sub_f32 v108, v108, v212
  v_sub_f32 v109, v109, v212
  v_sub_f32 v110, v110, v212
  v_sub_f32 v111, v111, v212
  v_sub_f32 v112, v112, v212
  v_sub_f32 v113, v113, v212
  v_sub_f32 v114, v114, v212
  v_sub_f32 v115, v115, v212
  v_sub_f32 v116, v116, v212
  v_sub_f32 v117, v117, v212
  v_sub_f32 v118, v118, v212
  v_sub_f32 v119, v119, v212
  v_sub_f32 v8, v8, v212
  v_sub_f32 v9, v9, v212
  v_sub_f32 v10, v10, v212
  v_sub_f32 v11, v11, v212
  v_sub_f32 v12, v12, v212
  v_sub_f32 v13, v13, v212
  v_sub_f32 v14, v14, v212
  v_sub_f32 v15, v15, v212
  v_sub_f32 v16, v16, v212
  v_sub_f32 v17, v17, v212
  v_sub_f32 v18, v18, v212
  v_sub_f32 v19, v19, v212
  v_sub_f32 v20, v20, v212
  v_sub_f32 v21, v21, v212
  v_sub_f32 v22, v22, v212
  v_sub_f32 v23, v23, v212
  v_sub_f32 v40, v40, v212
  v_sub_f32 v41, v41, v212
  v_sub_f32 v42, v42, v212
  v_sub_f32 v43, v43, v212
  v_sub_f32 v44, v44, v212
  v_sub_f32 v45, v45, v212
  v_sub_f32 v46, v46, v212
  v_sub_f32 v47, v47, v212
  v_sub_f32 v48, v48, v212
  v_sub_f32 v49, v49, v212
  v_sub_f32 v50, v50, v212
  v_sub_f32 v51, v51, v212
  v_sub_f32 v52, v52, v212
  v_sub_f32 v53, v53, v212
  v_sub_f32 v54, v54, v212
  v_sub_f32 v55, v55, v212
  v_sub_f32 v214, 0, v212
  v_exp_f32 v214, v214
  s_nop 0
  v_mul_f32 v210, v210, v214
  v_accvgpr_read_b32 v213, a0
  v_mul_f32 v213, v213, v214
  v_accvgpr_write_b32 a0, v213
  v_accvgpr_read_b32 v213, a1
  v_mul_f32 v213, v213, v214
  v_accvgpr_write_b32 a1, v213
  v_accvgpr_read_b32 v213, a2
  v_mul_f32 v213, v213, v214
  v_accvgpr_write_b32 a2, v213
  v_accvgpr_read_b32 v213, a3
  v_mul_f32 v213, v213, v214
  v_accvgpr_write_b32 a3, v213
  v_accvgpr_read_b32 v213, a4
  v_mul_f32 v213, v213, v214
  v_accvgpr_write_b32 a4, v213
  v_accvgpr_read_b32 v213, a5
  v_mul_f32 v213, v213, v214
  v_accvgpr_write_b32 a5, v213
  v_accvgpr_read_b32 v213, a6
  v_mul_f32 v213, v213, v214
  v_accvgpr_write_b32 a6, v213
  v_accvgpr_read_b32 v213, a7
  v_mul_f32 v213, v213, v214
  v_accvgpr_write_b32 a7, v213
  v_accvgpr_read_b32 v213, a8
  v_mul_f32 v213, v213, v214
  v_accvgpr_write_b32 a8, v213
  v_accvgpr_read_b32 v213, a9
  v_mul_f32 v213, v213, v214
  v_accvgpr_write_b32 a9, v213
  v_accvgpr_read_b32 v213, a10
  v_mul_f32 v213, v213, v214
  v_accvgpr_write_b32 a10, v213
  v_accvgpr_read_b32 v213, a11
  v_mul_f32 v213, v213, v214
  v_accvgpr_write_b32 a11, v213
  v_accvgpr_read_b32 v213, a12
  v_mul_f32 v213, v213, v214
  v_accvgpr_write_b32 a12, v213
  v_accvgpr_read_b32 v213, a13
  v_mul_f32 v213, v213, v214
  v_accvgpr_write_b32 a13, v213
  v_accvgpr_read_b32 v213, a14
  v_mul_f32 v213, v213, v214
  v_accvgpr_write_b32 a14, v213
  v_accvgpr_read_b32 v213, a15
  v_mul_f32 v213, v213, v214
  v_accvgpr_write_b32 a15, v213
  v_accvgpr_read_b32 v213, a32
  v_mul_f32 v213, v213, v214
  v_accvgpr_write_b32 a32, v213
  v_accvgpr_read_b32 v213, a33
  v_mul_f32 v213, v213, v214
  v_accvgpr_write_b32 a33, v213
  v_accvgpr_read_b32 v213, a34
  v_mul_f32 v213, v213, v214
  v_accvgpr_write_b32 a34, v213
  v_accvgpr_read_b32 v213, a35
  v_mul_f32 v213, v213, v214
  v_accvgpr_write_b32 a35, v213
  v_accvgpr_read_b32 v213, a36
  v_mul_f32 v213, v213, v214
  v_accvgpr_write_b32 a36, v213
  v_accvgpr_read_b32 v213, a37
  v_mul_f32 v213, v213, v214
  v_accvgpr_write_b32 a37, v213
  v_accvgpr_read_b32 v213, a38
  v_mul_f32 v213, v213, v214
  v_accvgpr_write_b32 a38, v213
  v_accvgpr_read_b32 v213, a39
  v_mul_f32 v213, v213, v214
  v_accvgpr_write_b32 a39, v213
  v_accvgpr_read_b32 v213, a40
  v_mul_f32 v213, v213, v214
  v_accvgpr_write_b32 a40, v213
  v_accvgpr_read_b32 v213, a41
  v_mul_f32 v213, v213, v214
  v_accvgpr_write_b32 a41, v213
  v_accvgpr_read_b32 v213, a42
  v_mul_f32 v213, v213, v214
  v_accvgpr_write_b32 a42, v213
  v_accvgpr_read_b32 v213, a43
  v_mul_f32 v213, v213, v214
  v_accvgpr_write_b32 a43, v213
  v_accvgpr_read_b32 v213, a44
  v_mul_f32 v213, v213, v214
  v_accvgpr_write_b32 a44, v213
  v_accvgpr_read_b32 v213, a45
  v_mul_f32 v213, v213, v214
  v_accvgpr_write_b32 a45, v213
  v_accvgpr_read_b32 v213, a46
  v_mul_f32 v213, v213, v214
  v_accvgpr_write_b32 a46, v213
  v_accvgpr_read_b32 v213, a47
  v_mul_f32 v213, v213, v214
  v_accvgpr_write_b32 a47, v213
  v_accvgpr_read_b32 v213, a64
  v_mul_f32 v213, v213, v214
  v_accvgpr_write_b32 a64, v213
  v_accvgpr_read_b32 v213, a65
  v_mul_f32 v213, v213, v214
  v_accvgpr_write_b32 a65, v213
  v_accvgpr_read_b32 v213, a66
  v_mul_f32 v213, v213, v214
  v_accvgpr_write_b32 a66, v213
  v_accvgpr_read_b32 v213, a67
  v_mul_f32 v213, v213, v214
  v_accvgpr_write_b32 a67, v213
  v_accvgpr_read_b32 v213, a68
  v_mul_f32 v213, v213, v214
  v_accvgpr_write_b32 a68, v213
  v_accvgpr_read_b32 v213, a69
  v_mul_f32 v213, v213, v214
  v_accvgpr_write_b32 a69, v213
  v_accvgpr_read_b32 v213, a70
  v_mul_f32 v213, v213, v214
  v_accvgpr_write_b32 a70, v213
  v_accvgpr_read_b32 v213, a71
  v_mul_f32 v213, v213, v214
  v_accvgpr_write_b32 a71, v213
  v_accvgpr_read_b32 v213, a72
  v_mul_f32 v213, v213, v214
  v_accvgpr_write_b32 a72, v213
  v_accvgpr_read_b32 v213, a73
  v_mul_f32 v213, v213, v214
  v_accvgpr_write_b32 a73, v213
  v_accvgpr_read_b32 v213, a74
  v_mul_f32 v213, v213, v214
  v_accvgpr_write_b32 a74, v213
  v_accvgpr_read_b32 v213, a75
  v_mul_f32 v213, v213, v214
  v_accvgpr_write_b32 a75, v213
  v_accvgpr_read_b32 v213, a76
  v_mul_f32 v213, v213, v214
  v_accvgpr_write_b32 a76, v213
  v_accvgpr_read_b32 v213, a77
  v_mul_f32 v213, v213, v214
  v_accvgpr_write_b32 a77, v213
  v_accvgpr_read_b32 v213, a78
  v_mul_f32 v213, v213, v214
  v_accvgpr_write_b32 a78, v213
  v_accvgpr_read_b32 v213, a79
  v_mul_f32 v213, v213, v214
  v_accvgpr_write_b32 a79, v213
  v_accvgpr_read_b32 v213, a96
  v_mul_f32 v213, v213, v214
  v_accvgpr_write_b32 a96, v213
  v_accvgpr_read_b32 v213, a97
  v_mul_f32 v213, v213, v214
  v_accvgpr_write_b32 a97, v213
  v_accvgpr_read_b32 v213, a98
  v_mul_f32 v213, v213, v214
  v_accvgpr_write_b32 a98, v213
  v_accvgpr_read_b32 v213, a99
  v_mul_f32 v213, v213, v214
  v_accvgpr_write_b32 a99, v213
  v_accvgpr_read_b32 v213, a100
  v_mul_f32 v213, v213, v214
  v_accvgpr_write_b32 a100, v213
  v_accvgpr_read_b32 v213, a101
  v_mul_f32 v213, v213, v214
  v_accvgpr_write_b32 a101, v213
  v_accvgpr_read_b32 v213, a102
  v_mul_f32 v213, v213, v214
  v_accvgpr_write_b32 a102, v213
  v_accvgpr_read_b32 v213, a103
  v_mul_f32 v213, v213, v214
  v_accvgpr_write_b32 a103, v213
  v_accvgpr_read_b32 v213, a104
  v_mul_f32 v213, v213, v214
  v_accvgpr_write_b32 a104, v213
  v_accvgpr_read_b32 v213, a105
  v_mul_f32 v213, v213, v214
  v_accvgpr_write_b32 a105, v213
  v_accvgpr_read_b32 v213, a106
  v_mul_f32 v213, v213, v214
  v_accvgpr_write_b32 a106, v213
  v_accvgpr_read_b32 v213, a107
  v_mul_f32 v213, v213, v214
  v_accvgpr_write_b32 a107, v213
  v_accvgpr_read_b32 v213, a108
  v_mul_f32 v213, v213, v214
  v_accvgpr_write_b32 a108, v213
  v_accvgpr_read_b32 v213, a109
  v_mul_f32 v213, v213, v214
  v_accvgpr_write_b32 a109, v213
  v_accvgpr_read_b32 v213, a110
  v_mul_f32 v213, v213, v214
  v_accvgpr_write_b32 a110, v213
  v_accvgpr_read_b32 v213, a111
  v_mul_f32 v213, v213, v214
  v_accvgpr_write_b32 a111, v213
  v_max3_f32 v212, v24, v25, v26
  v_max3_f32 v212, v212, v27, v28
  v_max3_f32 v212, v212, v29, v30
  v_max3_f32 v212, v212, v31, v32
  v_max3_f32 v212, v212, v33, v34
  v_max3_f32 v212, v212, v35, v36
  v_max3_f32 v212, v212, v37, v38
  v_max_f32 v212, v212, v39
  v_mov_b32 v213, v212
  s_nop 1
  v_permlane32_swap_b32 v212, v213
  v_max_f32 v212, v212, v213
  v_max_f32 v212, 0, v212
  v_sub_f32 v120, v120, v212
  v_sub_f32 v121, v121, v212
  v_sub_f32 v122, v122, v212
  v_sub_f32 v123, v123, v212
  v_sub_f32 v124, v124, v212
  v_sub_f32 v125, v125, v212
  v_sub_f32 v126, v126, v212
  v_sub_f32 v127, v127, v212
  v_sub_f32 v128, v128, v212
  v_sub_f32 v129, v129, v212
  v_sub_f32 v130, v130, v212
  v_sub_f32 v131, v131, v212
  v_sub_f32 v132, v132, v212
  v_sub_f32 v133, v133, v212
  v_sub_f32 v134, v134, v212
  v_sub_f32 v135, v135, v212
  v_sub_f32 v24, v24, v212
  v_sub_f32 v25, v25, v212
  v_sub_f32 v26, v26, v212
  v_sub_f32 v27, v27, v212
  v_sub_f32 v28, v28, v212
  v_sub_f32 v29, v29, v212
  v_sub_f32 v30, v30, v212
  v_sub_f32 v31, v31, v212
  v_sub_f32 v32, v32, v212
  v_sub_f32 v33, v33, v212
  v_sub_f32 v34, v34, v212
  v_sub_f32 v35, v35, v212
  v_sub_f32 v36, v36, v212
  v_sub_f32 v37, v37, v212
  v_sub_f32 v38, v38, v212
  v_sub_f32 v39, v39, v212
  v_sub_f32 v56, v56, v212
  v_sub_f32 v57, v57, v212
  v_sub_f32 v58, v58, v212
  v_sub_f32 v59, v59, v212
  v_sub_f32 v60, v60, v212
  v_sub_f32 v61, v61, v212
  v_sub_f32 v62, v62, v212
  v_sub_f32 v63, v63, v212
  v_sub_f32 v64, v64, v212
  v_sub_f32 v65, v65, v212
  v_sub_f32 v66, v66, v212
  v_sub_f32 v67, v67, v212
  v_sub_f32 v68, v68, v212
  v_sub_f32 v69, v69, v212
  v_sub_f32 v70, v70, v212
  v_sub_f32 v71, v71, v212
  v_sub_f32 v214, 0, v212
  v_exp_f32 v214, v214
  s_nop 0
  v_mul_f32 v211, v211, v214
  v_accvgpr_read_b32 v213, a16
  v_mul_f32 v213, v213, v214
  v_accvgpr_write_b32 a16, v213
  v_accvgpr_read_b32 v213, a17
  v_mul_f32 v213, v213, v214
  v_accvgpr_write_b32 a17, v213
  v_accvgpr_read_b32 v213, a18
  v_mul_f32 v213, v213, v214
  v_accvgpr_write_b32 a18, v213
  v_accvgpr_read_b32 v213, a19
  v_mul_f32 v213, v213, v214
  v_accvgpr_write_b32 a19, v213
  v_accvgpr_read_b32 v213, a20
  v_mul_f32 v213, v213, v214
  v_accvgpr_write_b32 a20, v213
  v_accvgpr_read_b32 v213, a21
  v_mul_f32 v213, v213, v214
  v_accvgpr_write_b32 a21, v213
  v_accvgpr_read_b32 v213, a22
  v_mul_f32 v213, v213, v214
  v_accvgpr_write_b32 a22, v213
  v_accvgpr_read_b32 v213, a23
  v_mul_f32 v213, v213, v214
  v_accvgpr_write_b32 a23, v213
  v_accvgpr_read_b32 v213, a24
  v_mul_f32 v213, v213, v214
  v_accvgpr_write_b32 a24, v213
  v_accvgpr_read_b32 v213, a25
  v_mul_f32 v213, v213, v214
  v_accvgpr_write_b32 a25, v213
  v_accvgpr_read_b32 v213, a26
  v_mul_f32 v213, v213, v214
  v_accvgpr_write_b32 a26, v213
  v_accvgpr_read_b32 v213, a27
  v_mul_f32 v213, v213, v214
  v_accvgpr_write_b32 a27, v213
  v_accvgpr_read_b32 v213, a28
  v_mul_f32 v213, v213, v214
  v_accvgpr_write_b32 a28, v213
  v_accvgpr_read_b32 v213, a29
  v_mul_f32 v213, v213, v214
  v_accvgpr_write_b32 a29, v213
  v_accvgpr_read_b32 v213, a30
  v_mul_f32 v213, v213, v214
  v_accvgpr_write_b32 a30, v213
  v_accvgpr_read_b32 v213, a31
  v_mul_f32 v213, v213, v214
  v_accvgpr_write_b32 a31, v213
  v_accvgpr_read_b32 v213, a48
  v_mul_f32 v213, v213, v214
  v_accvgpr_write_b32 a48, v213
  v_accvgpr_read_b32 v213, a49
  v_mul_f32 v213, v213, v214
  v_accvgpr_write_b32 a49, v213
  v_accvgpr_read_b32 v213, a50
  v_mul_f32 v213, v213, v214
  v_accvgpr_write_b32 a50, v213
  v_accvgpr_read_b32 v213, a51
  v_mul_f32 v213, v213, v214
  v_accvgpr_write_b32 a51, v213
  v_accvgpr_read_b32 v213, a52
  v_mul_f32 v213, v213, v214
  v_accvgpr_write_b32 a52, v213
  v_accvgpr_read_b32 v213, a53
  v_mul_f32 v213, v213, v214
  v_accvgpr_write_b32 a53, v213
  v_accvgpr_read_b32 v213, a54
  v_mul_f32 v213, v213, v214
  v_accvgpr_write_b32 a54, v213
  v_accvgpr_read_b32 v213, a55
  v_mul_f32 v213, v213, v214
  v_accvgpr_write_b32 a55, v213
  v_accvgpr_read_b32 v213, a56
  v_mul_f32 v213, v213, v214
  v_accvgpr_write_b32 a56, v213
  v_accvgpr_read_b32 v213, a57
  v_mul_f32 v213, v213, v214
  v_accvgpr_write_b32 a57, v213
  v_accvgpr_read_b32 v213, a58
  v_mul_f32 v213, v213, v214
  v_accvgpr_write_b32 a58, v213
  v_accvgpr_read_b32 v213, a59
  v_mul_f32 v213, v213, v214
  v_accvgpr_write_b32 a59, v213
  v_accvgpr_read_b32 v213, a60
  v_mul_f32 v213, v213, v214
  v_accvgpr_write_b32 a60, v213
  v_accvgpr_read_b32 v213, a61
  v_mul_f32 v213, v213, v214
  v_accvgpr_write_b32 a61, v213
  v_accvgpr_read_b32 v213, a62
  v_mul_f32 v213, v213, v214
  v_accvgpr_write_b32 a62, v213
  v_accvgpr_read_b32 v213, a63
  v_mul_f32 v213, v213, v214
  v_accvgpr_write_b32 a63, v213
  v_accvgpr_read_b32 v213, a80
  v_mul_f32 v213, v213, v214
  v_accvgpr_write_b32 a80, v213
  v_accvgpr_read_b32 v213, a81
  v_mul_f32 v213, v213, v214
  v_accvgpr_write_b32 a81, v213
  v_accvgpr_read_b32 v213, a82
  v_mul_f32 v213, v213, v214
  v_accvgpr_write_b32 a82, v213
  v_accvgpr_read_b32 v213, a83
  v_mul_f32 v213, v213, v214
  v_accvgpr_write_b32 a83, v213
  v_accvgpr_read_b32 v213, a84
  v_mul_f32 v213, v213, v214
  v_accvgpr_write_b32 a84, v213
  v_accvgpr_read_b32 v213, a85
  v_mul_f32 v213, v213, v214
  v_accvgpr_write_b32 a85, v213
  v_accvgpr_read_b32 v213, a86
  v_mul_f32 v213, v213, v214
  v_accvgpr_write_b32 a86, v213
  v_accvgpr_read_b32 v213, a87
  v_mul_f32 v213, v213, v214
  v_accvgpr_write_b32 a87, v213
  v_accvgpr_read_b32 v213, a88
  v_mul_f32 v213, v213, v214
  v_accvgpr_write_b32 a88, v213
  v_accvgpr_read_b32 v213, a89
  v_mul_f32 v213, v213, v214
  v_accvgpr_write_b32 a89, v213
  v_accvgpr_read_b32 v213, a90
  v_mul_f32 v213, v213, v214
  v_accvgpr_write_b32 a90, v213
  v_accvgpr_read_b32 v213, a91
  v_mul_f32 v213, v213, v214
  v_accvgpr_write_b32 a91, v213
  v_accvgpr_read_b32 v213, a92
  v_mul_f32 v213, v213, v214
  v_accvgpr_write_b32 a92, v213
  v_accvgpr_read_b32 v213, a93
  v_mul_f32 v213, v213, v214
  v_accvgpr_write_b32 a93, v213
  v_accvgpr_read_b32 v213, a94
  v_mul_f32 v213, v213, v214
  v_accvgpr_write_b32 a94, v213
  v_accvgpr_read_b32 v213, a95
  v_mul_f32 v213, v213, v214
  v_accvgpr_write_b32 a95, v213
  v_accvgpr_read_b32 v213, a112
  v_mul_f32 v213, v213, v214
  v_accvgpr_write_b32 a112, v213
  v_accvgpr_read_b32 v213, a113
  v_mul_f32 v213, v213, v214
  v_accvgpr_write_b32 a113, v213
  v_accvgpr_read_b32 v213, a114
  v_mul_f32 v213, v213, v214
  v_accvgpr_write_b32 a114, v213
  v_accvgpr_read_b32 v213, a115
  v_mul_f32 v213, v213, v214
  v_accvgpr_write_b32 a115, v213
  v_accvgpr_read_b32 v213, a116
  v_mul_f32 v213, v213, v214
  v_accvgpr_write_b32 a116, v213
  v_accvgpr_read_b32 v213, a117
  v_mul_f32 v213, v213, v214
  v_accvgpr_write_b32 a117, v213
  v_accvgpr_read_b32 v213, a118
  v_mul_f32 v213, v213, v214
  v_accvgpr_write_b32 a118, v213
  v_accvgpr_read_b32 v213, a119
  v_mul_f32 v213, v213, v214
  v_accvgpr_write_b32 a119, v213
  v_accvgpr_read_b32 v213, a120
  v_mul_f32 v213, v213, v214
  v_accvgpr_write_b32 a120, v213
  v_accvgpr_read_b32 v213, a121
  v_mul_f32 v213, v213, v214
  v_accvgpr_write_b32 a121, v213
  v_accvgpr_read_b32 v213, a122
  v_mul_f32 v213, v213, v214
  v_accvgpr_write_b32 a122, v213
  v_accvgpr_read_b32 v213, a123
  v_mul_f32 v213, v213, v214
  v_accvgpr_write_b32 a123, v213
  v_accvgpr_read_b32 v213, a124
  v_mul_f32 v213, v213, v214
  v_accvgpr_write_b32 a124, v213
  v_accvgpr_read_b32 v213, a125
  v_mul_f32 v213, v213, v214
  v_accvgpr_write_b32 a125, v213
  v_accvgpr_read_b32 v213, a126
  v_mul_f32 v213, v213, v214
  v_accvgpr_write_b32 a126, v213
  v_accvgpr_read_b32 v213, a127
  v_mul_f32 v213, v213, v214
  v_accvgpr_write_b32 a127, v213
  v_exp_f32 v200, v8
  v_exp_f32 v201, v9
  v_add_f32 v208, v210, v200
  v_exp_f32 v202, v10
  v_add_f32 v208, v208, v201
  v_cvt_pk_bf16_f32 v72, v200, v201
  v_exp_f32 v203, v11
  v_add_f32 v208, v208, v202
  v_exp_f32 v204, v12
  v_add_f32 v208, v208, v203
  v_cvt_pk_bf16_f32 v73, v202, v203
  v_exp_f32 v205, v13
  v_add_f32 v208, v208, v204
  v_exp_f32 v206, v14
  v_add_f32 v208, v208, v205
  v_cvt_pk_bf16_f32 v74, v204, v205
  v_exp_f32 v207, v15
  v_add_f32 v208, v208, v206
  v_exp_f32 v200, v16
  v_add_f32 v208, v208, v207
  v_cvt_pk_bf16_f32 v75, v206, v207
  v_exp_f32 v201, v17
  v_add_f32 v208, v208, v200
  v_exp_f32 v202, v18
  v_add_f32 v208, v208, v201
  v_cvt_pk_bf16_f32 v76, v200, v201
  v_exp_f32 v203, v19
  v_add_f32 v208, v208, v202
  v_exp_f32 v204, v20
  v_add_f32 v208, v208, v203
  v_cvt_pk_bf16_f32 v77, v202, v203
  v_exp_f32 v205, v21
  v_add_f32 v208, v208, v204
  v_exp_f32 v206, v22
  v_add_f32 v208, v208, v205
  v_cvt_pk_bf16_f32 v78, v204, v205
  v_exp_f32 v207, v23
  v_add_f32 v208, v208, v206
  v_exp_f32 v200, v24
  v_add_f32 v208, v208, v207
  v_cvt_pk_bf16_f32 v79, v206, v207
  v_exp_f32 v201, v25
  v_add_f32 v209, v211, v200
  v_exp_f32 v202, v26
  v_add_f32 v209, v209, v201
  v_cvt_pk_bf16_f32 v80, v200, v201
  v_exp_f32 v203, v27
  v_add_f32 v209, v209, v202
  v_exp_f32 v204, v28
  v_add_f32 v209, v209, v203
  v_cvt_pk_bf16_f32 v81, v202, v203
  v_exp_f32 v205, v29
  v_add_f32 v209, v209, v204
  v_exp_f32 v206, v30
  v_add_f32 v209, v209, v205
  v_cvt_pk_bf16_f32 v82, v204, v205
  v_exp_f32 v207, v31
  v_add_f32 v209, v209, v206
  v_exp_f32 v200, v32
  v_add_f32 v209, v209, v207
  v_cvt_pk_bf16_f32 v83, v206, v207
  v_exp_f32 v201, v33
  v_add_f32 v209, v209, v200
  v_exp_f32 v202, v34
  v_add_f32 v209, v209, v201
  v_cvt_pk_bf16_f32 v84, v200, v201
  v_exp_f32 v203, v35
  v_add_f32 v209, v209, v202
  v_exp_f32 v204, v36
  v_add_f32 v209, v209, v203
  v_cvt_pk_bf16_f32 v85, v202, v203
  v_exp_f32 v205, v37
  v_add_f32 v209, v209, v204
  v_exp_f32 v206, v38
  v_add_f32 v209, v209, v205
  v_cvt_pk_bf16_f32 v86, v204, v205
  v_exp_f32 v207, v39
  v_add_f32 v209, v209, v206
  v_add_f32 v209, v209, v207
  v_cvt_pk_bf16_f32 v87, v206, v207
  s_branch k2_ret11
k2_fb12:
  v_max3_f32 v212, v40, v41, v42
  v_max3_f32 v212, v212, v43, v44
  v_max3_f32 v212, v212, v45, v46
  v_max3_f32 v212, v212, v47, v48
  v_max3_f32 v212, v212, v49, v50
  v_max3_f32 v212, v212, v51, v52
  v_max3_f32 v212, v212, v53, v54
  v_max_f32 v212, v212, v55
  v_mov_b32 v213, v212
  s_nop 1
  v_permlane32_swap_b32 v212, v213
  v_max_f32 v212, v212, v213
  v_max_f32 v212, 0, v212
  v_sub_f32 v104, v104, v212
  v_sub_f32 v105, v105, v212
  v_sub_f32 v106, v106, v212
  v_sub_f32 v107, v107, v212
  v_sub_f32 v108, v108, v212
  v_sub_f32 v109, v109, v212
  v_sub_f32 v110, v110, v212
  v_sub_f32 v111, v111, v212
  v_sub_f32 v112, v112, v212
  v_sub_f32 v113, v113, v212
  v_sub_f32 v114, v114, v212
  v_sub_f32 v115, v115, v212
  v_sub_f32 v116, v116, v212
  v_sub_f32 v117, v117, v212
  v_sub_f32 v118, v118, v212
  v_sub_f32 v119, v119, v212
  v_sub_f32 v40, v40, v212
  v_sub_f32 v41, v41, v212
  v_sub_f32 v42, v42, v212
  v_sub_f32 v43, v43, v212
  v_sub_f32 v44, v44, v212
  v_sub_f32 v45, v45, v212
  v_sub_f32 v46, v46, v212
  v_sub_f32 v47, v47, v212
  v_sub_f32 v48, v48, v212
  v_sub_f32 v49, v49, v212
  v_sub_f32 v50, v50, v212
  v_sub_f32 v51, v51, v212
  v_sub_f32 v52, v52, v212
  v_sub_f32 v53, v53, v212
  v_sub_f32 v54, v54, v212
  v_sub_f32 v55, v55, v212
  v_sub_f32 v8, v8, v212
  v_sub_f32 v9, v9, v212
  v_sub_f32 v10, v10, v212
  v_sub_f32 v11, v11, v212
  v_sub_f32 v12, v12, v212
  v_sub_f32 v13, v13, v212
  v_sub_f32 v14, v14, v212
  v_sub_f32 v15, v15, v212
  v_sub_f32 v16, v16, v212
  v_sub_f32 v17, v17, v212
  v_sub_f32 v18, v18, v212
  v_sub_f32 v19, v19, v212
  v_sub_f32 v20, v20, v212
  v_sub_f32 v21, v21, v212
  v_sub_f32 v22, v22, v212
  v_sub_f32 v23, v23, v212
  v_sub_f32 v214, 0, v212
  v_exp_f32 v214, v214
  s_nop 0
  v_mul_f32 v208, v208, v214
  v_accvgpr_read_b32 v213, a0
  v_mul_f32 v213, v213, v214
  v_accvgpr_write_b32 a0, v213
  v_accvgpr_read_b32 v213, a1
  v_mul_f32 v213, v213, v214
  v_accvgpr_write_b32 a1, v213
  v_accvgpr_read_b32 v213, a2
  v_mul_f32 v213, v213, v214
  v_accvgpr_write_b32 a2, v213
  v_accvgpr_read_b32 v213, a3
  v_mul_f32 v213, v213, v214
  v_accvgpr_write_b32 a3, v213
  v_accvgpr_read_b32 v213, a4
  v_mul_f32 v213, v213, v214
  v_accvgpr_write_b32 a4, v213
  v_accvgpr_read_b32 v213, a5
  v_mul_f32 v213, v213, v214
  v_accvgpr_write_b32 a5, v213
  v_accvgpr_read_b32 v213, a6
  v_mul_f32 v213, v213, v214
  v_accvgpr_write_b32 a6, v213
  v_accvgpr_read_b32 v213, a7
  v_mul_f32 v213, v213, v214
  v_accvgpr_write_b32 a7, v213
  v_accvgpr_read_b32 v213, a8
  v_mul_f32 v213, v213, v214
  v_accvgpr_write_b32 a8, v213
  v_accvgpr_read_b32 v213, a9
  v_mul_f32 v213, v213, v214
  v_accvgpr_write_b32 a9, v213
  v_accvgpr_read_b32 v213, a10
  v_mul_f32 v213, v213, v214
  v_accvgpr_write_b32 a10, v213
  v_accvgpr_read_b32 v213, a11
  v_mul_f32 v213, v213, v214
  v_accvgpr_write_b32 a11, v213
  v_accvgpr_read_b32 v213, a12
  v_mul_f32 v213, v213, v214
  v_accvgpr_write_b32 a12, v213
  v_accvgpr_read_b32 v213, a13
  v_mul_f32 v213, v213, v214
  v_accvgpr_write_b32 a13, v213
  v_accvgpr_read_b32 v213, a14
  v_mul_f32 v213, v213, v214
  v_accvgpr_write_b32 a14, v213
  v_accvgpr_read_b32 v213, a15
  v_mul_f32 v213, v213, v214
  v_accvgpr_write_b32 a15, v213
  v_accvgpr_read_b32 v213, a32
  v_mul_f32 v213, v213, v214
  v_accvgpr_write_b32 a32, v213
  v_accvgpr_read_b32 v213, a33
  v_mul_f32 v213, v213, v214
  v_accvgpr_write_b32 a33, v213
  v_accvgpr_read_b32 v213, a34
  v_mul_f32 v213, v213, v214
  v_accvgpr_write_b32 a34, v213
  v_accvgpr_read_b32 v213, a35
  v_mul_f32 v213, v213, v214
  v_accvgpr_write_b32 a35, v213
  v_accvgpr_read_b32 v213, a36
  v_mul_f32 v213, v213, v214
  v_accvgpr_write_b32 a36, v213
  v_accvgpr_read_b32 v213, a37
  v_mul_f32 v213, v213, v214
  v_accvgpr_write_b32 a37, v213
  v_accvgpr_read_b32 v213, a38
  v_mul_f32 v213, v213, v214
  v_accvgpr_write_b32 a38, v213
  v_accvgpr_read_b32 v213, a39
  v_mul_f32 v213, v213, v214
  v_accvgpr_write_b32 a39, v213
  v_accvgpr_read_b32 v213, a40
  v_mul_f32 v213, v213, v214
  v_accvgpr_write_b32 a40, v213
  v_accvgpr_read_b32 v213, a41
  v_mul_f32 v213, v213, v214
  v_accvgpr_write_b32 a41, v213
  v_accvgpr_read_b32 v213, a42
  v_mul_f32 v213, v213, v214
  v_accvgpr_write_b32 a42, v213
  v_accvgpr_read_b32 v213, a43
  v_mul_f32 v213, v213, v214
  v_accvgpr_write_b32 a43, v213
  v_accvgpr_read_b32 v213, a44
  v_mul_f32 v213, v213, v214
  v_accvgpr_write_b32 a44, v213
  v_accvgpr_read_b32 v213, a45
  v_mul_f32 v213, v213, v214
  v_accvgpr_write_b32 a45, v213
  v_accvgpr_read_b32 v213, a46
  v_mul_f32 v213, v213, v214
  v_accvgpr_write_b32 a46, v213
  v_accvgpr_read_b32 v213, a47
  v_mul_f32 v213, v213, v214
  v_accvgpr_write_b32 a47, v213
  v_accvgpr_read_b32 v213, a64
  v_mul_f32 v213, v213, v214
  v_accvgpr_write_b32 a64, v213
  v_accvgpr_read_b32 v213, a65
  v_mul_f32 v213, v213, v214
  v_accvgpr_write_b32 a65, v213
  v_accvgpr_read_b32 v213, a66
  v_mul_f32 v213, v213, v214
  v_accvgpr_write_b32 a66, v213
  v_accvgpr_read_b32 v213, a67
  v_mul_f32 v213, v213, v214
  v_accvgpr_write_b32 a67, v213
  v_accvgpr_read_b32 v213, a68
  v_mul_f32 v213, v213, v214
  v_accvgpr_write_b32 a68, v213
  v_accvgpr_read_b32 v213, a69
  v_mul_f32 v213, v213, v214
  v_accvgpr_write_b32 a69, v213
  v_accvgpr_read_b32 v213, a70
  v_mul_f32 v213, v213, v214
  v_accvgpr_write_b32 a70, v213
  v_accvgpr_read_b32 v213, a71
  v_mul_f32 v213, v213, v214
  v_accvgpr_write_b32 a71, v213
  v_accvgpr_read_b32 v213, a72
  v_mul_f32 v213, v213, v214
  v_accvgpr_write_b32 a72, v213
  v_accvgpr_read_b32 v213, a73
  v_mul_f32 v213, v213, v214
  v_accvgpr_write_b32 a73, v213
  v_accvgpr_read_b32 v213, a74
  v_mul_f32 v213, v213, v214
  v_accvgpr_write_b32 a74, v213
  v_accvgpr_read_b32 v213, a75
  v_mul_f32 v213, v213, v214
  v_accvgpr_write_b32 a75, v213
  v_accvgpr_read_b32 v213, a76
  v_mul_f32 v213, v213, v214
  v_accvgpr_write_b32 a76, v213
  v_accvgpr_read_b32 v213, a77
  v_mul_f32 v213, v213, v214
  v_accvgpr_write_b32 a77, v213
  v_accvgpr_read_b32 v213, a78
  v_mul_f32 v213, v213, v214
  v_accvgpr_write_b32 a78, v213
  v_accvgpr_read_b32 v213, a79
  v_mul_f32 v213, v213, v214
  v_accvgpr_write_b32 a79, v213
  v_accvgpr_read_b32 v213, a96
  v_mul_f32 v213, v213, v214
  v_accvgpr_write_b32 a96, v213
  v_accvgpr_read_b32 v213, a97
  v_mul_f32 v213, v213, v214
  v_accvgpr_write_b32 a97, v213
  v_accvgpr_read_b32 v213, a98
  v_mul_f32 v213, v213, v214
  v_accvgpr_write_b32 a98, v213
  v_accvgpr_read_b32 v213, a99
  v_mul_f32 v213, v213, v214
  v_accvgpr_write_b32 a99, v213
  v_accvgpr_read_b32 v213, a100
  v_mul_f32 v213, v213, v214
  v_accvgpr_write_b32 a100, v213
  v_accvgpr_read_b32 v213, a101
  v_mul_f32 v213, v213, v214
  v_accvgpr_write_b32 a101, v213
  v_accvgpr_read_b32 v213, a102
  v_mul_f32 v213, v213, v214
  v_accvgpr_write_b32 a102, v213
  v_accvgpr_read_b32 v213, a103
  v_mul_f32 v213, v213, v214
  v_accvgpr_write_b32 a103, v213
  v_accvgpr_read_b32 v213, a104
  v_mul_f32 v213, v213, v214
  v_accvgpr_write_b32 a104, v213
  v_accvgpr_read_b32 v213, a105
  v_mul_f32 v213, v213, v214
  v_accvgpr_write_b32 a105, v213
  v_accvgpr_read_b32 v213, a106
  v_mul_f32 v213, v213, v214
  v_accvgpr_write_b32 a106, v213
  v_accvgpr_read_b32 v213, a107
  v_mul_f32 v213, v213, v214
  v_accvgpr_write_b32 a107, v213
  v_accvgpr_read_b32 v213, a108
  v_mul_f32 v213, v213, v214
  v_accvgpr_write_b32 a108, v213
  v_accvgpr_read_b32 v213, a109
  v_mul_f32 v213, v213, v214
  v_accvgpr_write_b32 a109, v213
  v_accvgpr_read_b32 v213, a110
  v_mul_f32 v213, v213, v214
  v_accvgpr_write_b32 a110, v213
  v_accvgpr_read_b32 v213, a111
  v_mul_f32 v213, v213, v214
  v_accvgpr_write_b32 a111, v213
  v_max3_f32 v212, v56, v57, v58
  v_max3_f32 v212, v212, v59, v60
  v_max3_f32 v212, v212, v61, v62
  v_max3_f32 v212, v212, v63, v64
  v_max3_f32 v212, v212, v65, v66
  v_max3_f32 v212, v212, v67, v68
  v_max3_f32 v212, v212, v69, v70
  v_max_f32 v212, v212, v71
  v_mov_b32 v213, v212
  s_nop 1
  v_permlane32_swap_b32 v212, v213
  v_max_f32 v212, v212, v213
  v_max_f32 v212, 0, v212
  v_sub_f32 v120, v120, v212
  v_sub_f32 v121, v121, v212
  v_sub_f32 v122, v122, v212
  v_sub_f32 v123, v123, v212
  v_sub_f32 v124, v124, v212
  v_sub_f32 v125, v125, v212
  v_sub_f32 v126, v126, v212
  v_sub_f32 v127, v127, v212
  v_sub_f32 v128, v128, v212
  v_sub_f32 v129, v129, v212
  v_sub_f32 v130, v130, v212
  v_sub_f32 v131, v131, v212
  v_sub_f32 v132, v132, v212
  v_sub_f32 v133, v133, v212
  v_sub_f32 v134, v134, v212
  v_sub_f32 v135, v135, v212
  v_sub_f32 v56, v56, v212
  v_sub_f32 v57, v57, v212
  v_sub_f32 v58, v58, v212
  v_sub_f32 v59, v59, v212
  v_sub_f32 v60, v60, v212
  v_sub_f32 v61, v61, v212
  v_sub_f32 v62, v62, v212
  v_sub_f32 v63, v63, v212
  v_sub_f32 v64, v64, v212
  v_sub_f32 v65, v65, v212
  v_sub_f32 v66, v66, v212
  v_sub_f32 v67, v67, v212
  v_sub_f32 v68, v68, v212
  v_sub_f32 v69, v69, v212
  v_sub_f32 v70, v70, v212
  v_sub_f32 v71, v71, v212
  v_sub_f32 v24, v24, v212
  v_sub_f32 v25, v25, v212
  v_sub_f32 v26, v26, v212
  v_sub_f32 v27, v27, v212
  v_sub_f32 v28, v28, v212
  v_sub_f32 v29, v29, v212
  v_sub_f32 v30, v30, v212
  v_sub_f32 v31, v31, v212
  v_sub_f32 v32, v32, v212
  v_sub_f32 v33, v33, v212
  v_sub_f32 v34, v34, v212
  v_sub_f32 v35, v35, v212
  v_sub_f32 v36, v36, v212
  v_sub_f32 v37, v37, v212
  v_sub_f32 v38, v38, v212
  v_sub_f32 v39, v39, v212
  v_sub_f32 v214, 0, v212
  v_exp_f32 v214, v214
  s_nop 0
  v_mul_f32 v209, v209, v214
  v_accvgpr_read_b32 v213, a16
  v_mul_f32 v213, v213, v214
  v_accvgpr_write_b32 a16, v213
  v_accvgpr_read_b32 v213, a17
  v_mul_f32 v213, v213, v214
  v_accvgpr_write_b32 a17, v213
  v_accvgpr_read_b32 v213, a18
  v_mul_f32 v213, v213, v214
  v_accvgpr_write_b32 a18, v213
  v_accvgpr_read_b32 v213, a19
  v_mul_f32 v213, v213, v214
  v_accvgpr_write_b32 a19, v213
  v_accvgpr_read_b32 v213, a20
  v_mul_f32 v213, v213, v214
  v_accvgpr_write_b32 a20, v213
  v_accvgpr_read_b32 v213, a21
  v_mul_f32 v213, v213, v214
  v_accvgpr_write_b32 a21, v213
  v_accvgpr_read_b32 v213, a22
  v_mul_f32 v213, v213, v214
  v_accvgpr_write_b32 a22, v213
  v_accvgpr_read_b32 v213, a23
  v_mul_f32 v213, v213, v214
  v_accvgpr_write_b32 a23, v213
  v_accvgpr_read_b32 v213, a24
  v_mul_f32 v213, v213, v214
  v_accvgpr_write_b32 a24, v213
  v_accvgpr_read_b32 v213, a25
  v_mul_f32 v213, v213, v214
  v_accvgpr_write_b32 a25, v213
  v_accvgpr_read_b32 v213, a26
  v_mul_f32 v213, v213, v214
  v_accvgpr_write_b32 a26, v213
  v_accvgpr_read_b32 v213, a27
  v_mul_f32 v213, v213, v214
  v_accvgpr_write_b32 a27, v213
  v_accvgpr_read_b32 v213, a28
  v_mul_f32 v213, v213, v214
  v_accvgpr_write_b32 a28, v213
  v_accvgpr_read_b32 v213, a29
  v_mul_f32 v213, v213, v214
  v_accvgpr_write_b32 a29, v213
  v_accvgpr_read_b32 v213, a30
  v_mul_f32 v213, v213, v214
  v_accvgpr_write_b32 a30, v213
  v_accvgpr_read_b32 v213, a31
  v_mul_f32 v213, v213, v214
  v_accvgpr_write_b32 a31, v213
  v_accvgpr_read_b32 v213, a48
  v_mul_f32 v213, v213, v214
  v_accvgpr_write_b32 a48, v213
  v_accvgpr_read_b32 v213, a49
  v_mul_f32 v213, v213, v214
  v_accvgpr_write_b32 a49, v213
  v_accvgpr_read_b32 v213, a50
  v_mul_f32 v213, v213, v214
  v_accvgpr_write_b32 a50, v213
  v_accvgpr_read_b32 v213, a51
  v_mul_f32 v213, v213, v214
  v_accvgpr_write_b32 a51, v213
  v_accvgpr_read_b32 v213, a52
  v_mul_f32 v213, v213, v214
  v_accvgpr_write_b32 a52, v213
  v_accvgpr_read_b32 v213, a53
  v_mul_f32 v213, v213, v214
  v_accvgpr_write_b32 a53, v213
  v_accvgpr_read_b32 v213, a54
  v_mul_f32 v213, v213, v214
  v_accvgpr_write_b32 a54, v213
  v_accvgpr_read_b32 v213, a55
  v_mul_f32 v213, v213, v214
  v_accvgpr_write_b32 a55, v213
  v_accvgpr_read_b32 v213, a56
  v_mul_f32 v213, v213, v214
  v_accvgpr_write_b32 a56, v213
  v_accvgpr_read_b32 v213, a57
  v_mul_f32 v213, v213, v214
  v_accvgpr_write_b32 a57, v213
  v_accvgpr_read_b32 v213, a58
  v_mul_f32 v213, v213, v214
  v_accvgpr_write_b32 a58, v213
  v_accvgpr_read_b32 v213, a59
  v_mul_f32 v213, v213, v214
  v_accvgpr_write_b32 a59, v213
  v_accvgpr_read_b32 v213, a60
  v_mul_f32 v213, v213, v214
  v_accvgpr_write_b32 a60, v213
  v_accvgpr_read_b32 v213, a61
  v_mul_f32 v213, v213, v214
  v_accvgpr_write_b32 a61, v213
  v_accvgpr_read_b32 v213, a62
  v_mul_f32 v213, v213, v214
  v_accvgpr_write_b32 a62, v213
  v_accvgpr_read_b32 v213, a63
  v_mul_f32 v213, v213, v214
  v_accvgpr_write_b32 a63, v213
  v_accvgpr_read_b32 v213, a80
  v_mul_f32 v213, v213, v214
  v_accvgpr_write_b32 a80, v213
  v_accvgpr_read_b32 v213, a81
  v_mul_f32 v213, v213, v214
  v_accvgpr_write_b32 a81, v213
  v_accvgpr_read_b32 v213, a82
  v_mul_f32 v213, v213, v214
  v_accvgpr_write_b32 a82, v213
  v_accvgpr_read_b32 v213, a83
  v_mul_f32 v213, v213, v214
  v_accvgpr_write_b32 a83, v213
  v_accvgpr_read_b32 v213, a84
  v_mul_f32 v213, v213, v214
  v_accvgpr_write_b32 a84, v213
  v_accvgpr_read_b32 v213, a85
  v_mul_f32 v213, v213, v214
  v_accvgpr_write_b32 a85, v213
  v_accvgpr_read_b32 v213, a86
  v_mul_f32 v213, v213, v214
  v_accvgpr_write_b32 a86, v213
  v_accvgpr_read_b32 v213, a87
  v_mul_f32 v213, v213, v214
  v_accvgpr_write_b32 a87, v213
  v_accvgpr_read_b32 v213, a88
  v_mul_f32 v213, v213, v214
  v_accvgpr_write_b32 a88, v213
  v_accvgpr_read_b32 v213, a89
  v_mul_f32 v213, v213, v214
  v_accvgpr_write_b32 a89, v213
  v_accvgpr_read_b32 v213, a90
  v_mul_f32 v213, v213, v214
  v_accvgpr_write_b32 a90, v213
  v_accvgpr_read_b32 v213, a91
  v_mul_f32 v213, v213, v214
  v_accvgpr_write_b32 a91, v213
  v_accvgpr_read_b32 v213, a92
  v_mul_f32 v213, v213, v214
  v_accvgpr_write_b32 a92, v213
  v_accvgpr_read_b32 v213, a93
  v_mul_f32 v213, v213, v214
  v_accvgpr_write_b32 a93, v213
  v_accvgpr_read_b32 v213, a94
  v_mul_f32 v213, v213, v214
  v_accvgpr_write_b32 a94, v213
  v_accvgpr_read_b32 v213, a95
  v_mul_f32 v213, v213, v214
  v_accvgpr_write_b32 a95, v213
  v_accvgpr_read_b32 v213, a112
  v_mul_f32 v213, v213, v214
  v_accvgpr_write_b32 a112, v213
  v_accvgpr_read_b32 v213, a113
  v_mul_f32 v213, v213, v214
  v_accvgpr_write_b32 a113, v213
  v_accvgpr_read_b32 v213, a114
  v_mul_f32 v213, v213, v214
  v_accvgpr_write_b32 a114, v213
  v_accvgpr_read_b32 v213, a115
  v_mul_f32 v213, v213, v214
  v_accvgpr_write_b32 a115, v213
  v_accvgpr_read_b32 v213, a116
  v_mul_f32 v213, v213, v214
  v_accvgpr_write_b32 a116, v213
  v_accvgpr_read_b32 v213, a117
  v_mul_f32 v213, v213, v214
  v_accvgpr_write_b32 a117, v213
  v_accvgpr_read_b32 v213, a118
  v_mul_f32 v213, v213, v214
  v_accvgpr_write_b32 a118, v213
  v_accvgpr_read_b32 v213, a119
  v_mul_f32 v213, v213, v214
  v_accvgpr_write_b32 a119, v213
  v_accvgpr_read_b32 v213, a120
  v_mul_f32 v213, v213, v214
  v_accvgpr_write_b32 a120, v213
  v_accvgpr_read_b32 v213, a121
  v_mul_f32 v213, v213, v214
  v_accvgpr_write_b32 a121, v213
  v_accvgpr_read_b32 v213, a122
  v_mul_f32 v213, v213, v214
  v_accvgpr_write_b32 a122, v213
  v_accvgpr_read_b32 v213, a123
  v_mul_f32 v213, v213, v214
  v_accvgpr_write_b32 a123, v213
  v_accvgpr_read_b32 v213, a124
  v_mul_f32 v213, v213, v214
  v_accvgpr_write_b32 a124, v213
  v_accvgpr_read_b32 v213, a125
  v_mul_f32 v213, v213, v214
  v_accvgpr_write_b32 a125, v213
  v_accvgpr_read_b32 v213, a126
  v_mul_f32 v213, v213, v214
  v_accvgpr_write_b32 a126, v213
  v_accvgpr_read_b32 v213, a127
  v_mul_f32 v213, v213, v214
  v_accvgpr_write_b32 a127, v213
  v_exp_f32 v200, v40
  v_exp_f32 v201, v41
  v_add_f32 v210, v208, v200
  v_exp_f32 v202, v42
  v_add_f32 v210, v210, v201
  v_cvt_pk_bf16_f32 v88, v200, v201
  v_exp_f32 v203, v43
  v_add_f32 v210, v210, v202
  v_exp_f32 v204, v44
  v_add_f32 v210, v210, v203
  v_cvt_pk_bf16_f32 v89, v202, v203
  v_exp_f32 v205, v45
  v_add_f32 v210, v210, v204
  v_exp_f32 v206, v46
  v_add_f32 v210, v210, v205
  v_cvt_pk_bf16_f32 v90, v204, v205
  v_exp_f32 v207, v47
  v_add_f32 v210, v210, v206
  v_exp_f32 v200, v48
  v_add_f32 v210, v210, v207
  v_cvt_pk_bf16_f32 v91, v206, v207
  v_exp_f32 v201, v49
  v_add_f32 v210, v210, v200
  v_exp_f32 v202, v50
  v_add_f32 v210, v210, v201
  v_cvt_pk_bf16_f32 v92, v200, v201
  v_exp_f32 v203, v51
  v_add_f32 v210, v210, v202
  v_exp_f32 v204, v52
  v_add_f32 v210, v210, v203
  v_cvt_pk_bf16_f32 v93, v202, v203
  v_exp_f32 v205, v53
  v_add_f32 v210, v210, v204
  v_exp_f32 v206, v54
  v_add_f32 v210, v210, v205
  v_cvt_pk_bf16_f32 v94, v204, v205
  v_exp_f32 v207, v55
  v_add_f32 v210, v210, v206
  v_exp_f32 v200, v56
  v_add_f32 v210, v210, v207
  v_cvt_pk_bf16_f32 v95, v206, v207
  v_exp_f32 v201, v57
  v_add_f32 v211, v209, v200
  v_exp_f32 v202, v58
  v_add_f32 v211, v211, v201
  v_cvt_pk_bf16_f32 v96, v200, v201
  v_exp_f32 v203, v59
  v_add_f32 v211, v211, v202
  v_exp_f32 v204, v60
  v_add_f32 v211, v211, v203
  v_cvt_pk_bf16_f32 v97, v202, v203
  v_exp_f32 v205, v61
  v_add_f32 v211, v211, v204
  v_exp_f32 v206, v62
  v_add_f32 v211, v211, v205
  v_cvt_pk_bf16_f32 v98, v204, v205
  v_exp_f32 v207, v63
  v_add_f32 v211, v211, v206
  v_exp_f32 v200, v64
  v_add_f32 v211, v211, v207
  v_cvt_pk_bf16_f32 v99, v206, v207
  v_exp_f32 v201, v65
  v_add_f32 v211, v211, v200
  v_exp_f32 v202, v66
  v_add_f32 v211, v211, v201
  v_cvt_pk_bf16_f32 v100, v200, v201
  v_exp_f32 v203, v67
  v_add_f32 v211, v211, v202
  v_exp_f32 v204, v68
  v_add_f32 v211, v211, v203
  v_cvt_pk_bf16_f32 v101, v202, v203
  v_exp_f32 v205, v69
  v_add_f32 v211, v211, v204
  v_exp_f32 v206, v70
  v_add_f32 v211, v211, v205
  v_cvt_pk_bf16_f32 v102, v204, v205
  v_exp_f32 v207, v71
  v_add_f32 v211, v211, v206
  v_add_f32 v211, v211, v207
  v_cvt_pk_bf16_f32 v103, v206, v207
  s_branch k2_ret13
k2_fb14:
  v_max3_f32 v212, v8, v9, v10
  v_max3_f32 v212, v212, v11, v12
  v_max3_f32 v212, v212, v13, v14
  v_max3_f32 v212, v212, v15, v16
  v_max3_f32 v212, v212, v17, v18
  v_max3_f32 v212, v212, v19, v20
  v_max3_f32 v212, v212, v21, v22
  v_max_f32 v212, v212, v23
  v_mov_b32 v213, v212
  s_nop 1
  v_permlane32_swap_b32 v212, v213
  v_max_f32 v212, v212, v213
  v_max_f32 v212, 0, v212
  v_sub_f32 v104, v104, v212
  v_sub_f32 v105, v105, v212
  v_sub_f32 v106, v106, v212
  v_sub_f32 v107, v107, v212
  v_sub_f32 v108, v108, v212
  v_sub_f32 v109, v109, v212
  v_sub_f32 v110, v110, v212
  v_sub_f32 v111, v111, v212
  v_sub_f32 v112, v112, v212
  v_sub_f32 v113, v113, v212
  v_sub_f32 v114, v114, v212
  v_sub_f32 v115, v115, v212
  v_sub_f32 v116, v116, v212
  v_sub_f32 v117, v117, v212
  v_sub_f32 v118, v118, v212
  v_sub_f32 v119, v119, v212
  v_sub_f32 v8, v8, v212
  v_sub_f32 v9, v9, v212
  v_sub_f32 v10, v10, v212
  v_sub_f32 v11, v11, v212
  v_sub_f32 v12, v12, v212
  v_sub_f32 v13, v13, v212
  v_sub_f32 v14, v14, v212
  v_sub_f32 v15, v15, v212
  v_sub_f32 v16, v16, v212
  v_sub_f32 v17, v17, v212
  v_sub_f32 v18, v18, v212
  v_sub_f32 v19, v19, v212
  v_sub_f32 v20, v20, v212
  v_sub_f32 v21, v21, v212
  v_sub_f32 v22, v22, v212
  v_sub_f32 v23, v23, v212
  v_sub_f32 v40, v40, v212
  v_sub_f32 v41, v41, v212
  v_sub_f32 v42, v42, v212
  v_sub_f32 v43, v43, v212
  v_sub_f32 v44, v44, v212
  v_sub_f32 v45, v45, v212
  v_sub_f32 v46, v46, v212
  v_sub_f32 v47, v47, v212
  v_sub_f32 v48, v48, v212
  v_sub_f32 v49, v49, v212
  v_sub_f32 v50, v50, v212
  v_sub_f32 v51, v51, v212
  v_sub_f32 v52, v52, v212
  v_sub_f32 v53, v53, v212
  v_sub_f32 v54, v54, v212
  v_sub_f32 v55, v55, v212
  v_sub_f32 v214, 0, v212
  v_exp_f32 v214, v214
  s_nop 0
  v_mul_f32 v210, v210, v214
  v_accvgpr_read_b32 v213, a0
  v_mul_f32 v213, v213, v214
  v_accvgpr_write_b32 a0, v213
  v_accvgpr_read_b32 v213, a1
  v_mul_f32 v213, v213, v214
  v_accvgpr_write_b32 a1, v213
  v_accvgpr_read_b32 v213, a2
  v_mul_f32 v213, v213, v214
  v_accvgpr_write_b32 a2, v213
  v_accvgpr_read_b32 v213, a3
  v_mul_f32 v213, v213, v214
  v_accvgpr_write_b32 a3, v213
  v_accvgpr_read_b32 v213, a4
  v_mul_f32 v213, v213, v214
  v_accvgpr_write_b32 a4, v213
  v_accvgpr_read_b32 v213, a5
  v_mul_f32 v213, v213, v214
  v_accvgpr_write_b32 a5, v213
  v_accvgpr_read_b32 v213, a6
  v_mul_f32 v213, v213, v214
  v_accvgpr_write_b32 a6, v213
  v_accvgpr_read_b32 v213, a7
  v_mul_f32 v213, v213, v214
  v_accvgpr_write_b32 a7, v213
  v_accvgpr_read_b32 v213, a8
  v_mul_f32 v213, v213, v214
  v_accvgpr_write_b32 a8, v213
  v_accvgpr_read_b32 v213, a9
  v_mul_f32 v213, v213, v214
  v_accvgpr_write_b32 a9, v213
  v_accvgpr_read_b32 v213, a10
  v_mul_f32 v213, v213, v214
  v_accvgpr_write_b32 a10, v213
  v_accvgpr_read_b32 v213, a11
  v_mul_f32 v213, v213, v214
  v_accvgpr_write_b32 a11, v213
  v_accvgpr_read_b32 v213, a12
  v_mul_f32 v213, v213, v214
  v_accvgpr_write_b32 a12, v213
  v_accvgpr_read_b32 v213, a13
  v_mul_f32 v213, v213, v214
  v_accvgpr_write_b32 a13, v213
  v_accvgpr_read_b32 v213, a14
  v_mul_f32 v213, v213, v214
  v_accvgpr_write_b32 a14, v213
  v_accvgpr_read_b32 v213, a15
  v_mul_f32 v213, v213, v214
  v_accvgpr_write_b32 a15, v213
  v_accvgpr_read_b32 v213, a32
  v_mul_f32 v213, v213, v214
  v_accvgpr_write_b32 a32, v213
  v_accvgpr_read_b32 v213, a33
  v_mul_f32 v213, v213, v214
  v_accvgpr_write_b32 a33, v213
  v_accvgpr_read_b32 v213, a34
  v_mul_f32 v213, v213, v214
  v_accvgpr_write_b32 a34, v213
  v_accvgpr_read_b32 v213, a35
  v_mul_f32 v213, v213, v214
  v_accvgpr_write_b32 a35, v213
  v_accvgpr_read_b32 v213, a36
  v_mul_f32 v213, v213, v214
  v_accvgpr_write_b32 a36, v213
  v_accvgpr_read_b32 v213, a37
  v_mul_f32 v213, v213, v214
  v_accvgpr_write_b32 a37, v213
  v_accvgpr_read_b32 v213, a38
  v_mul_f32 v213, v213, v214
  v_accvgpr_write_b32 a38, v213
  v_accvgpr_read_b32 v213, a39
  v_mul_f32 v213, v213, v214
  v_accvgpr_write_b32 a39, v213
  v_accvgpr_read_b32 v213, a40
  v_mul_f32 v213, v213, v214
  v_accvgpr_write_b32 a40, v213
  v_accvgpr_read_b32 v213, a41
  v_mul_f32 v213, v213, v214
  v_accvgpr_write_b32 a41, v213
  v_accvgpr_read_b32 v213, a42
  v_mul_f32 v213, v213, v214
  v_accvgpr_write_b32 a42, v213
  v_accvgpr_read_b32 v213, a43
  v_mul_f32 v213, v213, v214
  v_accvgpr_write_b32 a43, v213
  v_accvgpr_read_b32 v213, a44
  v_mul_f32 v213, v213, v214
  v_accvgpr_write_b32 a44, v213
  v_accvgpr_read_b32 v213, a45
  v_mul_f32 v213, v213, v214
  v_accvgpr_write_b32 a45, v213
  v_accvgpr_read_b32 v213, a46
  v_mul_f32 v213, v213, v214
  v_accvgpr_write_b32 a46, v213
  v_accvgpr_read_b32 v213, a47
  v_mul_f32 v213, v213, v214
  v_accvgpr_write_b32 a47, v213
  v_accvgpr_read_b32 v213, a64
  v_mul_f32 v213, v213, v214
  v_accvgpr_write_b32 a64, v213
  v_accvgpr_read_b32 v213, a65
  v_mul_f32 v213, v213, v214
  v_accvgpr_write_b32 a65, v213
  v_accvgpr_read_b32 v213, a66
  v_mul_f32 v213, v213, v214
  v_accvgpr_write_b32 a66, v213
  v_accvgpr_read_b32 v213, a67
  v_mul_f32 v213, v213, v214
  v_accvgpr_write_b32 a67, v213
  v_accvgpr_read_b32 v213, a68
  v_mul_f32 v213, v213, v214
  v_accvgpr_write_b32 a68, v213
  v_accvgpr_read_b32 v213, a69
  v_mul_f32 v213, v213, v214
  v_accvgpr_write_b32 a69, v213
  v_accvgpr_read_b32 v213, a70
  v_mul_f32 v213, v213, v214
  v_accvgpr_write_b32 a70, v213
  v_accvgpr_read_b32 v213, a71
  v_mul_f32 v213, v213, v214
  v_accvgpr_write_b32 a71, v213
  v_accvgpr_read_b32 v213, a72
  v_mul_f32 v213, v213, v214
  v_accvgpr_write_b32 a72, v213
  v_accvgpr_read_b32 v213, a73
  v_mul_f32 v213, v213, v214
  v_accvgpr_write_b32 a73, v213
  v_accvgpr_read_b32 v213, a74
  v_mul_f32 v213, v213, v214
  v_accvgpr_write_b32 a74, v213
  v_accvgpr_read_b32 v213, a75
  v_mul_f32 v213, v213, v214
  v_accvgpr_write_b32 a75, v213
  v_accvgpr_read_b32 v213, a76
  v_mul_f32 v213, v213, v214
  v_accvgpr_write_b32 a76, v213
  v_accvgpr_read_b32 v213, a77
  v_mul_f32 v213, v213, v214
  v_accvgpr_write_b32 a77, v213
  v_accvgpr_read_b32 v213, a78
  v_mul_f32 v213, v213, v214
  v_accvgpr_write_b32 a78, v213
  v_accvgpr_read_b32 v213, a79
  v_mul_f32 v213, v213, v214
  v_accvgpr_write_b32 a79, v213
  v_accvgpr_read_b32 v213, a96
  v_mul_f32 v213, v213, v214
  v_accvgpr_write_b32 a96, v213
  v_accvgpr_read_b32 v213, a97
  v_mul_f32 v213, v213, v214
  v_accvgpr_write_b32 a97, v213
  v_accvgpr_read_b32 v213, a98
  v_mul_f32 v213, v213, v214
  v_accvgpr_write_b32 a98, v213
  v_accvgpr_read_b32 v213, a99
  v_mul_f32 v213, v213, v214
  v_accvgpr_write_b32 a99, v213
  v_accvgpr_read_b32 v213, a100
  v_mul_f32 v213, v213, v214
  v_accvgpr_write_b32 a100, v213
  v_accvgpr_read_b32 v213, a101
  v_mul_f32 v213, v213, v214
  v_accvgpr_write_b32 a101, v213
  v_accvgpr_read_b32 v213, a102
  v_mul_f32 v213, v213, v214
  v_accvgpr_write_b32 a102, v213
  v_accvgpr_read_b32 v213, a103
  v_mul_f32 v213, v213, v214
  v_accvgpr_write_b32 a103, v213
  v_accvgpr_read_b32 v213, a104
  v_mul_f32 v213, v213, v214
  v_accvgpr_write_b32 a104, v213
  v_accvgpr_read_b32 v213, a105
  v_mul_f32 v213, v213, v214
  v_accvgpr_write_b32 a105, v213
  v_accvgpr_read_b32 v213, a106
  v_mul_f32 v213, v213, v214
  v_accvgpr_write_b32 a106, v213
  v_accvgpr_read_b32 v213, a107
  v_mul_f32 v213, v213, v214
  v_accvgpr_write_b32 a107, v213
  v_accvgpr_read_b32 v213, a108
  v_mul_f32 v213, v213, v214
  v_accvgpr_write_b32 a108, v213
  v_accvgpr_read_b32 v213, a109
  v_mul_f32 v213, v213, v214
  v_accvgpr_write_b32 a109, v213
  v_accvgpr_read_b32 v213, a110
  v_mul_f32 v213, v213, v214
  v_accvgpr_write_b32 a110, v213
  v_accvgpr_read_b32 v213, a111
  v_mul_f32 v213, v213, v214
  v_accvgpr_write_b32 a111, v213
  v_max3_f32 v212, v24, v25, v26
  v_max3_f32 v212, v212, v27, v28
  v_max3_f32 v212, v212, v29, v30
  v_max3_f32 v212, v212, v31, v32
  v_max3_f32 v212, v212, v33, v34
  v_max3_f32 v212, v212, v35, v36
  v_max3_f32 v212, v212, v37, v38
  v_max_f32 v212, v212, v39
  v_mov_b32 v213, v212
  s_nop 1
  v_permlane32_swap_b32 v212, v213
  v_max_f32 v212, v212, v213
  v_max_f32 v212, 0, v212
  v_sub_f32 v120, v120, v212
  v_sub_f32 v121, v121, v212
  v_sub_f32 v122, v122, v212
  v_sub_f32 v123, v123, v212
  v_sub_f32 v124, v124, v212
  v_sub_f32 v125, v125, v212
  v_sub_f32 v126, v126, v212
  v_sub_f32 v127, v127, v212
  v_sub_f32 v128, v128, v212
  v_sub_f32 v129, v129, v212
  v_sub_f32 v130, v130, v212
  v_sub_f32 v131, v131, v212
  v_sub_f32 v132, v132, v212
  v_sub_f32 v133, v133, v212
  v_sub_f32 v134, v134, v212
  v_sub_f32 v135, v135, v212
  v_sub_f32 v24, v24, v212
  v_sub_f32 v25, v25, v212
  v_sub_f32 v26, v26, v212
  v_sub_f32 v27, v27, v212
  v_sub_f32 v28, v28, v212
  v_sub_f32 v29, v29, v212
  v_sub_f32 v30, v30, v212
  v_sub_f32 v31, v31, v212
  v_sub_f32 v32, v32, v212
  v_sub_f32 v33, v33, v212
  v_sub_f32 v34, v34, v212
  v_sub_f32 v35, v35, v212
  v_sub_f32 v36, v36, v212
  v_sub_f32 v37, v37, v212
  v_sub_f32 v38, v38, v212
  v_sub_f32 v39, v39, v212
  v_sub_f32 v56, v56, v212
  v_sub_f32 v57, v57, v212
  v_sub_f32 v58, v58, v212
  v_sub_f32 v59, v59, v212
  v_sub_f32 v60, v60, v212
  v_sub_f32 v61, v61, v212
  v_sub_f32 v62, v62, v212
  v_sub_f32 v63, v63, v212
  v_sub_f32 v64, v64, v212
  v_sub_f32 v65, v65, v212
  v_sub_f32 v66, v66, v212
  v_sub_f32 v67, v67, v212
  v_sub_f32 v68, v68, v212
  v_sub_f32 v69, v69, v212
  v_sub_f32 v70, v70, v212
  v_sub_f32 v71, v71, v212
  v_sub_f32 v214, 0, v212
  v_exp_f32 v214, v214
  s_nop 0
  v_mul_f32 v211, v211, v214
  v_accvgpr_read_b32 v213, a16
  v_mul_f32 v213, v213, v214
  v_accvgpr_write_b32 a16, v213
  v_accvgpr_read_b32 v213, a17
  v_mul_f32 v213, v213, v214
  v_accvgpr_write_b32 a17, v213
  v_accvgpr_read_b32 v213, a18
  v_mul_f32 v213, v213, v214
  v_accvgpr_write_b32 a18, v213
  v_accvgpr_read_b32 v213, a19
  v_mul_f32 v213, v213, v214
  v_accvgpr_write_b32 a19, v213
  v_accvgpr_read_b32 v213, a20
  v_mul_f32 v213, v213, v214
  v_accvgpr_write_b32 a20, v213
  v_accvgpr_read_b32 v213, a21
  v_mul_f32 v213, v213, v214
  v_accvgpr_write_b32 a21, v213
  v_accvgpr_read_b32 v213, a22
  v_mul_f32 v213, v213, v214
  v_accvgpr_write_b32 a22, v213
  v_accvgpr_read_b32 v213, a23
  v_mul_f32 v213, v213, v214
  v_accvgpr_write_b32 a23, v213
  v_accvgpr_read_b32 v213, a24
  v_mul_f32 v213, v213, v214
  v_accvgpr_write_b32 a24, v213
  v_accvgpr_read_b32 v213, a25
  v_mul_f32 v213, v213, v214
  v_accvgpr_write_b32 a25, v213
  v_accvgpr_read_b32 v213, a26
  v_mul_f32 v213, v213, v214
  v_accvgpr_write_b32 a26, v213
  v_accvgpr_read_b32 v213, a27
  v_mul_f32 v213, v213, v214
  v_accvgpr_write_b32 a27, v213
  v_accvgpr_read_b32 v213, a28
  v_mul_f32 v213, v213, v214
  v_accvgpr_write_b32 a28, v213
  v_accvgpr_read_b32 v213, a29
  v_mul_f32 v213, v213, v214
  v_accvgpr_write_b32 a29, v213
  v_accvgpr_read_b32 v213, a30
  v_mul_f32 v213, v213, v214
  v_accvgpr_write_b32 a30, v213
  v_accvgpr_read_b32 v213, a31
  v_mul_f32 v213, v213, v214
  v_accvgpr_write_b32 a31, v213
  v_accvgpr_read_b32 v213, a48
  v_mul_f32 v213, v213, v214
  v_accvgpr_write_b32 a48, v213
  v_accvgpr_read_b32 v213, a49
  v_mul_f32 v213, v213, v214
  v_accvgpr_write_b32 a49, v213
  v_accvgpr_read_b32 v213, a50
  v_mul_f32 v213, v213, v214
  v_accvgpr_write_b32 a50, v213
  v_accvgpr_read_b32 v213, a51
  v_mul_f32 v213, v213, v214
  v_accvgpr_write_b32 a51, v213
  v_accvgpr_read_b32 v213, a52
  v_mul_f32 v213, v213, v214
  v_accvgpr_write_b32 a52, v213
  v_accvgpr_read_b32 v213, a53
  v_mul_f32 v213, v213, v214
  v_accvgpr_write_b32 a53, v213
  v_accvgpr_read_b32 v213, a54
  v_mul_f32 v213, v213, v214
  v_accvgpr_write_b32 a54, v213
  v_accvgpr_read_b32 v213, a55
  v_mul_f32 v213, v213, v214
  v_accvgpr_write_b32 a55, v213
  v_accvgpr_read_b32 v213, a56
  v_mul_f32 v213, v213, v214
  v_accvgpr_write_b32 a56, v213
  v_accvgpr_read_b32 v213, a57
  v_mul_f32 v213, v213, v214
  v_accvgpr_write_b32 a57, v213
  v_accvgpr_read_b32 v213, a58
  v_mul_f32 v213, v213, v214
  v_accvgpr_write_b32 a58, v213
  v_accvgpr_read_b32 v213, a59
  v_mul_f32 v213, v213, v214
  v_accvgpr_write_b32 a59, v213
  v_accvgpr_read_b32 v213, a60
  v_mul_f32 v213, v213, v214
  v_accvgpr_write_b32 a60, v213
  v_accvgpr_read_b32 v213, a61
  v_mul_f32 v213, v213, v214
  v_accvgpr_write_b32 a61, v213
  v_accvgpr_read_b32 v213, a62
  v_mul_f32 v213, v213, v214
  v_accvgpr_write_b32 a62, v213
  v_accvgpr_read_b32 v213, a63
  v_mul_f32 v213, v213, v214
  v_accvgpr_write_b32 a63, v213
  v_accvgpr_read_b32 v213, a80
  v_mul_f32 v213, v213, v214
  v_accvgpr_write_b32 a80, v213
  v_accvgpr_read_b32 v213, a81
  v_mul_f32 v213, v213, v214
  v_accvgpr_write_b32 a81, v213
  v_accvgpr_read_b32 v213, a82
  v_mul_f32 v213, v213, v214
  v_accvgpr_write_b32 a82, v213
  v_accvgpr_read_b32 v213, a83
  v_mul_f32 v213, v213, v214
  v_accvgpr_write_b32 a83, v213
  v_accvgpr_read_b32 v213, a84
  v_mul_f32 v213, v213, v214
  v_accvgpr_write_b32 a84, v213
  v_accvgpr_read_b32 v213, a85
  v_mul_f32 v213, v213, v214
  v_accvgpr_write_b32 a85, v213
  v_accvgpr_read_b32 v213, a86
  v_mul_f32 v213, v213, v214
  v_accvgpr_write_b32 a86, v213
  v_accvgpr_read_b32 v213, a87
  v_mul_f32 v213, v213, v214
  v_accvgpr_write_b32 a87, v213
  v_accvgpr_read_b32 v213, a88
  v_mul_f32 v213, v213, v214
  v_accvgpr_write_b32 a88, v213
  v_accvgpr_read_b32 v213, a89
  v_mul_f32 v213, v213, v214
  v_accvgpr_write_b32 a89, v213
  v_accvgpr_read_b32 v213, a90
  v_mul_f32 v213, v213, v214
  v_accvgpr_write_b32 a90, v213
  v_accvgpr_read_b32 v213, a91
  v_mul_f32 v213, v213, v214
  v_accvgpr_write_b32 a91, v213
  v_accvgpr_read_b32 v213, a92
  v_mul_f32 v213, v213, v214
  v_accvgpr_write_b32 a92, v213
  v_accvgpr_read_b32 v213, a93
  v_mul_f32 v213, v213, v214
  v_accvgpr_write_b32 a93, v213
  v_accvgpr_read_b32 v213, a94
  v_mul_f32 v213, v213, v214
  v_accvgpr_write_b32 a94, v213
  v_accvgpr_read_b32 v213, a95
  v_mul_f32 v213, v213, v214
  v_accvgpr_write_b32 a95, v213
  v_accvgpr_read_b32 v213, a112
  v_mul_f32 v213, v213, v214
  v_accvgpr_write_b32 a112, v213
  v_accvgpr_read_b32 v213, a113
  v_mul_f32 v213, v213, v214
  v_accvgpr_write_b32 a113, v213
  v_accvgpr_read_b32 v213, a114
  v_mul_f32 v213, v213, v214
  v_accvgpr_write_b32 a114, v213
  v_accvgpr_read_b32 v213, a115
  v_mul_f32 v213, v213, v214
  v_accvgpr_write_b32 a115, v213
  v_accvgpr_read_b32 v213, a116
  v_mul_f32 v213, v213, v214
  v_accvgpr_write_b32 a116, v213
  v_accvgpr_read_b32 v213, a117
  v_mul_f32 v213, v213, v214
  v_accvgpr_write_b32 a117, v213
  v_accvgpr_read_b32 v213, a118
  v_mul_f32 v213, v213, v214
  v_accvgpr_write_b32 a118, v213
  v_accvgpr_read_b32 v213, a119
  v_mul_f32 v213, v213, v214
  v_accvgpr_write_b32 a119, v213
  v_accvgpr_read_b32 v213, a120
  v_mul_f32 v213, v213, v214
  v_accvgpr_write_b32 a120, v213
  v_accvgpr_read_b32 v213, a121
  v_mul_f32 v213, v213, v214
  v_accvgpr_write_b32 a121, v213
  v_accvgpr_read_b32 v213, a122
  v_mul_f32 v213, v213, v214
  v_accvgpr_write_b32 a122, v213
  v_accvgpr_read_b32 v213, a123
  v_mul_f32 v213, v213, v214
  v_accvgpr_write_b32 a123, v213
  v_accvgpr_read_b32 v213, a124
  v_mul_f32 v213, v213, v214
  v_accvgpr_write_b32 a124, v213
  v_accvgpr_read_b32 v213, a125
  v_mul_f32 v213, v213, v214
  v_accvgpr_write_b32 a125, v213
  v_accvgpr_read_b32 v213, a126
  v_mul_f32 v213, v213, v214
  v_accvgpr_write_b32 a126, v213
  v_accvgpr_read_b32 v213, a127
  v_mul_f32 v213, v213, v214
  v_accvgpr_write_b32 a127, v213
  v_exp_f32 v200, v8
  v_exp_f32 v201, v9
  v_add_f32 v208, v210, v200
  v_exp_f32 v202, v10
  v_add_f32 v208, v208, v201
  v_cvt_pk_bf16_f32 v72, v200, v201
  v_exp_f32 v203, v11
  v_add_f32 v208, v208, v202
  v_exp_f32 v204, v12
  v_add_f32 v208, v208, v203
  v_cvt_pk_bf16_f32 v73, v202, v203
  v_exp_f32 v205, v13
  v_add_f32 v208, v208, v204
  v_exp_f32 v206, v14
  v_add_f32 v208, v208, v205
  v_cvt_pk_bf16_f32 v74, v204, v205
  v_exp_f32 v207, v15
  v_add_f32 v208, v208, v206
  v_exp_f32 v200, v16
  v_add_f32 v208, v208, v207
  v_cvt_pk_bf16_f32 v75, v206, v207
  v_exp_f32 v201, v17
  v_add_f32 v208, v208, v200
  v_exp_f32 v202, v18
  v_add_f32 v208, v208, v201
  v_cvt_pk_bf16_f32 v76, v200, v201
  v_exp_f32 v203, v19
  v_add_f32 v208, v208, v202
  v_exp_f32 v204, v20
  v_add_f32 v208, v208, v203
  v_cvt_pk_bf16_f32 v77, v202, v203
  v_exp_f32 v205, v21
  v_add_f32 v208, v208, v204
  v_exp_f32 v206, v22
  v_add_f32 v208, v208, v205
  v_cvt_pk_bf16_f32 v78, v204, v205
  v_exp_f32 v207, v23
  v_add_f32 v208, v208, v206
  v_exp_f32 v200, v24
  v_add_f32 v208, v208, v207
  v_cvt_pk_bf16_f32 v79, v206, v207
  v_exp_f32 v201, v25
  v_add_f32 v209, v211, v200
  v_exp_f32 v202, v26
  v_add_f32 v209, v209, v201
  v_cvt_pk_bf16_f32 v80, v200, v201
  v_exp_f32 v203, v27
  v_add_f32 v209, v209, v202
  v_exp_f32 v204, v28
  v_add_f32 v209, v209, v203
  v_cvt_pk_bf16_f32 v81, v202, v203
  v_exp_f32 v205, v29
  v_add_f32 v209, v209, v204
  v_exp_f32 v206, v30
  v_add_f32 v209, v209, v205
  v_cvt_pk_bf16_f32 v82, v204, v205
  v_exp_f32 v207, v31
  v_add_f32 v209, v209, v206
  v_exp_f32 v200, v32
  v_add_f32 v209, v209, v207
  v_cvt_pk_bf16_f32 v83, v206, v207
  v_exp_f32 v201, v33
  v_add_f32 v209, v209, v200
  v_exp_f32 v202, v34
  v_add_f32 v209, v209, v201
  v_cvt_pk_bf16_f32 v84, v200, v201
  v_exp_f32 v203, v35
  v_add_f32 v209, v209, v202
  v_exp_f32 v204, v36
  v_add_f32 v209, v209, v203
  v_cvt_pk_bf16_f32 v85, v202, v203
  v_exp_f32 v205, v37
  v_add_f32 v209, v209, v204
  v_exp_f32 v206, v38
  v_add_f32 v209, v209, v205
  v_cvt_pk_bf16_f32 v86, v204, v205
  v_exp_f32 v207, v39
  v_add_f32 v209, v209, v206
  v_add_f32 v209, v209, v207
  v_cvt_pk_bf16_f32 v87, v206, v207
  s_branch k2_ret15
k2_fb16:
  v_max3_f32 v212, v40, v41, v42
  v_max3_f32 v212, v212, v43, v44
  v_max3_f32 v212, v212, v45, v46
  v_max3_f32 v212, v212, v47, v48
  v_max3_f32 v212, v212, v49, v50
  v_max3_f32 v212, v212, v51, v52
  v_max3_f32 v212, v212, v53, v54
  v_max_f32 v212, v212, v55
  v_mov_b32 v213, v212
  s_nop 1
  v_permlane32_swap_b32 v212, v213
  v_max_f32 v212, v212, v213
  v_max_f32 v212, 0, v212
  v_sub_f32 v104, v104, v212
  v_sub_f32 v105, v105, v212
  v_sub_f32 v106, v106, v212
  v_sub_f32 v107, v107, v212
  v_sub_f32 v108, v108, v212
  v_sub_f32 v109, v109, v212
  v_sub_f32 v110, v110, v212
  v_sub_f32 v111, v111, v212
  v_sub_f32 v112, v112, v212
  v_sub_f32 v113, v113, v212
  v_sub_f32 v114, v114, v212
  v_sub_f32 v115, v115, v212
  v_sub_f32 v116, v116, v212
  v_sub_f32 v117, v117, v212
  v_sub_f32 v118, v118, v212
  v_sub_f32 v119, v119, v212
  v_sub_f32 v40, v40, v212
  v_sub_f32 v41, v41, v212
  v_sub_f32 v42, v42, v212
  v_sub_f32 v43, v43, v212
  v_sub_f32 v44, v44, v212
  v_sub_f32 v45, v45, v212
  v_sub_f32 v46, v46, v212
  v_sub_f32 v47, v47, v212
  v_sub_f32 v48, v48, v212
  v_sub_f32 v49, v49, v212
  v_sub_f32 v50, v50, v212
  v_sub_f32 v51, v51, v212
  v_sub_f32 v52, v52, v212
  v_sub_f32 v53, v53, v212
  v_sub_f32 v54, v54, v212
  v_sub_f32 v55, v55, v212
  v_sub_f32 v8, v8, v212
  v_sub_f32 v9, v9, v212
  v_sub_f32 v10, v10, v212
  v_sub_f32 v11, v11, v212
  v_sub_f32 v12, v12, v212
  v_sub_f32 v13, v13, v212
  v_sub_f32 v14, v14, v212
  v_sub_f32 v15, v15, v212
  v_sub_f32 v16, v16, v212
  v_sub_f32 v17, v17, v212
  v_sub_f32 v18, v18, v212
  v_sub_f32 v19, v19, v212
  v_sub_f32 v20, v20, v212
  v_sub_f32 v21, v21, v212
  v_sub_f32 v22, v22, v212
  v_sub_f32 v23, v23, v212
  v_sub_f32 v214, 0, v212
  v_exp_f32 v214, v214
  s_nop 0
  v_mul_f32 v208, v208, v214
  v_accvgpr_read_b32 v213, a0
  v_mul_f32 v213, v213, v214
  v_accvgpr_write_b32 a0, v213
  v_accvgpr_read_b32 v213, a1
  v_mul_f32 v213, v213, v214
  v_accvgpr_write_b32 a1, v213
  v_accvgpr_read_b32 v213, a2
  v_mul_f32 v213, v213, v214
  v_accvgpr_write_b32 a2, v213
  v_accvgpr_read_b32 v213, a3
  v_mul_f32 v213, v213, v214
  v_accvgpr_write_b32 a3, v213
  v_accvgpr_read_b32 v213, a4
  v_mul_f32 v213, v213, v214
  v_accvgpr_write_b32 a4, v213
  v_accvgpr_read_b32 v213, a5
  v_mul_f32 v213, v213, v214
  v_accvgpr_write_b32 a5, v213
  v_accvgpr_read_b32 v213, a6
  v_mul_f32 v213, v213, v214
  v_accvgpr_write_b32 a6, v213
  v_accvgpr_read_b32 v213, a7
  v_mul_f32 v213, v213, v214
  v_accvgpr_write_b32 a7, v213
  v_accvgpr_read_b32 v213, a8
  v_mul_f32 v213, v213, v214
  v_accvgpr_write_b32 a8, v213
  v_accvgpr_read_b32 v213, a9
  v_mul_f32 v213, v213, v214
  v_accvgpr_write_b32 a9, v213
  v_accvgpr_read_b32 v213, a10
  v_mul_f32 v213, v213, v214
  v_accvgpr_write_b32 a10, v213
  v_accvgpr_read_b32 v213, a11
  v_mul_f32 v213, v213, v214
  v_accvgpr_write_b32 a11, v213
  v_accvgpr_read_b32 v213, a12
  v_mul_f32 v213, v213, v214
  v_accvgpr_write_b32 a12, v213
  v_accvgpr_read_b32 v213, a13
  v_mul_f32 v213, v213, v214
  v_accvgpr_write_b32 a13, v213
  v_accvgpr_read_b32 v213, a14
  v_mul_f32 v213, v213, v214
  v_accvgpr_write_b32 a14, v213
  v_accvgpr_read_b32 v213, a15
  v_mul_f32 v213, v213, v214
  v_accvgpr_write_b32 a15, v213
  v_accvgpr_read_b32 v213, a32
  v_mul_f32 v213, v213, v214
  v_accvgpr_write_b32 a32, v213
  v_accvgpr_read_b32 v213, a33
  v_mul_f32 v213, v213, v214
  v_accvgpr_write_b32 a33, v213
  v_accvgpr_read_b32 v213, a34
  v_mul_f32 v213, v213, v214
  v_accvgpr_write_b32 a34, v213
  v_accvgpr_read_b32 v213, a35
  v_mul_f32 v213, v213, v214
  v_accvgpr_write_b32 a35, v213
  v_accvgpr_read_b32 v213, a36
  v_mul_f32 v213, v213, v214
  v_accvgpr_write_b32 a36, v213
  v_accvgpr_read_b32 v213, a37
  v_mul_f32 v213, v213, v214
  v_accvgpr_write_b32 a37, v213
  v_accvgpr_read_b32 v213, a38
  v_mul_f32 v213, v213, v214
  v_accvgpr_write_b32 a38, v213
  v_accvgpr_read_b32 v213, a39
  v_mul_f32 v213, v213, v214
  v_accvgpr_write_b32 a39, v213
  v_accvgpr_read_b32 v213, a40
  v_mul_f32 v213, v213, v214
  v_accvgpr_write_b32 a40, v213
  v_accvgpr_read_b32 v213, a41
  v_mul_f32 v213, v213, v214
  v_accvgpr_write_b32 a41, v213
  v_accvgpr_read_b32 v213, a42
  v_mul_f32 v213, v213, v214
  v_accvgpr_write_b32 a42, v213
  v_accvgpr_read_b32 v213, a43
  v_mul_f32 v213, v213, v214
  v_accvgpr_write_b32 a43, v213
  v_accvgpr_read_b32 v213, a44
  v_mul_f32 v213, v213, v214
  v_accvgpr_write_b32 a44, v213
  v_accvgpr_read_b32 v213, a45
  v_mul_f32 v213, v213, v214
  v_accvgpr_write_b32 a45, v213
  v_accvgpr_read_b32 v213, a46
  v_mul_f32 v213, v213, v214
  v_accvgpr_write_b32 a46, v213
  v_accvgpr_read_b32 v213, a47
  v_mul_f32 v213, v213, v214
  v_accvgpr_write_b32 a47, v213
  v_accvgpr_read_b32 v213, a64
  v_mul_f32 v213, v213, v214
  v_accvgpr_write_b32 a64, v213
  v_accvgpr_read_b32 v213, a65
  v_mul_f32 v213, v213, v214
  v_accvgpr_write_b32 a65, v213
  v_accvgpr_read_b32 v213, a66
  v_mul_f32 v213, v213, v214
  v_accvgpr_write_b32 a66, v213
  v_accvgpr_read_b32 v213, a67
  v_mul_f32 v213, v213, v214
  v_accvgpr_write_b32 a67, v213
  v_accvgpr_read_b32 v213, a68
  v_mul_f32 v213, v213, v214
  v_accvgpr_write_b32 a68, v213
  v_accvgpr_read_b32 v213, a69
  v_mul_f32 v213, v213, v214
  v_accvgpr_write_b32 a69, v213
  v_accvgpr_read_b32 v213, a70
  v_mul_f32 v213, v213, v214
  v_accvgpr_write_b32 a70, v213
  v_accvgpr_read_b32 v213, a71
  v_mul_f32 v213, v213, v214
  v_accvgpr_write_b32 a71, v213
  v_accvgpr_read_b32 v213, a72
  v_mul_f32 v213, v213, v214
  v_accvgpr_write_b32 a72, v213
  v_accvgpr_read_b32 v213, a73
  v_mul_f32 v213, v213, v214
  v_accvgpr_write_b32 a73, v213
  v_accvgpr_read_b32 v213, a74
  v_mul_f32 v213, v213, v214
  v_accvgpr_write_b32 a74, v213
  v_accvgpr_read_b32 v213, a75
  v_mul_f32 v213, v213, v214
  v_accvgpr_write_b32 a75, v213
  v_accvgpr_read_b32 v213, a76
  v_mul_f32 v213, v213, v214
  v_accvgpr_write_b32 a76, v213
  v_accvgpr_read_b32 v213, a77
  v_mul_f32 v213, v213, v214
  v_accvgpr_write_b32 a77, v213
  v_accvgpr_read_b32 v213, a78
  v_mul_f32 v213, v213, v214
  v_accvgpr_write_b32 a78, v213
  v_accvgpr_read_b32 v213, a79
  v_mul_f32 v213, v213, v214
  v_accvgpr_write_b32 a79, v213
  v_accvgpr_read_b32 v213, a96
  v_mul_f32 v213, v213, v214
  v_accvgpr_write_b32 a96, v213
  v_accvgpr_read_b32 v213, a97
  v_mul_f32 v213, v213, v214
  v_accvgpr_write_b32 a97, v213
  v_accvgpr_read_b32 v213, a98
  v_mul_f32 v213, v213, v214
  v_accvgpr_write_b32 a98, v213
  v_accvgpr_read_b32 v213, a99
  v_mul_f32 v213, v213, v214
  v_accvgpr_write_b32 a99, v213
  v_accvgpr_read_b32 v213, a100
  v_mul_f32 v213, v213, v214
  v_accvgpr_write_b32 a100, v213
  v_accvgpr_read_b32 v213, a101
  v_mul_f32 v213, v213, v214
  v_accvgpr_write_b32 a101, v213
  v_accvgpr_read_b32 v213, a102
  v_mul_f32 v213, v213, v214
  v_accvgpr_write_b32 a102, v213
  v_accvgpr_read_b32 v213, a103
  v_mul_f32 v213, v213, v214
  v_accvgpr_write_b32 a103, v213
  v_accvgpr_read_b32 v213, a104
  v_mul_f32 v213, v213, v214
  v_accvgpr_write_b32 a104, v213
  v_accvgpr_read_b32 v213, a105
  v_mul_f32 v213, v213, v214
  v_accvgpr_write_b32 a105, v213
  v_accvgpr_read_b32 v213, a106
  v_mul_f32 v213, v213, v214
  v_accvgpr_write_b32 a106, v213
  v_accvgpr_read_b32 v213, a107
  v_mul_f32 v213, v213, v214
  v_accvgpr_write_b32 a107, v213
  v_accvgpr_read_b32 v213, a108
  v_mul_f32 v213, v213, v214
  v_accvgpr_write_b32 a108, v213
  v_accvgpr_read_b32 v213, a109
  v_mul_f32 v213, v213, v214
  v_accvgpr_write_b32 a109, v213
  v_accvgpr_read_b32 v213, a110
  v_mul_f32 v213, v213, v214
  v_accvgpr_write_b32 a110, v213
  v_accvgpr_read_b32 v213, a111
  v_mul_f32 v213, v213, v214
  v_accvgpr_write_b32 a111, v213
  v_max3_f32 v212, v56, v57, v58
  v_max3_f32 v212, v212, v59, v60
  v_max3_f32 v212, v212, v61, v62
  v_max3_f32 v212, v212, v63, v64
  v_max3_f32 v212, v212, v65, v66
  v_max3_f32 v212, v212, v67, v68
  v_max3_f32 v212, v212, v69, v70
  v_max_f32 v212, v212, v71
  v_mov_b32 v213, v212
  s_nop 1
  v_permlane32_swap_b32 v212, v213
  v_max_f32 v212, v212, v213
  v_max_f32 v212, 0, v212
  v_sub_f32 v120, v120, v212
  v_sub_f32 v121, v121, v212
  v_sub_f32 v122, v122, v212
  v_sub_f32 v123, v123, v212
  v_sub_f32 v124, v124, v212
  v_sub_f32 v125, v125, v212
  v_sub_f32 v126, v126, v212
  v_sub_f32 v127, v127, v212
  v_sub_f32 v128, v128, v212
  v_sub_f32 v129, v129, v212
  v_sub_f32 v130, v130, v212
  v_sub_f32 v131, v131, v212
  v_sub_f32 v132, v132, v212
  v_sub_f32 v133, v133, v212
  v_sub_f32 v134, v134, v212
  v_sub_f32 v135, v135, v212
  v_sub_f32 v56, v56, v212
  v_sub_f32 v57, v57, v212
  v_sub_f32 v58, v58, v212
  v_sub_f32 v59, v59, v212
  v_sub_f32 v60, v60, v212
  v_sub_f32 v61, v61, v212
  v_sub_f32 v62, v62, v212
  v_sub_f32 v63, v63, v212
  v_sub_f32 v64, v64, v212
  v_sub_f32 v65, v65, v212
  v_sub_f32 v66, v66, v212
  v_sub_f32 v67, v67, v212
  v_sub_f32 v68, v68, v212
  v_sub_f32 v69, v69, v212
  v_sub_f32 v70, v70, v212
  v_sub_f32 v71, v71, v212
  v_sub_f32 v24, v24, v212
  v_sub_f32 v25, v25, v212
  v_sub_f32 v26, v26, v212
  v_sub_f32 v27, v27, v212
  v_sub_f32 v28, v28, v212
  v_sub_f32 v29, v29, v212
  v_sub_f32 v30, v30, v212
  v_sub_f32 v31, v31, v212
  v_sub_f32 v32, v32, v212
  v_sub_f32 v33, v33, v212
  v_sub_f32 v34, v34, v212
  v_sub_f32 v35, v35, v212
  v_sub_f32 v36, v36, v212
  v_sub_f32 v37, v37, v212
  v_sub_f32 v38, v38, v212
  v_sub_f32 v39, v39, v212
  v_sub_f32 v214, 0, v212
  v_exp_f32 v214, v214
  s_nop 0
  v_mul_f32 v209, v209, v214
  v_accvgpr_read_b32 v213, a16
  v_mul_f32 v213, v213, v214
  v_accvgpr_write_b32 a16, v213
  v_accvgpr_read_b32 v213, a17
  v_mul_f32 v213, v213, v214
  v_accvgpr_write_b32 a17, v213
  v_accvgpr_read_b32 v213, a18
  v_mul_f32 v213, v213, v214
  v_accvgpr_write_b32 a18, v213
  v_accvgpr_read_b32 v213, a19
  v_mul_f32 v213, v213, v214
  v_accvgpr_write_b32 a19, v213
  v_accvgpr_read_b32 v213, a20
  v_mul_f32 v213, v213, v214
  v_accvgpr_write_b32 a20, v213
  v_accvgpr_read_b32 v213, a21
  v_mul_f32 v213, v213, v214
  v_accvgpr_write_b32 a21, v213
  v_accvgpr_read_b32 v213, a22
  v_mul_f32 v213, v213, v214
  v_accvgpr_write_b32 a22, v213
  v_accvgpr_read_b32 v213, a23
  v_mul_f32 v213, v213, v214
  v_accvgpr_write_b32 a23, v213
  v_accvgpr_read_b32 v213, a24
  v_mul_f32 v213, v213, v214
  v_accvgpr_write_b32 a24, v213
  v_accvgpr_read_b32 v213, a25
  v_mul_f32 v213, v213, v214
  v_accvgpr_write_b32 a25, v213
  v_accvgpr_read_b32 v213, a26
  v_mul_f32 v213, v213, v214
  v_accvgpr_write_b32 a26, v213
  v_accvgpr_read_b32 v213, a27
  v_mul_f32 v213, v213, v214
  v_accvgpr_write_b32 a27, v213
  v_accvgpr_read_b32 v213, a28
  v_mul_f32 v213, v213, v214
  v_accvgpr_write_b32 a28, v213
  v_accvgpr_read_b32 v213, a29
  v_mul_f32 v213, v213, v214
  v_accvgpr_write_b32 a29, v213
  v_accvgpr_read_b32 v213, a30
  v_mul_f32 v213, v213, v214
  v_accvgpr_write_b32 a30, v213
  v_accvgpr_read_b32 v213, a31
  v_mul_f32 v213, v213, v214
  v_accvgpr_write_b32 a31, v213
  v_accvgpr_read_b32 v213, a48
  v_mul_f32 v213, v213, v214
  v_accvgpr_write_b32 a48, v213
  v_accvgpr_read_b32 v213, a49
  v_mul_f32 v213, v213, v214
  v_accvgpr_write_b32 a49, v213
  v_accvgpr_read_b32 v213, a50
  v_mul_f32 v213, v213, v214
  v_accvgpr_write_b32 a50, v213
  v_accvgpr_read_b32 v213, a51
  v_mul_f32 v213, v213, v214
  v_accvgpr_write_b32 a51, v213
  v_accvgpr_read_b32 v213, a52
  v_mul_f32 v213, v213, v214
  v_accvgpr_write_b32 a52, v213
  v_accvgpr_read_b32 v213, a53
  v_mul_f32 v213, v213, v214
  v_accvgpr_write_b32 a53, v213
  v_accvgpr_read_b32 v213, a54
  v_mul_f32 v213, v213, v214
  v_accvgpr_write_b32 a54, v213
  v_accvgpr_read_b32 v213, a55
  v_mul_f32 v213, v213, v214
  v_accvgpr_write_b32 a55, v213
  v_accvgpr_read_b32 v213, a56
  v_mul_f32 v213, v213, v214
  v_accvgpr_write_b32 a56, v213
  v_accvgpr_read_b32 v213, a57
  v_mul_f32 v213, v213, v214
  v_accvgpr_write_b32 a57, v213
  v_accvgpr_read_b32 v213, a58
  v_mul_f32 v213, v213, v214
  v_accvgpr_write_b32 a58, v213
  v_accvgpr_read_b32 v213, a59
  v_mul_f32 v213, v213, v214
  v_accvgpr_write_b32 a59, v213
  v_accvgpr_read_b32 v213, a60
  v_mul_f32 v213, v213, v214
  v_accvgpr_write_b32 a60, v213
  v_accvgpr_read_b32 v213, a61
  v_mul_f32 v213, v213, v214
  v_accvgpr_write_b32 a61, v213
  v_accvgpr_read_b32 v213, a62
  v_mul_f32 v213, v213, v214
  v_accvgpr_write_b32 a62, v213
  v_accvgpr_read_b32 v213, a63
  v_mul_f32 v213, v213, v214
  v_accvgpr_write_b32 a63, v213
  v_accvgpr_read_b32 v213, a80
  v_mul_f32 v213, v213, v214
  v_accvgpr_write_b32 a80, v213
  v_accvgpr_read_b32 v213, a81
  v_mul_f32 v213, v213, v214
  v_accvgpr_write_b32 a81, v213
  v_accvgpr_read_b32 v213, a82
  v_mul_f32 v213, v213, v214
  v_accvgpr_write_b32 a82, v213
  v_accvgpr_read_b32 v213, a83
  v_mul_f32 v213, v213, v214
  v_accvgpr_write_b32 a83, v213
  v_accvgpr_read_b32 v213, a84
  v_mul_f32 v213, v213, v214
  v_accvgpr_write_b32 a84, v213
  v_accvgpr_read_b32 v213, a85
  v_mul_f32 v213, v213, v214
  v_accvgpr_write_b32 a85, v213
  v_accvgpr_read_b32 v213, a86
  v_mul_f32 v213, v213, v214
  v_accvgpr_write_b32 a86, v213
  v_accvgpr_read_b32 v213, a87
  v_mul_f32 v213, v213, v214
  v_accvgpr_write_b32 a87, v213
  v_accvgpr_read_b32 v213, a88
  v_mul_f32 v213, v213, v214
  v_accvgpr_write_b32 a88, v213
  v_accvgpr_read_b32 v213, a89
  v_mul_f32 v213, v213, v214
  v_accvgpr_write_b32 a89, v213
  v_accvgpr_read_b32 v213, a90
  v_mul_f32 v213, v213, v214
  v_accvgpr_write_b32 a90, v213
  v_accvgpr_read_b32 v213, a91
  v_mul_f32 v213, v213, v214
  v_accvgpr_write_b32 a91, v213
  v_accvgpr_read_b32 v213, a92
  v_mul_f32 v213, v213, v214
  v_accvgpr_write_b32 a92, v213
  v_accvgpr_read_b32 v213, a93
  v_mul_f32 v213, v213, v214
  v_accvgpr_write_b32 a93, v213
  v_accvgpr_read_b32 v213, a94
  v_mul_f32 v213, v213, v214
  v_accvgpr_write_b32 a94, v213
  v_accvgpr_read_b32 v213, a95
  v_mul_f32 v213, v213, v214
  v_accvgpr_write_b32 a95, v213
  v_accvgpr_read_b32 v213, a112
  v_mul_f32 v213, v213, v214
  v_accvgpr_write_b32 a112, v213
  v_accvgpr_read_b32 v213, a113
  v_mul_f32 v213, v213, v214
  v_accvgpr_write_b32 a113, v213
  v_accvgpr_read_b32 v213, a114
  v_mul_f32 v213, v213, v214
  v_accvgpr_write_b32 a114, v213
  v_accvgpr_read_b32 v213, a115
  v_mul_f32 v213, v213, v214
  v_accvgpr_write_b32 a115, v213
  v_accvgpr_read_b32 v213, a116
  v_mul_f32 v213, v213, v214
  v_accvgpr_write_b32 a116, v213
  v_accvgpr_read_b32 v213, a117
  v_mul_f32 v213, v213, v214
  v_accvgpr_write_b32 a117, v213
  v_accvgpr_read_b32 v213, a118
  v_mul_f32 v213, v213, v214
  v_accvgpr_write_b32 a118, v213
  v_accvgpr_read_b32 v213, a119
  v_mul_f32 v213, v213, v214
  v_accvgpr_write_b32 a119, v213
  v_accvgpr_read_b32 v213, a120
  v_mul_f32 v213, v213, v214
  v_accvgpr_write_b32 a120, v213
  v_accvgpr_read_b32 v213, a121
  v_mul_f32 v213, v213, v214
  v_accvgpr_write_b32 a121, v213
  v_accvgpr_read_b32 v213, a122
  v_mul_f32 v213, v213, v214
  v_accvgpr_write_b32 a122, v213
  v_accvgpr_read_b32 v213, a123
  v_mul_f32 v213, v213, v214
  v_accvgpr_write_b32 a123, v213
  v_accvgpr_read_b32 v213, a124
  v_mul_f32 v213, v213, v214
  v_accvgpr_write_b32 a124, v213
  v_accvgpr_read_b32 v213, a125
  v_mul_f32 v213, v213, v214
  v_accvgpr_write_b32 a125, v213
  v_accvgpr_read_b32 v213, a126
  v_mul_f32 v213, v213, v214
  v_accvgpr_write_b32 a126, v213
  v_accvgpr_read_b32 v213, a127
  v_mul_f32 v213, v213, v214
  v_accvgpr_write_b32 a127, v213
  v_exp_f32 v200, v40
  v_exp_f32 v201, v41
  v_add_f32 v210, v208, v200
  v_exp_f32 v202, v42
  v_add_f32 v210, v210, v201
  v_cvt_pk_bf16_f32 v88, v200, v201
  v_exp_f32 v203, v43
  v_add_f32 v210, v210, v202
  v_exp_f32 v204, v44
  v_add_f32 v210, v210, v203
  v_cvt_pk_bf16_f32 v89, v202, v203
  v_exp_f32 v205, v45
  v_add_f32 v210, v210, v204
  v_exp_f32 v206, v46
  v_add_f32 v210, v210, v205
  v_cvt_pk_bf16_f32 v90, v204, v205
  v_exp_f32 v207, v47
  v_add_f32 v210, v210, v206
  v_exp_f32 v200, v48
  v_add_f32 v210, v210, v207
  v_cvt_pk_bf16_f32 v91, v206, v207
  v_exp_f32 v201, v49
  v_add_f32 v210, v210, v200
  v_exp_f32 v202, v50
  v_add_f32 v210, v210, v201
  v_cvt_pk_bf16_f32 v92, v200, v201
  v_exp_f32 v203, v51
  v_add_f32 v210, v210, v202
  v_exp_f32 v204, v52
  v_add_f32 v210, v210, v203
  v_cvt_pk_bf16_f32 v93, v202, v203
  v_exp_f32 v205, v53
  v_add_f32 v210, v210, v204
  v_exp_f32 v206, v54
  v_add_f32 v210, v210, v205
  v_cvt_pk_bf16_f32 v94, v204, v205
  v_exp_f32 v207, v55
  v_add_f32 v210, v210, v206
  v_exp_f32 v200, v56
  v_add_f32 v210, v210, v207
  v_cvt_pk_bf16_f32 v95, v206, v207
  v_exp_f32 v201, v57
  v_add_f32 v211, v209, v200
  v_exp_f32 v202, v58
  v_add_f32 v211, v211, v201
  v_cvt_pk_bf16_f32 v96, v200, v201
  v_exp_f32 v203, v59
  v_add_f32 v211, v211, v202
  v_exp_f32 v204, v60
  v_add_f32 v211, v211, v203
  v_cvt_pk_bf16_f32 v97, v202, v203
  v_exp_f32 v205, v61
  v_add_f32 v211, v211, v204
  v_exp_f32 v206, v62
  v_add_f32 v211, v211, v205
  v_cvt_pk_bf16_f32 v98, v204, v205
  v_exp_f32 v207, v63
  v_add_f32 v211, v211, v206
  v_exp_f32 v200, v64
  v_add_f32 v211, v211, v207
  v_cvt_pk_bf16_f32 v99, v206, v207
  v_exp_f32 v201, v65
  v_add_f32 v211, v211, v200
  v_exp_f32 v202, v66
  v_add_f32 v211, v211, v201
  v_cvt_pk_bf16_f32 v100, v200, v201
  v_exp_f32 v203, v67
  v_add_f32 v211, v211, v202
  v_exp_f32 v204, v68
  v_add_f32 v211, v211, v203
  v_cvt_pk_bf16_f32 v101, v202, v203
  v_exp_f32 v205, v69
  v_add_f32 v211, v211, v204
  v_exp_f32 v206, v70
  v_add_f32 v211, v211, v205
  v_cvt_pk_bf16_f32 v102, v204, v205
  v_exp_f32 v207, v71
  v_add_f32 v211, v211, v206
  v_add_f32 v211, v211, v207
  v_cvt_pk_bf16_f32 v103, v206, v207
  s_branch k2_ret17
k2_fb18:
  v_max3_f32 v212, v8, v9, v10
  v_max3_f32 v212, v212, v11, v12
  v_max3_f32 v212, v212, v13, v14
  v_max3_f32 v212, v212, v15, v16
  v_max3_f32 v212, v212, v17, v18
  v_max3_f32 v212, v212, v19, v20
  v_max3_f32 v212, v212, v21, v22
  v_max_f32 v212, v212, v23
  v_mov_b32 v213, v212
  s_nop 1
  v_permlane32_swap_b32 v212, v213
  v_max_f32 v212, v212, v213
  v_max_f32 v212, 0, v212
  v_sub_f32 v104, v104, v212
  v_sub_f32 v105, v105, v212
  v_sub_f32 v106, v106, v212
  v_sub_f32 v107, v107, v212
  v_sub_f32 v108, v108, v212
  v_sub_f32 v109, v109, v212
  v_sub_f32 v110, v110, v212
  v_sub_f32 v111, v111, v212
  v_sub_f32 v112, v112, v212
  v_sub_f32 v113, v113, v212
  v_sub_f32 v114, v114, v212
  v_sub_f32 v115, v115, v212
  v_sub_f32 v116, v116, v212
  v_sub_f32 v117, v117, v212
  v_sub_f32 v118, v118, v212
  v_sub_f32 v119, v119, v212
  v_sub_f32 v8, v8, v212
  v_sub_f32 v9, v9, v212
  v_sub_f32 v10, v10, v212
  v_sub_f32 v11, v11, v212
  v_sub_f32 v12, v12, v212
  v_sub_f32 v13, v13, v212
  v_sub_f32 v14, v14, v212
  v_sub_f32 v15, v15, v212
  v_sub_f32 v16, v16, v212
  v_sub_f32 v17, v17, v212
  v_sub_f32 v18, v18, v212
  v_sub_f32 v19, v19, v212
  v_sub_f32 v20, v20, v212
  v_sub_f32 v21, v21, v212
  v_sub_f32 v22, v22, v212
  v_sub_f32 v23, v23, v212
  v_sub_f32 v40, v40, v212
  v_sub_f32 v41, v41, v212
  v_sub_f32 v42, v42, v212
  v_sub_f32 v43, v43, v212
  v_sub_f32 v44, v44, v212
  v_sub_f32 v45, v45, v212
  v_sub_f32 v46, v46, v212
  v_sub_f32 v47, v47, v212
  v_sub_f32 v48, v48, v212
  v_sub_f32 v49, v49, v212
  v_sub_f32 v50, v50, v212
  v_sub_f32 v51, v51, v212
  v_sub_f32 v52, v52, v212
  v_sub_f32 v53, v53, v212
  v_sub_f32 v54, v54, v212
  v_sub_f32 v55, v55, v212
  v_sub_f32 v214, 0, v212
  v_exp_f32 v214, v214
  s_nop 0
  v_mul_f32 v210, v210, v214
  v_accvgpr_read_b32 v213, a0
  v_mul_f32 v213, v213, v214
  v_accvgpr_write_b32 a0, v213
  v_accvgpr_read_b32 v213, a1
  v_mul_f32 v213, v213, v214
  v_accvgpr_write_b32 a1, v213
  v_accvgpr_read_b32 v213, a2
  v_mul_f32 v213, v213, v214
  v_accvgpr_write_b32 a2, v213
  v_accvgpr_read_b32 v213, a3
  v_mul_f32 v213, v213, v214
  v_accvgpr_write_b32 a3, v213
  v_accvgpr_read_b32 v213, a4
  v_mul_f32 v213, v213, v214
  v_accvgpr_write_b32 a4, v213
  v_accvgpr_read_b32 v213, a5
  v_mul_f32 v213, v213, v214
  v_accvgpr_write_b32 a5, v213
  v_accvgpr_read_b32 v213, a6
  v_mul_f32 v213, v213, v214
  v_accvgpr_write_b32 a6, v213
  v_accvgpr_read_b32 v213, a7
  v_mul_f32 v213, v213, v214
  v_accvgpr_write_b32 a7, v213
  v_accvgpr_read_b32 v213, a8
  v_mul_f32 v213, v213, v214
  v_accvgpr_write_b32 a8, v213
  v_accvgpr_read_b32 v213, a9
  v_mul_f32 v213, v213, v214
  v_accvgpr_write_b32 a9, v213
  v_accvgpr_read_b32 v213, a10
  v_mul_f32 v213, v213, v214
  v_accvgpr_write_b32 a10, v213
  v_accvgpr_read_b32 v213, a11
  v_mul_f32 v213, v213, v214
  v_accvgpr_write_b32 a11, v213
  v_accvgpr_read_b32 v213, a12
  v_mul_f32 v213, v213, v214
  v_accvgpr_write_b32 a12, v213
  v_accvgpr_read_b32 v213, a13
  v_mul_f32 v213, v213, v214
  v_accvgpr_write_b32 a13, v213
  v_accvgpr_read_b32 v213, a14
  v_mul_f32 v213, v213, v214
  v_accvgpr_write_b32 a14, v213
  v_accvgpr_read_b32 v213, a15
  v_mul_f32 v213, v213, v214
  v_accvgpr_write_b32 a15, v213
  v_accvgpr_read_b32 v213, a32
  v_mul_f32 v213, v213, v214
  v_accvgpr_write_b32 a32, v213
  v_accvgpr_read_b32 v213, a33
  v_mul_f32 v213, v213, v214
  v_accvgpr_write_b32 a33, v213
  v_accvgpr_read_b32 v213, a34
  v_mul_f32 v213, v213, v214
  v_accvgpr_write_b32 a34, v213
  v_accvgpr_read_b32 v213, a35
  v_mul_f32 v213, v213, v214
  v_accvgpr_write_b32 a35, v213
  v_accvgpr_read_b32 v213, a36
  v_mul_f32 v213, v213, v214
  v_accvgpr_write_b32 a36, v213
  v_accvgpr_read_b32 v213, a37
  v_mul_f32 v213, v213, v214
  v_accvgpr_write_b32 a37, v213
  v_accvgpr_read_b32 v213, a38
  v_mul_f32 v213, v213, v214
  v_accvgpr_write_b32 a38, v213
  v_accvgpr_read_b32 v213, a39
  v_mul_f32 v213, v213, v214
  v_accvgpr_write_b32 a39, v213
  v_accvgpr_read_b32 v213, a40
  v_mul_f32 v213, v213, v214
  v_accvgpr_write_b32 a40, v213
  v_accvgpr_read_b32 v213, a41
  v_mul_f32 v213, v213, v214
  v_accvgpr_write_b32 a41, v213
  v_accvgpr_read_b32 v213, a42
  v_mul_f32 v213, v213, v214
  v_accvgpr_write_b32 a42, v213
  v_accvgpr_read_b32 v213, a43
  v_mul_f32 v213, v213, v214
  v_accvgpr_write_b32 a43, v213
  v_accvgpr_read_b32 v213, a44
  v_mul_f32 v213, v213, v214
  v_accvgpr_write_b32 a44, v213
  v_accvgpr_read_b32 v213, a45
  v_mul_f32 v213, v213, v214
  v_accvgpr_write_b32 a45, v213
  v_accvgpr_read_b32 v213, a46
  v_mul_f32 v213, v213, v214
  v_accvgpr_write_b32 a46, v213
  v_accvgpr_read_b32 v213, a47
  v_mul_f32 v213, v213, v214
  v_accvgpr_write_b32 a47, v213
  v_accvgpr_read_b32 v213, a64
  v_mul_f32 v213, v213, v214
  v_accvgpr_write_b32 a64, v213
  v_accvgpr_read_b32 v213, a65
  v_mul_f32 v213, v213, v214
  v_accvgpr_write_b32 a65, v213
  v_accvgpr_read_b32 v213, a66
  v_mul_f32 v213, v213, v214
  v_accvgpr_write_b32 a66, v213
  v_accvgpr_read_b32 v213, a67
  v_mul_f32 v213, v213, v214
  v_accvgpr_write_b32 a67, v213
  v_accvgpr_read_b32 v213, a68
  v_mul_f32 v213, v213, v214
  v_accvgpr_write_b32 a68, v213
  v_accvgpr_read_b32 v213, a69
  v_mul_f32 v213, v213, v214
  v_accvgpr_write_b32 a69, v213
  v_accvgpr_read_b32 v213, a70
  v_mul_f32 v213, v213, v214
  v_accvgpr_write_b32 a70, v213
  v_accvgpr_read_b32 v213, a71
  v_mul_f32 v213, v213, v214
  v_accvgpr_write_b32 a71, v213
  v_accvgpr_read_b32 v213, a72
  v_mul_f32 v213, v213, v214
  v_accvgpr_write_b32 a72, v213
  v_accvgpr_read_b32 v213, a73
  v_mul_f32 v213, v213, v214
  v_accvgpr_write_b32 a73, v213
  v_accvgpr_read_b32 v213, a74
  v_mul_f32 v213, v213, v214
  v_accvgpr_write_b32 a74, v213
  v_accvgpr_read_b32 v213, a75
  v_mul_f32 v213, v213, v214
  v_accvgpr_write_b32 a75, v213
  v_accvgpr_read_b32 v213, a76
  v_mul_f32 v213, v213, v214
  v_accvgpr_write_b32 a76, v213
  v_accvgpr_read_b32 v213, a77
  v_mul_f32 v213, v213, v214
  v_accvgpr_write_b32 a77, v213
  v_accvgpr_read_b32 v213, a78
  v_mul_f32 v213, v213, v214
  v_accvgpr_write_b32 a78, v213
  v_accvgpr_read_b32 v213, a79
  v_mul_f32 v213, v213, v214
  v_accvgpr_write_b32 a79, v213
  v_accvgpr_read_b32 v213, a96
  v_mul_f32 v213, v213, v214
  v_accvgpr_write_b32 a96, v213
  v_accvgpr_read_b32 v213, a97
  v_mul_f32 v213, v213, v214
  v_accvgpr_write_b32 a97, v213
  v_accvgpr_read_b32 v213, a98
  v_mul_f32 v213, v213, v214
  v_accvgpr_write_b32 a98, v213
  v_accvgpr_read_b32 v213, a99
  v_mul_f32 v213, v213, v214
  v_accvgpr_write_b32 a99, v213
  v_accvgpr_read_b32 v213, a100
  v_mul_f32 v213, v213, v214
  v_accvgpr_write_b32 a100, v213
  v_accvgpr_read_b32 v213, a101
  v_mul_f32 v213, v213, v214
  v_accvgpr_write_b32 a101, v213
  v_accvgpr_read_b32 v213, a102
  v_mul_f32 v213, v213, v214
  v_accvgpr_write_b32 a102, v213
  v_accvgpr_read_b32 v213, a103
  v_mul_f32 v213, v213, v214
  v_accvgpr_write_b32 a103, v213
  v_accvgpr_read_b32 v213, a104
  v_mul_f32 v213, v213, v214
  v_accvgpr_write_b32 a104, v213
  v_accvgpr_read_b32 v213, a105
  v_mul_f32 v213, v213, v214
  v_accvgpr_write_b32 a105, v213
  v_accvgpr_read_b32 v213, a106
  v_mul_f32 v213, v213, v214
  v_accvgpr_write_b32 a106, v213
  v_accvgpr_read_b32 v213, a107
  v_mul_f32 v213, v213, v214
  v_accvgpr_write_b32 a107, v213
  v_accvgpr_read_b32 v213, a108
  v_mul_f32 v213, v213, v214
  v_accvgpr_write_b32 a108, v213
  v_accvgpr_read_b32 v213, a109
  v_mul_f32 v213, v213, v214
  v_accvgpr_write_b32 a109, v213
  v_accvgpr_read_b32 v213, a110
  v_mul_f32 v213, v213, v214
  v_accvgpr_write_b32 a110, v213
  v_accvgpr_read_b32 v213, a111
  v_mul_f32 v213, v213, v214
  v_accvgpr_write_b32 a111, v213
  v_max3_f32 v212, v24, v25, v26
  v_max3_f32 v212, v212, v27, v28
  v_max3_f32 v212, v212, v29, v30
  v_max3_f32 v212, v212, v31, v32
  v_max3_f32 v212, v212, v33, v34
  v_max3_f32 v212, v212, v35, v36
  v_max3_f32 v212, v212, v37, v38
  v_max_f32 v212, v212, v39
  v_mov_b32 v213, v212
  s_nop 1
  v_permlane32_swap_b32 v212, v213
  v_max_f32 v212, v212, v213
  v_max_f32 v212, 0, v212
  v_sub_f32 v120, v120, v212
  v_sub_f32 v121, v121, v212
  v_sub_f32 v122, v122, v212
  v_sub_f32 v123, v123, v212
  v_sub_f32 v124, v124, v212
  v_sub_f32 v125, v125, v212
  v_sub_f32 v126, v126, v212
  v_sub_f32 v127, v127, v212
  v_sub_f32 v128, v128, v212
  v_sub_f32 v129, v129, v212
  v_sub_f32 v130, v130, v212
  v_sub_f32 v131, v131, v212
  v_sub_f32 v132, v132, v212
  v_sub_f32 v133, v133, v212
  v_sub_f32 v134, v134, v212
  v_sub_f32 v135, v135, v212
  v_sub_f32 v24, v24, v212
  v_sub_f32 v25, v25, v212
  v_sub_f32 v26, v26, v212
  v_sub_f32 v27, v27, v212
  v_sub_f32 v28, v28, v212
  v_sub_f32 v29, v29, v212
  v_sub_f32 v30, v30, v212
  v_sub_f32 v31, v31, v212
  v_sub_f32 v32, v32, v212
  v_sub_f32 v33, v33, v212
  v_sub_f32 v34, v34, v212
  v_sub_f32 v35, v35, v212
  v_sub_f32 v36, v36, v212
  v_sub_f32 v37, v37, v212
  v_sub_f32 v38, v38, v212
  v_sub_f32 v39, v39, v212
  v_sub_f32 v56, v56, v212
  v_sub_f32 v57, v57, v212
  v_sub_f32 v58, v58, v212
  v_sub_f32 v59, v59, v212
  v_sub_f32 v60, v60, v212
  v_sub_f32 v61, v61, v212
  v_sub_f32 v62, v62, v212
  v_sub_f32 v63, v63, v212
  v_sub_f32 v64, v64, v212
  v_sub_f32 v65, v65, v212
  v_sub_f32 v66, v66, v212
  v_sub_f32 v67, v67, v212
  v_sub_f32 v68, v68, v212
  v_sub_f32 v69, v69, v212
  v_sub_f32 v70, v70, v212
  v_sub_f32 v71, v71, v212
  v_sub_f32 v214, 0, v212
  v_exp_f32 v214, v214
  s_nop 0
  v_mul_f32 v211, v211, v214
  v_accvgpr_read_b32 v213, a16
  v_mul_f32 v213, v213, v214
  v_accvgpr_write_b32 a16, v213
  v_accvgpr_read_b32 v213, a17
  v_mul_f32 v213, v213, v214
  v_accvgpr_write_b32 a17, v213
  v_accvgpr_read_b32 v213, a18
  v_mul_f32 v213, v213, v214
  v_accvgpr_write_b32 a18, v213
  v_accvgpr_read_b32 v213, a19
  v_mul_f32 v213, v213, v214
  v_accvgpr_write_b32 a19, v213
  v_accvgpr_read_b32 v213, a20
  v_mul_f32 v213, v213, v214
  v_accvgpr_write_b32 a20, v213
  v_accvgpr_read_b32 v213, a21
  v_mul_f32 v213, v213, v214
  v_accvgpr_write_b32 a21, v213
  v_accvgpr_read_b32 v213, a22
  v_mul_f32 v213, v213, v214
  v_accvgpr_write_b32 a22, v213
  v_accvgpr_read_b32 v213, a23
  v_mul_f32 v213, v213, v214
  v_accvgpr_write_b32 a23, v213
  v_accvgpr_read_b32 v213, a24
  v_mul_f32 v213, v213, v214
  v_accvgpr_write_b32 a24, v213
  v_accvgpr_read_b32 v213, a25
  v_mul_f32 v213, v213, v214
  v_accvgpr_write_b32 a25, v213
  v_accvgpr_read_b32 v213, a26
  v_mul_f32 v213, v213, v214
  v_accvgpr_write_b32 a26, v213
  v_accvgpr_read_b32 v213, a27
  v_mul_f32 v213, v213, v214
  v_accvgpr_write_b32 a27, v213
  v_accvgpr_read_b32 v213, a28
  v_mul_f32 v213, v213, v214
  v_accvgpr_write_b32 a28, v213
  v_accvgpr_read_b32 v213, a29
  v_mul_f32 v213, v213, v214
  v_accvgpr_write_b32 a29, v213
  v_accvgpr_read_b32 v213, a30
  v_mul_f32 v213, v213, v214
  v_accvgpr_write_b32 a30, v213
  v_accvgpr_read_b32 v213, a31
  v_mul_f32 v213, v213, v214
  v_accvgpr_write_b32 a31, v213
  v_accvgpr_read_b32 v213, a48
  v_mul_f32 v213, v213, v214
  v_accvgpr_write_b32 a48, v213
  v_accvgpr_read_b32 v213, a49
  v_mul_f32 v213, v213, v214
  v_accvgpr_write_b32 a49, v213
  v_accvgpr_read_b32 v213, a50
  v_mul_f32 v213, v213, v214
  v_accvgpr_write_b32 a50, v213
  v_accvgpr_read_b32 v213, a51
  v_mul_f32 v213, v213, v214
  v_accvgpr_write_b32 a51, v213
  v_accvgpr_read_b32 v213, a52
  v_mul_f32 v213, v213, v214
  v_accvgpr_write_b32 a52, v213
  v_accvgpr_read_b32 v213, a53
  v_mul_f32 v213, v213, v214
  v_accvgpr_write_b32 a53, v213
  v_accvgpr_read_b32 v213, a54
  v_mul_f32 v213, v213, v214
  v_accvgpr_write_b32 a54, v213
  v_accvgpr_read_b32 v213, a55
  v_mul_f32 v213, v213, v214
  v_accvgpr_write_b32 a55, v213
  v_accvgpr_read_b32 v213, a56
  v_mul_f32 v213, v213, v214
  v_accvgpr_write_b32 a56, v213
  v_accvgpr_read_b32 v213, a57
  v_mul_f32 v213, v213, v214
  v_accvgpr_write_b32 a57, v213
  v_accvgpr_read_b32 v213, a58
  v_mul_f32 v213, v213, v214
  v_accvgpr_write_b32 a58, v213
  v_accvgpr_read_b32 v213, a59
  v_mul_f32 v213, v213, v214
  v_accvgpr_write_b32 a59, v213
  v_accvgpr_read_b32 v213, a60
  v_mul_f32 v213, v213, v214
  v_accvgpr_write_b32 a60, v213
  v_accvgpr_read_b32 v213, a61
  v_mul_f32 v213, v213, v214
  v_accvgpr_write_b32 a61, v213
  v_accvgpr_read_b32 v213, a62
  v_mul_f32 v213, v213, v214
  v_accvgpr_write_b32 a62, v213
  v_accvgpr_read_b32 v213, a63
  v_mul_f32 v213, v213, v214
  v_accvgpr_write_b32 a63, v213
  v_accvgpr_read_b32 v213, a80
  v_mul_f32 v213, v213, v214
  v_accvgpr_write_b32 a80, v213
  v_accvgpr_read_b32 v213, a81
  v_mul_f32 v213, v213, v214
  v_accvgpr_write_b32 a81, v213
  v_accvgpr_read_b32 v213, a82
  v_mul_f32 v213, v213, v214
  v_accvgpr_write_b32 a82, v213
  v_accvgpr_read_b32 v213, a83
  v_mul_f32 v213, v213, v214
  v_accvgpr_write_b32 a83, v213
  v_accvgpr_read_b32 v213, a84
  v_mul_f32 v213, v213, v214
  v_accvgpr_write_b32 a84, v213
  v_accvgpr_read_b32 v213, a85
  v_mul_f32 v213, v213, v214
  v_accvgpr_write_b32 a85, v213
  v_accvgpr_read_b32 v213, a86
  v_mul_f32 v213, v213, v214
  v_accvgpr_write_b32 a86, v213
  v_accvgpr_read_b32 v213, a87
  v_mul_f32 v213, v213, v214
  v_accvgpr_write_b32 a87, v213
  v_accvgpr_read_b32 v213, a88
  v_mul_f32 v213, v213, v214
  v_accvgpr_write_b32 a88, v213
  v_accvgpr_read_b32 v213, a89
  v_mul_f32 v213, v213, v214
  v_accvgpr_write_b32 a89, v213
  v_accvgpr_read_b32 v213, a90
  v_mul_f32 v213, v213, v214
  v_accvgpr_write_b32 a90, v213
  v_accvgpr_read_b32 v213, a91
  v_mul_f32 v213, v213, v214
  v_accvgpr_write_b32 a91, v213
  v_accvgpr_read_b32 v213, a92
  v_mul_f32 v213, v213, v214
  v_accvgpr_write_b32 a92, v213
  v_accvgpr_read_b32 v213, a93
  v_mul_f32 v213, v213, v214
  v_accvgpr_write_b32 a93, v213
  v_accvgpr_read_b32 v213, a94
  v_mul_f32 v213, v213, v214
  v_accvgpr_write_b32 a94, v213
  v_accvgpr_read_b32 v213, a95
  v_mul_f32 v213, v213, v214
  v_accvgpr_write_b32 a95, v213
  v_accvgpr_read_b32 v213, a112
  v_mul_f32 v213, v213, v214
  v_accvgpr_write_b32 a112, v213
  v_accvgpr_read_b32 v213, a113
  v_mul_f32 v213, v213, v214
  v_accvgpr_write_b32 a113, v213
  v_accvgpr_read_b32 v213, a114
  v_mul_f32 v213, v213, v214
  v_accvgpr_write_b32 a114, v213
  v_accvgpr_read_b32 v213, a115
  v_mul_f32 v213, v213, v214
  v_accvgpr_write_b32 a115, v213
  v_accvgpr_read_b32 v213, a116
  v_mul_f32 v213, v213, v214
  v_accvgpr_write_b32 a116, v213
  v_accvgpr_read_b32 v213, a117
  v_mul_f32 v213, v213, v214
  v_accvgpr_write_b32 a117, v213
  v_accvgpr_read_b32 v213, a118
  v_mul_f32 v213, v213, v214
  v_accvgpr_write_b32 a118, v213
  v_accvgpr_read_b32 v213, a119
  v_mul_f32 v213, v213, v214
  v_accvgpr_write_b32 a119, v213
  v_accvgpr_read_b32 v213, a120
  v_mul_f32 v213, v213, v214
  v_accvgpr_write_b32 a120, v213
  v_accvgpr_read_b32 v213, a121
  v_mul_f32 v213, v213, v214
  v_accvgpr_write_b32 a121, v213
  v_accvgpr_read_b32 v213, a122
  v_mul_f32 v213, v213, v214
  v_accvgpr_write_b32 a122, v213
  v_accvgpr_read_b32 v213, a123
  v_mul_f32 v213, v213, v214
  v_accvgpr_write_b32 a123, v213
  v_accvgpr_read_b32 v213, a124
  v_mul_f32 v213, v213, v214
  v_accvgpr_write_b32 a124, v213
  v_accvgpr_read_b32 v213, a125
  v_mul_f32 v213, v213, v214
  v_accvgpr_write_b32 a125, v213
  v_accvgpr_read_b32 v213, a126
  v_mul_f32 v213, v213, v214
  v_accvgpr_write_b32 a126, v213
  v_accvgpr_read_b32 v213, a127
  v_mul_f32 v213, v213, v214
  v_accvgpr_write_b32 a127, v213
  v_exp_f32 v200, v8
  v_exp_f32 v201, v9
  v_add_f32 v208, v210, v200
  v_exp_f32 v202, v10
  v_add_f32 v208, v208, v201
  v_cvt_pk_bf16_f32 v72, v200, v201
  v_exp_f32 v203, v11
  v_add_f32 v208, v208, v202
  v_exp_f32 v204, v12
  v_add_f32 v208, v208, v203
  v_cvt_pk_bf16_f32 v73, v202, v203
  v_exp_f32 v205, v13
  v_add_f32 v208, v208, v204
  v_exp_f32 v206, v14
  v_add_f32 v208, v208, v205
  v_cvt_pk_bf16_f32 v74, v204, v205
  v_exp_f32 v207, v15
  v_add_f32 v208, v208, v206
  v_exp_f32 v200, v16
  v_add_f32 v208, v208, v207
  v_cvt_pk_bf16_f32 v75, v206, v207
  v_exp_f32 v201, v17
  v_add_f32 v208, v208, v200
  v_exp_f32 v202, v18
  v_add_f32 v208, v208, v201
  v_cvt_pk_bf16_f32 v76, v200, v201
  v_exp_f32 v203, v19
  v_add_f32 v208, v208, v202
  v_exp_f32 v204, v20
  v_add_f32 v208, v208, v203
  v_cvt_pk_bf16_f32 v77, v202, v203
  v_exp_f32 v205, v21
  v_add_f32 v208, v208, v204
  v_exp_f32 v206, v22
  v_add_f32 v208, v208, v205
  v_cvt_pk_bf16_f32 v78, v204, v205
  v_exp_f32 v207, v23
  v_add_f32 v208, v208, v206
  v_exp_f32 v200, v24
  v_add_f32 v208, v208, v207
  v_cvt_pk_bf16_f32 v79, v206, v207
  v_exp_f32 v201, v25
  v_add_f32 v209, v211, v200
  v_exp_f32 v202, v26
  v_add_f32 v209, v209, v201
  v_cvt_pk_bf16_f32 v80, v200, v201
  v_exp_f32 v203, v27
  v_add_f32 v209, v209, v202
  v_exp_f32 v204, v28
  v_add_f32 v209, v209, v203
  v_cvt_pk_bf16_f32 v81, v202, v203
  v_exp_f32 v205, v29
  v_add_f32 v209, v209, v204
  v_exp_f32 v206, v30
  v_add_f32 v209, v209, v205
  v_cvt_pk_bf16_f32 v82, v204, v205
  v_exp_f32 v207, v31
  v_add_f32 v209, v209, v206
  v_exp_f32 v200, v32
  v_add_f32 v209, v209, v207
  v_cvt_pk_bf16_f32 v83, v206, v207
  v_exp_f32 v201, v33
  v_add_f32 v209, v209, v200
  v_exp_f32 v202, v34
  v_add_f32 v209, v209, v201
  v_cvt_pk_bf16_f32 v84, v200, v201
  v_exp_f32 v203, v35
  v_add_f32 v209, v209, v202
  v_exp_f32 v204, v36
  v_add_f32 v209, v209, v203
  v_cvt_pk_bf16_f32 v85, v202, v203
  v_exp_f32 v205, v37
  v_add_f32 v209, v209, v204
  v_exp_f32 v206, v38
  v_add_f32 v209, v209, v205
  v_cvt_pk_bf16_f32 v86, v204, v205
  v_exp_f32 v207, v39
  v_add_f32 v209, v209, v206
  v_add_f32 v209, v209, v207
  v_cvt_pk_bf16_f32 v87, v206, v207
  s_branch k2_ret19
k2_fb20:
  v_max3_f32 v212, v40, v41, v42
  v_max3_f32 v212, v212, v43, v44
  v_max3_f32 v212, v212, v45, v46
  v_max3_f32 v212, v212, v47, v48
  v_max3_f32 v212, v212, v49, v50
  v_max3_f32 v212, v212, v51, v52
  v_max3_f32 v212, v212, v53, v54
  v_max_f32 v212, v212, v55
  v_mov_b32 v213, v212
  s_nop 1
  v_permlane32_swap_b32 v212, v213
  v_max_f32 v212, v212, v213
  v_max_f32 v212, 0, v212
  v_sub_f32 v104, v104, v212
  v_sub_f32 v105, v105, v212
  v_sub_f32 v106, v106, v212
  v_sub_f32 v107, v107, v212
  v_sub_f32 v108, v108, v212
  v_sub_f32 v109, v109, v212
  v_sub_f32 v110, v110, v212
  v_sub_f32 v111, v111, v212
  v_sub_f32 v112, v112, v212
  v_sub_f32 v113, v113, v212
  v_sub_f32 v114, v114, v212
  v_sub_f32 v115, v115, v212
  v_sub_f32 v116, v116, v212
  v_sub_f32 v117, v117, v212
  v_sub_f32 v118, v118, v212
  v_sub_f32 v119, v119, v212
  v_sub_f32 v40, v40, v212
  v_sub_f32 v41, v41, v212
  v_sub_f32 v42, v42, v212
  v_sub_f32 v43, v43, v212
  v_sub_f32 v44, v44, v212
  v_sub_f32 v45, v45, v212
  v_sub_f32 v46, v46, v212
  v_sub_f32 v47, v47, v212
  v_sub_f32 v48, v48, v212
  v_sub_f32 v49, v49, v212
  v_sub_f32 v50, v50, v212
  v_sub_f32 v51, v51, v212
  v_sub_f32 v52, v52, v212
  v_sub_f32 v53, v53, v212
  v_sub_f32 v54, v54, v212
  v_sub_f32 v55, v55, v212
  v_sub_f32 v8, v8, v212
  v_sub_f32 v9, v9, v212
  v_sub_f32 v10, v10, v212
  v_sub_f32 v11, v11, v212
  v_sub_f32 v12, v12, v212
  v_sub_f32 v13, v13, v212
  v_sub_f32 v14, v14, v212
  v_sub_f32 v15, v15, v212
  v_sub_f32 v16, v16, v212
  v_sub_f32 v17, v17, v212
  v_sub_f32 v18, v18, v212
  v_sub_f32 v19, v19, v212
  v_sub_f32 v20, v20, v212
  v_sub_f32 v21, v21, v212
  v_sub_f32 v22, v22, v212
  v_sub_f32 v23, v23, v212
  v_sub_f32 v214, 0, v212
  v_exp_f32 v214, v214
  s_nop 0
  v_mul_f32 v208, v208, v214
  v_accvgpr_read_b32 v213, a0
  v_mul_f32 v213, v213, v214
  v_accvgpr_write_b32 a0, v213
  v_accvgpr_read_b32 v213, a1
  v_mul_f32 v213, v213, v214
  v_accvgpr_write_b32 a1, v213
  v_accvgpr_read_b32 v213, a2
  v_mul_f32 v213, v213, v214
  v_accvgpr_write_b32 a2, v213
  v_accvgpr_read_b32 v213, a3
  v_mul_f32 v213, v213, v214
  v_accvgpr_write_b32 a3, v213
  v_accvgpr_read_b32 v213, a4
  v_mul_f32 v213, v213, v214
  v_accvgpr_write_b32 a4, v213
  v_accvgpr_read_b32 v213, a5
  v_mul_f32 v213, v213, v214
  v_accvgpr_write_b32 a5, v213
  v_accvgpr_read_b32 v213, a6
  v_mul_f32 v213, v213, v214
  v_accvgpr_write_b32 a6, v213
  v_accvgpr_read_b32 v213, a7
  v_mul_f32 v213, v213, v214
  v_accvgpr_write_b32 a7, v213
  v_accvgpr_read_b32 v213, a8
  v_mul_f32 v213, v213, v214
  v_accvgpr_write_b32 a8, v213
  v_accvgpr_read_b32 v213, a9
  v_mul_f32 v213, v213, v214
  v_accvgpr_write_b32 a9, v213
  v_accvgpr_read_b32 v213, a10
  v_mul_f32 v213, v213, v214
  v_accvgpr_write_b32 a10, v213
  v_accvgpr_read_b32 v213, a11
  v_mul_f32 v213, v213, v214
  v_accvgpr_write_b32 a11, v213
  v_accvgpr_read_b32 v213, a12
  v_mul_f32 v213, v213, v214
  v_accvgpr_write_b32 a12, v213
  v_accvgpr_read_b32 v213, a13
  v_mul_f32 v213, v213, v214
  v_accvgpr_write_b32 a13, v213
  v_accvgpr_read_b32 v213, a14
  v_mul_f32 v213, v213, v214
  v_accvgpr_write_b32 a14, v213
  v_accvgpr_read_b32 v213, a15
  v_mul_f32 v213, v213, v214
  v_accvgpr_write_b32 a15, v213
  v_accvgpr_read_b32 v213, a32
  v_mul_f32 v213, v213, v214
  v_accvgpr_write_b32 a32, v213
  v_accvgpr_read_b32 v213, a33
  v_mul_f32 v213, v213, v214
  v_accvgpr_write_b32 a33, v213
  v_accvgpr_read_b32 v213, a34
  v_mul_f32 v213, v213, v214
  v_accvgpr_write_b32 a34, v213
  v_accvgpr_read_b32 v213, a35
  v_mul_f32 v213, v213, v214
  v_accvgpr_write_b32 a35, v213
  v_accvgpr_read_b32 v213, a36
  v_mul_f32 v213, v213, v214
  v_accvgpr_write_b32 a36, v213
  v_accvgpr_read_b32 v213, a37
  v_mul_f32 v213, v213, v214
  v_accvgpr_write_b32 a37, v213
  v_accvgpr_read_b32 v213, a38
  v_mul_f32 v213, v213, v214
  v_accvgpr_write_b32 a38, v213
  v_accvgpr_read_b32 v213, a39
  v_mul_f32 v213, v213, v214
  v_accvgpr_write_b32 a39, v213
  v_accvgpr_read_b32 v213, a40
  v_mul_f32 v213, v213, v214
  v_accvgpr_write_b32 a40, v213
  v_accvgpr_read_b32 v213, a41
  v_mul_f32 v213, v213, v214
  v_accvgpr_write_b32 a41, v213
  v_accvgpr_read_b32 v213, a42
  v_mul_f32 v213, v213, v214
  v_accvgpr_write_b32 a42, v213
  v_accvgpr_read_b32 v213, a43
  v_mul_f32 v213, v213, v214
  v_accvgpr_write_b32 a43, v213
  v_accvgpr_read_b32 v213, a44
  v_mul_f32 v213, v213, v214
  v_accvgpr_write_b32 a44, v213
  v_accvgpr_read_b32 v213, a45
  v_mul_f32 v213, v213, v214
  v_accvgpr_write_b32 a45, v213
  v_accvgpr_read_b32 v213, a46
  v_mul_f32 v213, v213, v214
  v_accvgpr_write_b32 a46, v213
  v_accvgpr_read_b32 v213, a47
  v_mul_f32 v213, v213, v214
  v_accvgpr_write_b32 a47, v213
  v_accvgpr_read_b32 v213, a64
  v_mul_f32 v213, v213, v214
  v_accvgpr_write_b32 a64, v213
  v_accvgpr_read_b32 v213, a65
  v_mul_f32 v213, v213, v214
  v_accvgpr_write_b32 a65, v213
  v_accvgpr_read_b32 v213, a66
  v_mul_f32 v213, v213, v214
  v_accvgpr_write_b32 a66, v213
  v_accvgpr_read_b32 v213, a67
  v_mul_f32 v213, v213, v214
  v_accvgpr_write_b32 a67, v213
  v_accvgpr_read_b32 v213, a68
  v_mul_f32 v213, v213, v214
  v_accvgpr_write_b32 a68, v213
  v_accvgpr_read_b32 v213, a69
  v_mul_f32 v213, v213, v214
  v_accvgpr_write_b32 a69, v213
  v_accvgpr_read_b32 v213, a70
  v_mul_f32 v213, v213, v214
  v_accvgpr_write_b32 a70, v213
  v_accvgpr_read_b32 v213, a71
  v_mul_f32 v213, v213, v214
  v_accvgpr_write_b32 a71, v213
  v_accvgpr_read_b32 v213, a72
  v_mul_f32 v213, v213, v214
  v_accvgpr_write_b32 a72, v213
  v_accvgpr_read_b32 v213, a73
  v_mul_f32 v213, v213, v214
  v_accvgpr_write_b32 a73, v213
  v_accvgpr_read_b32 v213, a74
  v_mul_f32 v213, v213, v214
  v_accvgpr_write_b32 a74, v213
  v_accvgpr_read_b32 v213, a75
  v_mul_f32 v213, v213, v214
  v_accvgpr_write_b32 a75, v213
  v_accvgpr_read_b32 v213, a76
  v_mul_f32 v213, v213, v214
  v_accvgpr_write_b32 a76, v213
  v_accvgpr_read_b32 v213, a77
  v_mul_f32 v213, v213, v214
  v_accvgpr_write_b32 a77, v213
  v_accvgpr_read_b32 v213, a78
  v_mul_f32 v213, v213, v214
  v_accvgpr_write_b32 a78, v213
  v_accvgpr_read_b32 v213, a79
  v_mul_f32 v213, v213, v214
  v_accvgpr_write_b32 a79, v213
  v_accvgpr_read_b32 v213, a96
  v_mul_f32 v213, v213, v214
  v_accvgpr_write_b32 a96, v213
  v_accvgpr_read_b32 v213, a97
  v_mul_f32 v213, v213, v214
  v_accvgpr_write_b32 a97, v213
  v_accvgpr_read_b32 v213, a98
  v_mul_f32 v213, v213, v214
  v_accvgpr_write_b32 a98, v213
  v_accvgpr_read_b32 v213, a99
  v_mul_f32 v213, v213, v214
  v_accvgpr_write_b32 a99, v213
  v_accvgpr_read_b32 v213, a100
  v_mul_f32 v213, v213, v214
  v_accvgpr_write_b32 a100, v213
  v_accvgpr_read_b32 v213, a101
  v_mul_f32 v213, v213, v214
  v_accvgpr_write_b32 a101, v213
  v_accvgpr_read_b32 v213, a102
  v_mul_f32 v213, v213, v214
  v_accvgpr_write_b32 a102, v213
  v_accvgpr_read_b32 v213, a103
  v_mul_f32 v213, v213, v214
  v_accvgpr_write_b32 a103, v213
  v_accvgpr_read_b32 v213, a104
  v_mul_f32 v213, v213, v214
  v_accvgpr_write_b32 a104, v213
  v_accvgpr_read_b32 v213, a105
  v_mul_f32 v213, v213, v214
  v_accvgpr_write_b32 a105, v213
  v_accvgpr_read_b32 v213, a106
  v_mul_f32 v213, v213, v214
  v_accvgpr_write_b32 a106, v213
  v_accvgpr_read_b32 v213, a107
  v_mul_f32 v213, v213, v214
  v_accvgpr_write_b32 a107, v213
  v_accvgpr_read_b32 v213, a108
  v_mul_f32 v213, v213, v214
  v_accvgpr_write_b32 a108, v213
  v_accvgpr_read_b32 v213, a109
  v_mul_f32 v213, v213, v214
  v_accvgpr_write_b32 a109, v213
  v_accvgpr_read_b32 v213, a110
  v_mul_f32 v213, v213, v214
  v_accvgpr_write_b32 a110, v213
  v_accvgpr_read_b32 v213, a111
  v_mul_f32 v213, v213, v214
  v_accvgpr_write_b32 a111, v213
  v_max3_f32 v212, v56, v57, v58
  v_max3_f32 v212, v212, v59, v60
  v_max3_f32 v212, v212, v61, v62
  v_max3_f32 v212, v212, v63, v64
  v_max3_f32 v212, v212, v65, v66
  v_max3_f32 v212, v212, v67, v68
  v_max3_f32 v212, v212, v69, v70
  v_max_f32 v212, v212, v71
  v_mov_b32 v213, v212
  s_nop 1
  v_permlane32_swap_b32 v212, v213
  v_max_f32 v212, v212, v213
  v_max_f32 v212, 0, v212
  v_sub_f32 v120, v120, v212
  v_sub_f32 v121, v121, v212
  v_sub_f32 v122, v122, v212
  v_sub_f32 v123, v123, v212
  v_sub_f32 v124, v124, v212
  v_sub_f32 v125, v125, v212
  v_sub_f32 v126, v126, v212
  v_sub_f32 v127, v127, v212
  v_sub_f32 v128, v128, v212
  v_sub_f32 v129, v129, v212
  v_sub_f32 v130, v130, v212
  v_sub_f32 v131, v131, v212
  v_sub_f32 v132, v132, v212
  v_sub_f32 v133, v133, v212
  v_sub_f32 v134, v134, v212
  v_sub_f32 v135, v135, v212
  v_sub_f32 v56, v56, v212
  v_sub_f32 v57, v57, v212
  v_sub_f32 v58, v58, v212
  v_sub_f32 v59, v59, v212
  v_sub_f32 v60, v60, v212
  v_sub_f32 v61, v61, v212
  v_sub_f32 v62, v62, v212
  v_sub_f32 v63, v63, v212
  v_sub_f32 v64, v64, v212
  v_sub_f32 v65, v65, v212
  v_sub_f32 v66, v66, v212
  v_sub_f32 v67, v67, v212
  v_sub_f32 v68, v68, v212
  v_sub_f32 v69, v69, v212
  v_sub_f32 v70, v70, v212
  v_sub_f32 v71, v71, v212
  v_sub_f32 v24, v24, v212
  v_sub_f32 v25, v25, v212
  v_sub_f32 v26, v26, v212
  v_sub_f32 v27, v27, v212
  v_sub_f32 v28, v28, v212
  v_sub_f32 v29, v29, v212
  v_sub_f32 v30, v30, v212
  v_sub_f32 v31, v31, v212
  v_sub_f32 v32, v32, v212
  v_sub_f32 v33, v33, v212
  v_sub_f32 v34, v34, v212
  v_sub_f32 v35, v35, v212
  v_sub_f32 v36, v36, v212
  v_sub_f32 v37, v37, v212
  v_sub_f32 v38, v38, v212
  v_sub_f32 v39, v39, v212
  v_sub_f32 v214, 0, v212
  v_exp_f32 v214, v214
  s_nop 0
  v_mul_f32 v209, v209, v214
  v_accvgpr_read_b32 v213, a16
  v_mul_f32 v213, v213, v214
  v_accvgpr_write_b32 a16, v213
  v_accvgpr_read_b32 v213, a17
  v_mul_f32 v213, v213, v214
  v_accvgpr_write_b32 a17, v213
  v_accvgpr_read_b32 v213, a18
  v_mul_f32 v213, v213, v214
  v_accvgpr_write_b32 a18, v213
  v_accvgpr_read_b32 v213, a19
  v_mul_f32 v213, v213, v214
  v_accvgpr_write_b32 a19, v213
  v_accvgpr_read_b32 v213, a20
  v_mul_f32 v213, v213, v214
  v_accvgpr_write_b32 a20, v213
  v_accvgpr_read_b32 v213, a21
  v_mul_f32 v213, v213, v214
  v_accvgpr_write_b32 a21, v213
  v_accvgpr_read_b32 v213, a22
  v_mul_f32 v213, v213, v214
  v_accvgpr_write_b32 a22, v213
  v_accvgpr_read_b32 v213, a23
  v_mul_f32 v213, v213, v214
  v_accvgpr_write_b32 a23, v213
  v_accvgpr_read_b32 v213, a24
  v_mul_f32 v213, v213, v214
  v_accvgpr_write_b32 a24, v213
  v_accvgpr_read_b32 v213, a25
  v_mul_f32 v213, v213, v214
  v_accvgpr_write_b32 a25, v213
  v_accvgpr_read_b32 v213, a26
  v_mul_f32 v213, v213, v214
  v_accvgpr_write_b32 a26, v213
  v_accvgpr_read_b32 v213, a27
  v_mul_f32 v213, v213, v214
  v_accvgpr_write_b32 a27, v213
  v_accvgpr_read_b32 v213, a28
  v_mul_f32 v213, v213, v214
  v_accvgpr_write_b32 a28, v213
  v_accvgpr_read_b32 v213, a29
  v_mul_f32 v213, v213, v214
  v_accvgpr_write_b32 a29, v213
  v_accvgpr_read_b32 v213, a30
  v_mul_f32 v213, v213, v214
  v_accvgpr_write_b32 a30, v213
  v_accvgpr_read_b32 v213, a31
  v_mul_f32 v213, v213, v214
  v_accvgpr_write_b32 a31, v213
  v_accvgpr_read_b32 v213, a48
  v_mul_f32 v213, v213, v214
  v_accvgpr_write_b32 a48, v213
  v_accvgpr_read_b32 v213, a49
  v_mul_f32 v213, v213, v214
  v_accvgpr_write_b32 a49, v213
  v_accvgpr_read_b32 v213, a50
  v_mul_f32 v213, v213, v214
  v_accvgpr_write_b32 a50, v213
  v_accvgpr_read_b32 v213, a51
  v_mul_f32 v213, v213, v214
  v_accvgpr_write_b32 a51, v213
  v_accvgpr_read_b32 v213, a52
  v_mul_f32 v213, v213, v214
  v_accvgpr_write_b32 a52, v213
  v_accvgpr_read_b32 v213, a53
  v_mul_f32 v213, v213, v214
  v_accvgpr_write_b32 a53, v213
  v_accvgpr_read_b32 v213, a54
  v_mul_f32 v213, v213, v214
  v_accvgpr_write_b32 a54, v213
  v_accvgpr_read_b32 v213, a55
  v_mul_f32 v213, v213, v214
  v_accvgpr_write_b32 a55, v213
  v_accvgpr_read_b32 v213, a56
  v_mul_f32 v213, v213, v214
  v_accvgpr_write_b32 a56, v213
  v_accvgpr_read_b32 v213, a57
  v_mul_f32 v213, v213, v214
  v_accvgpr_write_b32 a57, v213
  v_accvgpr_read_b32 v213, a58
  v_mul_f32 v213, v213, v214
  v_accvgpr_write_b32 a58, v213
  v_accvgpr_read_b32 v213, a59
  v_mul_f32 v213, v213, v214
  v_accvgpr_write_b32 a59, v213
  v_accvgpr_read_b32 v213, a60
  v_mul_f32 v213, v213, v214
  v_accvgpr_write_b32 a60, v213
  v_accvgpr_read_b32 v213, a61
  v_mul_f32 v213, v213, v214
  v_accvgpr_write_b32 a61, v213
  v_accvgpr_read_b32 v213, a62
  v_mul_f32 v213, v213, v214
  v_accvgpr_write_b32 a62, v213
  v_accvgpr_read_b32 v213, a63
  v_mul_f32 v213, v213, v214
  v_accvgpr_write_b32 a63, v213
  v_accvgpr_read_b32 v213, a80
  v_mul_f32 v213, v213, v214
  v_accvgpr_write_b32 a80, v213
  v_accvgpr_read_b32 v213, a81
  v_mul_f32 v213, v213, v214
  v_accvgpr_write_b32 a81, v213
  v_accvgpr_read_b32 v213, a82
  v_mul_f32 v213, v213, v214
  v_accvgpr_write_b32 a82, v213
  v_accvgpr_read_b32 v213, a83
  v_mul_f32 v213, v213, v214
  v_accvgpr_write_b32 a83, v213
  v_accvgpr_read_b32 v213, a84
  v_mul_f32 v213, v213, v214
  v_accvgpr_write_b32 a84, v213
  v_accvgpr_read_b32 v213, a85
  v_mul_f32 v213, v213, v214
  v_accvgpr_write_b32 a85, v213
  v_accvgpr_read_b32 v213, a86
  v_mul_f32 v213, v213, v214
  v_accvgpr_write_b32 a86, v213
  v_accvgpr_read_b32 v213, a87
  v_mul_f32 v213, v213, v214
  v_accvgpr_write_b32 a87, v213
  v_accvgpr_read_b32 v213, a88
  v_mul_f32 v213, v213, v214
  v_accvgpr_write_b32 a88, v213
  v_accvgpr_read_b32 v213, a89
  v_mul_f32 v213, v213, v214
  v_accvgpr_write_b32 a89, v213
  v_accvgpr_read_b32 v213, a90
  v_mul_f32 v213, v213, v214
  v_accvgpr_write_b32 a90, v213
  v_accvgpr_read_b32 v213, a91
  v_mul_f32 v213, v213, v214
  v_accvgpr_write_b32 a91, v213
  v_accvgpr_read_b32 v213, a92
  v_mul_f32 v213, v213, v214
  v_accvgpr_write_b32 a92, v213
  v_accvgpr_read_b32 v213, a93
  v_mul_f32 v213, v213, v214
  v_accvgpr_write_b32 a93, v213
  v_accvgpr_read_b32 v213, a94
  v_mul_f32 v213, v213, v214
  v_accvgpr_write_b32 a94, v213
  v_accvgpr_read_b32 v213, a95
  v_mul_f32 v213, v213, v214
  v_accvgpr_write_b32 a95, v213
  v_accvgpr_read_b32 v213, a112
  v_mul_f32 v213, v213, v214
  v_accvgpr_write_b32 a112, v213
  v_accvgpr_read_b32 v213, a113
  v_mul_f32 v213, v213, v214
  v_accvgpr_write_b32 a113, v213
  v_accvgpr_read_b32 v213, a114
  v_mul_f32 v213, v213, v214
  v_accvgpr_write_b32 a114, v213
  v_accvgpr_read_b32 v213, a115
  v_mul_f32 v213, v213, v214
  v_accvgpr_write_b32 a115, v213
  v_accvgpr_read_b32 v213, a116
  v_mul_f32 v213, v213, v214
  v_accvgpr_write_b32 a116, v213
  v_accvgpr_read_b32 v213, a117
  v_mul_f32 v213, v213, v214
  v_accvgpr_write_b32 a117, v213
  v_accvgpr_read_b32 v213, a118
  v_mul_f32 v213, v213, v214
  v_accvgpr_write_b32 a118, v213
  v_accvgpr_read_b32 v213, a119
  v_mul_f32 v213, v213, v214
  v_accvgpr_write_b32 a119, v213
  v_accvgpr_read_b32 v213, a120
  v_mul_f32 v213, v213, v214
  v_accvgpr_write_b32 a120, v213
  v_accvgpr_read_b32 v213, a121
  v_mul_f32 v213, v213, v214
  v_accvgpr_write_b32 a121, v213
  v_accvgpr_read_b32 v213, a122
  v_mul_f32 v213, v213, v214
  v_accvgpr_write_b32 a122, v213
  v_accvgpr_read_b32 v213, a123
  v_mul_f32 v213, v213, v214
  v_accvgpr_write_b32 a123, v213
  v_accvgpr_read_b32 v213, a124
  v_mul_f32 v213, v213, v214
  v_accvgpr_write_b32 a124, v213
  v_accvgpr_read_b32 v213, a125
  v_mul_f32 v213, v213, v214
  v_accvgpr_write_b32 a125, v213
  v_accvgpr_read_b32 v213, a126
  v_mul_f32 v213, v213, v214
  v_accvgpr_write_b32 a126, v213
  v_accvgpr_read_b32 v213, a127
  v_mul_f32 v213, v213, v214
  v_accvgpr_write_b32 a127, v213
  v_exp_f32 v200, v40
  v_exp_f32 v201, v41
  v_add_f32 v210, v208, v200
  v_exp_f32 v202, v42
  v_add_f32 v210, v210, v201
  v_cvt_pk_bf16_f32 v88, v200, v201
  v_exp_f32 v203, v43
  v_add_f32 v210, v210, v202
  v_exp_f32 v204, v44
  v_add_f32 v210, v210, v203
  v_cvt_pk_bf16_f32 v89, v202, v203
  v_exp_f32 v205, v45
  v_add_f32 v210, v210, v204
  v_exp_f32 v206, v46
  v_add_f32 v210, v210, v205
  v_cvt_pk_bf16_f32 v90, v204, v205
  v_exp_f32 v207, v47
  v_add_f32 v210, v210, v206
  v_exp_f32 v200, v48
  v_add_f32 v210, v210, v207
  v_cvt_pk_bf16_f32 v91, v206, v207
  v_exp_f32 v201, v49
  v_add_f32 v210, v210, v200
  v_exp_f32 v202, v50
  v_add_f32 v210, v210, v201
  v_cvt_pk_bf16_f32 v92, v200, v201
  v_exp_f32 v203, v51
  v_add_f32 v210, v210, v202
  v_exp_f32 v204, v52
  v_add_f32 v210, v210, v203
  v_cvt_pk_bf16_f32 v93, v202, v203
  v_exp_f32 v205, v53
  v_add_f32 v210, v210, v204
  v_exp_f32 v206, v54
  v_add_f32 v210, v210, v205
  v_cvt_pk_bf16_f32 v94, v204, v205
  v_exp_f32 v207, v55
  v_add_f32 v210, v210, v206
  v_exp_f32 v200, v56
  v_add_f32 v210, v210, v207
  v_cvt_pk_bf16_f32 v95, v206, v207
  v_exp_f32 v201, v57
  v_add_f32 v211, v209, v200
  v_exp_f32 v202, v58
  v_add_f32 v211, v211, v201
  v_cvt_pk_bf16_f32 v96, v200, v201
  v_exp_f32 v203, v59
  v_add_f32 v211, v211, v202
  v_exp_f32 v204, v60
  v_add_f32 v211, v211, v203
  v_cvt_pk_bf16_f32 v97, v202, v203
  v_exp_f32 v205, v61
  v_add_f32 v211, v211, v204
  v_exp_f32 v206, v62
  v_add_f32 v211, v211, v205
  v_cvt_pk_bf16_f32 v98, v204, v205
  v_exp_f32 v207, v63
  v_add_f32 v211, v211, v206
  v_exp_f32 v200, v64
  v_add_f32 v211, v211, v207
  v_cvt_pk_bf16_f32 v99, v206, v207
  v_exp_f32 v201, v65
  v_add_f32 v211, v211, v200
  v_exp_f32 v202, v66
  v_add_f32 v211, v211, v201
  v_cvt_pk_bf16_f32 v100, v200, v201
  v_exp_f32 v203, v67
  v_add_f32 v211, v211, v202
  v_exp_f32 v204, v68
  v_add_f32 v211, v211, v203
  v_cvt_pk_bf16_f32 v101, v202, v203
  v_exp_f32 v205, v69
  v_add_f32 v211, v211, v204
  v_exp_f32 v206, v70
  v_add_f32 v211, v211, v205
  v_cvt_pk_bf16_f32 v102, v204, v205
  v_exp_f32 v207, v71
  v_add_f32 v211, v211, v206
  v_add_f32 v211, v211, v207
  v_cvt_pk_bf16_f32 v103, v206, v207
  s_branch k2_ret21
k2_fb22:
  v_max3_f32 v212, v8, v9, v10
  v_max3_f32 v212, v212, v11, v12
  v_max3_f32 v212, v212, v13, v14
  v_max3_f32 v212, v212, v15, v16
  v_max3_f32 v212, v212, v17, v18
  v_max3_f32 v212, v212, v19, v20
  v_max3_f32 v212, v212, v21, v22
  v_max_f32 v212, v212, v23
  v_mov_b32 v213, v212
  s_nop 1
  v_permlane32_swap_b32 v212, v213
  v_max_f32 v212, v212, v213
  v_max_f32 v212, 0, v212
  v_sub_f32 v104, v104, v212
  v_sub_f32 v105, v105, v212
  v_sub_f32 v106, v106, v212
  v_sub_f32 v107, v107, v212
  v_sub_f32 v108, v108, v212
  v_sub_f32 v109, v109, v212
  v_sub_f32 v110, v110, v212
  v_sub_f32 v111, v111, v212
  v_sub_f32 v112, v112, v212
  v_sub_f32 v113, v113, v212
  v_sub_f32 v114, v114, v212
  v_sub_f32 v115, v115, v212
  v_sub_f32 v116, v116, v212
  v_sub_f32 v117, v117, v212
  v_sub_f32 v118, v118, v212
  v_sub_f32 v119, v119, v212
  v_sub_f32 v8, v8, v212
  v_sub_f32 v9, v9, v212
  v_sub_f32 v10, v10, v212
  v_sub_f32 v11, v11, v212
  v_sub_f32 v12, v12, v212
  v_sub_f32 v13, v13, v212
  v_sub_f32 v14, v14, v212
  v_sub_f32 v15, v15, v212
  v_sub_f32 v16, v16, v212
  v_sub_f32 v17, v17, v212
  v_sub_f32 v18, v18, v212
  v_sub_f32 v19, v19, v212
  v_sub_f32 v20, v20, v212
  v_sub_f32 v21, v21, v212
  v_sub_f32 v22, v22, v212
  v_sub_f32 v23, v23, v212
  v_sub_f32 v40, v40, v212
  v_sub_f32 v41, v41, v212
  v_sub_f32 v42, v42, v212
  v_sub_f32 v43, v43, v212
  v_sub_f32 v44, v44, v212
  v_sub_f32 v45, v45, v212
  v_sub_f32 v46, v46, v212
  v_sub_f32 v47, v47, v212
  v_sub_f32 v48, v48, v212
  v_sub_f32 v49, v49, v212
  v_sub_f32 v50, v50, v212
  v_sub_f32 v51, v51, v212
  v_sub_f32 v52, v52, v212
  v_sub_f32 v53, v53, v212
  v_sub_f32 v54, v54, v212
  v_sub_f32 v55, v55, v212
  v_sub_f32 v214, 0, v212
  v_exp_f32 v214, v214
  s_nop 0
  v_mul_f32 v210, v210, v214
  v_accvgpr_read_b32 v213, a0
  v_mul_f32 v213, v213, v214
  v_accvgpr_write_b32 a0, v213
  v_accvgpr_read_b32 v213, a1
  v_mul_f32 v213, v213, v214
  v_accvgpr_write_b32 a1, v213
  v_accvgpr_read_b32 v213, a2
  v_mul_f32 v213, v213, v214
  v_accvgpr_write_b32 a2, v213
  v_accvgpr_read_b32 v213, a3
  v_mul_f32 v213, v213, v214
  v_accvgpr_write_b32 a3, v213
  v_accvgpr_read_b32 v213, a4
  v_mul_f32 v213, v213, v214
  v_accvgpr_write_b32 a4, v213
  v_accvgpr_read_b32 v213, a5
  v_mul_f32 v213, v213, v214
  v_accvgpr_write_b32 a5, v213
  v_accvgpr_read_b32 v213, a6
  v_mul_f32 v213, v213, v214
  v_accvgpr_write_b32 a6, v213
  v_accvgpr_read_b32 v213, a7
  v_mul_f32 v213, v213, v214
  v_accvgpr_write_b32 a7, v213
  v_accvgpr_read_b32 v213, a8
  v_mul_f32 v213, v213, v214
  v_accvgpr_write_b32 a8, v213
  v_accvgpr_read_b32 v213, a9
  v_mul_f32 v213, v213, v214
  v_accvgpr_write_b32 a9, v213
  v_accvgpr_read_b32 v213, a10
  v_mul_f32 v213, v213, v214
  v_accvgpr_write_b32 a10, v213
  v_accvgpr_read_b32 v213, a11
  v_mul_f32 v213, v213, v214
  v_accvgpr_write_b32 a11, v213
  v_accvgpr_read_b32 v213, a12
  v_mul_f32 v213, v213, v214
  v_accvgpr_write_b32 a12, v213
  v_accvgpr_read_b32 v213, a13
  v_mul_f32 v213, v213, v214
  v_accvgpr_write_b32 a13, v213
  v_accvgpr_read_b32 v213, a14
  v_mul_f32 v213, v213, v214
  v_accvgpr_write_b32 a14, v213
  v_accvgpr_read_b32 v213, a15
  v_mul_f32 v213, v213, v214
  v_accvgpr_write_b32 a15, v213
  v_accvgpr_read_b32 v213, a32
  v_mul_f32 v213, v213, v214
  v_accvgpr_write_b32 a32, v213
  v_accvgpr_read_b32 v213, a33
  v_mul_f32 v213, v213, v214
  v_accvgpr_write_b32 a33, v213
  v_accvgpr_read_b32 v213, a34
  v_mul_f32 v213, v213, v214
  v_accvgpr_write_b32 a34, v213
  v_accvgpr_read_b32 v213, a35
  v_mul_f32 v213, v213, v214
  v_accvgpr_write_b32 a35, v213
  v_accvgpr_read_b32 v213, a36
  v_mul_f32 v213, v213, v214
  v_accvgpr_write_b32 a36, v213
  v_accvgpr_read_b32 v213, a37
  v_mul_f32 v213, v213, v214
  v_accvgpr_write_b32 a37, v213
  v_accvgpr_read_b32 v213, a38
  v_mul_f32 v213, v213, v214
  v_accvgpr_write_b32 a38, v213
  v_accvgpr_read_b32 v213, a39
  v_mul_f32 v213, v213, v214
  v_accvgpr_write_b32 a39, v213
  v_accvgpr_read_b32 v213, a40
  v_mul_f32 v213, v213, v214
  v_accvgpr_write_b32 a40, v213
  v_accvgpr_read_b32 v213, a41
  v_mul_f32 v213, v213, v214
  v_accvgpr_write_b32 a41, v213
  v_accvgpr_read_b32 v213, a42
  v_mul_f32 v213, v213, v214
  v_accvgpr_write_b32 a42, v213
  v_accvgpr_read_b32 v213, a43
  v_mul_f32 v213, v213, v214
  v_accvgpr_write_b32 a43, v213
  v_accvgpr_read_b32 v213, a44
  v_mul_f32 v213, v213, v214
  v_accvgpr_write_b32 a44, v213
  v_accvgpr_read_b32 v213, a45
  v_mul_f32 v213, v213, v214
  v_accvgpr_write_b32 a45, v213
  v_accvgpr_read_b32 v213, a46
  v_mul_f32 v213, v213, v214
  v_accvgpr_write_b32 a46, v213
  v_accvgpr_read_b32 v213, a47
  v_mul_f32 v213, v213, v214
  v_accvgpr_write_b32 a47, v213
  v_accvgpr_read_b32 v213, a64
  v_mul_f32 v213, v213, v214
  v_accvgpr_write_b32 a64, v213
  v_accvgpr_read_b32 v213, a65
  v_mul_f32 v213, v213, v214
  v_accvgpr_write_b32 a65, v213
  v_accvgpr_read_b32 v213, a66
  v_mul_f32 v213, v213, v214
  v_accvgpr_write_b32 a66, v213
  v_accvgpr_read_b32 v213, a67
  v_mul_f32 v213, v213, v214
  v_accvgpr_write_b32 a67, v213
  v_accvgpr_read_b32 v213, a68
  v_mul_f32 v213, v213, v214
  v_accvgpr_write_b32 a68, v213
  v_accvgpr_read_b32 v213, a69
  v_mul_f32 v213, v213, v214
  v_accvgpr_write_b32 a69, v213
  v_accvgpr_read_b32 v213, a70
  v_mul_f32 v213, v213, v214
  v_accvgpr_write_b32 a70, v213
  v_accvgpr_read_b32 v213, a71
  v_mul_f32 v213, v213, v214
  v_accvgpr_write_b32 a71, v213
  v_accvgpr_read_b32 v213, a72
  v_mul_f32 v213, v213, v214
  v_accvgpr_write_b32 a72, v213
  v_accvgpr_read_b32 v213, a73
  v_mul_f32 v213, v213, v214
  v_accvgpr_write_b32 a73, v213
  v_accvgpr_read_b32 v213, a74
  v_mul_f32 v213, v213, v214
  v_accvgpr_write_b32 a74, v213
  v_accvgpr_read_b32 v213, a75
  v_mul_f32 v213, v213, v214
  v_accvgpr_write_b32 a75, v213
  v_accvgpr_read_b32 v213, a76
  v_mul_f32 v213, v213, v214
  v_accvgpr_write_b32 a76, v213
  v_accvgpr_read_b32 v213, a77
  v_mul_f32 v213, v213, v214
  v_accvgpr_write_b32 a77, v213
  v_accvgpr_read_b32 v213, a78
  v_mul_f32 v213, v213, v214
  v_accvgpr_write_b32 a78, v213
  v_accvgpr_read_b32 v213, a79
  v_mul_f32 v213, v213, v214
  v_accvgpr_write_b32 a79, v213
  v_accvgpr_read_b32 v213, a96
  v_mul_f32 v213, v213, v214
  v_accvgpr_write_b32 a96, v213
  v_accvgpr_read_b32 v213, a97
  v_mul_f32 v213, v213, v214
  v_accvgpr_write_b32 a97, v213
  v_accvgpr_read_b32 v213, a98
  v_mul_f32 v213, v213, v214
  v_accvgpr_write_b32 a98, v213
  v_accvgpr_read_b32 v213, a99
  v_mul_f32 v213, v213, v214
  v_accvgpr_write_b32 a99, v213
  v_accvgpr_read_b32 v213, a100
  v_mul_f32 v213, v213, v214
  v_accvgpr_write_b32 a100, v213
  v_accvgpr_read_b32 v213, a101
  v_mul_f32 v213, v213, v214
  v_accvgpr_write_b32 a101, v213
  v_accvgpr_read_b32 v213, a102
  v_mul_f32 v213, v213, v214
  v_accvgpr_write_b32 a102, v213
  v_accvgpr_read_b32 v213, a103
  v_mul_f32 v213, v213, v214
  v_accvgpr_write_b32 a103, v213
  v_accvgpr_read_b32 v213, a104
  v_mul_f32 v213, v213, v214
  v_accvgpr_write_b32 a104, v213
  v_accvgpr_read_b32 v213, a105
  v_mul_f32 v213, v213, v214
  v_accvgpr_write_b32 a105, v213
  v_accvgpr_read_b32 v213, a106
  v_mul_f32 v213, v213, v214
  v_accvgpr_write_b32 a106, v213
  v_accvgpr_read_b32 v213, a107
  v_mul_f32 v213, v213, v214
  v_accvgpr_write_b32 a107, v213
  v_accvgpr_read_b32 v213, a108
  v_mul_f32 v213, v213, v214
  v_accvgpr_write_b32 a108, v213
  v_accvgpr_read_b32 v213, a109
  v_mul_f32 v213, v213, v214
  v_accvgpr_write_b32 a109, v213
  v_accvgpr_read_b32 v213, a110
  v_mul_f32 v213, v213, v214
  v_accvgpr_write_b32 a110, v213
  v_accvgpr_read_b32 v213, a111
  v_mul_f32 v213, v213, v214
  v_accvgpr_write_b32 a111, v213
  v_max3_f32 v212, v24, v25, v26
  v_max3_f32 v212, v212, v27, v28
  v_max3_f32 v212, v212, v29, v30
  v_max3_f32 v212, v212, v31, v32
  v_max3_f32 v212, v212, v33, v34
  v_max3_f32 v212, v212, v35, v36
  v_max3_f32 v212, v212, v37, v38
  v_max_f32 v212, v212, v39
  v_mov_b32 v213, v212
  s_nop 1
  v_permlane32_swap_b32 v212, v213
  v_max_f32 v212, v212, v213
  v_max_f32 v212, 0, v212
  v_sub_f32 v120, v120, v212
  v_sub_f32 v121, v121, v212
  v_sub_f32 v122, v122, v212
  v_sub_f32 v123, v123, v212
  v_sub_f32 v124, v124, v212
  v_sub_f32 v125, v125, v212
  v_sub_f32 v126, v126, v212
  v_sub_f32 v127, v127, v212
  v_sub_f32 v128, v128, v212
  v_sub_f32 v129, v129, v212
  v_sub_f32 v130, v130, v212
  v_sub_f32 v131, v131, v212
  v_sub_f32 v132, v132, v212
  v_sub_f32 v133, v133, v212
  v_sub_f32 v134, v134, v212
  v_sub_f32 v135, v135, v212
  v_sub_f32 v24, v24, v212
  v_sub_f32 v25, v25, v212
  v_sub_f32 v26, v26, v212
  v_sub_f32 v27, v27, v212
  v_sub_f32 v28, v28, v212
  v_sub_f32 v29, v29, v212
  v_sub_f32 v30, v30, v212
  v_sub_f32 v31, v31, v212
  v_sub_f32 v32, v32, v212
  v_sub_f32 v33, v33, v212
  v_sub_f32 v34, v34, v212
  v_sub_f32 v35, v35, v212
  v_sub_f32 v36, v36, v212
  v_sub_f32 v37, v37, v212
  v_sub_f32 v38, v38, v212
  v_sub_f32 v39, v39, v212
  v_sub_f32 v56, v56, v212
  v_sub_f32 v57, v57, v212
  v_sub_f32 v58, v58, v212
  v_sub_f32 v59, v59, v212
  v_sub_f32 v60, v60, v212
  v_sub_f32 v61, v61, v212
  v_sub_f32 v62, v62, v212
  v_sub_f32 v63, v63, v212
  v_sub_f32 v64, v64, v212
  v_sub_f32 v65, v65, v212
  v_sub_f32 v66, v66, v212
  v_sub_f32 v67, v67, v212
  v_sub_f32 v68, v68, v212
  v_sub_f32 v69, v69, v212
  v_sub_f32 v70, v70, v212
  v_sub_f32 v71, v71, v212
  v_sub_f32 v214, 0, v212
  v_exp_f32 v214, v214
  s_nop 0
  v_mul_f32 v211, v211, v214
  v_accvgpr_read_b32 v213, a16
  v_mul_f32 v213, v213, v214
  v_accvgpr_write_b32 a16, v213
  v_accvgpr_read_b32 v213, a17
  v_mul_f32 v213, v213, v214
  v_accvgpr_write_b32 a17, v213
  v_accvgpr_read_b32 v213, a18
  v_mul_f32 v213, v213, v214
  v_accvgpr_write_b32 a18, v213
  v_accvgpr_read_b32 v213, a19
  v_mul_f32 v213, v213, v214
  v_accvgpr_write_b32 a19, v213
  v_accvgpr_read_b32 v213, a20
  v_mul_f32 v213, v213, v214
  v_accvgpr_write_b32 a20, v213
  v_accvgpr_read_b32 v213, a21
  v_mul_f32 v213, v213, v214
  v_accvgpr_write_b32 a21, v213
  v_accvgpr_read_b32 v213, a22
  v_mul_f32 v213, v213, v214
  v_accvgpr_write_b32 a22, v213
  v_accvgpr_read_b32 v213, a23
  v_mul_f32 v213, v213, v214
  v_accvgpr_write_b32 a23, v213
  v_accvgpr_read_b32 v213, a24
  v_mul_f32 v213, v213, v214
  v_accvgpr_write_b32 a24, v213
  v_accvgpr_read_b32 v213, a25
  v_mul_f32 v213, v213, v214
  v_accvgpr_write_b32 a25, v213
  v_accvgpr_read_b32 v213, a26
  v_mul_f32 v213, v213, v214
  v_accvgpr_write_b32 a26, v213
  v_accvgpr_read_b32 v213, a27
  v_mul_f32 v213, v213, v214
  v_accvgpr_write_b32 a27, v213
  v_accvgpr_read_b32 v213, a28
  v_mul_f32 v213, v213, v214
  v_accvgpr_write_b32 a28, v213
  v_accvgpr_read_b32 v213, a29
  v_mul_f32 v213, v213, v214
  v_accvgpr_write_b32 a29, v213
  v_accvgpr_read_b32 v213, a30
  v_mul_f32 v213, v213, v214
  v_accvgpr_write_b32 a30, v213
  v_accvgpr_read_b32 v213, a31
  v_mul_f32 v213, v213, v214
  v_accvgpr_write_b32 a31, v213
  v_accvgpr_read_b32 v213, a48
  v_mul_f32 v213, v213, v214
  v_accvgpr_write_b32 a48, v213
  v_accvgpr_read_b32 v213, a49
  v_mul_f32 v213, v213, v214
  v_accvgpr_write_b32 a49, v213
  v_accvgpr_read_b32 v213, a50
  v_mul_f32 v213, v213, v214
  v_accvgpr_write_b32 a50, v213
  v_accvgpr_read_b32 v213, a51
  v_mul_f32 v213, v213, v214
  v_accvgpr_write_b32 a51, v213
  v_accvgpr_read_b32 v213, a52
  v_mul_f32 v213, v213, v214
  v_accvgpr_write_b32 a52, v213
  v_accvgpr_read_b32 v213, a53
  v_mul_f32 v213, v213, v214
  v_accvgpr_write_b32 a53, v213
  v_accvgpr_read_b32 v213, a54
  v_mul_f32 v213, v213, v214
  v_accvgpr_write_b32 a54, v213
  v_accvgpr_read_b32 v213, a55
  v_mul_f32 v213, v213, v214
  v_accvgpr_write_b32 a55, v213
  v_accvgpr_read_b32 v213, a56
  v_mul_f32 v213, v213, v214
  v_accvgpr_write_b32 a56, v213
  v_accvgpr_read_b32 v213, a57
  v_mul_f32 v213, v213, v214
  v_accvgpr_write_b32 a57, v213
  v_accvgpr_read_b32 v213, a58
  v_mul_f32 v213, v213, v214
  v_accvgpr_write_b32 a58, v213
  v_accvgpr_read_b32 v213, a59
  v_mul_f32 v213, v213, v214
  v_accvgpr_write_b32 a59, v213
  v_accvgpr_read_b32 v213, a60
  v_mul_f32 v213, v213, v214
  v_accvgpr_write_b32 a60, v213
  v_accvgpr_read_b32 v213, a61
  v_mul_f32 v213, v213, v214
  v_accvgpr_write_b32 a61, v213
  v_accvgpr_read_b32 v213, a62
  v_mul_f32 v213, v213, v214
  v_accvgpr_write_b32 a62, v213
  v_accvgpr_read_b32 v213, a63
  v_mul_f32 v213, v213, v214
  v_accvgpr_write_b32 a63, v213
  v_accvgpr_read_b32 v213, a80
  v_mul_f32 v213, v213, v214
  v_accvgpr_write_b32 a80, v213
  v_accvgpr_read_b32 v213, a81
  v_mul_f32 v213, v213, v214
  v_accvgpr_write_b32 a81, v213
  v_accvgpr_read_b32 v213, a82
  v_mul_f32 v213, v213, v214
  v_accvgpr_write_b32 a82, v213
  v_accvgpr_read_b32 v213, a83
  v_mul_f32 v213, v213, v214
  v_accvgpr_write_b32 a83, v213
  v_accvgpr_read_b32 v213, a84
  v_mul_f32 v213, v213, v214
  v_accvgpr_write_b32 a84, v213
  v_accvgpr_read_b32 v213, a85
  v_mul_f32 v213, v213, v214
  v_accvgpr_write_b32 a85, v213
  v_accvgpr_read_b32 v213, a86
  v_mul_f32 v213, v213, v214
  v_accvgpr_write_b32 a86, v213
  v_accvgpr_read_b32 v213, a87
  v_mul_f32 v213, v213, v214
  v_accvgpr_write_b32 a87, v213
  v_accvgpr_read_b32 v213, a88
  v_mul_f32 v213, v213, v214
  v_accvgpr_write_b32 a88, v213
  v_accvgpr_read_b32 v213, a89
  v_mul_f32 v213, v213, v214
  v_accvgpr_write_b32 a89, v213
  v_accvgpr_read_b32 v213, a90
  v_mul_f32 v213, v213, v214
  v_accvgpr_write_b32 a90, v213
  v_accvgpr_read_b32 v213, a91
  v_mul_f32 v213, v213, v214
  v_accvgpr_write_b32 a91, v213
  v_accvgpr_read_b32 v213, a92
  v_mul_f32 v213, v213, v214
  v_accvgpr_write_b32 a92, v213
  v_accvgpr_read_b32 v213, a93
  v_mul_f32 v213, v213, v214
  v_accvgpr_write_b32 a93, v213
  v_accvgpr_read_b32 v213, a94
  v_mul_f32 v213, v213, v214
  v_accvgpr_write_b32 a94, v213
  v_accvgpr_read_b32 v213, a95
  v_mul_f32 v213, v213, v214
  v_accvgpr_write_b32 a95, v213
  v_accvgpr_read_b32 v213, a112
  v_mul_f32 v213, v213, v214
  v_accvgpr_write_b32 a112, v213
  v_accvgpr_read_b32 v213, a113
  v_mul_f32 v213, v213, v214
  v_accvgpr_write_b32 a113, v213
  v_accvgpr_read_b32 v213, a114
  v_mul_f32 v213, v213, v214
  v_accvgpr_write_b32 a114, v213
  v_accvgpr_read_b32 v213, a115
  v_mul_f32 v213, v213, v214
  v_accvgpr_write_b32 a115, v213
  v_accvgpr_read_b32 v213, a116
  v_mul_f32 v213, v213, v214
  v_accvgpr_write_b32 a116, v213
  v_accvgpr_read_b32 v213, a117
  v_mul_f32 v213, v213, v214
  v_accvgpr_write_b32 a117, v213
  v_accvgpr_read_b32 v213, a118
  v_mul_f32 v213, v213, v214
  v_accvgpr_write_b32 a118, v213
  v_accvgpr_read_b32 v213, a119
  v_mul_f32 v213, v213, v214
  v_accvgpr_write_b32 a119, v213
  v_accvgpr_read_b32 v213, a120
  v_mul_f32 v213, v213, v214
  v_accvgpr_write_b32 a120, v213
  v_accvgpr_read_b32 v213, a121
  v_mul_f32 v213, v213, v214
  v_accvgpr_write_b32 a121, v213
  v_accvgpr_read_b32 v213, a122
  v_mul_f32 v213, v213, v214
  v_accvgpr_write_b32 a122, v213
  v_accvgpr_read_b32 v213, a123
  v_mul_f32 v213, v213, v214
  v_accvgpr_write_b32 a123, v213
  v_accvgpr_read_b32 v213, a124
  v_mul_f32 v213, v213, v214
  v_accvgpr_write_b32 a124, v213
  v_accvgpr_read_b32 v213, a125
  v_mul_f32 v213, v213, v214
  v_accvgpr_write_b32 a125, v213
  v_accvgpr_read_b32 v213, a126
  v_mul_f32 v213, v213, v214
  v_accvgpr_write_b32 a126, v213
  v_accvgpr_read_b32 v213, a127
  v_mul_f32 v213, v213, v214
  v_accvgpr_write_b32 a127, v213
  v_exp_f32 v200, v8
  v_exp_f32 v201, v9
  v_add_f32 v208, v210, v200
  v_exp_f32 v202, v10
  v_add_f32 v208, v208, v201
  v_cvt_pk_bf16_f32 v72, v200, v201
  v_exp_f32 v203, v11
  v_add_f32 v208, v208, v202
  v_exp_f32 v204, v12
  v_add_f32 v208, v208, v203
  v_cvt_pk_bf16_f32 v73, v202, v203
  v_exp_f32 v205, v13
  v_add_f32 v208, v208, v204
  v_exp_f32 v206, v14
  v_add_f32 v208, v208, v205
  v_cvt_pk_bf16_f32 v74, v204, v205
  v_exp_f32 v207, v15
  v_add_f32 v208, v208, v206
  v_exp_f32 v200, v16
  v_add_f32 v208, v208, v207
  v_cvt_pk_bf16_f32 v75, v206, v207
  v_exp_f32 v201, v17
  v_add_f32 v208, v208, v200
  v_exp_f32 v202, v18
  v_add_f32 v208, v208, v201
  v_cvt_pk_bf16_f32 v76, v200, v201
  v_exp_f32 v203, v19
  v_add_f32 v208, v208, v202
  v_exp_f32 v204, v20
  v_add_f32 v208, v208, v203
  v_cvt_pk_bf16_f32 v77, v202, v203
  v_exp_f32 v205, v21
  v_add_f32 v208, v208, v204
  v_exp_f32 v206, v22
  v_add_f32 v208, v208, v205
  v_cvt_pk_bf16_f32 v78, v204, v205
  v_exp_f32 v207, v23
  v_add_f32 v208, v208, v206
  v_exp_f32 v200, v24
  v_add_f32 v208, v208, v207
  v_cvt_pk_bf16_f32 v79, v206, v207
  v_exp_f32 v201, v25
  v_add_f32 v209, v211, v200
  v_exp_f32 v202, v26
  v_add_f32 v209, v209, v201
  v_cvt_pk_bf16_f32 v80, v200, v201
  v_exp_f32 v203, v27
  v_add_f32 v209, v209, v202
  v_exp_f32 v204, v28
  v_add_f32 v209, v209, v203
  v_cvt_pk_bf16_f32 v81, v202, v203
  v_exp_f32 v205, v29
  v_add_f32 v209, v209, v204
  v_exp_f32 v206, v30
  v_add_f32 v209, v209, v205
  v_cvt_pk_bf16_f32 v82, v204, v205
  v_exp_f32 v207, v31
  v_add_f32 v209, v209, v206
  v_exp_f32 v200, v32
  v_add_f32 v209, v209, v207
  v_cvt_pk_bf16_f32 v83, v206, v207
  v_exp_f32 v201, v33
  v_add_f32 v209, v209, v200
  v_exp_f32 v202, v34
  v_add_f32 v209, v209, v201
  v_cvt_pk_bf16_f32 v84, v200, v201
  v_exp_f32 v203, v35
  v_add_f32 v209, v209, v202
  v_exp_f32 v204, v36
  v_add_f32 v209, v209, v203
  v_cvt_pk_bf16_f32 v85, v202, v203
  v_exp_f32 v205, v37
  v_add_f32 v209, v209, v204
  v_exp_f32 v206, v38
  v_add_f32 v209, v209, v205
  v_cvt_pk_bf16_f32 v86, v204, v205
  v_exp_f32 v207, v39
  v_add_f32 v209, v209, v206
  v_add_f32 v209, v209, v207
  v_cvt_pk_bf16_f32 v87, v206, v207
  s_branch k2_ret23
k2_fb24:
  v_max3_f32 v212, v40, v41, v42
  v_max3_f32 v212, v212, v43, v44
  v_max3_f32 v212, v212, v45, v46
  v_max3_f32 v212, v212, v47, v48
  v_max3_f32 v212, v212, v49, v50
  v_max3_f32 v212, v212, v51, v52
  v_max3_f32 v212, v212, v53, v54
  v_max_f32 v212, v212, v55
  v_mov_b32 v213, v212
  s_nop 1
  v_permlane32_swap_b32 v212, v213
  v_max_f32 v212, v212, v213
  v_max_f32 v212, 0, v212
  v_sub_f32 v104, v104, v212
  v_sub_f32 v105, v105, v212
  v_sub_f32 v106, v106, v212
  v_sub_f32 v107, v107, v212
  v_sub_f32 v108, v108, v212
  v_sub_f32 v109, v109, v212
  v_sub_f32 v110, v110, v212
  v_sub_f32 v111, v111, v212
  v_sub_f32 v112, v112, v212
  v_sub_f32 v113, v113, v212
  v_sub_f32 v114, v114, v212
  v_sub_f32 v115, v115, v212
  v_sub_f32 v116, v116, v212
  v_sub_f32 v117, v117, v212
  v_sub_f32 v118, v118, v212
  v_sub_f32 v119, v119, v212
  v_sub_f32 v40, v40, v212
  v_sub_f32 v41, v41, v212
  v_sub_f32 v42, v42, v212
  v_sub_f32 v43, v43, v212
  v_sub_f32 v44, v44, v212
  v_sub_f32 v45, v45, v212
  v_sub_f32 v46, v46, v212
  v_sub_f32 v47, v47, v212
  v_sub_f32 v48, v48, v212
  v_sub_f32 v49, v49, v212
  v_sub_f32 v50, v50, v212
  v_sub_f32 v51, v51, v212
  v_sub_f32 v52, v52, v212
  v_sub_f32 v53, v53, v212
  v_sub_f32 v54, v54, v212
  v_sub_f32 v55, v55, v212
  v_sub_f32 v8, v8, v212
  v_sub_f32 v9, v9, v212
  v_sub_f32 v10, v10, v212
  v_sub_f32 v11, v11, v212
  v_sub_f32 v12, v12, v212
  v_sub_f32 v13, v13, v212
  v_sub_f32 v14, v14, v212
  v_sub_f32 v15, v15, v212
  v_sub_f32 v16, v16, v212
  v_sub_f32 v17, v17, v212
  v_sub_f32 v18, v18, v212
  v_sub_f32 v19, v19, v212
  v_sub_f32 v20, v20, v212
  v_sub_f32 v21, v21, v212
  v_sub_f32 v22, v22, v212
  v_sub_f32 v23, v23, v212
  v_sub_f32 v214, 0, v212
  v_exp_f32 v214, v214
  s_nop 0
  v_mul_f32 v208, v208, v214
  v_accvgpr_read_b32 v213, a0
  v_mul_f32 v213, v213, v214
  v_accvgpr_write_b32 a0, v213
  v_accvgpr_read_b32 v213, a1
  v_mul_f32 v213, v213, v214
  v_accvgpr_write_b32 a1, v213
  v_accvgpr_read_b32 v213, a2
  v_mul_f32 v213, v213, v214
  v_accvgpr_write_b32 a2, v213
  v_accvgpr_read_b32 v213, a3
  v_mul_f32 v213, v213, v214
  v_accvgpr_write_b32 a3, v213
  v_accvgpr_read_b32 v213, a4
  v_mul_f32 v213, v213, v214
  v_accvgpr_write_b32 a4, v213
  v_accvgpr_read_b32 v213, a5
  v_mul_f32 v213, v213, v214
  v_accvgpr_write_b32 a5, v213
  v_accvgpr_read_b32 v213, a6
  v_mul_f32 v213, v213, v214
  v_accvgpr_write_b32 a6, v213
  v_accvgpr_read_b32 v213, a7
  v_mul_f32 v213, v213, v214
  v_accvgpr_write_b32 a7, v213
  v_accvgpr_read_b32 v213, a8
  v_mul_f32 v213, v213, v214
  v_accvgpr_write_b32 a8, v213
  v_accvgpr_read_b32 v213, a9
  v_mul_f32 v213, v213, v214
  v_accvgpr_write_b32 a9, v213
  v_accvgpr_read_b32 v213, a10
  v_mul_f32 v213, v213, v214
  v_accvgpr_write_b32 a10, v213
  v_accvgpr_read_b32 v213, a11
  v_mul_f32 v213, v213, v214
  v_accvgpr_write_b32 a11, v213
  v_accvgpr_read_b32 v213, a12
  v_mul_f32 v213, v213, v214
  v_accvgpr_write_b32 a12, v213
  v_accvgpr_read_b32 v213, a13
  v_mul_f32 v213, v213, v214
  v_accvgpr_write_b32 a13, v213
  v_accvgpr_read_b32 v213, a14
  v_mul_f32 v213, v213, v214
  v_accvgpr_write_b32 a14, v213
  v_accvgpr_read_b32 v213, a15
  v_mul_f32 v213, v213, v214
  v_accvgpr_write_b32 a15, v213
  v_accvgpr_read_b32 v213, a32
  v_mul_f32 v213, v213, v214
  v_accvgpr_write_b32 a32, v213
  v_accvgpr_read_b32 v213, a33
  v_mul_f32 v213, v213, v214
  v_accvgpr_write_b32 a33, v213
  v_accvgpr_read_b32 v213, a34
  v_mul_f32 v213, v213, v214
  v_accvgpr_write_b32 a34, v213
  v_accvgpr_read_b32 v213, a35
  v_mul_f32 v213, v213, v214
  v_accvgpr_write_b32 a35, v213
  v_accvgpr_read_b32 v213, a36
  v_mul_f32 v213, v213, v214
  v_accvgpr_write_b32 a36, v213
  v_accvgpr_read_b32 v213, a37
  v_mul_f32 v213, v213, v214
  v_accvgpr_write_b32 a37, v213
  v_accvgpr_read_b32 v213, a38
  v_mul_f32 v213, v213, v214
  v_accvgpr_write_b32 a38, v213
  v_accvgpr_read_b32 v213, a39
  v_mul_f32 v213, v213, v214
  v_accvgpr_write_b32 a39, v213
  v_accvgpr_read_b32 v213, a40
  v_mul_f32 v213, v213, v214
  v_accvgpr_write_b32 a40, v213
  v_accvgpr_read_b32 v213, a41
  v_mul_f32 v213, v213, v214
  v_accvgpr_write_b32 a41, v213
  v_accvgpr_read_b32 v213, a42
  v_mul_f32 v213, v213, v214
  v_accvgpr_write_b32 a42, v213
  v_accvgpr_read_b32 v213, a43
  v_mul_f32 v213, v213, v214
  v_accvgpr_write_b32 a43, v213
  v_accvgpr_read_b32 v213, a44
  v_mul_f32 v213, v213, v214
  v_accvgpr_write_b32 a44, v213
  v_accvgpr_read_b32 v213, a45
  v_mul_f32 v213, v213, v214
  v_accvgpr_write_b32 a45, v213
  v_accvgpr_read_b32 v213, a46
  v_mul_f32 v213, v213, v214
  v_accvgpr_write_b32 a46, v213
  v_accvgpr_read_b32 v213, a47
  v_mul_f32 v213, v213, v214
  v_accvgpr_write_b32 a47, v213
  v_accvgpr_read_b32 v213, a64
  v_mul_f32 v213, v213, v214
  v_accvgpr_write_b32 a64, v213
  v_accvgpr_read_b32 v213, a65
  v_mul_f32 v213, v213, v214
  v_accvgpr_write_b32 a65, v213
  v_accvgpr_read_b32 v213, a66
  v_mul_f32 v213, v213, v214
  v_accvgpr_write_b32 a66, v213
  v_accvgpr_read_b32 v213, a67
  v_mul_f32 v213, v213, v214
  v_accvgpr_write_b32 a67, v213
  v_accvgpr_read_b32 v213, a68
  v_mul_f32 v213, v213, v214
  v_accvgpr_write_b32 a68, v213
  v_accvgpr_read_b32 v213, a69
  v_mul_f32 v213, v213, v214
  v_accvgpr_write_b32 a69, v213
  v_accvgpr_read_b32 v213, a70
  v_mul_f32 v213, v213, v214
  v_accvgpr_write_b32 a70, v213
  v_accvgpr_read_b32 v213, a71
  v_mul_f32 v213, v213, v214
  v_accvgpr_write_b32 a71, v213
  v_accvgpr_read_b32 v213, a72
  v_mul_f32 v213, v213, v214
  v_accvgpr_write_b32 a72, v213
  v_accvgpr_read_b32 v213, a73
  v_mul_f32 v213, v213, v214
  v_accvgpr_write_b32 a73, v213
  v_accvgpr_read_b32 v213, a74
  v_mul_f32 v213, v213, v214
  v_accvgpr_write_b32 a74, v213
  v_accvgpr_read_b32 v213, a75
  v_mul_f32 v213, v213, v214
  v_accvgpr_write_b32 a75, v213
  v_accvgpr_read_b32 v213, a76
  v_mul_f32 v213, v213, v214
  v_accvgpr_write_b32 a76, v213
  v_accvgpr_read_b32 v213, a77
  v_mul_f32 v213, v213, v214
  v_accvgpr_write_b32 a77, v213
  v_accvgpr_read_b32 v213, a78
  v_mul_f32 v213, v213, v214
  v_accvgpr_write_b32 a78, v213
  v_accvgpr_read_b32 v213, a79
  v_mul_f32 v213, v213, v214
  v_accvgpr_write_b32 a79, v213
  v_accvgpr_read_b32 v213, a96
  v_mul_f32 v213, v213, v214
  v_accvgpr_write_b32 a96, v213
  v_accvgpr_read_b32 v213, a97
  v_mul_f32 v213, v213, v214
  v_accvgpr_write_b32 a97, v213
  v_accvgpr_read_b32 v213, a98
  v_mul_f32 v213, v213, v214
  v_accvgpr_write_b32 a98, v213
  v_accvgpr_read_b32 v213, a99
  v_mul_f32 v213, v213, v214
  v_accvgpr_write_b32 a99, v213
  v_accvgpr_read_b32 v213, a100
  v_mul_f32 v213, v213, v214
  v_accvgpr_write_b32 a100, v213
  v_accvgpr_read_b32 v213, a101
  v_mul_f32 v213, v213, v214
  v_accvgpr_write_b32 a101, v213
  v_accvgpr_read_b32 v213, a102
  v_mul_f32 v213, v213, v214
  v_accvgpr_write_b32 a102, v213
  v_accvgpr_read_b32 v213, a103
  v_mul_f32 v213, v213, v214
  v_accvgpr_write_b32 a103, v213
  v_accvgpr_read_b32 v213, a104
  v_mul_f32 v213, v213, v214
  v_accvgpr_write_b32 a104, v213
  v_accvgpr_read_b32 v213, a105
  v_mul_f32 v213, v213, v214
  v_accvgpr_write_b32 a105, v213
  v_accvgpr_read_b32 v213, a106
  v_mul_f32 v213, v213, v214
  v_accvgpr_write_b32 a106, v213
  v_accvgpr_read_b32 v213, a107
  v_mul_f32 v213, v213, v214
  v_accvgpr_write_b32 a107, v213
  v_accvgpr_read_b32 v213, a108
  v_mul_f32 v213, v213, v214
  v_accvgpr_write_b32 a108, v213
  v_accvgpr_read_b32 v213, a109
  v_mul_f32 v213, v213, v214
  v_accvgpr_write_b32 a109, v213
  v_accvgpr_read_b32 v213, a110
  v_mul_f32 v213, v213, v214
  v_accvgpr_write_b32 a110, v213
  v_accvgpr_read_b32 v213, a111
  v_mul_f32 v213, v213, v214
  v_accvgpr_write_b32 a111, v213
  v_max3_f32 v212, v56, v57, v58
  v_max3_f32 v212, v212, v59, v60
  v_max3_f32 v212, v212, v61, v62
  v_max3_f32 v212, v212, v63, v64
  v_max3_f32 v212, v212, v65, v66
  v_max3_f32 v212, v212, v67, v68
  v_max3_f32 v212, v212, v69, v70
  v_max_f32 v212, v212, v71
  v_mov_b32 v213, v212
  s_nop 1
  v_permlane32_swap_b32 v212, v213
  v_max_f32 v212, v212, v213
  v_max_f32 v212, 0, v212
  v_sub_f32 v120, v120, v212
  v_sub_f32 v121, v121, v212
  v_sub_f32 v122, v122, v212
  v_sub_f32 v123, v123, v212
  v_sub_f32 v124, v124, v212
  v_sub_f32 v125, v125, v212
  v_sub_f32 v126, v126, v212
  v_sub_f32 v127, v127, v212
  v_sub_f32 v128, v128, v212
  v_sub_f32 v129, v129, v212
  v_sub_f32 v130, v130, v212
  v_sub_f32 v131, v131, v212
  v_sub_f32 v132, v132, v212
  v_sub_f32 v133, v133, v212
  v_sub_f32 v134, v134, v212
  v_sub_f32 v135, v135, v212
  v_sub_f32 v56, v56, v212
  v_sub_f32 v57, v57, v212
  v_sub_f32 v58, v58, v212
  v_sub_f32 v59, v59, v212
  v_sub_f32 v60, v60, v212
  v_sub_f32 v61, v61, v212
  v_sub_f32 v62, v62, v212
  v_sub_f32 v63, v63, v212
  v_sub_f32 v64, v64, v212
  v_sub_f32 v65, v65, v212
  v_sub_f32 v66, v66, v212
  v_sub_f32 v67, v67, v212
  v_sub_f32 v68, v68, v212
  v_sub_f32 v69, v69, v212
  v_sub_f32 v70, v70, v212
  v_sub_f32 v71, v71, v212
  v_sub_f32 v24, v24, v212
  v_sub_f32 v25, v25, v212
  v_sub_f32 v26, v26, v212
  v_sub_f32 v27, v27, v212
  v_sub_f32 v28, v28, v212
  v_sub_f32 v29, v29, v212
  v_sub_f32 v30, v30, v212
  v_sub_f32 v31, v31, v212
  v_sub_f32 v32, v32, v212
  v_sub_f32 v33, v33, v212
  v_sub_f32 v34, v34, v212
  v_sub_f32 v35, v35, v212
  v_sub_f32 v36, v36, v212
  v_sub_f32 v37, v37, v212
  v_sub_f32 v38, v38, v212
  v_sub_f32 v39, v39, v212
  v_sub_f32 v214, 0, v212
  v_exp_f32 v214, v214
  s_nop 0
  v_mul_f32 v209, v209, v214
  v_accvgpr_read_b32 v213, a16
  v_mul_f32 v213, v213, v214
  v_accvgpr_write_b32 a16, v213
  v_accvgpr_read_b32 v213, a17
  v_mul_f32 v213, v213, v214
  v_accvgpr_write_b32 a17, v213
  v_accvgpr_read_b32 v213, a18
  v_mul_f32 v213, v213, v214
  v_accvgpr_write_b32 a18, v213
  v_accvgpr_read_b32 v213, a19
  v_mul_f32 v213, v213, v214
  v_accvgpr_write_b32 a19, v213
  v_accvgpr_read_b32 v213, a20
  v_mul_f32 v213, v213, v214
  v_accvgpr_write_b32 a20, v213
  v_accvgpr_read_b32 v213, a21
  v_mul_f32 v213, v213, v214
  v_accvgpr_write_b32 a21, v213
  v_accvgpr_read_b32 v213, a22
  v_mul_f32 v213, v213, v214
  v_accvgpr_write_b32 a22, v213
  v_accvgpr_read_b32 v213, a23
  v_mul_f32 v213, v213, v214
  v_accvgpr_write_b32 a23, v213
  v_accvgpr_read_b32 v213, a24
  v_mul_f32 v213, v213, v214
  v_accvgpr_write_b32 a24, v213
  v_accvgpr_read_b32 v213, a25
  v_mul_f32 v213, v213, v214
  v_accvgpr_write_b32 a25, v213
  v_accvgpr_read_b32 v213, a26
  v_mul_f32 v213, v213, v214
  v_accvgpr_write_b32 a26, v213
  v_accvgpr_read_b32 v213, a27
  v_mul_f32 v213, v213, v214
  v_accvgpr_write_b32 a27, v213
  v_accvgpr_read_b32 v213, a28
  v_mul_f32 v213, v213, v214
  v_accvgpr_write_b32 a28, v213
  v_accvgpr_read_b32 v213, a29
  v_mul_f32 v213, v213, v214
  v_accvgpr_write_b32 a29, v213
  v_accvgpr_read_b32 v213, a30
  v_mul_f32 v213, v213, v214
  v_accvgpr_write_b32 a30, v213
  v_accvgpr_read_b32 v213, a31
  v_mul_f32 v213, v213, v214
  v_accvgpr_write_b32 a31, v213
  v_accvgpr_read_b32 v213, a48
  v_mul_f32 v213, v213, v214
  v_accvgpr_write_b32 a48, v213
  v_accvgpr_read_b32 v213, a49
  v_mul_f32 v213, v213, v214
  v_accvgpr_write_b32 a49, v213
  v_accvgpr_read_b32 v213, a50
  v_mul_f32 v213, v213, v214
  v_accvgpr_write_b32 a50, v213
  v_accvgpr_read_b32 v213, a51
  v_mul_f32 v213, v213, v214
  v_accvgpr_write_b32 a51, v213
  v_accvgpr_read_b32 v213, a52
  v_mul_f32 v213, v213, v214
  v_accvgpr_write_b32 a52, v213
  v_accvgpr_read_b32 v213, a53
  v_mul_f32 v213, v213, v214
  v_accvgpr_write_b32 a53, v213
  v_accvgpr_read_b32 v213, a54
  v_mul_f32 v213, v213, v214
  v_accvgpr_write_b32 a54, v213
  v_accvgpr_read_b32 v213, a55
  v_mul_f32 v213, v213, v214
  v_accvgpr_write_b32 a55, v213
  v_accvgpr_read_b32 v213, a56
  v_mul_f32 v213, v213, v214
  v_accvgpr_write_b32 a56, v213
  v_accvgpr_read_b32 v213, a57
  v_mul_f32 v213, v213, v214
  v_accvgpr_write_b32 a57, v213
  v_accvgpr_read_b32 v213, a58
  v_mul_f32 v213, v213, v214
  v_accvgpr_write_b32 a58, v213
  v_accvgpr_read_b32 v213, a59
  v_mul_f32 v213, v213, v214
  v_accvgpr_write_b32 a59, v213
  v_accvgpr_read_b32 v213, a60
  v_mul_f32 v213, v213, v214
  v_accvgpr_write_b32 a60, v213
  v_accvgpr_read_b32 v213, a61
  v_mul_f32 v213, v213, v214
  v_accvgpr_write_b32 a61, v213
  v_accvgpr_read_b32 v213, a62
  v_mul_f32 v213, v213, v214
  v_accvgpr_write_b32 a62, v213
  v_accvgpr_read_b32 v213, a63
  v_mul_f32 v213, v213, v214
  v_accvgpr_write_b32 a63, v213
  v_accvgpr_read_b32 v213, a80
  v_mul_f32 v213, v213, v214
  v_accvgpr_write_b32 a80, v213
  v_accvgpr_read_b32 v213, a81
  v_mul_f32 v213, v213, v214
  v_accvgpr_write_b32 a81, v213
  v_accvgpr_read_b32 v213, a82
  v_mul_f32 v213, v213, v214
  v_accvgpr_write_b32 a82, v213
  v_accvgpr_read_b32 v213, a83
  v_mul_f32 v213, v213, v214
  v_accvgpr_write_b32 a83, v213
  v_accvgpr_read_b32 v213, a84
  v_mul_f32 v213, v213, v214
  v_accvgpr_write_b32 a84, v213
  v_accvgpr_read_b32 v213, a85
  v_mul_f32 v213, v213, v214
  v_accvgpr_write_b32 a85, v213
  v_accvgpr_read_b32 v213, a86
  v_mul_f32 v213, v213, v214
  v_accvgpr_write_b32 a86, v213
  v_accvgpr_read_b32 v213, a87
  v_mul_f32 v213, v213, v214
  v_accvgpr_write_b32 a87, v213
  v_accvgpr_read_b32 v213, a88
  v_mul_f32 v213, v213, v214
  v_accvgpr_write_b32 a88, v213
  v_accvgpr_read_b32 v213, a89
  v_mul_f32 v213, v213, v214
  v_accvgpr_write_b32 a89, v213
  v_accvgpr_read_b32 v213, a90
  v_mul_f32 v213, v213, v214
  v_accvgpr_write_b32 a90, v213
  v_accvgpr_read_b32 v213, a91
  v_mul_f32 v213, v213, v214
  v_accvgpr_write_b32 a91, v213
  v_accvgpr_read_b32 v213, a92
  v_mul_f32 v213, v213, v214
  v_accvgpr_write_b32 a92, v213
  v_accvgpr_read_b32 v213, a93
  v_mul_f32 v213, v213, v214
  v_accvgpr_write_b32 a93, v213
  v_accvgpr_read_b32 v213, a94
  v_mul_f32 v213, v213, v214
  v_accvgpr_write_b32 a94, v213
  v_accvgpr_read_b32 v213, a95
  v_mul_f32 v213, v213, v214
  v_accvgpr_write_b32 a95, v213
  v_accvgpr_read_b32 v213, a112
  v_mul_f32 v213, v213, v214
  v_accvgpr_write_b32 a112, v213
  v_accvgpr_read_b32 v213, a113
  v_mul_f32 v213, v213, v214
  v_accvgpr_write_b32 a113, v213
  v_accvgpr_read_b32 v213, a114
  v_mul_f32 v213, v213, v214
  v_accvgpr_write_b32 a114, v213
  v_accvgpr_read_b32 v213, a115
  v_mul_f32 v213, v213, v214
  v_accvgpr_write_b32 a115, v213
  v_accvgpr_read_b32 v213, a116
  v_mul_f32 v213, v213, v214
  v_accvgpr_write_b32 a116, v213
  v_accvgpr_read_b32 v213, a117
  v_mul_f32 v213, v213, v214
  v_accvgpr_write_b32 a117, v213
  v_accvgpr_read_b32 v213, a118
  v_mul_f32 v213, v213, v214
  v_accvgpr_write_b32 a118, v213
  v_accvgpr_read_b32 v213, a119
  v_mul_f32 v213, v213, v214
  v_accvgpr_write_b32 a119, v213
  v_accvgpr_read_b32 v213, a120
  v_mul_f32 v213, v213, v214
  v_accvgpr_write_b32 a120, v213
  v_accvgpr_read_b32 v213, a121
  v_mul_f32 v213, v213, v214
  v_accvgpr_write_b32 a121, v213
  v_accvgpr_read_b32 v213, a122
  v_mul_f32 v213, v213, v214
  v_accvgpr_write_b32 a122, v213
  v_accvgpr_read_b32 v213, a123
  v_mul_f32 v213, v213, v214
  v_accvgpr_write_b32 a123, v213
  v_accvgpr_read_b32 v213, a124
  v_mul_f32 v213, v213, v214
  v_accvgpr_write_b32 a124, v213
  v_accvgpr_read_b32 v213, a125
  v_mul_f32 v213, v213, v214
  v_accvgpr_write_b32 a125, v213
  v_accvgpr_read_b32 v213, a126
  v_mul_f32 v213, v213, v214
  v_accvgpr_write_b32 a126, v213
  v_accvgpr_read_b32 v213, a127
  v_mul_f32 v213, v213, v214
  v_accvgpr_write_b32 a127, v213
  v_exp_f32 v200, v40
  v_exp_f32 v201, v41
  v_add_f32 v210, v208, v200
  v_exp_f32 v202, v42
  v_add_f32 v210, v210, v201
  v_cvt_pk_bf16_f32 v88, v200, v201
  v_exp_f32 v203, v43
  v_add_f32 v210, v210, v202
  v_exp_f32 v204, v44
  v_add_f32 v210, v210, v203
  v_cvt_pk_bf16_f32 v89, v202, v203
  v_exp_f32 v205, v45
  v_add_f32 v210, v210, v204
  v_exp_f32 v206, v46
  v_add_f32 v210, v210, v205
  v_cvt_pk_bf16_f32 v90, v204, v205
  v_exp_f32 v207, v47
  v_add_f32 v210, v210, v206
  v_exp_f32 v200, v48
  v_add_f32 v210, v210, v207
  v_cvt_pk_bf16_f32 v91, v206, v207
  v_exp_f32 v201, v49
  v_add_f32 v210, v210, v200
  v_exp_f32 v202, v50
  v_add_f32 v210, v210, v201
  v_cvt_pk_bf16_f32 v92, v200, v201
  v_exp_f32 v203, v51
  v_add_f32 v210, v210, v202
  v_exp_f32 v204, v52
  v_add_f32 v210, v210, v203
  v_cvt_pk_bf16_f32 v93, v202, v203
  v_exp_f32 v205, v53
  v_add_f32 v210, v210, v204
  v_exp_f32 v206, v54
  v_add_f32 v210, v210, v205
  v_cvt_pk_bf16_f32 v94, v204, v205
  v_exp_f32 v207, v55
  v_add_f32 v210, v210, v206
  v_exp_f32 v200, v56
  v_add_f32 v210, v210, v207
  v_cvt_pk_bf16_f32 v95, v206, v207
  v_exp_f32 v201, v57
  v_add_f32 v211, v209, v200
  v_exp_f32 v202, v58
  v_add_f32 v211, v211, v201
  v_cvt_pk_bf16_f32 v96, v200, v201
  v_exp_f32 v203, v59
  v_add_f32 v211, v211, v202
  v_exp_f32 v204, v60
  v_add_f32 v211, v211, v203
  v_cvt_pk_bf16_f32 v97, v202, v203
  v_exp_f32 v205, v61
  v_add_f32 v211, v211, v204
  v_exp_f32 v206, v62
  v_add_f32 v211, v211, v205
  v_cvt_pk_bf16_f32 v98, v204, v205
  v_exp_f32 v207, v63
  v_add_f32 v211, v211, v206
  v_exp_f32 v200, v64
  v_add_f32 v211, v211, v207
  v_cvt_pk_bf16_f32 v99, v206, v207
  v_exp_f32 v201, v65
  v_add_f32 v211, v211, v200
  v_exp_f32 v202, v66
  v_add_f32 v211, v211, v201
  v_cvt_pk_bf16_f32 v100, v200, v201
  v_exp_f32 v203, v67
  v_add_f32 v211, v211, v202
  v_exp_f32 v204, v68
  v_add_f32 v211, v211, v203
  v_cvt_pk_bf16_f32 v101, v202, v203
  v_exp_f32 v205, v69
  v_add_f32 v211, v211, v204
  v_exp_f32 v206, v70
  v_add_f32 v211, v211, v205
  v_cvt_pk_bf16_f32 v102, v204, v205
  v_exp_f32 v207, v71
  v_add_f32 v211, v211, v206
  v_add_f32 v211, v211, v207
  v_cvt_pk_bf16_f32 v103, v206, v207
  s_branch k2_ret25
k2_fb26:
  v_max3_f32 v212, v8, v9, v10
  v_max3_f32 v212, v212, v11, v12
  v_max3_f32 v212, v212, v13, v14
  v_max3_f32 v212, v212, v15, v16
  v_max3_f32 v212, v212, v17, v18
  v_max3_f32 v212, v212, v19, v20
  v_max3_f32 v212, v212, v21, v22
  v_max_f32 v212, v212, v23
  v_mov_b32 v213, v212
  s_nop 1
  v_permlane32_swap_b32 v212, v213
  v_max_f32 v212, v212, v213
  v_max_f32 v212, 0, v212
  v_sub_f32 v104, v104, v212
  v_sub_f32 v105, v105, v212
  v_sub_f32 v106, v106, v212
  v_sub_f32 v107, v107, v212
  v_sub_f32 v108, v108, v212
  v_sub_f32 v109, v109, v212
  v_sub_f32 v110, v110, v212
  v_sub_f32 v111, v111, v212
  v_sub_f32 v112, v112, v212
  v_sub_f32 v113, v113, v212
  v_sub_f32 v114, v114, v212
  v_sub_f32 v115, v115, v212
  v_sub_f32 v116, v116, v212
  v_sub_f32 v117, v117, v212
  v_sub_f32 v118, v118, v212
  v_sub_f32 v119, v119, v212
  v_sub_f32 v8, v8, v212
  v_sub_f32 v9, v9, v212
  v_sub_f32 v10, v10, v212
  v_sub_f32 v11, v11, v212
  v_sub_f32 v12, v12, v212
  v_sub_f32 v13, v13, v212
  v_sub_f32 v14, v14, v212
  v_sub_f32 v15, v15, v212
  v_sub_f32 v16, v16, v212
  v_sub_f32 v17, v17, v212
  v_sub_f32 v18, v18, v212
  v_sub_f32 v19, v19, v212
  v_sub_f32 v20, v20, v212
  v_sub_f32 v21, v21, v212
  v_sub_f32 v22, v22, v212
  v_sub_f32 v23, v23, v212
  v_sub_f32 v40, v40, v212
  v_sub_f32 v41, v41, v212
  v_sub_f32 v42, v42, v212
  v_sub_f32 v43, v43, v212
  v_sub_f32 v44, v44, v212
  v_sub_f32 v45, v45, v212
  v_sub_f32 v46, v46, v212
  v_sub_f32 v47, v47, v212
  v_sub_f32 v48, v48, v212
  v_sub_f32 v49, v49, v212
  v_sub_f32 v50, v50, v212
  v_sub_f32 v51, v51, v212
  v_sub_f32 v52, v52, v212
  v_sub_f32 v53, v53, v212
  v_sub_f32 v54, v54, v212
  v_sub_f32 v55, v55, v212
  v_sub_f32 v214, 0, v212
  v_exp_f32 v214, v214
  s_nop 0
  v_mul_f32 v210, v210, v214
  v_accvgpr_read_b32 v213, a0
  v_mul_f32 v213, v213, v214
  v_accvgpr_write_b32 a0, v213
  v_accvgpr_read_b32 v213, a1
  v_mul_f32 v213, v213, v214
  v_accvgpr_write_b32 a1, v213
  v_accvgpr_read_b32 v213, a2
  v_mul_f32 v213, v213, v214
  v_accvgpr_write_b32 a2, v213
  v_accvgpr_read_b32 v213, a3
  v_mul_f32 v213, v213, v214
  v_accvgpr_write_b32 a3, v213
  v_accvgpr_read_b32 v213, a4
  v_mul_f32 v213, v213, v214
  v_accvgpr_write_b32 a4, v213
  v_accvgpr_read_b32 v213, a5
  v_mul_f32 v213, v213, v214
  v_accvgpr_write_b32 a5, v213
  v_accvgpr_read_b32 v213, a6
  v_mul_f32 v213, v213, v214
  v_accvgpr_write_b32 a6, v213
  v_accvgpr_read_b32 v213, a7
  v_mul_f32 v213, v213, v214
  v_accvgpr_write_b32 a7, v213
  v_accvgpr_read_b32 v213, a8
  v_mul_f32 v213, v213, v214
  v_accvgpr_write_b32 a8, v213
  v_accvgpr_read_b32 v213, a9
  v_mul_f32 v213, v213, v214
  v_accvgpr_write_b32 a9, v213
  v_accvgpr_read_b32 v213, a10
  v_mul_f32 v213, v213, v214
  v_accvgpr_write_b32 a10, v213
  v_accvgpr_read_b32 v213, a11
  v_mul_f32 v213, v213, v214
  v_accvgpr_write_b32 a11, v213
  v_accvgpr_read_b32 v213, a12
  v_mul_f32 v213, v213, v214
  v_accvgpr_write_b32 a12, v213
  v_accvgpr_read_b32 v213, a13
  v_mul_f32 v213, v213, v214
  v_accvgpr_write_b32 a13, v213
  v_accvgpr_read_b32 v213, a14
  v_mul_f32 v213, v213, v214
  v_accvgpr_write_b32 a14, v213
  v_accvgpr_read_b32 v213, a15
  v_mul_f32 v213, v213, v214
  v_accvgpr_write_b32 a15, v213
  v_accvgpr_read_b32 v213, a32
  v_mul_f32 v213, v213, v214
  v_accvgpr_write_b32 a32, v213
  v_accvgpr_read_b32 v213, a33
  v_mul_f32 v213, v213, v214
  v_accvgpr_write_b32 a33, v213
  v_accvgpr_read_b32 v213, a34
  v_mul_f32 v213, v213, v214
  v_accvgpr_write_b32 a34, v213
  v_accvgpr_read_b32 v213, a35
  v_mul_f32 v213, v213, v214
  v_accvgpr_write_b32 a35, v213
  v_accvgpr_read_b32 v213, a36
  v_mul_f32 v213, v213, v214
  v_accvgpr_write_b32 a36, v213
  v_accvgpr_read_b32 v213, a37
  v_mul_f32 v213, v213, v214
  v_accvgpr_write_b32 a37, v213
  v_accvgpr_read_b32 v213, a38
  v_mul_f32 v213, v213, v214
  v_accvgpr_write_b32 a38, v213
  v_accvgpr_read_b32 v213, a39
  v_mul_f32 v213, v213, v214
  v_accvgpr_write_b32 a39, v213
  v_accvgpr_read_b32 v213, a40
  v_mul_f32 v213, v213, v214
  v_accvgpr_write_b32 a40, v213
  v_accvgpr_read_b32 v213, a41
  v_mul_f32 v213, v213, v214
  v_accvgpr_write_b32 a41, v213
  v_accvgpr_read_b32 v213, a42
  v_mul_f32 v213, v213, v214
  v_accvgpr_write_b32 a42, v213
  v_accvgpr_read_b32 v213, a43
  v_mul_f32 v213, v213, v214
  v_accvgpr_write_b32 a43, v213
  v_accvgpr_read_b32 v213, a44
  v_mul_f32 v213, v213, v214
  v_accvgpr_write_b32 a44, v213
  v_accvgpr_read_b32 v213, a45
  v_mul_f32 v213, v213, v214
  v_accvgpr_write_b32 a45, v213
  v_accvgpr_read_b32 v213, a46
  v_mul_f32 v213, v213, v214
  v_accvgpr_write_b32 a46, v213
  v_accvgpr_read_b32 v213, a47
  v_mul_f32 v213, v213, v214
  v_accvgpr_write_b32 a47, v213
  v_accvgpr_read_b32 v213, a64
  v_mul_f32 v213, v213, v214
  v_accvgpr_write_b32 a64, v213
  v_accvgpr_read_b32 v213, a65
  v_mul_f32 v213, v213, v214
  v_accvgpr_write_b32 a65, v213
  v_accvgpr_read_b32 v213, a66
  v_mul_f32 v213, v213, v214
  v_accvgpr_write_b32 a66, v213
  v_accvgpr_read_b32 v213, a67
  v_mul_f32 v213, v213, v214
  v_accvgpr_write_b32 a67, v213
  v_accvgpr_read_b32 v213, a68
  v_mul_f32 v213, v213, v214
  v_accvgpr_write_b32 a68, v213
  v_accvgpr_read_b32 v213, a69
  v_mul_f32 v213, v213, v214
  v_accvgpr_write_b32 a69, v213
  v_accvgpr_read_b32 v213, a70
  v_mul_f32 v213, v213, v214
  v_accvgpr_write_b32 a70, v213
  v_accvgpr_read_b32 v213, a71
  v_mul_f32 v213, v213, v214
  v_accvgpr_write_b32 a71, v213
  v_accvgpr_read_b32 v213, a72
  v_mul_f32 v213, v213, v214
  v_accvgpr_write_b32 a72, v213
  v_accvgpr_read_b32 v213, a73
  v_mul_f32 v213, v213, v214
  v_accvgpr_write_b32 a73, v213
  v_accvgpr_read_b32 v213, a74
  v_mul_f32 v213, v213, v214
  v_accvgpr_write_b32 a74, v213
  v_accvgpr_read_b32 v213, a75
  v_mul_f32 v213, v213, v214
  v_accvgpr_write_b32 a75, v213
  v_accvgpr_read_b32 v213, a76
  v_mul_f32 v213, v213, v214
  v_accvgpr_write_b32 a76, v213
  v_accvgpr_read_b32 v213, a77
  v_mul_f32 v213, v213, v214
  v_accvgpr_write_b32 a77, v213
  v_accvgpr_read_b32 v213, a78
  v_mul_f32 v213, v213, v214
  v_accvgpr_write_b32 a78, v213
  v_accvgpr_read_b32 v213, a79
  v_mul_f32 v213, v213, v214
  v_accvgpr_write_b32 a79, v213
  v_accvgpr_read_b32 v213, a96
  v_mul_f32 v213, v213, v214
  v_accvgpr_write_b32 a96, v213
  v_accvgpr_read_b32 v213, a97
  v_mul_f32 v213, v213, v214
  v_accvgpr_write_b32 a97, v213
  v_accvgpr_read_b32 v213, a98
  v_mul_f32 v213, v213, v214
  v_accvgpr_write_b32 a98, v213
  v_accvgpr_read_b32 v213, a99
  v_mul_f32 v213, v213, v214
  v_accvgpr_write_b32 a99, v213
  v_accvgpr_read_b32 v213, a100
  v_mul_f32 v213, v213, v214
  v_accvgpr_write_b32 a100, v213
  v_accvgpr_read_b32 v213, a101
  v_mul_f32 v213, v213, v214
  v_accvgpr_write_b32 a101, v213
  v_accvgpr_read_b32 v213, a102
  v_mul_f32 v213, v213, v214
  v_accvgpr_write_b32 a102, v213
  v_accvgpr_read_b32 v213, a103
  v_mul_f32 v213, v213, v214
  v_accvgpr_write_b32 a103, v213
  v_accvgpr_read_b32 v213, a104
  v_mul_f32 v213, v213, v214
  v_accvgpr_write_b32 a104, v213
  v_accvgpr_read_b32 v213, a105
  v_mul_f32 v213, v213, v214
  v_accvgpr_write_b32 a105, v213
  v_accvgpr_read_b32 v213, a106
  v_mul_f32 v213, v213, v214
  v_accvgpr_write_b32 a106, v213
  v_accvgpr_read_b32 v213, a107
  v_mul_f32 v213, v213, v214
  v_accvgpr_write_b32 a107, v213
  v_accvgpr_read_b32 v213, a108
  v_mul_f32 v213, v213, v214
  v_accvgpr_write_b32 a108, v213
  v_accvgpr_read_b32 v213, a109
  v_mul_f32 v213, v213, v214
  v_accvgpr_write_b32 a109, v213
  v_accvgpr_read_b32 v213, a110
  v_mul_f32 v213, v213, v214
  v_accvgpr_write_b32 a110, v213
  v_accvgpr_read_b32 v213, a111
  v_mul_f32 v213, v213, v214
  v_accvgpr_write_b32 a111, v213
  v_max3_f32 v212, v24, v25, v26
  v_max3_f32 v212, v212, v27, v28
  v_max3_f32 v212, v212, v29, v30
  v_max3_f32 v212, v212, v31, v32
  v_max3_f32 v212, v212, v33, v34
  v_max3_f32 v212, v212, v35, v36
  v_max3_f32 v212, v212, v37, v38
  v_max_f32 v212, v212, v39
  v_mov_b32 v213, v212
  s_nop 1
  v_permlane32_swap_b32 v212, v213
  v_max_f32 v212, v212, v213
  v_max_f32 v212, 0, v212
  v_sub_f32 v120, v120, v212
  v_sub_f32 v121, v121, v212
  v_sub_f32 v122, v122, v212
  v_sub_f32 v123, v123, v212
  v_sub_f32 v124, v124, v212
  v_sub_f32 v125, v125, v212
  v_sub_f32 v126, v126, v212
  v_sub_f32 v127, v127, v212
  v_sub_f32 v128, v128, v212
  v_sub_f32 v129, v129, v212
  v_sub_f32 v130, v130, v212
  v_sub_f32 v131, v131, v212
  v_sub_f32 v132, v132, v212
  v_sub_f32 v133, v133, v212
  v_sub_f32 v134, v134, v212
  v_sub_f32 v135, v135, v212
  v_sub_f32 v24, v24, v212
  v_sub_f32 v25, v25, v212
  v_sub_f32 v26, v26, v212
  v_sub_f32 v27, v27, v212
  v_sub_f32 v28, v28, v212
  v_sub_f32 v29, v29, v212
  v_sub_f32 v30, v30, v212
  v_sub_f32 v31, v31, v212
  v_sub_f32 v32, v32, v212
  v_sub_f32 v33, v33, v212
  v_sub_f32 v34, v34, v212
  v_sub_f32 v35, v35, v212
  v_sub_f32 v36, v36, v212
  v_sub_f32 v37, v37, v212
  v_sub_f32 v38, v38, v212
  v_sub_f32 v39, v39, v212
  v_sub_f32 v56, v56, v212
  v_sub_f32 v57, v57, v212
  v_sub_f32 v58, v58, v212
  v_sub_f32 v59, v59, v212
  v_sub_f32 v60, v60, v212
  v_sub_f32 v61, v61, v212
  v_sub_f32 v62, v62, v212
  v_sub_f32 v63, v63, v212
  v_sub_f32 v64, v64, v212
  v_sub_f32 v65, v65, v212
  v_sub_f32 v66, v66, v212
  v_sub_f32 v67, v67, v212
  v_sub_f32 v68, v68, v212
  v_sub_f32 v69, v69, v212
  v_sub_f32 v70, v70, v212
  v_sub_f32 v71, v71, v212
  v_sub_f32 v214, 0, v212
  v_exp_f32 v214, v214
  s_nop 0
  v_mul_f32 v211, v211, v214
  v_accvgpr_read_b32 v213, a16
  v_mul_f32 v213, v213, v214
  v_accvgpr_write_b32 a16, v213
  v_accvgpr_read_b32 v213, a17
  v_mul_f32 v213, v213, v214
  v_accvgpr_write_b32 a17, v213
  v_accvgpr_read_b32 v213, a18
  v_mul_f32 v213, v213, v214
  v_accvgpr_write_b32 a18, v213
  v_accvgpr_read_b32 v213, a19
  v_mul_f32 v213, v213, v214
  v_accvgpr_write_b32 a19, v213
  v_accvgpr_read_b32 v213, a20
  v_mul_f32 v213, v213, v214
  v_accvgpr_write_b32 a20, v213
  v_accvgpr_read_b32 v213, a21
  v_mul_f32 v213, v213, v214
  v_accvgpr_write_b32 a21, v213
  v_accvgpr_read_b32 v213, a22
  v_mul_f32 v213, v213, v214
  v_accvgpr_write_b32 a22, v213
  v_accvgpr_read_b32 v213, a23
  v_mul_f32 v213, v213, v214
  v_accvgpr_write_b32 a23, v213
  v_accvgpr_read_b32 v213, a24
  v_mul_f32 v213, v213, v214
  v_accvgpr_write_b32 a24, v213
  v_accvgpr_read_b32 v213, a25
  v_mul_f32 v213, v213, v214
  v_accvgpr_write_b32 a25, v213
  v_accvgpr_read_b32 v213, a26
  v_mul_f32 v213, v213, v214
  v_accvgpr_write_b32 a26, v213
  v_accvgpr_read_b32 v213, a27
  v_mul_f32 v213, v213, v214
  v_accvgpr_write_b32 a27, v213
  v_accvgpr_read_b32 v213, a28
  v_mul_f32 v213, v213, v214
  v_accvgpr_write_b32 a28, v213
  v_accvgpr_read_b32 v213, a29
  v_mul_f32 v213, v213, v214
  v_accvgpr_write_b32 a29, v213
  v_accvgpr_read_b32 v213, a30
  v_mul_f32 v213, v213, v214
  v_accvgpr_write_b32 a30, v213
  v_accvgpr_read_b32 v213, a31
  v_mul_f32 v213, v213, v214
  v_accvgpr_write_b32 a31, v213
  v_accvgpr_read_b32 v213, a48
  v_mul_f32 v213, v213, v214
  v_accvgpr_write_b32 a48, v213
  v_accvgpr_read_b32 v213, a49
  v_mul_f32 v213, v213, v214
  v_accvgpr_write_b32 a49, v213
  v_accvgpr_read_b32 v213, a50
  v_mul_f32 v213, v213, v214
  v_accvgpr_write_b32 a50, v213
  v_accvgpr_read_b32 v213, a51
  v_mul_f32 v213, v213, v214
  v_accvgpr_write_b32 a51, v213
  v_accvgpr_read_b32 v213, a52
  v_mul_f32 v213, v213, v214
  v_accvgpr_write_b32 a52, v213
  v_accvgpr_read_b32 v213, a53
  v_mul_f32 v213, v213, v214
  v_accvgpr_write_b32 a53, v213
  v_accvgpr_read_b32 v213, a54
  v_mul_f32 v213, v213, v214
  v_accvgpr_write_b32 a54, v213
  v_accvgpr_read_b32 v213, a55
  v_mul_f32 v213, v213, v214
  v_accvgpr_write_b32 a55, v213
  v_accvgpr_read_b32 v213, a56
  v_mul_f32 v213, v213, v214
  v_accvgpr_write_b32 a56, v213
  v_accvgpr_read_b32 v213, a57
  v_mul_f32 v213, v213, v214
  v_accvgpr_write_b32 a57, v213
  v_accvgpr_read_b32 v213, a58
  v_mul_f32 v213, v213, v214
  v_accvgpr_write_b32 a58, v213
  v_accvgpr_read_b32 v213, a59
  v_mul_f32 v213, v213, v214
  v_accvgpr_write_b32 a59, v213
  v_accvgpr_read_b32 v213, a60
  v_mul_f32 v213, v213, v214
  v_accvgpr_write_b32 a60, v213
  v_accvgpr_read_b32 v213, a61
  v_mul_f32 v213, v213, v214
  v_accvgpr_write_b32 a61, v213
  v_accvgpr_read_b32 v213, a62
  v_mul_f32 v213, v213, v214
  v_accvgpr_write_b32 a62, v213
  v_accvgpr_read_b32 v213, a63
  v_mul_f32 v213, v213, v214
  v_accvgpr_write_b32 a63, v213
  v_accvgpr_read_b32 v213, a80
  v_mul_f32 v213, v213, v214
  v_accvgpr_write_b32 a80, v213
  v_accvgpr_read_b32 v213, a81
  v_mul_f32 v213, v213, v214
  v_accvgpr_write_b32 a81, v213
  v_accvgpr_read_b32 v213, a82
  v_mul_f32 v213, v213, v214
  v_accvgpr_write_b32 a82, v213
  v_accvgpr_read_b32 v213, a83
  v_mul_f32 v213, v213, v214
  v_accvgpr_write_b32 a83, v213
  v_accvgpr_read_b32 v213, a84
  v_mul_f32 v213, v213, v214
  v_accvgpr_write_b32 a84, v213
  v_accvgpr_read_b32 v213, a85
  v_mul_f32 v213, v213, v214
  v_accvgpr_write_b32 a85, v213
  v_accvgpr_read_b32 v213, a86
  v_mul_f32 v213, v213, v214
  v_accvgpr_write_b32 a86, v213
  v_accvgpr_read_b32 v213, a87
  v_mul_f32 v213, v213, v214
  v_accvgpr_write_b32 a87, v213
  v_accvgpr_read_b32 v213, a88
  v_mul_f32 v213, v213, v214
  v_accvgpr_write_b32 a88, v213
  v_accvgpr_read_b32 v213, a89
  v_mul_f32 v213, v213, v214
  v_accvgpr_write_b32 a89, v213
  v_accvgpr_read_b32 v213, a90
  v_mul_f32 v213, v213, v214
  v_accvgpr_write_b32 a90, v213
  v_accvgpr_read_b32 v213, a91
  v_mul_f32 v213, v213, v214
  v_accvgpr_write_b32 a91, v213
  v_accvgpr_read_b32 v213, a92
  v_mul_f32 v213, v213, v214
  v_accvgpr_write_b32 a92, v213
  v_accvgpr_read_b32 v213, a93
  v_mul_f32 v213, v213, v214
  v_accvgpr_write_b32 a93, v213
  v_accvgpr_read_b32 v213, a94
  v_mul_f32 v213, v213, v214
  v_accvgpr_write_b32 a94, v213
  v_accvgpr_read_b32 v213, a95
  v_mul_f32 v213, v213, v214
  v_accvgpr_write_b32 a95, v213
  v_accvgpr_read_b32 v213, a112
  v_mul_f32 v213, v213, v214
  v_accvgpr_write_b32 a112, v213
  v_accvgpr_read_b32 v213, a113
  v_mul_f32 v213, v213, v214
  v_accvgpr_write_b32 a113, v213
  v_accvgpr_read_b32 v213, a114
  v_mul_f32 v213, v213, v214
  v_accvgpr_write_b32 a114, v213
  v_accvgpr_read_b32 v213, a115
  v_mul_f32 v213, v213, v214
  v_accvgpr_write_b32 a115, v213
  v_accvgpr_read_b32 v213, a116
  v_mul_f32 v213, v213, v214
  v_accvgpr_write_b32 a116, v213
  v_accvgpr_read_b32 v213, a117
  v_mul_f32 v213, v213, v214
  v_accvgpr_write_b32 a117, v213
  v_accvgpr_read_b32 v213, a118
  v_mul_f32 v213, v213, v214
  v_accvgpr_write_b32 a118, v213
  v_accvgpr_read_b32 v213, a119
  v_mul_f32 v213, v213, v214
  v_accvgpr_write_b32 a119, v213
  v_accvgpr_read_b32 v213, a120
  v_mul_f32 v213, v213, v214
  v_accvgpr_write_b32 a120, v213
  v_accvgpr_read_b32 v213, a121
  v_mul_f32 v213, v213, v214
  v_accvgpr_write_b32 a121, v213
  v_accvgpr_read_b32 v213, a122
  v_mul_f32 v213, v213, v214
  v_accvgpr_write_b32 a122, v213
  v_accvgpr_read_b32 v213, a123
  v_mul_f32 v213, v213, v214
  v_accvgpr_write_b32 a123, v213
  v_accvgpr_read_b32 v213, a124
  v_mul_f32 v213, v213, v214
  v_accvgpr_write_b32 a124, v213
  v_accvgpr_read_b32 v213, a125
  v_mul_f32 v213, v213, v214
  v_accvgpr_write_b32 a125, v213
  v_accvgpr_read_b32 v213, a126
  v_mul_f32 v213, v213, v214
  v_accvgpr_write_b32 a126, v213
  v_accvgpr_read_b32 v213, a127
  v_mul_f32 v213, v213, v214
  v_accvgpr_write_b32 a127, v213
  v_exp_f32 v200, v8
  v_exp_f32 v201, v9
  v_add_f32 v208, v210, v200
  v_exp_f32 v202, v10
  v_add_f32 v208, v208, v201
  v_cvt_pk_bf16_f32 v72, v200, v201
  v_exp_f32 v203, v11
  v_add_f32 v208, v208, v202
  v_exp_f32 v204, v12
  v_add_f32 v208, v208, v203
  v_cvt_pk_bf16_f32 v73, v202, v203
  v_exp_f32 v205, v13
  v_add_f32 v208, v208, v204
  v_exp_f32 v206, v14
  v_add_f32 v208, v208, v205
  v_cvt_pk_bf16_f32 v74, v204, v205
  v_exp_f32 v207, v15
  v_add_f32 v208, v208, v206
  v_exp_f32 v200, v16
  v_add_f32 v208, v208, v207
  v_cvt_pk_bf16_f32 v75, v206, v207
  v_exp_f32 v201, v17
  v_add_f32 v208, v208, v200
  v_exp_f32 v202, v18
  v_add_f32 v208, v208, v201
  v_cvt_pk_bf16_f32 v76, v200, v201
  v_exp_f32 v203, v19
  v_add_f32 v208, v208, v202
  v_exp_f32 v204, v20
  v_add_f32 v208, v208, v203
  v_cvt_pk_bf16_f32 v77, v202, v203
  v_exp_f32 v205, v21
  v_add_f32 v208, v208, v204
  v_exp_f32 v206, v22
  v_add_f32 v208, v208, v205
  v_cvt_pk_bf16_f32 v78, v204, v205
  v_exp_f32 v207, v23
  v_add_f32 v208, v208, v206
  v_exp_f32 v200, v24
  v_add_f32 v208, v208, v207
  v_cvt_pk_bf16_f32 v79, v206, v207
  v_exp_f32 v201, v25
  v_add_f32 v209, v211, v200
  v_exp_f32 v202, v26
  v_add_f32 v209, v209, v201
  v_cvt_pk_bf16_f32 v80, v200, v201
  v_exp_f32 v203, v27
  v_add_f32 v209, v209, v202
  v_exp_f32 v204, v28
  v_add_f32 v209, v209, v203
  v_cvt_pk_bf16_f32 v81, v202, v203
  v_exp_f32 v205, v29
  v_add_f32 v209, v209, v204
  v_exp_f32 v206, v30
  v_add_f32 v209, v209, v205
  v_cvt_pk_bf16_f32 v82, v204, v205
  v_exp_f32 v207, v31
  v_add_f32 v209, v209, v206
  v_exp_f32 v200, v32
  v_add_f32 v209, v209, v207
  v_cvt_pk_bf16_f32 v83, v206, v207
  v_exp_f32 v201, v33
  v_add_f32 v209, v209, v200
  v_exp_f32 v202, v34
  v_add_f32 v209, v209, v201
  v_cvt_pk_bf16_f32 v84, v200, v201
  v_exp_f32 v203, v35
  v_add_f32 v209, v209, v202
  v_exp_f32 v204, v36
  v_add_f32 v209, v209, v203
  v_cvt_pk_bf16_f32 v85, v202, v203
  v_exp_f32 v205, v37
  v_add_f32 v209, v209, v204
  v_exp_f32 v206, v38
  v_add_f32 v209, v209, v205
  v_cvt_pk_bf16_f32 v86, v204, v205
  v_exp_f32 v207, v39
  v_add_f32 v209, v209, v206
  v_add_f32 v209, v209, v207
  v_cvt_pk_bf16_f32 v87, v206, v207
  s_branch k2_ret27
k2_fb28:
  v_max3_f32 v212, v40, v41, v42
  v_max3_f32 v212, v212, v43, v44
  v_max3_f32 v212, v212, v45, v46
  v_max3_f32 v212, v212, v47, v48
  v_max3_f32 v212, v212, v49, v50
  v_max3_f32 v212, v212, v51, v52
  v_max3_f32 v212, v212, v53, v54
  v_max_f32 v212, v212, v55
  v_mov_b32 v213, v212
  s_nop 1
  v_permlane32_swap_b32 v212, v213
  v_max_f32 v212, v212, v213
  v_max_f32 v212, 0, v212
  v_sub_f32 v104, v104, v212
  v_sub_f32 v105, v105, v212
  v_sub_f32 v106, v106, v212
  v_sub_f32 v107, v107, v212
  v_sub_f32 v108, v108, v212
  v_sub_f32 v109, v109, v212
  v_sub_f32 v110, v110, v212
  v_sub_f32 v111, v111, v212
  v_sub_f32 v112, v112, v212
  v_sub_f32 v113, v113, v212
  v_sub_f32 v114, v114, v212
  v_sub_f32 v115, v115, v212
  v_sub_f32 v116, v116, v212
  v_sub_f32 v117, v117, v212
  v_sub_f32 v118, v118, v212
  v_sub_f32 v119, v119, v212
  v_sub_f32 v40, v40, v212
  v_sub_f32 v41, v41, v212
  v_sub_f32 v42, v42, v212
  v_sub_f32 v43, v43, v212
  v_sub_f32 v44, v44, v212
  v_sub_f32 v45, v45, v212
  v_sub_f32 v46, v46, v212
  v_sub_f32 v47, v47, v212
  v_sub_f32 v48, v48, v212
  v_sub_f32 v49, v49, v212
  v_sub_f32 v50, v50, v212
  v_sub_f32 v51, v51, v212
  v_sub_f32 v52, v52, v212
  v_sub_f32 v53, v53, v212
  v_sub_f32 v54, v54, v212
  v_sub_f32 v55, v55, v212
  v_sub_f32 v8, v8, v212
  v_sub_f32 v9, v9, v212
  v_sub_f32 v10, v10, v212
  v_sub_f32 v11, v11, v212
  v_sub_f32 v12, v12, v212
  v_sub_f32 v13, v13, v212
  v_sub_f32 v14, v14, v212
  v_sub_f32 v15, v15, v212
  v_sub_f32 v16, v16, v212
  v_sub_f32 v17, v17, v212
  v_sub_f32 v18, v18, v212
  v_sub_f32 v19, v19, v212
  v_sub_f32 v20, v20, v212
  v_sub_f32 v21, v21, v212
  v_sub_f32 v22, v22, v212
  v_sub_f32 v23, v23, v212
  v_sub_f32 v214, 0, v212
  v_exp_f32 v214, v214
  s_nop 0
  v_mul_f32 v208, v208, v214
  v_accvgpr_read_b32 v213, a0
  v_mul_f32 v213, v213, v214
  v_accvgpr_write_b32 a0, v213
  v_accvgpr_read_b32 v213, a1
  v_mul_f32 v213, v213, v214
  v_accvgpr_write_b32 a1, v213
  v_accvgpr_read_b32 v213, a2
  v_mul_f32 v213, v213, v214
  v_accvgpr_write_b32 a2, v213
  v_accvgpr_read_b32 v213, a3
  v_mul_f32 v213, v213, v214
  v_accvgpr_write_b32 a3, v213
  v_accvgpr_read_b32 v213, a4
  v_mul_f32 v213, v213, v214
  v_accvgpr_write_b32 a4, v213
  v_accvgpr_read_b32 v213, a5
  v_mul_f32 v213, v213, v214
  v_accvgpr_write_b32 a5, v213
  v_accvgpr_read_b32 v213, a6
  v_mul_f32 v213, v213, v214
  v_accvgpr_write_b32 a6, v213
  v_accvgpr_read_b32 v213, a7
  v_mul_f32 v213, v213, v214
  v_accvgpr_write_b32 a7, v213
  v_accvgpr_read_b32 v213, a8
  v_mul_f32 v213, v213, v214
  v_accvgpr_write_b32 a8, v213
  v_accvgpr_read_b32 v213, a9
  v_mul_f32 v213, v213, v214
  v_accvgpr_write_b32 a9, v213
  v_accvgpr_read_b32 v213, a10
  v_mul_f32 v213, v213, v214
  v_accvgpr_write_b32 a10, v213
  v_accvgpr_read_b32 v213, a11
  v_mul_f32 v213, v213, v214
  v_accvgpr_write_b32 a11, v213
  v_accvgpr_read_b32 v213, a12
  v_mul_f32 v213, v213, v214
  v_accvgpr_write_b32 a12, v213
  v_accvgpr_read_b32 v213, a13
  v_mul_f32 v213, v213, v214
  v_accvgpr_write_b32 a13, v213
  v_accvgpr_read_b32 v213, a14
  v_mul_f32 v213, v213, v214
  v_accvgpr_write_b32 a14, v213
  v_accvgpr_read_b32 v213, a15
  v_mul_f32 v213, v213, v214
  v_accvgpr_write_b32 a15, v213
  v_accvgpr_read_b32 v213, a32
  v_mul_f32 v213, v213, v214
  v_accvgpr_write_b32 a32, v213
  v_accvgpr_read_b32 v213, a33
  v_mul_f32 v213, v213, v214
  v_accvgpr_write_b32 a33, v213
  v_accvgpr_read_b32 v213, a34
  v_mul_f32 v213, v213, v214
  v_accvgpr_write_b32 a34, v213
  v_accvgpr_read_b32 v213, a35
  v_mul_f32 v213, v213, v214
  v_accvgpr_write_b32 a35, v213
  v_accvgpr_read_b32 v213, a36
  v_mul_f32 v213, v213, v214
  v_accvgpr_write_b32 a36, v213
  v_accvgpr_read_b32 v213, a37
  v_mul_f32 v213, v213, v214
  v_accvgpr_write_b32 a37, v213
  v_accvgpr_read_b32 v213, a38
  v_mul_f32 v213, v213, v214
  v_accvgpr_write_b32 a38, v213
  v_accvgpr_read_b32 v213, a39
  v_mul_f32 v213, v213, v214
  v_accvgpr_write_b32 a39, v213
  v_accvgpr_read_b32 v213, a40
  v_mul_f32 v213, v213, v214
  v_accvgpr_write_b32 a40, v213
  v_accvgpr_read_b32 v213, a41
  v_mul_f32 v213, v213, v214
  v_accvgpr_write_b32 a41, v213
  v_accvgpr_read_b32 v213, a42
  v_mul_f32 v213, v213, v214
  v_accvgpr_write_b32 a42, v213
  v_accvgpr_read_b32 v213, a43
  v_mul_f32 v213, v213, v214
  v_accvgpr_write_b32 a43, v213
  v_accvgpr_read_b32 v213, a44
  v_mul_f32 v213, v213, v214
  v_accvgpr_write_b32 a44, v213
  v_accvgpr_read_b32 v213, a45
  v_mul_f32 v213, v213, v214
  v_accvgpr_write_b32 a45, v213
  v_accvgpr_read_b32 v213, a46
  v_mul_f32 v213, v213, v214
  v_accvgpr_write_b32 a46, v213
  v_accvgpr_read_b32 v213, a47
  v_mul_f32 v213, v213, v214
  v_accvgpr_write_b32 a47, v213
  v_accvgpr_read_b32 v213, a64
  v_mul_f32 v213, v213, v214
  v_accvgpr_write_b32 a64, v213
  v_accvgpr_read_b32 v213, a65
  v_mul_f32 v213, v213, v214
  v_accvgpr_write_b32 a65, v213
  v_accvgpr_read_b32 v213, a66
  v_mul_f32 v213, v213, v214
  v_accvgpr_write_b32 a66, v213
  v_accvgpr_read_b32 v213, a67
  v_mul_f32 v213, v213, v214
  v_accvgpr_write_b32 a67, v213
  v_accvgpr_read_b32 v213, a68
  v_mul_f32 v213, v213, v214
  v_accvgpr_write_b32 a68, v213
  v_accvgpr_read_b32 v213, a69
  v_mul_f32 v213, v213, v214
  v_accvgpr_write_b32 a69, v213
  v_accvgpr_read_b32 v213, a70
  v_mul_f32 v213, v213, v214
  v_accvgpr_write_b32 a70, v213
  v_accvgpr_read_b32 v213, a71
  v_mul_f32 v213, v213, v214
  v_accvgpr_write_b32 a71, v213
  v_accvgpr_read_b32 v213, a72
  v_mul_f32 v213, v213, v214
  v_accvgpr_write_b32 a72, v213
  v_accvgpr_read_b32 v213, a73
  v_mul_f32 v213, v213, v214
  v_accvgpr_write_b32 a73, v213
  v_accvgpr_read_b32 v213, a74
  v_mul_f32 v213, v213, v214
  v_accvgpr_write_b32 a74, v213
  v_accvgpr_read_b32 v213, a75
  v_mul_f32 v213, v213, v214
  v_accvgpr_write_b32 a75, v213
  v_accvgpr_read_b32 v213, a76
  v_mul_f32 v213, v213, v214
  v_accvgpr_write_b32 a76, v213
  v_accvgpr_read_b32 v213, a77
  v_mul_f32 v213, v213, v214
  v_accvgpr_write_b32 a77, v213
  v_accvgpr_read_b32 v213, a78
  v_mul_f32 v213, v213, v214
  v_accvgpr_write_b32 a78, v213
  v_accvgpr_read_b32 v213, a79
  v_mul_f32 v213, v213, v214
  v_accvgpr_write_b32 a79, v213
  v_accvgpr_read_b32 v213, a96
  v_mul_f32 v213, v213, v214
  v_accvgpr_write_b32 a96, v213
  v_accvgpr_read_b32 v213, a97
  v_mul_f32 v213, v213, v214
  v_accvgpr_write_b32 a97, v213
  v_accvgpr_read_b32 v213, a98
  v_mul_f32 v213, v213, v214
  v_accvgpr_write_b32 a98, v213
  v_accvgpr_read_b32 v213, a99
  v_mul_f32 v213, v213, v214
  v_accvgpr_write_b32 a99, v213
  v_accvgpr_read_b32 v213, a100
  v_mul_f32 v213, v213, v214
  v_accvgpr_write_b32 a100, v213
  v_accvgpr_read_b32 v213, a101
  v_mul_f32 v213, v213, v214
  v_accvgpr_write_b32 a101, v213
  v_accvgpr_read_b32 v213, a102
  v_mul_f32 v213, v213, v214
  v_accvgpr_write_b32 a102, v213
  v_accvgpr_read_b32 v213, a103
  v_mul_f32 v213, v213, v214
  v_accvgpr_write_b32 a103, v213
  v_accvgpr_read_b32 v213, a104
  v_mul_f32 v213, v213, v214
  v_accvgpr_write_b32 a104, v213
  v_accvgpr_read_b32 v213, a105
  v_mul_f32 v213, v213, v214
  v_accvgpr_write_b32 a105, v213
  v_accvgpr_read_b32 v213, a106
  v_mul_f32 v213, v213, v214
  v_accvgpr_write_b32 a106, v213
  v_accvgpr_read_b32 v213, a107
  v_mul_f32 v213, v213, v214
  v_accvgpr_write_b32 a107, v213
  v_accvgpr_read_b32 v213, a108
  v_mul_f32 v213, v213, v214
  v_accvgpr_write_b32 a108, v213
  v_accvgpr_read_b32 v213, a109
  v_mul_f32 v213, v213, v214
  v_accvgpr_write_b32 a109, v213
  v_accvgpr_read_b32 v213, a110
  v_mul_f32 v213, v213, v214
  v_accvgpr_write_b32 a110, v213
  v_accvgpr_read_b32 v213, a111
  v_mul_f32 v213, v213, v214
  v_accvgpr_write_b32 a111, v213
  v_max3_f32 v212, v56, v57, v58
  v_max3_f32 v212, v212, v59, v60
  v_max3_f32 v212, v212, v61, v62
  v_max3_f32 v212, v212, v63, v64
  v_max3_f32 v212, v212, v65, v66
  v_max3_f32 v212, v212, v67, v68
  v_max3_f32 v212, v212, v69, v70
  v_max_f32 v212, v212, v71
  v_mov_b32 v213, v212
  s_nop 1
  v_permlane32_swap_b32 v212, v213
  v_max_f32 v212, v212, v213
  v_max_f32 v212, 0, v212
  v_sub_f32 v120, v120, v212
  v_sub_f32 v121, v121, v212
  v_sub_f32 v122, v122, v212
  v_sub_f32 v123, v123, v212
  v_sub_f32 v124, v124, v212
  v_sub_f32 v125, v125, v212
  v_sub_f32 v126, v126, v212
  v_sub_f32 v127, v127, v212
  v_sub_f32 v128, v128, v212
  v_sub_f32 v129, v129, v212
  v_sub_f32 v130, v130, v212
  v_sub_f32 v131, v131, v212
  v_sub_f32 v132, v132, v212
  v_sub_f32 v133, v133, v212
  v_sub_f32 v134, v134, v212
  v_sub_f32 v135, v135, v212
  v_sub_f32 v56, v56, v212
  v_sub_f32 v57, v57, v212
  v_sub_f32 v58, v58, v212
  v_sub_f32 v59, v59, v212
  v_sub_f32 v60, v60, v212
  v_sub_f32 v61, v61, v212
  v_sub_f32 v62, v62, v212
  v_sub_f32 v63, v63, v212
  v_sub_f32 v64, v64, v212
  v_sub_f32 v65, v65, v212
  v_sub_f32 v66, v66, v212
  v_sub_f32 v67, v67, v212
  v_sub_f32 v68, v68, v212
  v_sub_f32 v69, v69, v212
  v_sub_f32 v70, v70, v212
  v_sub_f32 v71, v71, v212
  v_sub_f32 v24, v24, v212
  v_sub_f32 v25, v25, v212
  v_sub_f32 v26, v26, v212
  v_sub_f32 v27, v27, v212
  v_sub_f32 v28, v28, v212
  v_sub_f32 v29, v29, v212
  v_sub_f32 v30, v30, v212
  v_sub_f32 v31, v31, v212
  v_sub_f32 v32, v32, v212
  v_sub_f32 v33, v33, v212
  v_sub_f32 v34, v34, v212
  v_sub_f32 v35, v35, v212
  v_sub_f32 v36, v36, v212
  v_sub_f32 v37, v37, v212
  v_sub_f32 v38, v38, v212
  v_sub_f32 v39, v39, v212
  v_sub_f32 v214, 0, v212
  v_exp_f32 v214, v214
  s_nop 0
  v_mul_f32 v209, v209, v214
  v_accvgpr_read_b32 v213, a16
  v_mul_f32 v213, v213, v214
  v_accvgpr_write_b32 a16, v213
  v_accvgpr_read_b32 v213, a17
  v_mul_f32 v213, v213, v214
  v_accvgpr_write_b32 a17, v213
  v_accvgpr_read_b32 v213, a18
  v_mul_f32 v213, v213, v214
  v_accvgpr_write_b32 a18, v213
  v_accvgpr_read_b32 v213, a19
  v_mul_f32 v213, v213, v214
  v_accvgpr_write_b32 a19, v213
  v_accvgpr_read_b32 v213, a20
  v_mul_f32 v213, v213, v214
  v_accvgpr_write_b32 a20, v213
  v_accvgpr_read_b32 v213, a21
  v_mul_f32 v213, v213, v214
  v_accvgpr_write_b32 a21, v213
  v_accvgpr_read_b32 v213, a22
  v_mul_f32 v213, v213, v214
  v_accvgpr_write_b32 a22, v213
  v_accvgpr_read_b32 v213, a23
  v_mul_f32 v213, v213, v214
  v_accvgpr_write_b32 a23, v213
  v_accvgpr_read_b32 v213, a24
  v_mul_f32 v213, v213, v214
  v_accvgpr_write_b32 a24, v213
  v_accvgpr_read_b32 v213, a25
  v_mul_f32 v213, v213, v214
  v_accvgpr_write_b32 a25, v213
  v_accvgpr_read_b32 v213, a26
  v_mul_f32 v213, v213, v214
  v_accvgpr_write_b32 a26, v213
  v_accvgpr_read_b32 v213, a27
  v_mul_f32 v213, v213, v214
  v_accvgpr_write_b32 a27, v213
  v_accvgpr_read_b32 v213, a28
  v_mul_f32 v213, v213, v214
  v_accvgpr_write_b32 a28, v213
  v_accvgpr_read_b32 v213, a29
  v_mul_f32 v213, v213, v214
  v_accvgpr_write_b32 a29, v213
  v_accvgpr_read_b32 v213, a30
  v_mul_f32 v213, v213, v214
  v_accvgpr_write_b32 a30, v213
  v_accvgpr_read_b32 v213, a31
  v_mul_f32 v213, v213, v214
  v_accvgpr_write_b32 a31, v213
  v_accvgpr_read_b32 v213, a48
  v_mul_f32 v213, v213, v214
  v_accvgpr_write_b32 a48, v213
  v_accvgpr_read_b32 v213, a49
  v_mul_f32 v213, v213, v214
  v_accvgpr_write_b32 a49, v213
  v_accvgpr_read_b32 v213, a50
  v_mul_f32 v213, v213, v214
  v_accvgpr_write_b32 a50, v213
  v_accvgpr_read_b32 v213, a51
  v_mul_f32 v213, v213, v214
  v_accvgpr_write_b32 a51, v213
  v_accvgpr_read_b32 v213, a52
  v_mul_f32 v213, v213, v214
  v_accvgpr_write_b32 a52, v213
  v_accvgpr_read_b32 v213, a53
  v_mul_f32 v213, v213, v214
  v_accvgpr_write_b32 a53, v213
  v_accvgpr_read_b32 v213, a54
  v_mul_f32 v213, v213, v214
  v_accvgpr_write_b32 a54, v213
  v_accvgpr_read_b32 v213, a55
  v_mul_f32 v213, v213, v214
  v_accvgpr_write_b32 a55, v213
  v_accvgpr_read_b32 v213, a56
  v_mul_f32 v213, v213, v214
  v_accvgpr_write_b32 a56, v213
  v_accvgpr_read_b32 v213, a57
  v_mul_f32 v213, v213, v214
  v_accvgpr_write_b32 a57, v213
  v_accvgpr_read_b32 v213, a58
  v_mul_f32 v213, v213, v214
  v_accvgpr_write_b32 a58, v213
  v_accvgpr_read_b32 v213, a59
  v_mul_f32 v213, v213, v214
  v_accvgpr_write_b32 a59, v213
  v_accvgpr_read_b32 v213, a60
  v_mul_f32 v213, v213, v214
  v_accvgpr_write_b32 a60, v213
  v_accvgpr_read_b32 v213, a61
  v_mul_f32 v213, v213, v214
  v_accvgpr_write_b32 a61, v213
  v_accvgpr_read_b32 v213, a62
  v_mul_f32 v213, v213, v214
  v_accvgpr_write_b32 a62, v213
  v_accvgpr_read_b32 v213, a63
  v_mul_f32 v213, v213, v214
  v_accvgpr_write_b32 a63, v213
  v_accvgpr_read_b32 v213, a80
  v_mul_f32 v213, v213, v214
  v_accvgpr_write_b32 a80, v213
  v_accvgpr_read_b32 v213, a81
  v_mul_f32 v213, v213, v214
  v_accvgpr_write_b32 a81, v213
  v_accvgpr_read_b32 v213, a82
  v_mul_f32 v213, v213, v214
  v_accvgpr_write_b32 a82, v213
  v_accvgpr_read_b32 v213, a83
  v_mul_f32 v213, v213, v214
  v_accvgpr_write_b32 a83, v213
  v_accvgpr_read_b32 v213, a84
  v_mul_f32 v213, v213, v214
  v_accvgpr_write_b32 a84, v213
  v_accvgpr_read_b32 v213, a85
  v_mul_f32 v213, v213, v214
  v_accvgpr_write_b32 a85, v213
  v_accvgpr_read_b32 v213, a86
  v_mul_f32 v213, v213, v214
  v_accvgpr_write_b32 a86, v213
  v_accvgpr_read_b32 v213, a87
  v_mul_f32 v213, v213, v214
  v_accvgpr_write_b32 a87, v213
  v_accvgpr_read_b32 v213, a88
  v_mul_f32 v213, v213, v214
  v_accvgpr_write_b32 a88, v213
  v_accvgpr_read_b32 v213, a89
  v_mul_f32 v213, v213, v214
  v_accvgpr_write_b32 a89, v213
  v_accvgpr_read_b32 v213, a90
  v_mul_f32 v213, v213, v214
  v_accvgpr_write_b32 a90, v213
  v_accvgpr_read_b32 v213, a91
  v_mul_f32 v213, v213, v214
  v_accvgpr_write_b32 a91, v213
  v_accvgpr_read_b32 v213, a92
  v_mul_f32 v213, v213, v214
  v_accvgpr_write_b32 a92, v213
  v_accvgpr_read_b32 v213, a93
  v_mul_f32 v213, v213, v214
  v_accvgpr_write_b32 a93, v213
  v_accvgpr_read_b32 v213, a94
  v_mul_f32 v213, v213, v214
  v_accvgpr_write_b32 a94, v213
  v_accvgpr_read_b32 v213, a95
  v_mul_f32 v213, v213, v214
  v_accvgpr_write_b32 a95, v213
  v_accvgpr_read_b32 v213, a112
  v_mul_f32 v213, v213, v214
  v_accvgpr_write_b32 a112, v213
  v_accvgpr_read_b32 v213, a113
  v_mul_f32 v213, v213, v214
  v_accvgpr_write_b32 a113, v213
  v_accvgpr_read_b32 v213, a114
  v_mul_f32 v213, v213, v214
  v_accvgpr_write_b32 a114, v213
  v_accvgpr_read_b32 v213, a115
  v_mul_f32 v213, v213, v214
  v_accvgpr_write_b32 a115, v213
  v_accvgpr_read_b32 v213, a116
  v_mul_f32 v213, v213, v214
  v_accvgpr_write_b32 a116, v213
  v_accvgpr_read_b32 v213, a117
  v_mul_f32 v213, v213, v214
  v_accvgpr_write_b32 a117, v213
  v_accvgpr_read_b32 v213, a118
  v_mul_f32 v213, v213, v214
  v_accvgpr_write_b32 a118, v213
  v_accvgpr_read_b32 v213, a119
  v_mul_f32 v213, v213, v214
  v_accvgpr_write_b32 a119, v213
  v_accvgpr_read_b32 v213, a120
  v_mul_f32 v213, v213, v214
  v_accvgpr_write_b32 a120, v213
  v_accvgpr_read_b32 v213, a121
  v_mul_f32 v213, v213, v214
  v_accvgpr_write_b32 a121, v213
  v_accvgpr_read_b32 v213, a122
  v_mul_f32 v213, v213, v214
  v_accvgpr_write_b32 a122, v213
  v_accvgpr_read_b32 v213, a123
  v_mul_f32 v213, v213, v214
  v_accvgpr_write_b32 a123, v213
  v_accvgpr_read_b32 v213, a124
  v_mul_f32 v213, v213, v214
  v_accvgpr_write_b32 a124, v213
  v_accvgpr_read_b32 v213, a125
  v_mul_f32 v213, v213, v214
  v_accvgpr_write_b32 a125, v213
  v_accvgpr_read_b32 v213, a126
  v_mul_f32 v213, v213, v214
  v_accvgpr_write_b32 a126, v213
  v_accvgpr_read_b32 v213, a127
  v_mul_f32 v213, v213, v214
  v_accvgpr_write_b32 a127, v213
  v_exp_f32 v200, v40
  v_exp_f32 v201, v41
  v_add_f32 v210, v208, v200
  v_exp_f32 v202, v42
  v_add_f32 v210, v210, v201
  v_cvt_pk_bf16_f32 v88, v200, v201
  v_exp_f32 v203, v43
  v_add_f32 v210, v210, v202
  v_exp_f32 v204, v44
  v_add_f32 v210, v210, v203
  v_cvt_pk_bf16_f32 v89, v202, v203
  v_exp_f32 v205, v45
  v_add_f32 v210, v210, v204
  v_exp_f32 v206, v46
  v_add_f32 v210, v210, v205
  v_cvt_pk_bf16_f32 v90, v204, v205
  v_exp_f32 v207, v47
  v_add_f32 v210, v210, v206
  v_exp_f32 v200, v48
  v_add_f32 v210, v210, v207
  v_cvt_pk_bf16_f32 v91, v206, v207
  v_exp_f32 v201, v49
  v_add_f32 v210, v210, v200
  v_exp_f32 v202, v50
  v_add_f32 v210, v210, v201
  v_cvt_pk_bf16_f32 v92, v200, v201
  v_exp_f32 v203, v51
  v_add_f32 v210, v210, v202
  v_exp_f32 v204, v52
  v_add_f32 v210, v210, v203
  v_cvt_pk_bf16_f32 v93, v202, v203
  v_exp_f32 v205, v53
  v_add_f32 v210, v210, v204
  v_exp_f32 v206, v54
  v_add_f32 v210, v210, v205
  v_cvt_pk_bf16_f32 v94, v204, v205
  v_exp_f32 v207, v55
  v_add_f32 v210, v210, v206
  v_exp_f32 v200, v56
  v_add_f32 v210, v210, v207
  v_cvt_pk_bf16_f32 v95, v206, v207
  v_exp_f32 v201, v57
  v_add_f32 v211, v209, v200
  v_exp_f32 v202, v58
  v_add_f32 v211, v211, v201
  v_cvt_pk_bf16_f32 v96, v200, v201
  v_exp_f32 v203, v59
  v_add_f32 v211, v211, v202
  v_exp_f32 v204, v60
  v_add_f32 v211, v211, v203
  v_cvt_pk_bf16_f32 v97, v202, v203
  v_exp_f32 v205, v61
  v_add_f32 v211, v211, v204
  v_exp_f32 v206, v62
  v_add_f32 v211, v211, v205
  v_cvt_pk_bf16_f32 v98, v204, v205
  v_exp_f32 v207, v63
  v_add_f32 v211, v211, v206
  v_exp_f32 v200, v64
  v_add_f32 v211, v211, v207
  v_cvt_pk_bf16_f32 v99, v206, v207
  v_exp_f32 v201, v65
  v_add_f32 v211, v211, v200
  v_exp_f32 v202, v66
  v_add_f32 v211, v211, v201
  v_cvt_pk_bf16_f32 v100, v200, v201
  v_exp_f32 v203, v67
  v_add_f32 v211, v211, v202
  v_exp_f32 v204, v68
  v_add_f32 v211, v211, v203
  v_cvt_pk_bf16_f32 v101, v202, v203
  v_exp_f32 v205, v69
  v_add_f32 v211, v211, v204
  v_exp_f32 v206, v70
  v_add_f32 v211, v211, v205
  v_cvt_pk_bf16_f32 v102, v204, v205
  v_exp_f32 v207, v71
  v_add_f32 v211, v211, v206
  v_add_f32 v211, v211, v207
  v_cvt_pk_bf16_f32 v103, v206, v207
  s_branch k2_ret29
k2_fb30:
  v_max3_f32 v212, v8, v9, v10
  v_max3_f32 v212, v212, v11, v12
  v_max3_f32 v212, v212, v13, v14
  v_max3_f32 v212, v212, v15, v16
  v_max3_f32 v212, v212, v17, v18
  v_max3_f32 v212, v212, v19, v20
  v_max3_f32 v212, v212, v21, v22
  v_max_f32 v212, v212, v23
  v_mov_b32 v213, v212
  s_nop 1
  v_permlane32_swap_b32 v212, v213
  v_max_f32 v212, v212, v213
  v_max_f32 v212, 0, v212
  v_sub_f32 v104, v104, v212
  v_sub_f32 v105, v105, v212
  v_sub_f32 v106, v106, v212
  v_sub_f32 v107, v107, v212
  v_sub_f32 v108, v108, v212
  v_sub_f32 v109, v109, v212
  v_sub_f32 v110, v110, v212
  v_sub_f32 v111, v111, v212
  v_sub_f32 v112, v112, v212
  v_sub_f32 v113, v113, v212
  v_sub_f32 v114, v114, v212
  v_sub_f32 v115, v115, v212
  v_sub_f32 v116, v116, v212
  v_sub_f32 v117, v117, v212
  v_sub_f32 v118, v118, v212
  v_sub_f32 v119, v119, v212
  v_sub_f32 v8, v8, v212
  v_sub_f32 v9, v9, v212
  v_sub_f32 v10, v10, v212
  v_sub_f32 v11, v11, v212
  v_sub_f32 v12, v12, v212
  v_sub_f32 v13, v13, v212
  v_sub_f32 v14, v14, v212
  v_sub_f32 v15, v15, v212
  v_sub_f32 v16, v16, v212
  v_sub_f32 v17, v17, v212
  v_sub_f32 v18, v18, v212
  v_sub_f32 v19, v19, v212
  v_sub_f32 v20, v20, v212
  v_sub_f32 v21, v21, v212
  v_sub_f32 v22, v22, v212
  v_sub_f32 v23, v23, v212
  v_sub_f32 v40, v40, v212
  v_sub_f32 v41, v41, v212
  v_sub_f32 v42, v42, v212
  v_sub_f32 v43, v43, v212
  v_sub_f32 v44, v44, v212
  v_sub_f32 v45, v45, v212
  v_sub_f32 v46, v46, v212
  v_sub_f32 v47, v47, v212
  v_sub_f32 v48, v48, v212
  v_sub_f32 v49, v49, v212
  v_sub_f32 v50, v50, v212
  v_sub_f32 v51, v51, v212
  v_sub_f32 v52, v52, v212
  v_sub_f32 v53, v53, v212
  v_sub_f32 v54, v54, v212
  v_sub_f32 v55, v55, v212
  v_sub_f32 v214, 0, v212
  v_exp_f32 v214, v214
  s_nop 0
  v_mul_f32 v210, v210, v214
  v_accvgpr_read_b32 v213, a0
  v_mul_f32 v213, v213, v214
  v_accvgpr_write_b32 a0, v213
  v_accvgpr_read_b32 v213, a1
  v_mul_f32 v213, v213, v214
  v_accvgpr_write_b32 a1, v213
  v_accvgpr_read_b32 v213, a2
  v_mul_f32 v213, v213, v214
  v_accvgpr_write_b32 a2, v213
  v_accvgpr_read_b32 v213, a3
  v_mul_f32 v213, v213, v214
  v_accvgpr_write_b32 a3, v213
  v_accvgpr_read_b32 v213, a4
  v_mul_f32 v213, v213, v214
  v_accvgpr_write_b32 a4, v213
  v_accvgpr_read_b32 v213, a5
  v_mul_f32 v213, v213, v214
  v_accvgpr_write_b32 a5, v213
  v_accvgpr_read_b32 v213, a6
  v_mul_f32 v213, v213, v214
  v_accvgpr_write_b32 a6, v213
  v_accvgpr_read_b32 v213, a7
  v_mul_f32 v213, v213, v214
  v_accvgpr_write_b32 a7, v213
  v_accvgpr_read_b32 v213, a8
  v_mul_f32 v213, v213, v214
  v_accvgpr_write_b32 a8, v213
  v_accvgpr_read_b32 v213, a9
  v_mul_f32 v213, v213, v214
  v_accvgpr_write_b32 a9, v213
  v_accvgpr_read_b32 v213, a10
  v_mul_f32 v213, v213, v214
  v_accvgpr_write_b32 a10, v213
  v_accvgpr_read_b32 v213, a11
  v_mul_f32 v213, v213, v214
  v_accvgpr_write_b32 a11, v213
  v_accvgpr_read_b32 v213, a12
  v_mul_f32 v213, v213, v214
  v_accvgpr_write_b32 a12, v213
  v_accvgpr_read_b32 v213, a13
  v_mul_f32 v213, v213, v214
  v_accvgpr_write_b32 a13, v213
  v_accvgpr_read_b32 v213, a14
  v_mul_f32 v213, v213, v214
  v_accvgpr_write_b32 a14, v213
  v_accvgpr_read_b32 v213, a15
  v_mul_f32 v213, v213, v214
  v_accvgpr_write_b32 a15, v213
  v_accvgpr_read_b32 v213, a32
  v_mul_f32 v213, v213, v214
  v_accvgpr_write_b32 a32, v213
  v_accvgpr_read_b32 v213, a33
  v_mul_f32 v213, v213, v214
  v_accvgpr_write_b32 a33, v213
  v_accvgpr_read_b32 v213, a34
  v_mul_f32 v213, v213, v214
  v_accvgpr_write_b32 a34, v213
  v_accvgpr_read_b32 v213, a35
  v_mul_f32 v213, v213, v214
  v_accvgpr_write_b32 a35, v213
  v_accvgpr_read_b32 v213, a36
  v_mul_f32 v213, v213, v214
  v_accvgpr_write_b32 a36, v213
  v_accvgpr_read_b32 v213, a37
  v_mul_f32 v213, v213, v214
  v_accvgpr_write_b32 a37, v213
  v_accvgpr_read_b32 v213, a38
  v_mul_f32 v213, v213, v214
  v_accvgpr_write_b32 a38, v213
  v_accvgpr_read_b32 v213, a39
  v_mul_f32 v213, v213, v214
  v_accvgpr_write_b32 a39, v213
  v_accvgpr_read_b32 v213, a40
  v_mul_f32 v213, v213, v214
  v_accvgpr_write_b32 a40, v213
  v_accvgpr_read_b32 v213, a41
  v_mul_f32 v213, v213, v214
  v_accvgpr_write_b32 a41, v213
  v_accvgpr_read_b32 v213, a42
  v_mul_f32 v213, v213, v214
  v_accvgpr_write_b32 a42, v213
  v_accvgpr_read_b32 v213, a43
  v_mul_f32 v213, v213, v214
  v_accvgpr_write_b32 a43, v213
  v_accvgpr_read_b32 v213, a44
  v_mul_f32 v213, v213, v214
  v_accvgpr_write_b32 a44, v213
  v_accvgpr_read_b32 v213, a45
  v_mul_f32 v213, v213, v214
  v_accvgpr_write_b32 a45, v213
  v_accvgpr_read_b32 v213, a46
  v_mul_f32 v213, v213, v214
  v_accvgpr_write_b32 a46, v213
  v_accvgpr_read_b32 v213, a47
  v_mul_f32 v213, v213, v214
  v_accvgpr_write_b32 a47, v213
  v_accvgpr_read_b32 v213, a64
  v_mul_f32 v213, v213, v214
  v_accvgpr_write_b32 a64, v213
  v_accvgpr_read_b32 v213, a65
  v_mul_f32 v213, v213, v214
  v_accvgpr_write_b32 a65, v213
  v_accvgpr_read_b32 v213, a66
  v_mul_f32 v213, v213, v214
  v_accvgpr_write_b32 a66, v213
  v_accvgpr_read_b32 v213, a67
  v_mul_f32 v213, v213, v214
  v_accvgpr_write_b32 a67, v213
  v_accvgpr_read_b32 v213, a68
  v_mul_f32 v213, v213, v214
  v_accvgpr_write_b32 a68, v213
  v_accvgpr_read_b32 v213, a69
  v_mul_f32 v213, v213, v214
  v_accvgpr_write_b32 a69, v213
  v_accvgpr_read_b32 v213, a70
  v_mul_f32 v213, v213, v214
  v_accvgpr_write_b32 a70, v213
  v_accvgpr_read_b32 v213, a71
  v_mul_f32 v213, v213, v214
  v_accvgpr_write_b32 a71, v213
  v_accvgpr_read_b32 v213, a72
  v_mul_f32 v213, v213, v214
  v_accvgpr_write_b32 a72, v213
  v_accvgpr_read_b32 v213, a73
  v_mul_f32 v213, v213, v214
  v_accvgpr_write_b32 a73, v213
  v_accvgpr_read_b32 v213, a74
  v_mul_f32 v213, v213, v214
  v_accvgpr_write_b32 a74, v213
  v_accvgpr_read_b32 v213, a75
  v_mul_f32 v213, v213, v214
  v_accvgpr_write_b32 a75, v213
  v_accvgpr_read_b32 v213, a76
  v_mul_f32 v213, v213, v214
  v_accvgpr_write_b32 a76, v213
  v_accvgpr_read_b32 v213, a77
  v_mul_f32 v213, v213, v214
  v_accvgpr_write_b32 a77, v213
  v_accvgpr_read_b32 v213, a78
  v_mul_f32 v213, v213, v214
  v_accvgpr_write_b32 a78, v213
  v_accvgpr_read_b32 v213, a79
  v_mul_f32 v213, v213, v214
  v_accvgpr_write_b32 a79, v213
  v_accvgpr_read_b32 v213, a96
  v_mul_f32 v213, v213, v214
  v_accvgpr_write_b32 a96, v213
  v_accvgpr_read_b32 v213, a97
  v_mul_f32 v213, v213, v214
  v_accvgpr_write_b32 a97, v213
  v_accvgpr_read_b32 v213, a98
  v_mul_f32 v213, v213, v214
  v_accvgpr_write_b32 a98, v213
  v_accvgpr_read_b32 v213, a99
  v_mul_f32 v213, v213, v214
  v_accvgpr_write_b32 a99, v213
  v_accvgpr_read_b32 v213, a100
  v_mul_f32 v213, v213, v214
  v_accvgpr_write_b32 a100, v213
  v_accvgpr_read_b32 v213, a101
  v_mul_f32 v213, v213, v214
  v_accvgpr_write_b32 a101, v213
  v_accvgpr_read_b32 v213, a102
  v_mul_f32 v213, v213, v214
  v_accvgpr_write_b32 a102, v213
  v_accvgpr_read_b32 v213, a103
  v_mul_f32 v213, v213, v214
  v_accvgpr_write_b32 a103, v213
  v_accvgpr_read_b32 v213, a104
  v_mul_f32 v213, v213, v214
  v_accvgpr_write_b32 a104, v213
  v_accvgpr_read_b32 v213, a105
  v_mul_f32 v213, v213, v214
  v_accvgpr_write_b32 a105, v213
  v_accvgpr_read_b32 v213, a106
  v_mul_f32 v213, v213, v214
  v_accvgpr_write_b32 a106, v213
  v_accvgpr_read_b32 v213, a107
  v_mul_f32 v213, v213, v214
  v_accvgpr_write_b32 a107, v213
  v_accvgpr_read_b32 v213, a108
  v_mul_f32 v213, v213, v214
  v_accvgpr_write_b32 a108, v213
  v_accvgpr_read_b32 v213, a109
  v_mul_f32 v213, v213, v214
  v_accvgpr_write_b32 a109, v213
  v_accvgpr_read_b32 v213, a110
  v_mul_f32 v213, v213, v214
  v_accvgpr_write_b32 a110, v213
  v_accvgpr_read_b32 v213, a111
  v_mul_f32 v213, v213, v214
  v_accvgpr_write_b32 a111, v213
  v_max3_f32 v212, v24, v25, v26
  v_max3_f32 v212, v212, v27, v28
  v_max3_f32 v212, v212, v29, v30
  v_max3_f32 v212, v212, v31, v32
  v_max3_f32 v212, v212, v33, v34
  v_max3_f32 v212, v212, v35, v36
  v_max3_f32 v212, v212, v37, v38
  v_max_f32 v212, v212, v39
  v_mov_b32 v213, v212
  s_nop 1
  v_permlane32_swap_b32 v212, v213
  v_max_f32 v212, v212, v213
  v_max_f32 v212, 0, v212
  v_sub_f32 v120, v120, v212
  v_sub_f32 v121, v121, v212
  v_sub_f32 v122, v122, v212
  v_sub_f32 v123, v123, v212
  v_sub_f32 v124, v124, v212
  v_sub_f32 v125, v125, v212
  v_sub_f32 v126, v126, v212
  v_sub_f32 v127, v127, v212
  v_sub_f32 v128, v128, v212
  v_sub_f32 v129, v129, v212
  v_sub_f32 v130, v130, v212
  v_sub_f32 v131, v131, v212
  v_sub_f32 v132, v132, v212
  v_sub_f32 v133, v133, v212
  v_sub_f32 v134, v134, v212
  v_sub_f32 v135, v135, v212
  v_sub_f32 v24, v24, v212
  v_sub_f32 v25, v25, v212
  v_sub_f32 v26, v26, v212
  v_sub_f32 v27, v27, v212
  v_sub_f32 v28, v28, v212
  v_sub_f32 v29, v29, v212
  v_sub_f32 v30, v30, v212
  v_sub_f32 v31, v31, v212
  v_sub_f32 v32, v32, v212
  v_sub_f32 v33, v33, v212
  v_sub_f32 v34, v34, v212
  v_sub_f32 v35, v35, v212
  v_sub_f32 v36, v36, v212
  v_sub_f32 v37, v37, v212
  v_sub_f32 v38, v38, v212
  v_sub_f32 v39, v39, v212
  v_sub_f32 v56, v56, v212
  v_sub_f32 v57, v57, v212
  v_sub_f32 v58, v58, v212
  v_sub_f32 v59, v59, v212
  v_sub_f32 v60, v60, v212
  v_sub_f32 v61, v61, v212
  v_sub_f32 v62, v62, v212
  v_sub_f32 v63, v63, v212
  v_sub_f32 v64, v64, v212
  v_sub_f32 v65, v65, v212
  v_sub_f32 v66, v66, v212
  v_sub_f32 v67, v67, v212
  v_sub_f32 v68, v68, v212
  v_sub_f32 v69, v69, v212
  v_sub_f32 v70, v70, v212
  v_sub_f32 v71, v71, v212
  v_sub_f32 v214, 0, v212
  v_exp_f32 v214, v214
  s_nop 0
  v_mul_f32 v211, v211, v214
  v_accvgpr_read_b32 v213, a16
  v_mul_f32 v213, v213, v214
  v_accvgpr_write_b32 a16, v213
  v_accvgpr_read_b32 v213, a17
  v_mul_f32 v213, v213, v214
  v_accvgpr_write_b32 a17, v213
  v_accvgpr_read_b32 v213, a18
  v_mul_f32 v213, v213, v214
  v_accvgpr_write_b32 a18, v213
  v_accvgpr_read_b32 v213, a19
  v_mul_f32 v213, v213, v214
  v_accvgpr_write_b32 a19, v213
  v_accvgpr_read_b32 v213, a20
  v_mul_f32 v213, v213, v214
  v_accvgpr_write_b32 a20, v213
  v_accvgpr_read_b32 v213, a21
  v_mul_f32 v213, v213, v214
  v_accvgpr_write_b32 a21, v213
  v_accvgpr_read_b32 v213, a22
  v_mul_f32 v213, v213, v214
  v_accvgpr_write_b32 a22, v213
  v_accvgpr_read_b32 v213, a23
  v_mul_f32 v213, v213, v214
  v_accvgpr_write_b32 a23, v213
  v_accvgpr_read_b32 v213, a24
  v_mul_f32 v213, v213, v214
  v_accvgpr_write_b32 a24, v213
  v_accvgpr_read_b32 v213, a25
  v_mul_f32 v213, v213, v214
  v_accvgpr_write_b32 a25, v213
  v_accvgpr_read_b32 v213, a26
  v_mul_f32 v213, v213, v214
  v_accvgpr_write_b32 a26, v213
  v_accvgpr_read_b32 v213, a27
  v_mul_f32 v213, v213, v214
  v_accvgpr_write_b32 a27, v213
  v_accvgpr_read_b32 v213, a28
  v_mul_f32 v213, v213, v214
  v_accvgpr_write_b32 a28, v213
  v_accvgpr_read_b32 v213, a29
  v_mul_f32 v213, v213, v214
  v_accvgpr_write_b32 a29, v213
  v_accvgpr_read_b32 v213, a30
  v_mul_f32 v213, v213, v214
  v_accvgpr_write_b32 a30, v213
  v_accvgpr_read_b32 v213, a31
  v_mul_f32 v213, v213, v214
  v_accvgpr_write_b32 a31, v213
  v_accvgpr_read_b32 v213, a48
  v_mul_f32 v213, v213, v214
  v_accvgpr_write_b32 a48, v213
  v_accvgpr_read_b32 v213, a49
  v_mul_f32 v213, v213, v214
  v_accvgpr_write_b32 a49, v213
  v_accvgpr_read_b32 v213, a50
  v_mul_f32 v213, v213, v214
  v_accvgpr_write_b32 a50, v213
  v_accvgpr_read_b32 v213, a51
  v_mul_f32 v213, v213, v214
  v_accvgpr_write_b32 a51, v213
  v_accvgpr_read_b32 v213, a52
  v_mul_f32 v213, v213, v214
  v_accvgpr_write_b32 a52, v213
  v_accvgpr_read_b32 v213, a53
  v_mul_f32 v213, v213, v214
  v_accvgpr_write_b32 a53, v213
  v_accvgpr_read_b32 v213, a54
  v_mul_f32 v213, v213, v214
  v_accvgpr_write_b32 a54, v213
  v_accvgpr_read_b32 v213, a55
  v_mul_f32 v213, v213, v214
  v_accvgpr_write_b32 a55, v213
  v_accvgpr_read_b32 v213, a56
  v_mul_f32 v213, v213, v214
  v_accvgpr_write_b32 a56, v213
  v_accvgpr_read_b32 v213, a57
  v_mul_f32 v213, v213, v214
  v_accvgpr_write_b32 a57, v213
  v_accvgpr_read_b32 v213, a58
  v_mul_f32 v213, v213, v214
  v_accvgpr_write_b32 a58, v213
  v_accvgpr_read_b32 v213, a59
  v_mul_f32 v213, v213, v214
  v_accvgpr_write_b32 a59, v213
  v_accvgpr_read_b32 v213, a60
  v_mul_f32 v213, v213, v214
  v_accvgpr_write_b32 a60, v213
  v_accvgpr_read_b32 v213, a61
  v_mul_f32 v213, v213, v214
  v_accvgpr_write_b32 a61, v213
  v_accvgpr_read_b32 v213, a62
  v_mul_f32 v213, v213, v214
  v_accvgpr_write_b32 a62, v213
  v_accvgpr_read_b32 v213, a63
  v_mul_f32 v213, v213, v214
  v_accvgpr_write_b32 a63, v213
  v_accvgpr_read_b32 v213, a80
  v_mul_f32 v213, v213, v214
  v_accvgpr_write_b32 a80, v213
  v_accvgpr_read_b32 v213, a81
  v_mul_f32 v213, v213, v214
  v_accvgpr_write_b32 a81, v213
  v_accvgpr_read_b32 v213, a82
  v_mul_f32 v213, v213, v214
  v_accvgpr_write_b32 a82, v213
  v_accvgpr_read_b32 v213, a83
  v_mul_f32 v213, v213, v214
  v_accvgpr_write_b32 a83, v213
  v_accvgpr_read_b32 v213, a84
  v_mul_f32 v213, v213, v214
  v_accvgpr_write_b32 a84, v213
  v_accvgpr_read_b32 v213, a85
  v_mul_f32 v213, v213, v214
  v_accvgpr_write_b32 a85, v213
  v_accvgpr_read_b32 v213, a86
  v_mul_f32 v213, v213, v214
  v_accvgpr_write_b32 a86, v213
  v_accvgpr_read_b32 v213, a87
  v_mul_f32 v213, v213, v214
  v_accvgpr_write_b32 a87, v213
  v_accvgpr_read_b32 v213, a88
  v_mul_f32 v213, v213, v214
  v_accvgpr_write_b32 a88, v213
  v_accvgpr_read_b32 v213, a89
  v_mul_f32 v213, v213, v214
  v_accvgpr_write_b32 a89, v213
  v_accvgpr_read_b32 v213, a90
  v_mul_f32 v213, v213, v214
  v_accvgpr_write_b32 a90, v213
  v_accvgpr_read_b32 v213, a91
  v_mul_f32 v213, v213, v214
  v_accvgpr_write_b32 a91, v213
  v_accvgpr_read_b32 v213, a92
  v_mul_f32 v213, v213, v214
  v_accvgpr_write_b32 a92, v213
  v_accvgpr_read_b32 v213, a93
  v_mul_f32 v213, v213, v214
  v_accvgpr_write_b32 a93, v213
  v_accvgpr_read_b32 v213, a94
  v_mul_f32 v213, v213, v214
  v_accvgpr_write_b32 a94, v213
  v_accvgpr_read_b32 v213, a95
  v_mul_f32 v213, v213, v214
  v_accvgpr_write_b32 a95, v213
  v_accvgpr_read_b32 v213, a112
  v_mul_f32 v213, v213, v214
  v_accvgpr_write_b32 a112, v213
  v_accvgpr_read_b32 v213, a113
  v_mul_f32 v213, v213, v214
  v_accvgpr_write_b32 a113, v213
  v_accvgpr_read_b32 v213, a114
  v_mul_f32 v213, v213, v214
  v_accvgpr_write_b32 a114, v213
  v_accvgpr_read_b32 v213, a115
  v_mul_f32 v213, v213, v214
  v_accvgpr_write_b32 a115, v213
  v_accvgpr_read_b32 v213, a116
  v_mul_f32 v213, v213, v214
  v_accvgpr_write_b32 a116, v213
  v_accvgpr_read_b32 v213, a117
  v_mul_f32 v213, v213, v214
  v_accvgpr_write_b32 a117, v213
  v_accvgpr_read_b32 v213, a118
  v_mul_f32 v213, v213, v214
  v_accvgpr_write_b32 a118, v213
  v_accvgpr_read_b32 v213, a119
  v_mul_f32 v213, v213, v214
  v_accvgpr_write_b32 a119, v213
  v_accvgpr_read_b32 v213, a120
  v_mul_f32 v213, v213, v214
  v_accvgpr_write_b32 a120, v213
  v_accvgpr_read_b32 v213, a121
  v_mul_f32 v213, v213, v214
  v_accvgpr_write_b32 a121, v213
  v_accvgpr_read_b32 v213, a122
  v_mul_f32 v213, v213, v214
  v_accvgpr_write_b32 a122, v213
  v_accvgpr_read_b32 v213, a123
  v_mul_f32 v213, v213, v214
  v_accvgpr_write_b32 a123, v213
  v_accvgpr_read_b32 v213, a124
  v_mul_f32 v213, v213, v214
  v_accvgpr_write_b32 a124, v213
  v_accvgpr_read_b32 v213, a125
  v_mul_f32 v213, v213, v214
  v_accvgpr_write_b32 a125, v213
  v_accvgpr_read_b32 v213, a126
  v_mul_f32 v213, v213, v214
  v_accvgpr_write_b32 a126, v213
  v_accvgpr_read_b32 v213, a127
  v_mul_f32 v213, v213, v214
  v_accvgpr_write_b32 a127, v213
  v_exp_f32 v200, v8
  v_exp_f32 v201, v9
  v_add_f32 v208, v210, v200
  v_exp_f32 v202, v10
  v_add_f32 v208, v208, v201
  v_cvt_pk_bf16_f32 v72, v200, v201
  v_exp_f32 v203, v11
  v_add_f32 v208, v208, v202
  v_exp_f32 v204, v12
  v_add_f32 v208, v208, v203
  v_cvt_pk_bf16_f32 v73, v202, v203
  v_exp_f32 v205, v13
  v_add_f32 v208, v208, v204
  v_exp_f32 v206, v14
  v_add_f32 v208, v208, v205
  v_cvt_pk_bf16_f32 v74, v204, v205
  v_exp_f32 v207, v15
  v_add_f32 v208, v208, v206
  v_exp_f32 v200, v16
  v_add_f32 v208, v208, v207
  v_cvt_pk_bf16_f32 v75, v206, v207
  v_exp_f32 v201, v17
  v_add_f32 v208, v208, v200
  v_exp_f32 v202, v18
  v_add_f32 v208, v208, v201
  v_cvt_pk_bf16_f32 v76, v200, v201
  v_exp_f32 v203, v19
  v_add_f32 v208, v208, v202
  v_exp_f32 v204, v20
  v_add_f32 v208, v208, v203
  v_cvt_pk_bf16_f32 v77, v202, v203
  v_exp_f32 v205, v21
  v_add_f32 v208, v208, v204
  v_exp_f32 v206, v22
  v_add_f32 v208, v208, v205
  v_cvt_pk_bf16_f32 v78, v204, v205
  v_exp_f32 v207, v23
  v_add_f32 v208, v208, v206
  v_exp_f32 v200, v24
  v_add_f32 v208, v208, v207
  v_cvt_pk_bf16_f32 v79, v206, v207
  v_exp_f32 v201, v25
  v_add_f32 v209, v211, v200
  v_exp_f32 v202, v26
  v_add_f32 v209, v209, v201
  v_cvt_pk_bf16_f32 v80, v200, v201
  v_exp_f32 v203, v27
  v_add_f32 v209, v209, v202
  v_exp_f32 v204, v28
  v_add_f32 v209, v209, v203
  v_cvt_pk_bf16_f32 v81, v202, v203
  v_exp_f32 v205, v29
  v_add_f32 v209, v209, v204
  v_exp_f32 v206, v30
  v_add_f32 v209, v209, v205
  v_cvt_pk_bf16_f32 v82, v204, v205
  v_exp_f32 v207, v31
  v_add_f32 v209, v209, v206
  v_exp_f32 v200, v32
  v_add_f32 v209, v209, v207
  v_cvt_pk_bf16_f32 v83, v206, v207
  v_exp_f32 v201, v33
  v_add_f32 v209, v209, v200
  v_exp_f32 v202, v34
  v_add_f32 v209, v209, v201
  v_cvt_pk_bf16_f32 v84, v200, v201
  v_exp_f32 v203, v35
  v_add_f32 v209, v209, v202
  v_exp_f32 v204, v36
  v_add_f32 v209, v209, v203
  v_cvt_pk_bf16_f32 v85, v202, v203
  v_exp_f32 v205, v37
  v_add_f32 v209, v209, v204
  v_exp_f32 v206, v38
  v_add_f32 v209, v209, v205
  v_cvt_pk_bf16_f32 v86, v204, v205
  v_exp_f32 v207, v39
  v_add_f32 v209, v209, v206
  v_add_f32 v209, v209, v207
  v_cvt_pk_bf16_f32 v87, v206, v207
  s_branch k2_ret31
k2_fb32:
  v_max3_f32 v212, v40, v41, v42
  v_max3_f32 v212, v212, v43, v44
  v_max3_f32 v212, v212, v45, v46
  v_max3_f32 v212, v212, v47, v48
  v_max3_f32 v212, v212, v49, v50
  v_max3_f32 v212, v212, v51, v52
  v_max3_f32 v212, v212, v53, v54
  v_max_f32 v212, v212, v55
  v_mov_b32 v213, v212
  s_nop 1
  v_permlane32_swap_b32 v212, v213
  v_max_f32 v212, v212, v213
  v_max_f32 v212, 0, v212
  v_sub_f32 v104, v104, v212
  v_sub_f32 v105, v105, v212
  v_sub_f32 v106, v106, v212
  v_sub_f32 v107, v107, v212
  v_sub_f32 v108, v108, v212
  v_sub_f32 v109, v109, v212
  v_sub_f32 v110, v110, v212
  v_sub_f32 v111, v111, v212
  v_sub_f32 v112, v112, v212
  v_sub_f32 v113, v113, v212
  v_sub_f32 v114, v114, v212
  v_sub_f32 v115, v115, v212
  v_sub_f32 v116, v116, v212
  v_sub_f32 v117, v117, v212
  v_sub_f32 v118, v118, v212
  v_sub_f32 v119, v119, v212
  v_sub_f32 v40, v40, v212
  v_sub_f32 v41, v41, v212
  v_sub_f32 v42, v42, v212
  v_sub_f32 v43, v43, v212
  v_sub_f32 v44, v44, v212
  v_sub_f32 v45, v45, v212
  v_sub_f32 v46, v46, v212
  v_sub_f32 v47, v47, v212
  v_sub_f32 v48, v48, v212
  v_sub_f32 v49, v49, v212
  v_sub_f32 v50, v50, v212
  v_sub_f32 v51, v51, v212
  v_sub_f32 v52, v52, v212
  v_sub_f32 v53, v53, v212
  v_sub_f32 v54, v54, v212
  v_sub_f32 v55, v55, v212
  v_sub_f32 v214, 0, v212
  v_exp_f32 v214, v214
  s_nop 0
  v_mul_f32 v208, v208, v214
  v_accvgpr_read_b32 v213, a0
  v_mul_f32 v213, v213, v214
  v_accvgpr_write_b32 a0, v213
  v_accvgpr_read_b32 v213, a1
  v_mul_f32 v213, v213, v214
  v_accvgpr_write_b32 a1, v213
  v_accvgpr_read_b32 v213, a2
  v_mul_f32 v213, v213, v214
  v_accvgpr_write_b32 a2, v213
  v_accvgpr_read_b32 v213, a3
  v_mul_f32 v213, v213, v214
  v_accvgpr_write_b32 a3, v213
  v_accvgpr_read_b32 v213, a4
  v_mul_f32 v213, v213, v214
  v_accvgpr_write_b32 a4, v213
  v_accvgpr_read_b32 v213, a5
  v_mul_f32 v213, v213, v214
  v_accvgpr_write_b32 a5, v213
  v_accvgpr_read_b32 v213, a6
  v_mul_f32 v213, v213, v214
  v_accvgpr_write_b32 a6, v213
  v_accvgpr_read_b32 v213, a7
  v_mul_f32 v213, v213, v214
  v_accvgpr_write_b32 a7, v213
  v_accvgpr_read_b32 v213, a8
  v_mul_f32 v213, v213, v214
  v_accvgpr_write_b32 a8, v213
  v_accvgpr_read_b32 v213, a9
  v_mul_f32 v213, v213, v214
  v_accvgpr_write_b32 a9, v213
  v_accvgpr_read_b32 v213, a10
  v_mul_f32 v213, v213, v214
  v_accvgpr_write_b32 a10, v213
  v_accvgpr_read_b32 v213, a11
  v_mul_f32 v213, v213, v214
  v_accvgpr_write_b32 a11, v213
  v_accvgpr_read_b32 v213, a12
  v_mul_f32 v213, v213, v214
  v_accvgpr_write_b32 a12, v213
  v_accvgpr_read_b32 v213, a13
  v_mul_f32 v213, v213, v214
  v_accvgpr_write_b32 a13, v213
  v_accvgpr_read_b32 v213, a14
  v_mul_f32 v213, v213, v214
  v_accvgpr_write_b32 a14, v213
  v_accvgpr_read_b32 v213, a15
  v_mul_f32 v213, v213, v214
  v_accvgpr_write_b32 a15, v213
  v_accvgpr_read_b32 v213, a32
  v_mul_f32 v213, v213, v214
  v_accvgpr_write_b32 a32, v213
  v_accvgpr_read_b32 v213, a33
  v_mul_f32 v213, v213, v214
  v_accvgpr_write_b32 a33, v213
  v_accvgpr_read_b32 v213, a34
  v_mul_f32 v213, v213, v214
  v_accvgpr_write_b32 a34, v213
  v_accvgpr_read_b32 v213, a35
  v_mul_f32 v213, v213, v214
  v_accvgpr_write_b32 a35, v213
  v_accvgpr_read_b32 v213, a36
  v_mul_f32 v213, v213, v214
  v_accvgpr_write_b32 a36, v213
  v_accvgpr_read_b32 v213, a37
  v_mul_f32 v213, v213, v214
  v_accvgpr_write_b32 a37, v213
  v_accvgpr_read_b32 v213, a38
  v_mul_f32 v213, v213, v214
  v_accvgpr_write_b32 a38, v213
  v_accvgpr_read_b32 v213, a39
  v_mul_f32 v213, v213, v214
  v_accvgpr_write_b32 a39, v213
  v_accvgpr_read_b32 v213, a40
  v_mul_f32 v213, v213, v214
  v_accvgpr_write_b32 a40, v213
  v_accvgpr_read_b32 v213, a41
  v_mul_f32 v213, v213, v214
  v_accvgpr_write_b32 a41, v213
  v_accvgpr_read_b32 v213, a42
  v_mul_f32 v213, v213, v214
  v_accvgpr_write_b32 a42, v213
  v_accvgpr_read_b32 v213, a43
  v_mul_f32 v213, v213, v214
  v_accvgpr_write_b32 a43, v213
  v_accvgpr_read_b32 v213, a44
  v_mul_f32 v213, v213, v214
  v_accvgpr_write_b32 a44, v213
  v_accvgpr_read_b32 v213, a45
  v_mul_f32 v213, v213, v214
  v_accvgpr_write_b32 a45, v213
  v_accvgpr_read_b32 v213, a46
  v_mul_f32 v213, v213, v214
  v_accvgpr_write_b32 a46, v213
  v_accvgpr_read_b32 v213, a47
  v_mul_f32 v213, v213, v214
  v_accvgpr_write_b32 a47, v213
  v_accvgpr_read_b32 v213, a64
  v_mul_f32 v213, v213, v214
  v_accvgpr_write_b32 a64, v213
  v_accvgpr_read_b32 v213, a65
  v_mul_f32 v213, v213, v214
  v_accvgpr_write_b32 a65, v213
  v_accvgpr_read_b32 v213, a66
  v_mul_f32 v213, v213, v214
  v_accvgpr_write_b32 a66, v213
  v_accvgpr_read_b32 v213, a67
  v_mul_f32 v213, v213, v214
  v_accvgpr_write_b32 a67, v213
  v_accvgpr_read_b32 v213, a68
  v_mul_f32 v213, v213, v214
  v_accvgpr_write_b32 a68, v213
  v_accvgpr_read_b32 v213, a69
  v_mul_f32 v213, v213, v214
  v_accvgpr_write_b32 a69, v213
  v_accvgpr_read_b32 v213, a70
  v_mul_f32 v213, v213, v214
  v_accvgpr_write_b32 a70, v213
  v_accvgpr_read_b32 v213, a71
  v_mul_f32 v213, v213, v214
  v_accvgpr_write_b32 a71, v213
  v_accvgpr_read_b32 v213, a72
  v_mul_f32 v213, v213, v214
  v_accvgpr_write_b32 a72, v213
  v_accvgpr_read_b32 v213, a73
  v_mul_f32 v213, v213, v214
  v_accvgpr_write_b32 a73, v213
  v_accvgpr_read_b32 v213, a74
  v_mul_f32 v213, v213, v214
  v_accvgpr_write_b32 a74, v213
  v_accvgpr_read_b32 v213, a75
  v_mul_f32 v213, v213, v214
  v_accvgpr_write_b32 a75, v213
  v_accvgpr_read_b32 v213, a76
  v_mul_f32 v213, v213, v214
  v_accvgpr_write_b32 a76, v213
  v_accvgpr_read_b32 v213, a77
  v_mul_f32 v213, v213, v214
  v_accvgpr_write_b32 a77, v213
  v_accvgpr_read_b32 v213, a78
  v_mul_f32 v213, v213, v214
  v_accvgpr_write_b32 a78, v213
  v_accvgpr_read_b32 v213, a79
  v_mul_f32 v213, v213, v214
  v_accvgpr_write_b32 a79, v213
  v_accvgpr_read_b32 v213, a96
  v_mul_f32 v213, v213, v214
  v_accvgpr_write_b32 a96, v213
  v_accvgpr_read_b32 v213, a97
  v_mul_f32 v213, v213, v214
  v_accvgpr_write_b32 a97, v213
  v_accvgpr_read_b32 v213, a98
  v_mul_f32 v213, v213, v214
  v_accvgpr_write_b32 a98, v213
  v_accvgpr_read_b32 v213, a99
  v_mul_f32 v213, v213, v214
  v_accvgpr_write_b32 a99, v213
  v_accvgpr_read_b32 v213, a100
  v_mul_f32 v213, v213, v214
  v_accvgpr_write_b32 a100, v213
  v_accvgpr_read_b32 v213, a101
  v_mul_f32 v213, v213, v214
  v_accvgpr_write_b32 a101, v213
  v_accvgpr_read_b32 v213, a102
  v_mul_f32 v213, v213, v214
  v_accvgpr_write_b32 a102, v213
  v_accvgpr_read_b32 v213, a103
  v_mul_f32 v213, v213, v214
  v_accvgpr_write_b32 a103, v213
  v_accvgpr_read_b32 v213, a104
  v_mul_f32 v213, v213, v214
  v_accvgpr_write_b32 a104, v213
  v_accvgpr_read_b32 v213, a105
  v_mul_f32 v213, v213, v214
  v_accvgpr_write_b32 a105, v213
  v_accvgpr_read_b32 v213, a106
  v_mul_f32 v213, v213, v214
  v_accvgpr_write_b32 a106, v213
  v_accvgpr_read_b32 v213, a107
  v_mul_f32 v213, v213, v214
  v_accvgpr_write_b32 a107, v213
  v_accvgpr_read_b32 v213, a108
  v_mul_f32 v213, v213, v214
  v_accvgpr_write_b32 a108, v213
  v_accvgpr_read_b32 v213, a109
  v_mul_f32 v213, v213, v214
  v_accvgpr_write_b32 a109, v213
  v_accvgpr_read_b32 v213, a110
  v_mul_f32 v213, v213, v214
  v_accvgpr_write_b32 a110, v213
  v_accvgpr_read_b32 v213, a111
  v_mul_f32 v213, v213, v214
  v_accvgpr_write_b32 a111, v213
  v_max3_f32 v212, v56, v57, v58
  v_max3_f32 v212, v212, v59, v60
  v_max3_f32 v212, v212, v61, v62
  v_max3_f32 v212, v212, v63, v64
  v_max3_f32 v212, v212, v65, v66
  v_max3_f32 v212, v212, v67, v68
  v_max3_f32 v212, v212, v69, v70
  v_max_f32 v212, v212, v71
  v_mov_b32 v213, v212
  s_nop 1
  v_permlane32_swap_b32 v212, v213
  v_max_f32 v212, v212, v213
  v_max_f32 v212, 0, v212
  v_sub_f32 v120, v120, v212
  v_sub_f32 v121, v121, v212
  v_sub_f32 v122, v122, v212
  v_sub_f32 v123, v123, v212
  v_sub_f32 v124, v124, v212
  v_sub_f32 v125, v125, v212
  v_sub_f32 v126, v126, v212
  v_sub_f32 v127, v127, v212
  v_sub_f32 v128, v128, v212
  v_sub_f32 v129, v129, v212
  v_sub_f32 v130, v130, v212
  v_sub_f32 v131, v131, v212
  v_sub_f32 v132, v132, v212
  v_sub_f32 v133, v133, v212
  v_sub_f32 v134, v134, v212
  v_sub_f32 v135, v135, v212
  v_sub_f32 v56, v56, v212
  v_sub_f32 v57, v57, v212
  v_sub_f32 v58, v58, v212
  v_sub_f32 v59, v59, v212
  v_sub_f32 v60, v60, v212
  v_sub_f32 v61, v61, v212
  v_sub_f32 v62, v62, v212
  v_sub_f32 v63, v63, v212
  v_sub_f32 v64, v64, v212
  v_sub_f32 v65, v65, v212
  v_sub_f32 v66, v66, v212
  v_sub_f32 v67, v67, v212
  v_sub_f32 v68, v68, v212
  v_sub_f32 v69, v69, v212
  v_sub_f32 v70, v70, v212
  v_sub_f32 v71, v71, v212
  v_sub_f32 v214, 0, v212
  v_exp_f32 v214, v214
  s_nop 0
  v_mul_f32 v209, v209, v214
  v_accvgpr_read_b32 v213, a16
  v_mul_f32 v213, v213, v214
  v_accvgpr_write_b32 a16, v213
  v_accvgpr_read_b32 v213, a17
  v_mul_f32 v213, v213, v214
  v_accvgpr_write_b32 a17, v213
  v_accvgpr_read_b32 v213, a18
  v_mul_f32 v213, v213, v214
  v_accvgpr_write_b32 a18, v213
  v_accvgpr_read_b32 v213, a19
  v_mul_f32 v213, v213, v214
  v_accvgpr_write_b32 a19, v213
  v_accvgpr_read_b32 v213, a20
  v_mul_f32 v213, v213, v214
  v_accvgpr_write_b32 a20, v213
  v_accvgpr_read_b32 v213, a21
  v_mul_f32 v213, v213, v214
  v_accvgpr_write_b32 a21, v213
  v_accvgpr_read_b32 v213, a22
  v_mul_f32 v213, v213, v214
  v_accvgpr_write_b32 a22, v213
  v_accvgpr_read_b32 v213, a23
  v_mul_f32 v213, v213, v214
  v_accvgpr_write_b32 a23, v213
  v_accvgpr_read_b32 v213, a24
  v_mul_f32 v213, v213, v214
  v_accvgpr_write_b32 a24, v213
  v_accvgpr_read_b32 v213, a25
  v_mul_f32 v213, v213, v214
  v_accvgpr_write_b32 a25, v213
  v_accvgpr_read_b32 v213, a26
  v_mul_f32 v213, v213, v214
  v_accvgpr_write_b32 a26, v213
  v_accvgpr_read_b32 v213, a27
  v_mul_f32 v213, v213, v214
  v_accvgpr_write_b32 a27, v213
  v_accvgpr_read_b32 v213, a28
  v_mul_f32 v213, v213, v214
  v_accvgpr_write_b32 a28, v213
  v_accvgpr_read_b32 v213, a29
  v_mul_f32 v213, v213, v214
  v_accvgpr_write_b32 a29, v213
  v_accvgpr_read_b32 v213, a30
  v_mul_f32 v213, v213, v214
  v_accvgpr_write_b32 a30, v213
  v_accvgpr_read_b32 v213, a31
  v_mul_f32 v213, v213, v214
  v_accvgpr_write_b32 a31, v213
  v_accvgpr_read_b32 v213, a48
  v_mul_f32 v213, v213, v214
  v_accvgpr_write_b32 a48, v213
  v_accvgpr_read_b32 v213, a49
  v_mul_f32 v213, v213, v214
  v_accvgpr_write_b32 a49, v213
  v_accvgpr_read_b32 v213, a50
  v_mul_f32 v213, v213, v214
  v_accvgpr_write_b32 a50, v213
  v_accvgpr_read_b32 v213, a51
  v_mul_f32 v213, v213, v214
  v_accvgpr_write_b32 a51, v213
  v_accvgpr_read_b32 v213, a52
  v_mul_f32 v213, v213, v214
  v_accvgpr_write_b32 a52, v213
  v_accvgpr_read_b32 v213, a53
  v_mul_f32 v213, v213, v214
  v_accvgpr_write_b32 a53, v213
  v_accvgpr_read_b32 v213, a54
  v_mul_f32 v213, v213, v214
  v_accvgpr_write_b32 a54, v213
  v_accvgpr_read_b32 v213, a55
  v_mul_f32 v213, v213, v214
  v_accvgpr_write_b32 a55, v213
  v_accvgpr_read_b32 v213, a56
  v_mul_f32 v213, v213, v214
  v_accvgpr_write_b32 a56, v213
  v_accvgpr_read_b32 v213, a57
  v_mul_f32 v213, v213, v214
  v_accvgpr_write_b32 a57, v213
  v_accvgpr_read_b32 v213, a58
  v_mul_f32 v213, v213, v214
  v_accvgpr_write_b32 a58, v213
  v_accvgpr_read_b32 v213, a59
  v_mul_f32 v213, v213, v214
  v_accvgpr_write_b32 a59, v213
  v_accvgpr_read_b32 v213, a60
  v_mul_f32 v213, v213, v214
  v_accvgpr_write_b32 a60, v213
  v_accvgpr_read_b32 v213, a61
  v_mul_f32 v213, v213, v214
  v_accvgpr_write_b32 a61, v213
  v_accvgpr_read_b32 v213, a62
  v_mul_f32 v213, v213, v214
  v_accvgpr_write_b32 a62, v213
  v_accvgpr_read_b32 v213, a63
  v_mul_f32 v213, v213, v214
  v_accvgpr_write_b32 a63, v213
  v_accvgpr_read_b32 v213, a80
  v_mul_f32 v213, v213, v214
  v_accvgpr_write_b32 a80, v213
  v_accvgpr_read_b32 v213, a81
  v_mul_f32 v213, v213, v214
  v_accvgpr_write_b32 a81, v213
  v_accvgpr_read_b32 v213, a82
  v_mul_f32 v213, v213, v214
  v_accvgpr_write_b32 a82, v213
  v_accvgpr_read_b32 v213, a83
  v_mul_f32 v213, v213, v214
  v_accvgpr_write_b32 a83, v213
  v_accvgpr_read_b32 v213, a84
  v_mul_f32 v213, v213, v214
  v_accvgpr_write_b32 a84, v213
  v_accvgpr_read_b32 v213, a85
  v_mul_f32 v213, v213, v214
  v_accvgpr_write_b32 a85, v213
  v_accvgpr_read_b32 v213, a86
  v_mul_f32 v213, v213, v214
  v_accvgpr_write_b32 a86, v213
  v_accvgpr_read_b32 v213, a87
  v_mul_f32 v213, v213, v214
  v_accvgpr_write_b32 a87, v213
  v_accvgpr_read_b32 v213, a88
  v_mul_f32 v213, v213, v214
  v_accvgpr_write_b32 a88, v213
  v_accvgpr_read_b32 v213, a89
  v_mul_f32 v213, v213, v214
  v_accvgpr_write_b32 a89, v213
  v_accvgpr_read_b32 v213, a90
  v_mul_f32 v213, v213, v214
  v_accvgpr_write_b32 a90, v213
  v_accvgpr_read_b32 v213, a91
  v_mul_f32 v213, v213, v214
  v_accvgpr_write_b32 a91, v213
  v_accvgpr_read_b32 v213, a92
  v_mul_f32 v213, v213, v214
  v_accvgpr_write_b32 a92, v213
  v_accvgpr_read_b32 v213, a93
  v_mul_f32 v213, v213, v214
  v_accvgpr_write_b32 a93, v213
  v_accvgpr_read_b32 v213, a94
  v_mul_f32 v213, v213, v214
  v_accvgpr_write_b32 a94, v213
  v_accvgpr_read_b32 v213, a95
  v_mul_f32 v213, v213, v214
  v_accvgpr_write_b32 a95, v213
  v_accvgpr_read_b32 v213, a112
  v_mul_f32 v213, v213, v214
  v_accvgpr_write_b32 a112, v213
  v_accvgpr_read_b32 v213, a113
  v_mul_f32 v213, v213, v214
  v_accvgpr_write_b32 a113, v213
  v_accvgpr_read_b32 v213, a114
  v_mul_f32 v213, v213, v214
  v_accvgpr_write_b32 a114, v213
  v_accvgpr_read_b32 v213, a115
  v_mul_f32 v213, v213, v214
  v_accvgpr_write_b32 a115, v213
  v_accvgpr_read_b32 v213, a116
  v_mul_f32 v213, v213, v214
  v_accvgpr_write_b32 a116, v213
  v_accvgpr_read_b32 v213, a117
  v_mul_f32 v213, v213, v214
  v_accvgpr_write_b32 a117, v213
  v_accvgpr_read_b32 v213, a118
  v_mul_f32 v213, v213, v214
  v_accvgpr_write_b32 a118, v213
  v_accvgpr_read_b32 v213, a119
  v_mul_f32 v213, v213, v214
  v_accvgpr_write_b32 a119, v213
  v_accvgpr_read_b32 v213, a120
  v_mul_f32 v213, v213, v214
  v_accvgpr_write_b32 a120, v213
  v_accvgpr_read_b32 v213, a121
  v_mul_f32 v213, v213, v214
  v_accvgpr_write_b32 a121, v213
  v_accvgpr_read_b32 v213, a122
  v_mul_f32 v213, v213, v214
  v_accvgpr_write_b32 a122, v213
  v_accvgpr_read_b32 v213, a123
  v_mul_f32 v213, v213, v214
  v_accvgpr_write_b32 a123, v213
  v_accvgpr_read_b32 v213, a124
  v_mul_f32 v213, v213, v214
  v_accvgpr_write_b32 a124, v213
  v_accvgpr_read_b32 v213, a125
  v_mul_f32 v213, v213, v214
  v_accvgpr_write_b32 a125, v213
  v_accvgpr_read_b32 v213, a126
  v_mul_f32 v213, v213, v214
  v_accvgpr_write_b32 a126, v213
  v_accvgpr_read_b32 v213, a127
  v_mul_f32 v213, v213, v214
  v_accvgpr_write_b32 a127, v213
  v_exp_f32 v200, v40
  v_exp_f32 v201, v41
  v_add_f32 v210, v208, v200
  v_exp_f32 v202, v42
  v_add_f32 v210, v210, v201
  v_cvt_pk_bf16_f32 v88, v200, v201
  v_exp_f32 v203, v43
  v_add_f32 v210, v210, v202
  v_exp_f32 v204, v44
  v_add_f32 v210, v210, v203
  v_cvt_pk_bf16_f32 v89, v202, v203
  v_exp_f32 v205, v45
  v_add_f32 v210, v210, v204
  v_exp_f32 v206, v46
  v_add_f32 v210, v210, v205
  v_cvt_pk_bf16_f32 v90, v204, v205
  v_exp_f32 v207, v47
  v_add_f32 v210, v210, v206
  v_exp_f32 v200, v48
  v_add_f32 v210, v210, v207
  v_cvt_pk_bf16_f32 v91, v206, v207
  v_exp_f32 v201, v49
  v_add_f32 v210, v210, v200
  v_exp_f32 v202, v50
  v_add_f32 v210, v210, v201
  v_cvt_pk_bf16_f32 v92, v200, v201
  v_exp_f32 v203, v51
  v_add_f32 v210, v210, v202
  v_exp_f32 v204, v52
  v_add_f32 v210, v210, v203
  v_cvt_pk_bf16_f32 v93, v202, v203
  v_exp_f32 v205, v53
  v_add_f32 v210, v210, v204
  v_exp_f32 v206, v54
  v_add_f32 v210, v210, v205
  v_cvt_pk_bf16_f32 v94, v204, v205
  v_exp_f32 v207, v55
  v_add_f32 v210, v210, v206
  v_exp_f32 v200, v56
  v_add_f32 v210, v210, v207
  v_cvt_pk_bf16_f32 v95, v206, v207
  v_exp_f32 v201, v57
  v_add_f32 v211, v209, v200
  v_exp_f32 v202, v58
  v_add_f32 v211, v211, v201
  v_cvt_pk_bf16_f32 v96, v200, v201
  v_exp_f32 v203, v59
  v_add_f32 v211, v211, v202
  v_exp_f32 v204, v60
  v_add_f32 v211, v211, v203
  v_cvt_pk_bf16_f32 v97, v202, v203
  v_exp_f32 v205, v61
  v_add_f32 v211, v211, v204
  v_exp_f32 v206, v62
  v_add_f32 v211, v211, v205
  v_cvt_pk_bf16_f32 v98, v204, v205
  v_exp_f32 v207, v63
  v_add_f32 v211, v211, v206
  v_exp_f32 v200, v64
  v_add_f32 v211, v211, v207
  v_cvt_pk_bf16_f32 v99, v206, v207
  v_exp_f32 v201, v65
  v_add_f32 v211, v211, v200
  v_exp_f32 v202, v66
  v_add_f32 v211, v211, v201
  v_cvt_pk_bf16_f32 v100, v200, v201
  v_exp_f32 v203, v67
  v_add_f32 v211, v211, v202
  v_exp_f32 v204, v68
  v_add_f32 v211, v211, v203
  v_cvt_pk_bf16_f32 v101, v202, v203
  v_exp_f32 v205, v69
  v_add_f32 v211, v211, v204
  v_exp_f32 v206, v70
  v_add_f32 v211, v211, v205
  v_cvt_pk_bf16_f32 v102, v204, v205
  v_exp_f32 v207, v71
  v_add_f32 v211, v211, v206
  v_add_f32 v211, v211, v207
  v_cvt_pk_bf16_f32 v103, v206, v207
  s_branch k2_ret33
  s_endpgm
.text
.globl k3_kernel
.p2align 8
.type k3_kernel,@function
k3_kernel:
  s_cmp_lt_u32 s2, 256
  s_cbranch_scc1 k3_go1
  s_endpgm
k3_go1:
  s_load_dwordx2 s[4:5], s[0:1], 32
  s_load_dwordx2 s[6:7], s[0:1], 104
  s_load_dwordx2 s[8:9], s[0:1], 0
  v_and_b32 v1, 63, v0
  v_lshrrev_b32 v2, 6, v0
  s_nop 0
  v_readfirstlane_b32 s10, v2
  s_and_b32 s13, s2, 7
  s_lshr_b32 s14, s2, 3
  s_lshr_b32 s11, s13, 1
  s_lshl_b32 s11, s11, 3
  s_lshr_b32 s12, s14, 2
  s_add_u32 s11, s11, s12
  s_and_b32 s12, s13, 1
  s_lshl_b32 s12, s12, 2
  s_and_b32 s14, s14, 3
  s_add_u32 s12, s12, s14
  s_waitcnt lgkmcnt(0)
  s_mov_b32 s16, s4
  s_mov_b32 s17, s5
  s_mov_b32 s18, 4194304
  s_mov_b32 s19, 0x20000
  s_add_u32 s20, s6, 16777216
  s_addc_u32 s21, s7, 0
  s_mov_b32 s22, 16777216
  s_mov_b32 s23, 0x20000
  s_add_u32 s32, s6, 69632
  s_addc_u32 s33, s7, 0
  s_mov_b32 s34, 2048
  s_mov_b32 s35, 0x20000
  s_mov_b32 s24, s8
  s_mov_b32 s25, s9
  s_mov_b32 s26, 2097152
  s_mov_b32 s27, 0x20000
  s_add_u32 s28, s6, 3145728
  s_addc_u32 s29, s7, 0
  s_mov_b32 s30, 2097152
  s_mov_b32 s31, 0x20000
  s_lshl_b32 s36, s10, 6
  v_lshlrev_b32 v3, 4, v1
  s_mul_i32 s37, s11, 524288
  s_lshl_b32 s13, s36, 11
  s_add_u32 s37, s37, s13
  v_lshrrev_b32 v4, 3, v1
  v_lshlrev_b32 v4, 10, v4
  v_bfe_u32 v2, v1, 4, 1
  v_lshlrev_b32 v2, 2, v2
  v_xor_b32 v2, v2, v1
  v_and_b32 v2, 7, v2
  v_lshl_add_u32 v4, v2, 4, v4
  s_lshl_b32 s38, s36, 14
  s_lshl_b32 s13, s12, 7
  s_add_u32 s38, s38, s13
  s_lshl_b32 s39, s10, 15
  v_lshrrev_b32 v5, 5, v1
  v_lshlrev_b32 v5, 10, v5
  v_bfe_u32 v2, v1, 2, 2
  v_lshl_add_u32 v5, v2, 7, v5
  v_bfe_u32 v2, v1, 4, 1
  v_lshl_add_u32 v5, v2, 5, v5
  v_and_b32 v2, 1, v1
  v_lshl_add_u32 v5, v2, 4, v5
  v_bfe_u32 v2, v1, 1, 1
  v_lshl_add_u32 v5, v2, 3, v5
  v_add_u32 v5, s39, v5
  v_bfe_u32 v2, v1, 3, 1
  v_lshlrev_b32 v2, 6, v2
  v_xor_b32 v6, 64, v2
  v_add_u32 v6, v5, v6
  v_add_u32 v5, v5, v2
  v_lshlrev_b32 v7, 7, v1
  v_lshlrev_b32 v8, 10, v1
  s_and_b32 s13, s12, 3
  s_lshl_b32 s13, s13, 13
  s_add_u32 s40, s37, s13
  s_and_b32 s13, s11, 7
  s_lshl_b32 s13, s13, 16
  s_add_u32 s41, s38, s13
  s_mov_b32 s42, s11
  s_and_b32 s42, s42, 7
  s_lshl_b32 s42, s42, 3
  s_lshl_b32 s13, s42, 14
  s_add_u32 s38, s38, s13
  s_lshl_b32 s13, s42, 11
  s_add_u32 s37, s37, s13
  s_lshr_b32 s43, s10, 1
  s_and_b32 s44, s10, 1
  v_lshrrev_b32 v9, 5, v1
  v_and_b32 v10, 31, v1
  s_lshl_b32 s45, s12, 6
  s_lshl_b32 s13, s43, 5
  s_add_u32 s45, s45, s13
  s_lshl_b32 s13, s11, 6
  s_lshl_b32 s14, s44, 5
  s_add_u32 s13, s13, s14
  s_mov_b32 s46, s13
  v_add_u32 v11, s13, v10
  v_lshlrev_b32 v11, 10, v11
  v_lshl_add_u32 v11, v9, 4, v11
  s_lshl_b32 s14, s45, 1
  v_add_u32 v11, s14, v11
  s_lshl_b32 s13, s46, 10
  s_lshl_b32 s14, s45, 6
  s_add_u32 s13, s13, s14
  v_add_u32 v12, s13, v3
  s_lshl_b32 s13, s45, 2
  v_lshlrev_b32 v13, 5, v9
  v_add_u32 v13, s13, v13
  s_load_dwordx2 s[48:49], s[0:1], 48
  s_load_dwordx2 s[60:61], s[0:1], 56
  s_and_b32 s13, s2, 7
  s_lshr_b32 s65, s13, 2
  s_and_b32 s13, s13, 3
  s_mul_i32 s64, s13, 22
  s_lshr_b32 s14, s2, 3
  s_and_b32 s66, s14, 3
  s_lshr_b32 s67, s14, 2
  s_sub_u32 s14, s14, s67
  s_cmp_eq_u32 s66, 3
  s_cselect_b32 s14, 31, s14
  s_add_u32 s64, s64, s14
  s_lshr_b32 s66, s64, 2
  s_and_b32 s67, s64, 3
  s_cmp_eq_u32 s65, 1
  s_waitcnt lgkmcnt(0)
  s_cselect_b32 s48, s60, s48
  s_cselect_b32 s49, s61, s49
  s_mov_b32 s51, 0x20000
  s_add_u32 s52, s6, 71680
  s_addc_u32 s53, s7, 0
  s_mov_b32 s54, 4096
  s_mov_b32 s55, 0x20000
  s_add_u32 s56, s6, 5242880
  s_addc_u32 s57, s7, 0
  s_mov_b32 s58, 2818048
  s_mov_b32 s59, 0x20000
  s_add_u32 s60, s6, 524288
  s_addc_u32 s61, s7, 0
  s_mov_b32 s62, 90112
  s_mov_b32 s63, 0x20000
  s_cmp_lt_u32 s14, 22
  s_cselect_b32 s50, 1409024, 0
  s_cselect_b32 s58, 2818048, 0
  s_cselect_b32 s62, 90112, 0
  s_cselect_b32 s66, s66, 0
  s_mul_i32 s68, s67, 352256
  s_lshl_b32 s13, s66, 7
  s_add_u32 s68, s68, s13
  s_lshl_b32 s69, s66, 17
  s_lshl_b32 s13, s67, 14
  s_add_u32 s69, s69, s13
  s_lshl_b32 s13, s65, 10
  s_add_u32 s69, s69, s13
  s_mul_i32 s70, s67, 22528
  s_lshl_b32 s13, s66, 10
  s_add_u32 s70, s70, s13
  s_lshl_b32 s13, s65, 8
  s_add_u32 s70, s70, s13
  s_lshl_b32 s71, s67, 9
  v_lshrrev_b32 v185, 4, v0
  v_and_b32 v187, 15, v0
  s_movk_i32 s13, 22016
  v_mul_lo_u32 v184, v185, s13
  v_lshl_add_u32 v184, v187, 3, v184
  v_bfe_u32 v186, v0, 4, 2
  v_lshlrev_b32 v186, 9, v186
  v_and_b32 v2, 1, v187
  v_lshl_add_u32 v186, v2, 7, v186
  v_bfe_u32 v2, v187, 1, 1
  v_lshl_add_u32 v186, v2, 6, v186
  v_bfe_u32 v2, v187, 2, 1
  v_lshl_add_u32 v186, v2, 8, v186
  v_lshrrev_b32 v2, 3, v187
  v_lshl_add_u32 v186, v2, 11, v186
  s_lshl_b32 s72, s10, 12
  s_add_u32 s69, s69, s72
  s_add_u32 s73, s69, 65536
  s_add_u32 s72, s72, 133120
  v_add_u32 v186, s72, v186
  v_add_u32 v188, s72, v3
  v_lshlrev_b32 v185, 5, v185
  s_add_u32 m0, s39, 0
  s_add_u32 s14, s38, 8192
  buffer_load_dwordx4 v4, s[16:19], s38 offen lds
  s_add_u32 m0, s39, 1024
  s_nop 0
  buffer_load_dwordx4 v4, s[16:19], s14 offen lds
  buffer_load_dwordx4 a[8:11], v3, s[20:23], s37 offen offset:0
  buffer_load_dwordx4 a[12:15], v3, s[20:23], s37 offen offset:1024
  s_add_u32 s38, s38, 16384
  s_add_u32 s37, s37, 2048
  s_add_u32 m0, s39, 2048
  s_add_u32 s14, s38, 8192
  buffer_load_dwordx4 v4, s[16:19], s38 offen lds
  s_add_u32 m0, s39, 3072
  s_nop 0
  buffer_load_dwordx4 v4, s[16:19], s14 offen lds
  buffer_load_dwordx4 a[16:19], v3, s[20:23], s37 offen offset:0
  buffer_load_dwordx4 a[20:23], v3, s[20:23], s37 offen offset:1024
  s_add_u32 s38, s38, 16384
  s_add_u32 s37, s37, 2048
  s_add_u32 m0, s39, 4096
  s_add_u32 s14, s38, 8192
  buffer_load_dwordx4 v4, s[16:19], s38 offen lds
  s_add_u32 m0, s39, 5120
  s_nop 0
  buffer_load_dwordx4 v4, s[16:19], s14 offen lds
  buffer_load_dwordx4 a[24:27], v3, s[20:23], s37 offen offset:0
  buffer_load_dwordx4 a[28:31], v3, s[20:23], s37 offen offset:1024
  s_add_u32 s38, s38, 16384
  s_add_u32 s37, s37, 2048
  s_add_u32 s13, s68, 0
  buffer_load_dwordx2 v[104:105], v184, s[48:51], s13 offen
  s_add_u32 s13, s68, 2752
  buffer_load_dwordx2 v[106:107], v184, s[48:51], s13 offen
  s_add_u32 s13, s68, 5504
  buffer_load_dwordx2 v[108:109], v184, s[48:51], s13 offen
  s_add_u32 s13, s68, 8256
  buffer_load_dwordx2 v[110:111], v184, s[48:51], s13 offen
  s_add_u32 s13, s68, 11008
  buffer_load_dwordx2 v[112:113], v184, s[48:51], s13 offen
  s_add_u32 s13, s68, 13760
  buffer_load_dwordx2 v[114:115], v184, s[48:51], s13 offen
  s_add_u32 s13, s68, 16512
  buffer_load_dwordx2 v[116:117], v184, s[48:51], s13 offen
  s_add_u32 s13, s68, 19264
  buffer_load_dwordx2 v[118:119], v184, s[48:51], s13 offen
  buffer_load_dwordx4 v[120:123], v185, s[52:55], s71 offen offset:0
  buffer_load_dwordx4 v[124:127], v185, s[52:55], s71 offen offset:16
  buffer_load_dwordx4 v[128:131], v185, s[52:55], s71 offen offset:2048
  buffer_load_dwordx4 v[132:135], v185, s[52:55], s71 offen offset:2064
  s_waitcnt vmcnt(22)
  ds_read_b64_tr_b16 v[192:193], v5 offset:0
  ds_read_b64_tr_b16 v[194:195], v5 offset:512
  ds_read_b64_tr_b16 v[196:197], v6 offset:0
  ds_read_b64_tr_b16 v[198:199], v6 offset:512
  s_add_u32 m0, s39, 6144
  s_add_u32 s14, s38, 8192
  buffer_load_dwordx4 v4, s[16:19], s38 offen lds
  s_add_u32 m0, s39, 7168
  s_nop 0
  buffer_load_dwordx4 v4, s[16:19], s14 offen lds
  buffer_load_dwordx4 a[32:35], v3, s[20:23], s37 offen offset:0
  buffer_load_dwordx4 a[36:39], v3, s[20:23], s37 offen offset:1024
  s_add_u32 s38, s38, 16384
  s_add_u32 s37, s37, 2048
  s_add_u32 m0, s39, 8192
  s_add_u32 s14, s38, 8192
  buffer_load_dwordx4 v4, s[16:19], s38 offen lds
  s_add_u32 m0, s39, 9216
  s_nop 0
  buffer_load_dwordx4 v4, s[16:19], s14 offen lds
  buffer_load_dwordx4 a[40:43], v3, s[20:23], s37 offen offset:0
  buffer_load_dwordx4 a[44:47], v3, s[20:23], s37 offen offset:1024
  s_add_u32 s38, s38, 16384
  s_add_u32 s37, s37, 2048
  s_add_u32 m0, s39, 10240
  s_add_u32 s14, s38, 8192
  buffer_load_dwordx4 v4, s[16:19], s38 offen lds
  s_add_u32 m0, s39, 11264
  s_nop 0
  buffer_load_dwordx4 v4, s[16:19], s14 offen lds
  buffer_load_dwordx4 a[48:51], v3, s[20:23], s37 offen offset:0
  buffer_load_dwordx4 a[52:55], v3, s[20:23], s37 offen offset:1024
  s_add_u32 s38, s38, 16384
  s_add_u32 s37, s37, 2048
  s_waitcnt vmcnt(30)
  ds_read_b64_tr_b16 v[200:201], v5 offset:2048
  ds_read_b64_tr_b16 v[202:203], v5 offset:2560
  ds_read_b64_tr_b16 v[204:205], v6 offset:2048
  ds_read_b64_tr_b16 v[206:207], v6 offset:2560
  s_waitcnt lgkmcnt(6)
  v_mfma_f32_32x32x16_bf16 v[40:55], v[192:195], a[8:11], 0
  v_mfma_f32_32x32x16_bf16 v[56:71], v[192:195], a[12:15], 0
  s_waitcnt lgkmcnt(4)
  v_mfma_f32_32x32x16_bf16 v[72:87], v[196:199], a[8:11], 0
  v_mfma_f32_32x32x16_bf16 v[88:103], v[196:199], a[12:15], 0
  s_add_u32 m0, s39, 12288
  s_add_u32 s14, s38, 8192
  buffer_load_dwordx4 v4, s[16:19], s38 offen lds
  s_add_u32 m0, s39, 13312
  s_nop 0
  buffer_load_dwordx4 v4, s[16:19], s14 offen lds
  buffer_load_dwordx4 a[56:59], v3, s[20:23], s37 offen offset:0
  buffer_load_dwordx4 a[60:63], v3, s[20:23], s37 offen offset:1024
  s_add_u32 s38, s38, 16384
  s_add_u32 s37, s37, 2048
  s_add_u32 m0, s39, 14336
  s_add_u32 s14, s38, 8192
  buffer_load_dwordx4 v4, s[16:19], s38 offen lds
  s_add_u32 m0, s39, 15360
  s_nop 0
  buffer_load_dwordx4 v4, s[16:19], s14 offen lds
  buffer_load_dwordx4 a[64:67], v3, s[20:23], s37 offen offset:0
  buffer_load_dwordx4 a[68:71], v3, s[20:23], s37 offen offset:1024
  s_add_u32 s38, s38, 16384
  s_add_u32 s37, s37, 2048
  s_add_u32 s42, s42, 8
  s_cmp_eq_u32 s42, 64
  s_cselect_b32 s13, 1048576, 0
  s_cselect_b32 s14, 131072, 0
  s_sub_u32 s38, s38, s13
  s_sub_u32 s37, s37, s14
  s_add_u32 m0, s39, 16384
  s_add_u32 s14, s38, 8192
  buffer_load_dwordx4 v4, s[16:19], s38 offen lds
  s_add_u32 m0, s39, 17408
  s_nop 0
  buffer_load_dwordx4 v4, s[16:19], s14 offen lds
  buffer_load_dwordx4 a[72:75], v3, s[20:23], s37 offen offset:0
  buffer_load_dwordx4 a[76:79], v3, s[20:23], s37 offen offset:1024
  s_add_u32 s38, s38, 16384
  s_add_u32 s37, s37, 2048
  s_waitcnt vmcnt(38)
  ds_read_b64_tr_b16 v[192:193], v5 offset:4096
  ds_read_b64_tr_b16 v[194:195], v5 offset:4608
  ds_read_b64_tr_b16 v[196:197], v6 offset:4096
  ds_read_b64_tr_b16 v[198:199], v6 offset:4608
  s_waitcnt lgkmcnt(6)
  v_mfma_f32_32x32x16_bf16 v[40:55], v[200:203], a[16:19], v[40:55]
  v_mfma_f32_32x32x16_bf16 v[56:71], v[200:203], a[20:23], v[56:71]
  s_waitcnt lgkmcnt(4)
  v_mfma_f32_32x32x16_bf16 v[72:87], v[204:207], a[16:19], v[72:87]
  v_mfma_f32_32x32x16_bf16 v[88:103], v[204:207], a[20:23], v[88:103]
  s_add_u32 m0, s39, 18432
  s_add_u32 s14, s38, 8192
  buffer_load_dwordx4 v4, s[16:19], s38 offen lds
  s_add_u32 m0, s39, 19456
  s_nop 0
  buffer_load_dwordx4 v4, s[16:19], s14 offen lds
  buffer_load_dwordx4 a[80:83], v3, s[20:23], s37 offen offset:0
  buffer_load_dwordx4 a[84:87], v3, s[20:23], s37 offen offset:1024
  s_add_u32 s38, s38, 16384
  s_add_u32 s37, s37, 2048
  s_add_u32 m0, s39, 20480
  s_add_u32 s14, s38, 8192
  buffer_load_dwordx4 v4, s[16:19], s38 offen lds
  s_add_u32 m0, s39, 21504
  s_nop 0
  buffer_load_dwordx4 v4, s[16:19], s14 offen lds
  buffer_load_dwordx4 a[88:91], v3, s[20:23], s37 offen offset:0
  buffer_load_dwordx4 a[92:95], v3, s[20:23], s37 offen offset:1024
  s_add_u32 s38, s38, 16384
  s_add_u32 s37, s37, 2048
  s_waitcnt vmcnt(30)
  ds_read_b64_tr_b16 v[200:201], v5 offset:6144
  ds_read_b64_tr_b16 v[202:203], v5 offset:6656
  ds_read_b64_tr_b16 v[204:205], v6 offset:6144
  ds_read_b64_tr_b16 v[206:207], v6 offset:6656
  s_waitcnt lgkmcnt(6)
  v_mfma_f32_32x32x16_bf16 v[40:55], v[192:195], a[24:27], v[40:55]
  v_mfma_f32_32x32x16_bf16 v[56:71], v[192:195], a[28:31], v[56:71]
  s_waitcnt lgkmcnt(4)
  v_mfma_f32_32x32x16_bf16 v[72:87], v[196:199], a[24:27], v[72:87]
  v_mfma_f32_32x32x16_bf16 v[88:103], v[196:199], a[28:31], v[88:103]
  s_add_u32 m0, s39, 22528
  s_add_u32 s14, s38, 8192
  buffer_load_dwordx4 v4, s[16:19], s38 offen lds
  s_add_u32 m0, s39, 23552
  s_nop 0
  buffer_load_dwordx4 v4, s[16:19], s14 offen lds
  buffer_load_dwordx4 a[96:99], v3, s[20:23], s37 offen offset:0
  buffer_load_dwordx4 a[100:103], v3, s[20:23], s37 offen offset:1024
  s_add_u32 s38, s38, 16384
  s_add_u32 s37, s37, 2048
  s_waitcnt vmcnt(30)
  ds_read_b64_tr_b16 v[192:193], v5 offset:8192
  ds_read_b64_tr_b16 v[194:195], v5 offset:8704
  ds_read_b64_tr_b16 v[196:197], v6 offset:8192
  ds_read_b64_tr_b16 v[198:199], v6 offset:8704
  s_waitcnt lgkmcnt(6)
  v_mfma_f32_32x32x16_bf16 v[40:55], v[200:203], a[32:35], v[40:55]
  v_mfma_f32_32x32x16_bf16 v[56:71], v[200:203], a[36:39], v[56:71]
  s_waitcnt lgkmcnt(4)
  v_mfma_f32_32x32x16_bf16 v[72:87], v[204:207], a[32:35], v[72:87]
  v_mfma_f32_32x32x16_bf16 v[88:103], v[204:207], a[36:39], v[88:103]
  s_add_u32 m0, s39, 24576
  s_add_u32 s14, s38, 8192
  buffer_load_dwordx4 v4, s[16:19], s38 offen lds
  s_add_u32 m0, s39, 25600
  s_nop 0
  buffer_load_dwordx4 v4, s[16:19], s14 offen lds
  buffer_load_dwordx4 a[104:107], v3, s[20:23], s37 offen offset:0
  buffer_load_dwordx4 a[108:111], v3, s[20:23], s37 offen offset:1024
  s_add_u32 s38, s38, 16384
  s_add_u32 s37, s37, 2048
  s_waitcnt vmcnt(30)
  ds_read_b64_tr_b16 v[200:201], v5 offset:10240
  ds_read_b64_tr_b16 v[202:203], v5 offset:10752
  ds_read_b64_tr_b16 v[204:205], v6 offset:10240
  ds_read_b64_tr_b16 v[206:207], v6 offset:10752
  s_waitcnt lgkmcnt(6)
  v_mfma_f32_32x32x16_bf16 v[40:55], v[192:195], a[40:43], v[40:55]
  v_mfma_f32_32x32x16_bf16 v[56:71], v[192:195], a[44:47], v[56:71]
  s_waitcnt lgkmcnt(4)
  v_mfma_f32_32x32x16_bf16 v[72:87], v[196:199], a[40:43], v[72:87]
  v_mfma_f32_32x32x16_bf16 v[88:103], v[196:199], a[44:47], v[88:103]
  s_add_u32 m0, s39, 26624
  s_add_u32 s14, s38, 8192
  buffer_load_dwordx4 v4, s[16:19], s38 offen lds
  s_add_u32 m0, s39, 27648
  s_nop 0
  buffer_load_dwordx4 v4, s[16:19], s14 offen lds
  buffer_load_dwordx4 a[112:115], v3, s[20:23], s37 offen offset:0
  buffer_load_dwordx4 a[116:119], v3, s[20:23], s37 offen offset:1024
  s_add_u32 s38, s38, 16384
  s_add_u32 s37, s37, 2048
  s_waitcnt vmcnt(30)
  ds_read_b64_tr_b16 v[192:193], v5 offset:12288
  ds_read_b64_tr_b16 v[194:195], v5 offset:12800
  ds_read_b64_tr_b16 v[196:197], v6 offset:12288
  ds_read_b64_tr_b16 v[198:199], v6 offset:12800
  s_waitcnt lgkmcnt(6)
  v_mfma_f32_32x32x16_bf16 v[40:55], v[200:203], a[48:51], v[40:55]
  v_mfma_f32_32x32x16_bf16 v[56:71], v[200:203], a[52:55], v[56:71]
  s_waitcnt lgkmcnt(4)
  v_mfma_f32_32x32x16_bf16 v[72:87], v[204:207], a[48:51], v[72:87]
  v_mfma_f32_32x32x16_bf16 v[88:103], v[204:207], a[52:55], v[88:103]
  s_add_u32 m0, s39, 28672
  s_add_u32 s14, s38, 8192
  buffer_load_dwordx4 v4, s[16:19], s38 offen lds
  s_add_u32 m0, s39, 29696
  s_nop 0
  buffer_load_dwordx4 v4, s[16:19], s14 offen lds
  buffer_load_dwordx4 a[120:123], v3, s[20:23], s37 offen offset:0
  buffer_load_dwordx4 a[124:127], v3, s[20:23], s37 offen offset:1024
  s_add_u32 s38, s38, 16384
  s_add_u32 s37, s37, 2048
  s_waitcnt vmcnt(30)
  ds_read_b64_tr_b16 v[200:201], v5 offset:14336
  ds_read_b64_tr_b16 v[202:203], v5 offset:14848
  ds_read_b64_tr_b16 v[204:205], v6 offset:14336
  ds_read_b64_tr_b16 v[206:207], v6 offset:14848
  s_waitcnt lgkmcnt(6)
  v_mfma_f32_32x32x16_bf16 v[40:55], v[192:195], a[56:59], v[40:55]
  v_mfma_f32_32x32x16_bf16 v[56:71], v[192:195], a[60:63], v[56:71]
  s_waitcnt lgkmcnt(4)
  v_mfma_f32_32x32x16_bf16 v[72:87], v[196:199], a[56:59], v[72:87]
  v_mfma_f32_32x32x16_bf16 v[88:103], v[196:199], a[60:63], v[88:103]
  s_add_u32 m0, s39, 30720
  s_add_u32 s14, s38, 8192
  buffer_load_dwordx4 v4, s[16:19], s38 offen lds
  s_add_u32 m0, s39, 31744
  s_nop 0
  buffer_load_dwordx4 v4, s[16:19], s14 offen lds
  buffer_load_dwordx4 a[128:131], v3, s[20:23], s37 offen offset:0
  buffer_load_dwordx4 a[132:135], v3, s[20:23], s37 offen offset:1024
  s_add_u32 s38, s38, 16384
  s_add_u32 s37, s37, 2048
  s_waitcnt vmcnt(30)
  ds_read_b64_tr_b16 v[192:193], v5 offset:16384
  ds_read_b64_tr_b16 v[194:195], v5 offset:16896
  ds_read_b64_tr_b16 v[196:197], v6 offset:16384
  ds_read_b64_tr_b16 v[198:199], v6 offset:16896
  s_waitcnt lgkmcnt(6)
  v_mfma_f32_32x32x16_bf16 v[40:55], v[200:203], a[64:67], v[40:55]
  v_mfma_f32_32x32x16_bf16 v[56:71], v[200:203], a[68:71], v[56:71]
  s_waitcnt lgkmcnt(4)
  v_mfma_f32_32x32x16_bf16 v[72:87], v[204:207], a[64:67], v[72:87]
  v_mfma_f32_32x32x16_bf16 v[88:103], v[204:207], a[68:71], v[88:103]
  s_add_u32 s42, s42, 8
  s_cmp_eq_u32 s42, 64
  s_cselect_b32 s13, 1048576, 0
  s_cselect_b32 s14, 131072, 0
  s_sub_u32 s38, s38, s13
  s_sub_u32 s37, s37, s14
  s_add_u32 m0, s39, 0
  s_add_u32 s14, s38, 8192
  buffer_load_dwordx4 v4, s[16:19], s38 offen lds
  s_add_u32 m0, s39, 1024
  s_nop 0
  buffer_load_dwordx4 v4, s[16:19], s14 offen lds
  buffer_load_dwordx4 a[8:11], v3, s[20:23], s37 offen offset:0
  buffer_load_dwordx4 a[12:15], v3, s[20:23], s37 offen offset:1024
  s_add_u32 s38, s38, 16384
  s_add_u32 s37, s37, 2048
  s_waitcnt vmcnt(30)
  ds_read_b64_tr_b16 v[200:201], v5 offset:18432
  ds_read_b64_tr_b16 v[202:203], v5 offset:18944
  ds_read_b64_tr_b16 v[204:205], v6 offset:18432
  ds_read_b64_tr_b16 v[206:207], v6 offset:18944
  s_waitcnt lgkmcnt(6)
  v_mfma_f32_32x32x16_bf16 v[40:55], v[192:195], a[72:75], v[40:55]
  s_mov_b32 s74, 0x3f803f80
  v_and_b32 v144, 0xffff0000, v104
  v_mfma_f32_32x32x16_bf16 v[56:71], v[192:195], a[76:79], v[56:71]
  v_lshlrev_b32 v136, 16, v104
  v_and_b32 v145, 0xffff0000, v106
  s_waitcnt lgkmcnt(4)
  v_mfma_f32_32x32x16_bf16 v[72:87], v[196:199], a[72:75], v[72:87]
  v_lshlrev_b32 v137, 16, v106
  v_and_b32 v146, 0xffff0000, v108
  v_mfma_f32_32x32x16_bf16 v[88:103], v[196:199], a[76:79], v[88:103]
  v_lshlrev_b32 v138, 16, v108
  v_and_b32 v147, 0xffff0000, v110
  s_add_u32 m0, s39, 2048
  s_add_u32 s14, s38, 8192
  buffer_load_dwordx4 v4, s[16:19], s38 offen lds
  s_add_u32 m0, s39, 3072
  s_nop 0
  buffer_load_dwordx4 v4, s[16:19], s14 offen lds
  buffer_load_dwordx4 a[16:19], v3, s[20:23], s37 offen offset:0
  buffer_load_dwordx4 a[20:23], v3, s[20:23], s37 offen offset:1024
  s_add_u32 s38, s38, 16384
  s_add_u32 s37, s37, 2048
  buffer_load_dwordx4 v[16:19], v11, s[24:27], 0 offen
  buffer_load_dwordx4 v[20:23], v11, s[24:27], 0 offen offset:32
  buffer_load_dwordx4 v[24:27], v13, s[32:35], 0 offen offset:0
  buffer_load_dwordx4 v[28:31], v13, s[32:35], 0 offen offset:16
  buffer_load_dwordx4 v[32:35], v13, s[32:35], 0 offen offset:64
  buffer_load_dwordx4 v[36:39], v13, s[32:35], 0 offen offset:80
  s_waitcnt vmcnt(36)
  ds_read_b64_tr_b16 v[192:193], v5 offset:20480
  ds_read_b64_tr_b16 v[194:195], v5 offset:20992
  ds_read_b64_tr_b16 v[196:197], v6 offset:20480
  ds_read_b64_tr_b16 v[198:199], v6 offset:20992
  s_waitcnt lgkmcnt(6)
  v_mfma_f32_32x32x16_bf16 v[40:55], v[200:203], a[80:83], v[40:55]
  v_lshlrev_b32 v139, 16, v110
  v_and_b32 v148, 0xffff0000, v112
  v_mfma_f32_32x32x16_bf16 v[56:71], v[200:203], a[84:87], v[56:71]
  v_lshlrev_b32 v140, 16, v112
  v_and_b32 v149, 0xffff0000, v114
  s_waitcnt lgkmcnt(4)
  v_mfma_f32_32x32x16_bf16 v[72:87], v[204:207], a[80:83], v[72:87]
  v_lshlrev_b32 v141, 16, v114
  v_and_b32 v150, 0xffff0000, v116
  v_mfma_f32_32x32x16_bf16 v[88:103], v[204:207], a[84:87], v[88:103]
  v_lshlrev_b32 v142, 16, v116
  v_and_b32 v151, 0xffff0000, v118
  s_add_u32 m0, s39, 4096
  s_add_u32 s14, s38, 8192
  buffer_load_dwordx4 v4, s[16:19], s38 offen lds
  s_add_u32 m0, s39, 5120
  s_nop 0
  buffer_load_dwordx4 v4, s[16:19], s14 offen lds
  buffer_load_dwordx4 a[24:27], v3, s[20:23], s37 offen offset:0
  buffer_load_dwordx4 a[28:31], v3, s[20:23], s37 offen offset:1024
  s_add_u32 s38, s38, 16384
  s_add_u32 s37, s37, 2048
  s_waitcnt vmcnt(36)
  ds_read_b64_tr_b16 v[200:201], v5 offset:22528
  ds_read_b64_tr_b16 v[202:203], v5 offset:23040
  ds_read_b64_tr_b16 v[204:205], v6 offset:22528
  ds_read_b64_tr_b16 v[206:207], v6 offset:23040
  s_waitcnt lgkmcnt(6)
  v_mfma_f32_32x32x16_bf16 v[40:55], v[192:195], a[88:91], v[40:55]
  v_lshlrev_b32 v143, 16, v118
  v_mul_f32 v172, v120, v136
  v_mfma_f32_32x32x16_bf16 v[56:71], v[192:195], a[92:95], v[56:71]
  v_mul_f32 v173, v120, v144
  v_fmac_f32 v172, v121, v137
  s_waitcnt lgkmcnt(4)
  v_mfma_f32_32x32x16_bf16 v[72:87], v[196:199], a[88:91], v[72:87]
  v_fmac_f32 v173, v121, v145
  v_fmac_f32 v172, v122, v138
  v_mfma_f32_32x32x16_bf16 v[88:103], v[196:199], a[92:95], v[88:103]
  v_fmac_f32 v173, v122, v146
  v_fmac_f32 v172, v123, v139
  s_add_u32 m0, s39, 6144
  s_add_u32 s14, s38, 8192
  buffer_load_dwordx4 v4, s[16:19], s38 offen lds
  s_add_u32 m0, s39, 7168
  s_nop 0
  buffer_load_dwordx4 v4, s[16:19], s14 offen lds
  buffer_load_dwordx4 a[32:35], v3, s[20:23], s37 offen offset:0
  buffer_load_dwordx4 a[36:39], v3, s[20:23], s37 offen offset:1024
  s_add_u32 s38, s38, 16384
  s_add_u32 s37, s37, 2048
  s_waitcnt vmcnt(36)
  ds_read_b64_tr_b16 v[192:193], v5 offset:24576
  ds_read_b64_tr_b16 v[194:195], v5 offset:25088
  ds_read_b64_tr_b16 v[196:197], v6 offset:24576
  ds_read_b64_tr_b16 v[198:199], v6 offset:25088
  s_waitcnt lgkmcnt(6)
  v_mfma_f32_32x32x16_bf16 v[40:55], v[200:203], a[96:99], v[40:55]
  v_fmac_f32 v173, v123, v147
  v_fmac_f32 v172, v124, v140
  v_mfma_f32_32x32x16_bf16 v[56:71], v[200:203], a[100:103], v[56:71]
  v_fmac_f32 v173, v124, v148
  v_fmac_f32 v172, v125, v141
  s_waitcnt lgkmcnt(4)
  v_mfma_f32_32x32x16_bf16 v[72:87], v[204:207], a[96:99], v[72:87]
  v_fmac_f32 v173, v125, v149
  v_fmac_f32 v172, v126, v142
  v_mfma_f32_32x32x16_bf16 v[88:103], v[204:207], a[100:103], v[88:103]
  v_fmac_f32 v173, v126, v150
  v_fmac_f32 v172, v127, v143
  s_add_u32 m0, s39, 8192
  s_add_u32 s14, s38, 8192
  buffer_load_dwordx4 v4, s[16:19], s38 offen lds
  s_add_u32 m0, s39, 9216
  s_nop 0
  buffer_load_dwordx4 v4, s[16:19], s14 offen lds
  buffer_load_dwordx4 a[40:43], v3, s[20:23], s37 offen offset:0
  buffer_load_dwordx4 a[44:47], v3, s[20:23], s37 offen offset:1024
  s_add_u32 s38, s38, 16384
  s_add_u32 s37, s37, 2048
  s_waitcnt vmcnt(36)
  ds_read_b64_tr_b16 v[200:201], v5 offset:26624
  ds_read_b64_tr_b16 v[202:203], v5 offset:27136
  ds_read_b64_tr_b16 v[204:205], v6 offset:26624
  ds_read_b64_tr_b16 v[206:207], v6 offset:27136
  s_waitcnt lgkmcnt(6)
  v_mfma_f32_32x32x16_bf16 v[40:55], v[192:195], a[104:107], v[40:55]
  v_fmac_f32 v173, v127, v151
  v_mul_f32 v136, v128, v136
  v_mfma_f32_32x32x16_bf16 v[56:71], v[192:195], a[108:111], v[56:71]
  v_mul_f32 v144, v128, v144
  v_mul_f32 v137, v129, v137
  s_waitcnt lgkmcnt(4)
  v_mfma_f32_32x32x16_bf16 v[72:87], v[196:199], a[104:107], v[72:87]
  v_mul_f32 v145, v129, v145
  v_mul_f32 v138, v130, v138
  v_mfma_f32_32x32x16_bf16 v[88:103], v[196:199], a[108:111], v[88:103]
  v_mul_f32 v146, v130, v146
  v_mul_f32 v139, v131, v139
  s_add_u32 m0, s39, 10240
  s_add_u32 s14, s38, 8192
  buffer_load_dwordx4 v4, s[16:19], s38 offen lds
  s_add_u32 m0, s39, 11264
  s_nop 0
  buffer_load_dwordx4 v4, s[16:19], s14 offen lds
  buffer_load_dwordx4 a[48:51], v3, s[20:23], s37 offen offset:0
  buffer_load_dwordx4 a[52:55], v3, s[20:23], s37 offen offset:1024
  s_add_u32 s38, s38, 16384
  s_add_u32 s37, s37, 2048
  s_waitcnt vmcnt(36)
  ds_read_b64_tr_b16 v[192:193], v5 offset:28672
  ds_read_b64_tr_b16 v[194:195], v5 offset:29184
  ds_read_b64_tr_b16 v[196:197], v6 offset:28672
  ds_read_b64_tr_b16 v[198:199], v6 offset:29184
  s_waitcnt lgkmcnt(6)
  v_mfma_f32_32x32x16_bf16 v[40:55], v[200:203], a[112:115], v[40:55]
  v_mul_f32 v147, v131, v147
  v_mul_f32 v140, v132, v140
  v_mfma_f32_32x32x16_bf16 v[56:71], v[200:203], a[116:119], v[56:71]
  v_mul_f32 v148, v132, v148
  v_mul_f32 v141, v133, v141
  s_waitcnt lgkmcnt(4)
  v_mfma_f32_32x32x16_bf16 v[72:87], v[204:207], a[112:115], v[72:87]
  v_mul_f32 v149, v133, v149
  v_mul_f32 v142, v134, v142
  v_mfma_f32_32x32x16_bf16 v[88:103], v[204:207], a[116:119], v[88:103]
  v_mul_f32 v150, v134, v150
  v_mul_f32 v143, v135, v143
  s_add_u32 m0, s39, 12288
  s_add_u32 s14, s38, 8192
  buffer_load_dwordx4 v4, s[16:19], s38 offen lds
  s_add_u32 m0, s39, 13312
  s_nop 0
  buffer_load_dwordx4 v4, s[16:19], s14 offen lds
  buffer_load_dwordx4 a[56:59], v3, s[20:23], s37 offen offset:0
  buffer_load_dwordx4 a[60:63], v3, s[20:23], s37 offen offset:1024
  s_add_u32 s38, s38, 16384
  s_add_u32 s37, s37, 2048
  s_waitcnt vmcnt(36)
  ds_read_b64_tr_b16 v[200:201], v5 offset:30720
  ds_read_b64_tr_b16 v[202:203], v5 offset:31232
  ds_read_b64_tr_b16 v[204:205], v6 offset:30720
  ds_read_b64_tr_b16 v[206:207], v6 offset:31232
  s_waitcnt lgkmcnt(6)
  v_mfma_f32_32x32x16_bf16 v[40:55], v[192:195], a[120:123], v[40:55]
  v_mul_f32 v151, v135, v151
  v_cvt_pk_bf16_f32 v152, v136, v137
  v_mfma_f32_32x32x16_bf16 v[56:71], v[192:195], a[124:127], v[56:71]
  v_cvt_pk_bf16_f32 v153, v138, v139
  v_cvt_pk_bf16_f32 v154, v140, v141
  s_waitcnt lgkmcnt(4)
  v_mfma_f32_32x32x16_bf16 v[72:87], v[196:199], a[120:123], v[72:87]
  v_cvt_pk_bf16_f32 v155, v142, v143
  ds_write_b128 v186, v[152:155] offset:0
  v_mfma_f32_32x32x16_bf16 v[88:103], v[196:199], a[124:127], v[88:103]
  v_cvt_pk_bf16_f32 v156, v144, v145
  v_cvt_pk_bf16_f32 v157, v146, v147
  s_add_u32 m0, s39, 14336
  s_add_u32 s14, s38, 8192
  buffer_load_dwordx4 v4, s[16:19], s38 offen lds
  s_add_u32 m0, s39, 15360
  s_nop 0
  buffer_load_dwordx4 v4, s[16:19], s14 offen lds
  buffer_load_dwordx4 a[64:67], v3, s[20:23], s37 offen offset:0
  buffer_load_dwordx4 a[68:71], v3, s[20:23], s37 offen offset:1024
  s_add_u32 s38, s38, 16384
  s_add_u32 s37, s37, 2048
  s_waitcnt vmcnt(36)
  ds_read_b64_tr_b16 v[192:193], v5 offset:0
  ds_read_b64_tr_b16 v[194:195], v5 offset:512
  ds_read_b64_tr_b16 v[196:197], v6 offset:0
  ds_read_b64_tr_b16 v[198:199], v6 offset:512
  s_waitcnt lgkmcnt(7)
  v_mfma_f32_32x32x16_bf16 v[40:55], v[200:203], a[128:131], v[40:55]
  v_cvt_pk_bf16_f32 v158, v148, v149
  v_cvt_pk_bf16_f32 v159, v150, v151
  v_mfma_f32_32x32x16_bf16 v[56:71], v[200:203], a[132:135], v[56:71]
  ds_write_b128 v186, v[156:159] offset:16
  v_mov_b32 v168, 0
  s_waitcnt lgkmcnt(6)
  v_mfma_f32_32x32x16_bf16 v[72:87], v[204:207], a[128:131], v[72:87]
  v_mov_b32 v169, 0
  v_dot2_f32_bf16 v168, v152, s74, v168
  v_mfma_f32_32x32x16_bf16 v[88:103], v[204:207], a[132:135], v[88:103]
  v_dot2_f32_bf16 v169, v156, s74, v169
  v_dot2_f32_bf16 v168, v153, s74, v168
  s_add_u32 s42, s42, 8
  s_cmp_eq_u32 s42, 64
  s_cselect_b32 s13, 1048576, 0
  s_cselect_b32 s14, 131072, 0
  s_sub_u32 s38, s38, s13
  s_sub_u32 s37, s37, s14
  s_add_u32 m0, s39, 16384
  s_add_u32 s14, s38, 8192
  buffer_load_dwordx4 v4, s[16:19], s38 offen lds
  s_add_u32 m0, s39, 17408
  s_nop 0
  buffer_load_dwordx4 v4, s[16:19], s14 offen lds
  buffer_load_dwordx4 a[72:75], v3, s[20:23], s37 offen offset:0
  buffer_load_dwordx4 a[76:79], v3, s[20:23], s37 offen offset:1024
  s_add_u32 s38, s38, 16384
  s_add_u32 s37, s37, 2048
  s_waitcnt vmcnt(36)
  ds_read_b64_tr_b16 v[200:201], v5 offset:2048
  ds_read_b64_tr_b16 v[202:203], v5 offset:2560
  ds_read_b64_tr_b16 v[204:205], v6 offset:2048
  ds_read_b64_tr_b16 v[206:207], v6 offset:2560
  s_waitcnt lgkmcnt(7)
  v_mfma_f32_32x32x16_bf16 v[40:55], v[192:195], a[8:11], v[40:55]
  v_dot2_f32_bf16 v169, v157, s74, v169
  v_dot2_f32_bf16 v168, v154, s74, v168
  v_mfma_f32_32x32x16_bf16 v[56:71], v[192:195], a[12:15], v[56:71]
  v_dot2_f32_bf16 v169, v158, s74, v169
  v_dot2_f32_bf16 v168, v155, s74, v168
  s_waitcnt lgkmcnt(5)
  v_mfma_f32_32x32x16_bf16 v[72:87], v[196:199], a[8:11], v[72:87]
  v_dot2_f32_bf16 v169, v159, s74, v169
  v_and_b32 v144, 0xffff0000, v105
  v_mfma_f32_32x32x16_bf16 v[88:103], v[196:199], a[12:15], v[88:103]
  v_lshlrev_b32 v136, 16, v105
  v_and_b32 v145, 0xffff0000, v107
  s_add_u32 m0, s39, 18432
  s_add_u32 s14, s38, 8192
  buffer_load_dwordx4 v4, s[16:19], s38 offen lds
  s_add_u32 m0, s39, 19456
  s_nop 0
  buffer_load_dwordx4 v4, s[16:19], s14 offen lds
  buffer_load_dwordx4 a[80:83], v3, s[20:23], s37 offen offset:0
  buffer_load_dwordx4 a[84:87], v3, s[20:23], s37 offen offset:1024
  s_add_u32 s38, s38, 16384
  s_add_u32 s37, s37, 2048
  s_waitcnt vmcnt(30)
  ds_read_b64_tr_b16 v[192:193], v5 offset:4096
  ds_read_b64_tr_b16 v[194:195], v5 offset:4608
  ds_read_b64_tr_b16 v[196:197], v6 offset:4096
  ds_read_b64_tr_b16 v[198:199], v6 offset:4608
  s_waitcnt lgkmcnt(6)
  v_mfma_f32_32x32x16_bf16 v[40:55], v[200:203], a[16:19], v[40:55]
  v_lshlrev_b32 v137, 16, v107
  v_and_b32 v146, 0xffff0000, v109
  v_mfma_f32_32x32x16_bf16 v[56:71], v[200:203], a[20:23], v[56:71]
  v_lshlrev_b32 v138, 16, v109
  v_and_b32 v147, 0xffff0000, v111
  s_waitcnt lgkmcnt(4)
  v_mfma_f32_32x32x16_bf16 v[72:87], v[204:207], a[16:19], v[72:87]
  v_lshlrev_b32 v139, 16, v111
  v_and_b32 v148, 0xffff0000, v113
  v_mfma_f32_32x32x16_bf16 v[88:103], v[204:207], a[20:23], v[88:103]
  v_lshlrev_b32 v140, 16, v113
  v_and_b32 v149, 0xffff0000, v115
  s_add_u32 m0, s39, 20480
  s_add_u32 s14, s38, 8192
  buffer_load_dwordx4 v4, s[16:19], s38 offen lds
  s_add_u32 m0, s39, 21504
  s_nop 0
  buffer_load_dwordx4 v4, s[16:19], s14 offen lds
  buffer_load_dwordx4 a[88:91], v3, s[20:23], s37 offen offset:0
  buffer_load_dwordx4 a[92:95], v3, s[20:23], s37 offen offset:1024
  s_add_u32 s38, s38, 16384
  s_add_u32 s37, s37, 2048
  s_waitcnt vmcnt(30)
  ds_read_b64_tr_b16 v[200:201], v5 offset:6144
  ds_read_b64_tr_b16 v[202:203], v5 offset:6656
  ds_read_b64_tr_b16 v[204:205], v6 offset:6144
  ds_read_b64_tr_b16 v[206:207], v6 offset:6656
  s_waitcnt lgkmcnt(6)
  v_mfma_f32_32x32x16_bf16 v[40:55], v[192:195], a[24:27], v[40:55]
  v_lshlrev_b32 v141, 16, v115
  v_and_b32 v150, 0xffff0000, v117
  v_mfma_f32_32x32x16_bf16 v[56:71], v[192:195], a[28:31], v[56:71]
  v_lshlrev_b32 v142, 16, v117
  v_and_b32 v151, 0xffff0000, v119
  s_waitcnt lgkmcnt(4)
  v_mfma_f32_32x32x16_bf16 v[72:87], v[196:199], a[24:27], v[72:87]
  v_lshlrev_b32 v143, 16, v119
  v_mul_f32 v174, v120, v136
  v_mfma_f32_32x32x16_bf16 v[88:103], v[196:199], a[28:31], v[88:103]
  v_mul_f32 v175, v120, v144
  v_fmac_f32 v174, v121, v137
  s_add_u32 m0, s39, 22528
  s_add_u32 s14, s38, 8192
  buffer_load_dwordx4 v4, s[16:19], s38 offen lds
  s_add_u32 m0, s39, 23552
  s_nop 0
  buffer_load_dwordx4 v4, s[16:19], s14 offen lds
  buffer_load_dwordx4 a[96:99], v3, s[20:23], s37 offen offset:0
  buffer_load_dwordx4 a[100:103], v3, s[20:23], s37 offen offset:1024
  s_add_u32 s38, s38, 16384
  s_add_u32 s37, s37, 2048
  s_waitcnt vmcnt(30)
  ds_read_b64_tr_b16 v[192:193], v5 offset:8192
  ds_read_b64_tr_b16 v[194:195], v5 offset:8704
  ds_read_b64_tr_b16 v[196:197], v6 offset:8192
  ds_read_b64_tr_b16 v[198:199], v6 offset:8704
  s_waitcnt lgkmcnt(6)
  v_mfma_f32_32x32x16_bf16 v[40:55], v[200:203], a[32:35], v[40:55]
  v_fmac_f32 v175, v121, v145
  v_fmac_f32 v174, v122, v138
  v_mfma_f32_32x32x16_bf16 v[56:71], v[200:203], a[36:39], v[56:71]
  v_fmac_f32 v175, v122, v146
  v_fmac_f32 v174, v123, v139
  s_waitcnt lgkmcnt(4)
  v_mfma_f32_32x32x16_bf16 v[72:87], v[204:207], a[32:35], v[72:87]
  v_fmac_f32 v175, v123, v147
  v_fmac_f32 v174, v124, v140
  v_mfma_f32_32x32x16_bf16 v[88:103], v[204:207], a[36:39], v[88:103]
  v_fmac_f32 v175, v124, v148
  v_fmac_f32 v174, v125, v141
  s_add_u32 m0, s39, 24576
  s_add_u32 s14, s38, 8192
  buffer_load_dwordx4 v4, s[16:19], s38 offen lds
  s_add_u32 m0, s39, 25600
  s_nop 0
  buffer_load_dwordx4 v4, s[16:19], s14 offen lds
  buffer_load_dwordx4 a[104:107], v3, s[20:23], s37 offen offset:0
  buffer_load_dwordx4 a[108:111], v3, s[20:23], s37 offen offset:1024
  s_add_u32 s38, s38, 16384
  s_add_u32 s37, s37, 2048
  s_waitcnt vmcnt(30)
  ds_read_b64_tr_b16 v[200:201], v5 offset:10240
  ds_read_b64_tr_b16 v[202:203], v5 offset:10752
  ds_read_b64_tr_b16 v[204:205], v6 offset:10240
  ds_read_b64_tr_b16 v[206:207], v6 offset:10752
  s_waitcnt lgkmcnt(6)
  v_mfma_f32_32x32x16_bf16 v[40:55], v[192:195], a[40:43], v[40:55]
  v_fmac_f32 v175, v125, v149
  v_fmac_f32 v174, v126, v142
  v_mfma_f32_32x32x16_bf16 v[56:71], v[192:195], a[44:47], v[56:71]
  v_fmac_f32 v175, v126, v150
  v_fmac_f32 v174, v127, v143
  s_waitcnt lgkmcnt(4)
  v_mfma_f32_32x32x16_bf16 v[72:87], v[196:199], a[40:43], v[72:87]
  v_fmac_f32 v175, v127, v151
  v_mul_f32 v136, v128, v136
  v_mfma_f32_32x32x16_bf16 v[88:103], v[196:199], a[44:47], v[88:103]
  v_mul_f32 v144, v128, v144
  v_mul_f32 v137, v129, v137
  s_add_u32 m0, s39, 26624
  s_add_u32 s14, s38, 8192
  buffer_load_dwordx4 v4, s[16:19], s38 offen lds
  s_add_u32 m0, s39, 27648
  s_nop 0
  buffer_load_dwordx4 v4, s[16:19], s14 offen lds
  buffer_load_dwordx4 a[112:115], v3, s[20:23], s37 offen offset:0
  buffer_load_dwordx4 a[116:119], v3, s[20:23], s37 offen offset:1024
  s_add_u32 s38, s38, 16384
  s_add_u32 s37, s37, 2048
  s_waitcnt vmcnt(30)
  ds_read_b64_tr_b16 v[192:193], v5 offset:12288
  ds_read_b64_tr_b16 v[194:195], v5 offset:12800
  ds_read_b64_tr_b16 v[196:197], v6 offset:12288
  ds_read_b64_tr_b16 v[198:199], v6 offset:12800
  s_waitcnt lgkmcnt(6)
  v_mfma_f32_32x32x16_bf16 v[40:55], v[200:203], a[48:51], v[40:55]
  v_mul_f32 v145, v129, v145
  v_mul_f32 v138, v130, v138
  v_mfma_f32_32x32x16_bf16 v[56:71], v[200:203], a[52:55], v[56:71]
  v_mul_f32 v146, v130, v146
  v_mul_f32 v139, v131, v139
  s_waitcnt lgkmcnt(4)
  v_mfma_f32_32x32x16_bf16 v[72:87], v[204:207], a[48:51], v[72:87]
  v_mul_f32 v147, v131, v147
  v_mul_f32 v140, v132, v140
  v_mfma_f32_32x32x16_bf16 v[88:103], v[204:207], a[52:55], v[88:103]
  v_mul_f32 v148, v132, v148
  v_mul_f32 v141, v133, v141
  s_add_u32 m0, s39, 28672
  s_add_u32 s14, s38, 8192
  buffer_load_dwordx4 v4, s[16:19], s38 offen lds
  s_add_u32 m0, s39, 29696
  s_nop 0
  buffer_load_dwordx4 v4, s[16:19], s14 offen lds
  buffer_load_dwordx4 a[120:123], v3, s[20:23], s37 offen offset:0
  buffer_load_dwordx4 a[124:127], v3, s[20:23], s37 offen offset:1024
  s_add_u32 s38, s38, 16384
  s_add_u32 s37, s37, 2048
  s_waitcnt vmcnt(30)
  ds_read_b64_tr_b16 v[200:201], v5 offset:14336
  ds_read_b64_tr_b16 v[202:203], v5 offset:14848
  ds_read_b64_tr_b16 v[204:205], v6 offset:14336
  ds_read_b64_tr_b16 v[206:207], v6 offset:14848
  s_waitcnt lgkmcnt(6)
  v_mfma_f32_32x32x16_bf16 v[40:55], v[192:195], a[56:59], v[40:55]
  v_mul_f32 v149, v133, v149
  v_mul_f32 v142, v134, v142
  v_mfma_f32_32x32x16_bf16 v[56:71], v[192:195], a[60:63], v[56:71]
  v_mul_f32 v150, v134, v150
  v_mul_f32 v143, v135, v143
  s_waitcnt lgkmcnt(4)
  v_mfma_f32_32x32x16_bf16 v[72:87], v[196:199], a[56:59], v[72:87]
  v_mul_f32 v151, v135, v151
  v_cvt_pk_bf16_f32 v160, v136, v137
  v_mfma_f32_32x32x16_bf16 v[88:103], v[196:199], a[60:63], v[88:103]
  v_cvt_pk_bf16_f32 v161, v138, v139
  v_cvt_pk_bf16_f32 v162, v140, v141
  s_add_u32 m0, s39, 30720
  s_add_u32 s14, s38, 8192
  buffer_load_dwordx4 v4, s[16:19], s38 offen lds
  s_add_u32 m0, s39, 31744
  s_nop 0
  buffer_load_dwordx4 v4, s[16:19], s14 offen lds
  buffer_load_dwordx4 a[128:131], v3, s[20:23], s37 offen offset:0
  buffer_load_dwordx4 a[132:135], v3, s[20:23], s37 offen offset:1024
  s_add_u32 s38, s38, 16384
  s_add_u32 s37, s37, 2048
  s_waitcnt vmcnt(30)
  ds_read_b64_tr_b16 v[192:193], v5 offset:16384
  ds_read_b64_tr_b16 v[194:195], v5 offset:16896
  ds_read_b64_tr_b16 v[196:197], v6 offset:16384
  ds_read_b64_tr_b16 v[198:199], v6 offset:16896
  s_waitcnt lgkmcnt(6)
  v_mfma_f32_32x32x16_bf16 v[40:55], v[200:203], a[64:67], v[40:55]
  v_cvt_pk_bf16_f32 v163, v142, v143
  ds_write_b128 v186, v[160:163] offset:32
  v_mfma_f32_32x32x16_bf16 v[56:71], v[200:203], a[68:71], v[56:71]
  v_cvt_pk_bf16_f32 v164, v144, v145
  v_cvt_pk_bf16_f32 v165, v146, v147
  s_waitcnt lgkmcnt(5)
  v_mfma_f32_32x32x16_bf16 v[72:87], v[204:207], a[64:67], v[72:87]
  v_cvt_pk_bf16_f32 v166, v148, v149
  v_cvt_pk_bf16_f32 v167, v150, v151
  v_mfma_f32_32x32x16_bf16 v[88:103], v[204:207], a[68:71], v[88:103]
  ds_write_b128 v186, v[164:167] offset:48
  v_mov_b32 v170, 0
  s_add_u32 s42, s42, 8
  s_cmp_eq_u32 s42, 64
  s_cselect_b32 s13, 1048576, 0
  s_cselect_b32 s14, 131072, 0
  s_sub_u32 s38, s38, s13
  s_sub_u32 s37, s37, s14
  s_add_u32 m0, s39, 0
  s_add_u32 s14, s38, 8192
  buffer_load_dwordx4 v4, s[16:19], s38 offen lds
  s_add_u32 m0, s39, 1024
  s_nop 0
  buffer_load_dwordx4 v4, s[16:19], s14 offen lds
  buffer_load_dwordx4 a[8:11], v3, s[20:23], s37 offen offset:0
  buffer_load_dwordx4 a[12:15], v3, s[20:23], s37 offen offset:1024
  s_add_u32 s38, s38, 16384
  s_add_u32 s37, s37, 2048
  s_waitcnt vmcnt(30)
  ds_read_b64_tr_b16 v[200:201], v5 offset:18432
  ds_read_b64_tr_b16 v[202:203], v5 offset:18944
  ds_read_b64_tr_b16 v[204:205], v6 offset:18432
  ds_read_b64_tr_b16 v[206:207], v6 offset:18944
  s_waitcnt lgkmcnt(8)
  v_mfma_f32_32x32x16_bf16 v[40:55], v[192:195], a[72:75], v[40:55]
  v_mov_b32 v171, 0
  v_dot2_f32_bf16 v170, v160, s74, v170
  v_mfma_f32_32x32x16_bf16 v[56:71], v[192:195], a[76:79], v[56:71]
  v_dot2_f32_bf16 v171, v164, s74, v171
  v_dot2_f32_bf16 v170, v161, s74, v170
  s_waitcnt lgkmcnt(6)
  v_mfma_f32_32x32x16_bf16 v[72:87], v[196:199], a[72:75], v[72:87]
  v_dot2_f32_bf16 v171, v165, s74, v171
  v_dot2_f32_bf16 v170, v162, s74, v170
  v_mfma_f32_32x32x16_bf16 v[88:103], v[196:199], a[76:79], v[88:103]
  v_dot2_f32_bf16 v171, v166, s74, v171
  v_dot2_f32_bf16 v170, v163, s74, v170
  s_add_u32 m0, s39, 2048
  s_add_u32 s14, s38, 8192
  buffer_load_dwordx4 v4, s[16:19], s38 offen lds
  s_add_u32 m0, s39, 3072
  s_nop 0
  buffer_load_dwordx4 v4, s[16:19], s14 offen lds
  buffer_load_dwordx4 a[16:19], v3, s[20:23], s37 offen offset:0
  buffer_load_dwordx4 a[20:23], v3, s[20:23], s37 offen offset:1024
  s_add_u32 s38, s38, 16384
  s_add_u32 s37, s37, 2048
  s_waitcnt vmcnt(30)
  ds_read_b64_tr_b16 v[192:193], v5 offset:20480
  ds_read_b64_tr_b16 v[194:195], v5 offset:20992
  ds_read_b64_tr_b16 v[196:197], v6 offset:20480
  ds_read_b64_tr_b16 v[198:199], v6 offset:20992
  s_waitcnt lgkmcnt(6)
  v_mfma_f32_32x32x16_bf16 v[40:55], v[200:203], a[80:83], v[40:55]
  v_dot2_f32_bf16 v171, v167, s74, v171
  ds_read_b128 v[136:139], v188 offset:0
  v_mfma_f32_32x32x16_bf16 v[56:71], v[200:203], a[84:87], v[56:71]
  ds_read_b128 v[140:143], v188 offset:1024
  ds_read_b128 v[144:147], v188 offset:2048
  s_waitcnt lgkmcnt(7)
  v_mfma_f32_32x32x16_bf16 v[72:87], v[204:207], a[80:83], v[72:87]
  ds_read_b128 v[148:151], v188 offset:3072
  s_nop 3
  v_mfma_f32_32x32x16_bf16 v[88:103], v[204:207], a[84:87], v[88:103]
  v_mov_b32 v176, v168
  v_mov_b32 v177, v169
  s_add_u32 m0, s39, 4096
  s_add_u32 s14, s38, 8192
  buffer_load_dwordx4 v4, s[16:19], s38 offen lds
  s_add_u32 m0, s39, 5120
  s_nop 0
  buffer_load_dwordx4 v4, s[16:19], s14 offen lds
  buffer_load_dwordx4 a[24:27], v3, s[20:23], s37 offen offset:0
  buffer_load_dwordx4 a[28:31], v3, s[20:23], s37 offen offset:1024
  s_add_u32 s38, s38, 16384
  s_add_u32 s37, s37, 2048
  s_waitcnt vmcnt(30)
  ds_read_b64_tr_b16 v[200:201], v5 offset:22528
  ds_read_b64_tr_b16 v[202:203], v5 offset:23040
  ds_read_b64_tr_b16 v[204:205], v6 offset:22528
  ds_read_b64_tr_b16 v[206:207], v6 offset:23040
  s_waitcnt lgkmcnt(10)
  v_mfma_f32_32x32x16_bf16 v[40:55], v[192:195], a[88:91], v[40:55]
  v_mov_b32 v178, v170
  v_mov_b32 v179, v171
  v_mfma_f32_32x32x16_bf16 v[56:71], v[192:195], a[92:95], v[56:71]
  v_mov_b32 v180, v172
  v_mov_b32 v181, v173
  s_waitcnt lgkmcnt(8)
  v_mfma_f32_32x32x16_bf16 v[72:87], v[196:199], a[88:91], v[72:87]
  v_mov_b32 v182, v174
  v_mov_b32 v183, v175
  v_mfma_f32_32x32x16_bf16 v[88:103], v[196:199], a[92:95], v[88:103]
  v_permlane16_swap_b32 v168, v176
  v_permlane16_swap_b32 v169, v177
  s_add_u32 m0, s39, 6144
  s_add_u32 s14, s38, 8192
  buffer_load_dwordx4 v4, s[16:19], s38 offen lds
  s_add_u32 m0, s39, 7168
  s_nop 0
  buffer_load_dwordx4 v4, s[16:19], s14 offen lds
  buffer_load_dwordx4 a[32:35], v3, s[20:23], s37 offen offset:0
  buffer_load_dwordx4 a[36:39], v3, s[20:23], s37 offen offset:1024
  s_add_u32 s38, s38, 16384
  s_add_u32 s37, s37, 2048
  s_waitcnt vmcnt(30)
  ds_read_b64_tr_b16 v[192:193], v5 offset:24576
  ds_read_b64_tr_b16 v[194:195], v5 offset:25088
  ds_read_b64_tr_b16 v[196:197], v6 offset:24576
  ds_read_b64_tr_b16 v[198:199], v6 offset:25088
  s_waitcnt lgkmcnt(6)
  v_mfma_f32_32x32x16_bf16 v[40:55], v[200:203], a[96:99], v[40:55]
  v_permlane16_swap_b32 v170, v178
  v_permlane16_swap_b32 v171, v179
  v_mfma_f32_32x32x16_bf16 v[56:71], v[200:203], a[100:103], v[56:71]
  v_permlane16_swap_b32 v172, v180
  v_permlane16_swap_b32 v173, v181
  s_waitcnt lgkmcnt(4)
  v_mfma_f32_32x32x16_bf16 v[72:87], v[204:207], a[96:99], v[72:87]
  v_permlane16_swap_b32 v174, v182
  v_permlane16_swap_b32 v175, v183
  v_mfma_f32_32x32x16_bf16 v[88:103], v[204:207], a[100:103], v[88:103]
  v_add_f32 v168, v168, v176
  v_add_f32 v169, v169, v177
  s_add_u32 m0, s39, 8192
  s_add_u32 s14, s38, 8192
  buffer_load_dwordx4 v4, s[16:19], s38 offen lds
  s_add_u32 m0, s39, 9216
  s_nop 0
  buffer_load_dwordx4 v4, s[16:19], s14 offen lds
  buffer_load_dwordx4 a[40:43], v3, s[20:23], s37 offen offset:0
  buffer_load_dwordx4 a[44:47], v3, s[20:23], s37 offen offset:1024
  s_add_u32 s38, s38, 16384
  s_add_u32 s37, s37, 2048
  s_waitcnt vmcnt(30)
  ds_read_b64_tr_b16 v[200:201], v5 offset:26624
  ds_read_b64_tr_b16 v[202:203], v5 offset:27136
  ds_read_b64_tr_b16 v[204:205], v6 offset:26624
  ds_read_b64_tr_b16 v[206:207], v6 offset:27136
  s_waitcnt lgkmcnt(6)
  v_mfma_f32_32x32x16_bf16 v[40:55], v[192:195], a[104:107], v[40:55]
  v_add_f32 v170, v170, v178
  v_add_f32 v171, v171, v179
  v_mfma_f32_32x32x16_bf16 v[56:71], v[192:195], a[108:111], v[56:71]
  v_add_f32 v172, v172, v180
  v_add_f32 v173, v173, v181
  s_waitcnt lgkmcnt(4)
  v_mfma_f32_32x32x16_bf16 v[72:87], v[196:199], a[104:107], v[72:87]
  v_add_f32 v174, v174, v182
  v_add_f32 v175, v175, v183
  v_mfma_f32_32x32x16_bf16 v[88:103], v[196:199], a[108:111], v[88:103]
  v_mov_b32 v176, v168
  v_mov_b32 v177, v169
  s_add_u32 m0, s39, 10240
  s_add_u32 s14, s38, 8192
  buffer_load_dwordx4 v4, s[16:19], s38 offen lds
  s_add_u32 m0, s39, 11264
  s_nop 0
  buffer_load_dwordx4 v4, s[16:19], s14 offen lds
  buffer_load_dwordx4 a[48:51], v3, s[20:23], s37 offen offset:0
  buffer_load_dwordx4 a[52:55], v3, s[20:23], s37 offen offset:1024
  s_add_u32 s38, s38, 16384
  s_add_u32 s37, s37, 2048
  s_waitcnt vmcnt(30)
  ds_read_b64_tr_b16 v[192:193], v5 offset:28672
  ds_read_b64_tr_b16 v[194:195], v5 offset:29184
  ds_read_b64_tr_b16 v[196:197], v6 offset:28672
  ds_read_b64_tr_b16 v[198:199], v6 offset:29184
  s_waitcnt lgkmcnt(6)
  v_mfma_f32_32x32x16_bf16 v[40:55], v[200:203], a[112:115], v[40:55]
  v_mov_b32 v178, v170
  v_mov_b32 v179, v171
  v_mfma_f32_32x32x16_bf16 v[56:71], v[200:203], a[116:119], v[56:71]
  v_mov_b32 v180, v172
  v_mov_b32 v181, v173
  s_waitcnt lgkmcnt(4)
  v_mfma_f32_32x32x16_bf16 v[72:87], v[204:207], a[112:115], v[72:87]
  v_mov_b32 v182, v174
  v_mov_b32 v183, v175
  v_mfma_f32_32x32x16_bf16 v[88:103], v[204:207], a[116:119], v[88:103]
  v_permlane32_swap_b32 v168, v176
  v_permlane32_swap_b32 v169, v177
  s_add_u32 m0, s39, 12288
  s_add_u32 s14, s38, 8192
  buffer_load_dwordx4 v4, s[16:19], s38 offen lds
  s_add_u32 m0, s39, 13312
  s_nop 0
  buffer_load_dwordx4 v4, s[16:19], s14 offen lds
  buffer_load_dwordx4 a[56:59], v3, s[20:23], s37 offen offset:0
  buffer_load_dwordx4 a[60:63], v3, s[20:23], s37 offen offset:1024
  s_add_u32 s38, s38, 16384
  s_add_u32 s37, s37, 2048
  s_waitcnt vmcnt(30)
  ds_read_b64_tr_b16 v[200:201], v5 offset:30720
  ds_read_b64_tr_b16 v[202:203], v5 offset:31232
  ds_read_b64_tr_b16 v[204:205], v6 offset:30720
  ds_read_b64_tr_b16 v[206:207], v6 offset:31232
  s_waitcnt lgkmcnt(6)
  v_mfma_f32_32x32x16_bf16 v[40:55], v[192:195], a[120:123], v[40:55]
  v_permlane32_swap_b32 v170, v178
  v_permlane32_swap_b32 v171, v179
  v_mfma_f32_32x32x16_bf16 v[56:71], v[192:195], a[124:127], v[56:71]
  v_permlane32_swap_b32 v172, v180
  v_permlane32_swap_b32 v173, v181
  s_waitcnt lgkmcnt(4)
  v_mfma_f32_32x32x16_bf16 v[72:87], v[196:199], a[120:123], v[72:87]
  v_permlane32_swap_b32 v174, v182
  v_permlane32_swap_b32 v175, v183
  v_mfma_f32_32x32x16_bf16 v[88:103], v[196:199], a[124:127], v[88:103]
  v_add_f32 v168, v168, v176
  v_add_f32 v169, v169, v177
  s_add_u32 m0, s39, 14336
  s_add_u32 s14, s38, 8192
  buffer_load_dwordx4 v4, s[16:19], s38 offen lds
  s_add_u32 m0, s39, 15360
  s_nop 0
  buffer_load_dwordx4 v4, s[16:19], s14 offen lds
  buffer_load_dwordx4 a[64:67], v3, s[20:23], s37 offen offset:0
  buffer_load_dwordx4 a[68:71], v3, s[20:23], s37 offen offset:1024
  s_add_u32 s38, s38, 16384
  s_add_u32 s37, s37, 2048
  s_waitcnt vmcnt(30)
  ds_read_b64_tr_b16 v[192:193], v5 offset:0
  ds_read_b64_tr_b16 v[194:195], v5 offset:512
  ds_read_b64_tr_b16 v[196:197], v6 offset:0
  ds_read_b64_tr_b16 v[198:199], v6 offset:512
  s_waitcnt lgkmcnt(6)
  v_mfma_f32_32x32x16_bf16 v[40:55], v[200:203], a[128:131], v[40:55]
  v_add_f32 v170, v170, v178
  v_add_f32 v171, v171, v179
  v_mfma_f32_32x32x16_bf16 v[56:71], v[200:203], a[132:135], v[56:71]
  v_add_f32 v172, v172, v180
  v_add_f32 v173, v173, v181
  s_waitcnt lgkmcnt(4)
  v_mfma_f32_32x32x16_bf16 v[72:87], v[204:207], a[128:131], v[72:87]
  v_add_f32 v174, v174, v182
  v_add_f32 v175, v175, v183
  v_mfma_f32_32x32x16_bf16 v[88:103], v[204:207], a[132:135], v[88:103]
  buffer_store_dwordx4 v[136:139], v3, s[56:59], s69 offen offset:0
  buffer_store_dwordx4 v[140:143], v3, s[56:59], s69 offen offset:2048
  s_add_u32 s42, s42, 8
  s_cmp_eq_u32 s42, 64
  s_cselect_b32 s13, 1048576, 0
  s_cselect_b32 s14, 131072, 0
  s_sub_u32 s38, s38, s13
  s_sub_u32 s37, s37, s14
  s_add_u32 m0, s39, 16384
  s_add_u32 s14, s38, 8192
  buffer_load_dwordx4 v4, s[16:19], s38 offen lds
  s_add_u32 m0, s39, 17408
  s_nop 0
  buffer_load_dwordx4 v4, s[16:19], s14 offen lds
  buffer_load_dwordx4 a[72:75], v3, s[20:23], s37 offen offset:0
  buffer_load_dwordx4 a[76:79], v3, s[20:23], s37 offen offset:1024
  s_add_u32 s38, s38, 16384
  s_add_u32 s37, s37, 2048
  s_waitcnt vmcnt(32)
  ds_read_b64_tr_b16 v[200:201], v5 offset:2048
  ds_read_b64_tr_b16 v[202:203], v5 offset:2560
  ds_read_b64_tr_b16 v[204:205], v6 offset:2048
  ds_read_b64_tr_b16 v[206:207], v6 offset:2560
  s_waitcnt lgkmcnt(6)
  v_mfma_f32_32x32x16_bf16 v[40:55], v[192:195], a[8:11], v[40:55]
  buffer_store_dwordx4 v[144:147], v3, s[56:59], s73 offen offset:0
  buffer_store_dwordx4 v[148:151], v3, s[56:59], s73 offen offset:2048
  v_mfma_f32_32x32x16_bf16 v[56:71], v[192:195], a[12:15], v[56:71]
  v_lshlrev_b32 v187, 4, v187
  s_lshl_b32 s75, s10, 9
  s_waitcnt lgkmcnt(4)
  v_mfma_f32_32x32x16_bf16 v[72:87], v[196:199], a[8:11], v[72:87]
  s_add_u32 s75, s75, 131072
  v_add_u32 v187, s75, v187
  v_mfma_f32_32x32x16_bf16 v[88:103], v[196:199], a[12:15], v[88:103]
  ds_write_b128 v187, v[168:171]
  ds_write_b128 v187, v[172:175] offset:256
  s_add_u32 m0, s39, 18432
  s_add_u32 s14, s38, 8192
  buffer_load_dwordx4 v4, s[16:19], s38 offen lds
  s_add_u32 m0, s39, 19456
  s_nop 0
  buffer_load_dwordx4 v4, s[16:19], s14 offen lds
  buffer_load_dwordx4 a[80:83], v3, s[20:23], s37 offen offset:0
  buffer_load_dwordx4 a[84:87], v3, s[20:23], s37 offen offset:1024
  s_add_u32 s38, s38, 16384
  s_add_u32 s37, s37, 2048
  s_waitcnt vmcnt(34)
  ds_read_b64_tr_b16 v[192:193], v5 offset:4096
  ds_read_b64_tr_b16 v[194:195], v5 offset:4608
  ds_read_b64_tr_b16 v[196:197], v6 offset:4096
  ds_read_b64_tr_b16 v[198:199], v6 offset:4608
  s_waitcnt lgkmcnt(8)
  v_mfma_f32_32x32x16_bf16 v[40:55], v[200:203], a[16:19], v[40:55]
  v_mfma_f32_32x32x16_bf16 v[56:71], v[200:203], a[20:23], v[56:71]
  s_waitcnt lgkmcnt(6)
  v_mfma_f32_32x32x16_bf16 v[72:87], v[204:207], a[16:19], v[72:87]
  v_mfma_f32_32x32x16_bf16 v[88:103], v[204:207], a[20:23], v[88:103]
  s_add_u32 m0, s39, 20480
  s_add_u32 s14, s38, 8192
  buffer_load_dwordx4 v4, s[16:19], s38 offen lds
  s_add_u32 m0, s39, 21504
  s_nop 0
  buffer_load_dwordx4 v4, s[16:19], s14 offen lds
  buffer_load_dwordx4 a[88:91], v3, s[20:23], s37 offen offset:0
  buffer_load_dwordx4 a[92:95], v3, s[20:23], s37 offen offset:1024
  s_add_u32 s38, s38, 16384
  s_add_u32 s37, s37, 2048
  s_waitcnt vmcnt(34)
  ds_read_b64_tr_b16 v[200:201], v5 offset:6144
  ds_read_b64_tr_b16 v[202:203], v5 offset:6656
  ds_read_b64_tr_b16 v[204:205], v6 offset:6144
  ds_read_b64_tr_b16 v[206:207], v6 offset:6656
  s_waitcnt lgkmcnt(6)
  v_mfma_f32_32x32x16_bf16 v[40:55], v[192:195], a[24:27], v[40:55]
  v_mfma_f32_32x32x16_bf16 v[56:71], v[192:195], a[28:31], v[56:71]
  s_waitcnt lgkmcnt(4)
  v_mfma_f32_32x32x16_bf16 v[72:87], v[196:199], a[24:27], v[72:87]
  v_mfma_f32_32x32x16_bf16 v[88:103], v[196:199], a[28:31], v[88:103]
  s_add_u32 m0, s39, 22528
  s_add_u32 s14, s38, 8192
  buffer_load_dwordx4 v4, s[16:19], s38 offen lds
  s_add_u32 m0, s39, 23552
  s_nop 0
  buffer_load_dwordx4 v4, s[16:19], s14 offen lds
  buffer_load_dwordx4 a[96:99], v3, s[20:23], s37 offen offset:0
  buffer_load_dwordx4 a[100:103], v3, s[20:23], s37 offen offset:1024
  s_add_u32 s38, s38, 16384
  s_add_u32 s37, s37, 2048
  s_waitcnt vmcnt(34)
  ds_read_b64_tr_b16 v[192:193], v5 offset:8192
  ds_read_b64_tr_b16 v[194:195], v5 offset:8704
  ds_read_b64_tr_b16 v[196:197], v6 offset:8192
  ds_read_b64_tr_b16 v[198:199], v6 offset:8704
  s_waitcnt lgkmcnt(6)
  v_mfma_f32_32x32x16_bf16 v[40:55], v[200:203], a[32:35], v[40:55]
  v_mfma_f32_32x32x16_bf16 v[56:71], v[200:203], a[36:39], v[56:71]
  s_waitcnt lgkmcnt(4)
  v_mfma_f32_32x32x16_bf16 v[72:87], v[204:207], a[32:35], v[72:87]
  v_mfma_f32_32x32x16_bf16 v[88:103], v[204:207], a[36:39], v[88:103]
  s_add_u32 m0, s39, 24576
  s_add_u32 s14, s38, 8192
  buffer_load_dwordx4 v4, s[16:19], s38 offen lds
  s_add_u32 m0, s39, 25600
  s_nop 0
  buffer_load_dwordx4 v4, s[16:19], s14 offen lds
  buffer_load_dwordx4 a[104:107], v3, s[20:23], s37 offen offset:0
  buffer_load_dwordx4 a[108:111], v3, s[20:23], s37 offen offset:1024
  s_add_u32 s38, s38, 16384
  s_add_u32 s37, s37, 2048
  s_waitcnt vmcnt(34)
  ds_read_b64_tr_b16 v[200:201], v5 offset:10240
  ds_read_b64_tr_b16 v[202:203], v5 offset:10752
  ds_read_b64_tr_b16 v[204:205], v6 offset:10240
  ds_read_b64_tr_b16 v[206:207], v6 offset:10752
  s_waitcnt lgkmcnt(6)
  v_mfma_f32_32x32x16_bf16 v[40:55], v[192:195], a[40:43], v[40:55]
  v_mfma_f32_32x32x16_bf16 v[56:71], v[192:195], a[44:47], v[56:71]
  s_waitcnt lgkmcnt(4)
  v_mfma_f32_32x32x16_bf16 v[72:87], v[196:199], a[40:43], v[72:87]
  v_mfma_f32_32x32x16_bf16 v[88:103], v[196:199], a[44:47], v[88:103]
  s_add_u32 m0, s39, 26624
  s_add_u32 s14, s38, 8192
  buffer_load_dwordx4 v4, s[16:19], s38 offen lds
  s_add_u32 m0, s39, 27648
  s_nop 0
  buffer_load_dwordx4 v4, s[16:19], s14 offen lds
  buffer_load_dwordx4 a[112:115], v3, s[20:23], s37 offen offset:0
  buffer_load_dwordx4 a[116:119], v3, s[20:23], s37 offen offset:1024
  s_add_u32 s38, s38, 16384
  s_add_u32 s37, s37, 2048
  s_waitcnt vmcnt(34)
  ds_read_b64_tr_b16 v[192:193], v5 offset:12288
  ds_read_b64_tr_b16 v[194:195], v5 offset:12800
  ds_read_b64_tr_b16 v[196:197], v6 offset:12288
  ds_read_b64_tr_b16 v[198:199], v6 offset:12800
  s_waitcnt lgkmcnt(6)
  v_mfma_f32_32x32x16_bf16 v[40:55], v[200:203], a[48:51], v[40:55]
  v_mfma_f32_32x32x16_bf16 v[56:71], v[200:203], a[52:55], v[56:71]
  s_waitcnt lgkmcnt(4)
  v_mfma_f32_32x32x16_bf16 v[72:87], v[204:207], a[48:51], v[72:87]
  v_mfma_f32_32x32x16_bf16 v[88:103], v[204:207], a[52:55], v[88:103]
  s_add_u32 m0, s39, 28672
  s_add_u32 s14, s38, 8192
  buffer_load_dwordx4 v4, s[16:19], s38 offen lds
  s_add_u32 m0, s39, 29696
  s_nop 0
  buffer_load_dwordx4 v4, s[16:19], s14 offen lds
  buffer_load_dwordx4 a[120:123], v3, s[20:23], s37 offen offset:0
  buffer_load_dwordx4 a[124:127], v3, s[20:23], s37 offen offset:1024
  s_add_u32 s38, s38, 16384
  s_add_u32 s37, s37, 2048
  s_waitcnt vmcnt(34)
  ds_read_b64_tr_b16 v[200:201], v5 offset:14336
  ds_read_b64_tr_b16 v[202:203], v5 offset:14848
  ds_read_b64_tr_b16 v[204:205], v6 offset:14336
  ds_read_b64_tr_b16 v[206:207], v6 offset:14848
  s_waitcnt lgkmcnt(6)
  v_mfma_f32_32x32x16_bf16 v[40:55], v[192:195], a[56:59], v[40:55]
  v_mfma_f32_32x32x16_bf16 v[56:71], v[192:195], a[60:63], v[56:71]
  s_waitcnt lgkmcnt(4)
  v_mfma_f32_32x32x16_bf16 v[72:87], v[196:199], a[56:59], v[72:87]
  v_mfma_f32_32x32x16_bf16 v[88:103], v[196:199], a[60:63], v[88:103]
  s_add_u32 m0, s39, 30720
  s_add_u32 s14, s38, 8192
  buffer_load_dwordx4 v4, s[16:19], s38 offen lds
  s_add_u32 m0, s39, 31744
  s_nop 0
  buffer_load_dwordx4 v4, s[16:19], s14 offen lds
  buffer_load_dwordx4 a[128:131], v3, s[20:23], s37 offen offset:0
  buffer_load_dwordx4 a[132:135], v3, s[20:23], s37 offen offset:1024
  s_add_u32 s38, s38, 16384
  s_add_u32 s37, s37, 2048
  s_waitcnt vmcnt(32)
  ds_read_b64_tr_b16 v[192:193], v5 offset:16384
  ds_read_b64_tr_b16 v[194:195], v5 offset:16896
  ds_read_b64_tr_b16 v[196:197], v6 offset:16384
  ds_read_b64_tr_b16 v[198:199], v6 offset:16896
  s_waitcnt lgkmcnt(6)
  v_mfma_f32_32x32x16_bf16 v[40:55], v[200:203], a[64:67], v[40:55]
  v_mfma_f32_32x32x16_bf16 v[56:71], v[200:203], a[68:71], v[56:71]
  s_waitcnt lgkmcnt(4)
  v_mfma_f32_32x32x16_bf16 v[72:87], v[204:207], a[64:67], v[72:87]
  v_mfma_f32_32x32x16_bf16 v[88:103], v[204:207], a[68:71], v[88:103]
  s_add_u32 s42, s42, 8
  s_cmp_eq_u32 s42, 64
  s_cselect_b32 s13, 1048576, 0
  s_cselect_b32 s14, 131072, 0
  s_sub_u32 s38, s38, s13
  s_sub_u32 s37, s37, s14
  s_add_u32 m0, s39, 0
  s_add_u32 s14, s38, 8192
  buffer_load_dwordx4 v4, s[16:19], s38 offen lds
  s_add_u32 m0, s39, 1024
  s_nop 0
  buffer_load_dwordx4 v4, s[16:19], s14 offen lds
  buffer_load_dwordx4 a[8:11], v3, s[20:23], s37 offen offset:0
  buffer_load_dwordx4 a[12:15], v3, s[20:23], s37 offen offset:1024
  s_add_u32 s38, s38, 16384
  s_add_u32 s37, s37, 2048
  s_waitcnt vmcnt(30)
  ds_read_b64_tr_b16 v[200:201], v5 offset:18432
  ds_read_b64_tr_b16 v[202:203], v5 offset:18944
  ds_read_b64_tr_b16 v[204:205], v6 offset:18432
  ds_read_b64_tr_b16 v[206:207], v6 offset:18944
  s_waitcnt lgkmcnt(6)
  v_mfma_f32_32x32x16_bf16 v[40:55], v[192:195], a[72:75], v[40:55]
  v_mfma_f32_32x32x16_bf16 v[56:71], v[192:195], a[76:79], v[56:71]
  s_waitcnt lgkmcnt(4)
  v_mfma_f32_32x32x16_bf16 v[72:87], v[196:199], a[72:75], v[72:87]
  v_mfma_f32_32x32x16_bf16 v[88:103], v[196:199], a[76:79], v[88:103]
  s_add_u32 m0, s39, 2048
  s_add_u32 s14, s38, 8192
  buffer_load_dwordx4 v4, s[16:19], s38 offen lds
  s_add_u32 m0, s39, 3072
  s_nop 0
  buffer_load_dwordx4 v4, s[16:19], s14 offen lds
  buffer_load_dwordx4 a[16:19], v3, s[20:23], s37 offen offset:0
  buffer_load_dwordx4 a[20:23], v3, s[20:23], s37 offen offset:1024
  s_add_u32 s38, s38, 16384
  s_add_u32 s37, s37, 2048
  s_waitcnt vmcnt(30)
  ds_read_b64_tr_b16 v[192:193], v5 offset:20480
  ds_read_b64_tr_b16 v[194:195], v5 offset:20992
  ds_read_b64_tr_b16 v[196:197], v6 offset:20480
  ds_read_b64_tr_b16 v[198:199], v6 offset:20992
  s_waitcnt lgkmcnt(6)
  v_mfma_f32_32x32x16_bf16 v[40:55], v[200:203], a[80:83], v[40:55]
  v_mfma_f32_32x32x16_bf16 v[56:71], v[200:203], a[84:87], v[56:71]
  s_waitcnt lgkmcnt(4)
  v_mfma_f32_32x32x16_bf16 v[72:87], v[204:207], a[80:83], v[72:87]
  v_mfma_f32_32x32x16_bf16 v[88:103], v[204:207], a[84:87], v[88:103]
  s_add_u32 m0, s39, 4096
  s_add_u32 s14, s38, 8192
  buffer_load_dwordx4 v4, s[16:19], s38 offen lds
  s_add_u32 m0, s39, 5120
  s_nop 0
  buffer_load_dwordx4 v4, s[16:19], s14 offen lds
  buffer_load_dwordx4 a[24:27], v3, s[20:23], s37 offen offset:0
  buffer_load_dwordx4 a[28:31], v3, s[20:23], s37 offen offset:1024
  s_add_u32 s38, s38, 16384
  s_add_u32 s37, s37, 2048
  s_waitcnt vmcnt(30)
  ds_read_b64_tr_b16 v[200:201], v5 offset:22528
  ds_read_b64_tr_b16 v[202:203], v5 offset:23040
  ds_read_b64_tr_b16 v[204:205], v6 offset:22528
  ds_read_b64_tr_b16 v[206:207], v6 offset:23040
  s_waitcnt lgkmcnt(6)
  v_mfma_f32_32x32x16_bf16 v[40:55], v[192:195], a[88:91], v[40:55]
  v_mfma_f32_32x32x16_bf16 v[56:71], v[192:195], a[92:95], v[56:71]
  s_waitcnt lgkmcnt(4)
  v_mfma_f32_32x32x16_bf16 v[72:87], v[196:199], a[88:91], v[72:87]
  v_mfma_f32_32x32x16_bf16 v[88:103], v[196:199], a[92:95], v[88:103]
  s_add_u32 m0, s39, 6144
  s_add_u32 s14, s38, 8192
  buffer_load_dwordx4 v4, s[16:19], s38 offen lds
  s_add_u32 m0, s39, 7168
  s_nop 0
  buffer_load_dwordx4 v4, s[16:19], s14 offen lds
  buffer_load_dwordx4 a[32:35], v3, s[20:23], s37 offen offset:0
  buffer_load_dwordx4 a[36:39], v3, s[20:23], s37 offen offset:1024
  s_add_u32 s38, s38, 16384
  s_add_u32 s37, s37, 2048
  s_waitcnt vmcnt(30)
  ds_read_b64_tr_b16 v[192:193], v5 offset:24576
  ds_read_b64_tr_b16 v[194:195], v5 offset:25088
  ds_read_b64_tr_b16 v[196:197], v6 offset:24576
  ds_read_b64_tr_b16 v[198:199], v6 offset:25088
  s_waitcnt lgkmcnt(6)
  v_mfma_f32_32x32x16_bf16 v[40:55], v[200:203], a[96:99], v[40:55]
  v_mfma_f32_32x32x16_bf16 v[56:71], v[200:203], a[100:103], v[56:71]
  s_waitcnt lgkmcnt(4)
  v_mfma_f32_32x32x16_bf16 v[72:87], v[204:207], a[96:99], v[72:87]
  v_mfma_f32_32x32x16_bf16 v[88:103], v[204:207], a[100:103], v[88:103]
  s_add_u32 m0, s39, 8192
  s_add_u32 s14, s38, 8192
  buffer_load_dwordx4 v4, s[16:19], s38 offen lds
  s_add_u32 m0, s39, 9216
  s_nop 0
  buffer_load_dwordx4 v4, s[16:19], s14 offen lds
  buffer_load_dwordx4 a[40:43], v3, s[20:23], s37 offen offset:0
  buffer_load_dwordx4 a[44:47], v3, s[20:23], s37 offen offset:1024
  s_add_u32 s38, s38, 16384
  s_add_u32 s37, s37, 2048
  s_waitcnt vmcnt(30)
  ds_read_b64_tr_b16 v[200:201], v5 offset:26624
  ds_read_b64_tr_b16 v[202:203], v5 offset:27136
  ds_read_b64_tr_b16 v[204:205], v6 offset:26624
  ds_read_b64_tr_b16 v[206:207], v6 offset:27136
  s_waitcnt lgkmcnt(6)
  v_mfma_f32_32x32x16_bf16 v[40:55], v[192:195], a[104:107], v[40:55]
  v_mfma_f32_32x32x16_bf16 v[56:71], v[192:195], a[108:111], v[56:71]
  s_waitcnt lgkmcnt(4)
  v_mfma_f32_32x32x16_bf16 v[72:87], v[196:199], a[104:107], v[72:87]
  v_mfma_f32_32x32x16_bf16 v[88:103], v[196:199], a[108:111], v[88:103]
  s_add_u32 m0, s39, 10240
  s_add_u32 s14, s38, 8192
  buffer_load_dwordx4 v4, s[16:19], s38 offen lds
  s_add_u32 m0, s39, 11264
  s_nop 0
  buffer_load_dwordx4 v4, s[16:19], s14 offen lds
  buffer_load_dwordx4 a[48:51], v3, s[20:23], s37 offen offset:0
  buffer_load_dwordx4 a[52:55], v3, s[20:23], s37 offen offset:1024
  s_add_u32 s38, s38, 16384
  s_add_u32 s37, s37, 2048
  s_waitcnt vmcnt(30)
  ds_read_b64_tr_b16 v[192:193], v5 offset:28672
  ds_read_b64_tr_b16 v[194:195], v5 offset:29184
  ds_read_b64_tr_b16 v[196:197], v6 offset:28672
  ds_read_b64_tr_b16 v[198:199], v6 offset:29184
  s_waitcnt lgkmcnt(6)
  v_mfma_f32_32x32x16_bf16 v[40:55], v[200:203], a[112:115], v[40:55]
  v_mfma_f32_32x32x16_bf16 v[56:71], v[200:203], a[116:119], v[56:71]
  s_waitcnt lgkmcnt(4)
  v_mfma_f32_32x32x16_bf16 v[72:87], v[204:207], a[112:115], v[72:87]
  v_mfma_f32_32x32x16_bf16 v[88:103], v[204:207], a[116:119], v[88:103]
  s_add_u32 m0, s39, 12288
  s_add_u32 s14, s38, 8192
  buffer_load_dwordx4 v4, s[16:19], s38 offen lds
  s_add_u32 m0, s39, 13312
  s_nop 0
  buffer_load_dwordx4 v4, s[16:19], s14 offen lds
  buffer_load_dwordx4 a[56:59], v3, s[20:23], s37 offen offset:0
  buffer_load_dwordx4 a[60:63], v3, s[20:23], s37 offen offset:1024
  s_add_u32 s38, s38, 16384
  s_add_u32 s37, s37, 2048
  s_waitcnt vmcnt(30)
  ds_read_b64_tr_b16 v[200:201], v5 offset:30720
  ds_read_b64_tr_b16 v[202:203], v5 offset:31232
  ds_read_b64_tr_b16 v[204:205], v6 offset:30720
  ds_read_b64_tr_b16 v[206:207], v6 offset:31232
  s_waitcnt lgkmcnt(6)
  v_mfma_f32_32x32x16_bf16 v[40:55], v[192:195], a[120:123], v[40:55]
  v_mfma_f32_32x32x16_bf16 v[56:71], v[192:195], a[124:127], v[56:71]
  s_waitcnt lgkmcnt(4)
  v_mfma_f32_32x32x16_bf16 v[72:87], v[196:199], a[120:123], v[72:87]
  v_mfma_f32_32x32x16_bf16 v[88:103], v[196:199], a[124:127], v[88:103]
  s_add_u32 m0, s39, 14336
  s_add_u32 s14, s38, 8192
  buffer_load_dwordx4 v4, s[16:19], s38 offen lds
  s_add_u32 m0, s39, 15360
  s_nop 0
  buffer_load_dwordx4 v4, s[16:19], s14 offen lds
  buffer_load_dwordx4 a[64:67], v3, s[20:23], s37 offen offset:0
  buffer_load_dwordx4 a[68:71], v3, s[20:23], s37 offen offset:1024
  s_add_u32 s38, s38, 16384
  s_add_u32 s37, s37, 2048
  s_waitcnt vmcnt(30)
  ds_read_b64_tr_b16 v[192:193], v5 offset:0
  ds_read_b64_tr_b16 v[194:195], v5 offset:512
  ds_read_b64_tr_b16 v[196:197], v6 offset:0
  ds_read_b64_tr_b16 v[198:199], v6 offset:512
  s_waitcnt lgkmcnt(6)
  v_mfma_f32_32x32x16_bf16 v[40:55], v[200:203], a[128:131], v[40:55]
  v_mfma_f32_32x32x16_bf16 v[56:71], v[200:203], a[132:135], v[56:71]
  s_waitcnt lgkmcnt(4)
  v_mfma_f32_32x32x16_bf16 v[72:87], v[204:207], a[128:131], v[72:87]
  v_mfma_f32_32x32x16_bf16 v[88:103], v[204:207], a[132:135], v[88:103]
  s_add_u32 s42, s42, 8
  s_cmp_eq_u32 s42, 64
  s_cselect_b32 s13, 1048576, 0
  s_cselect_b32 s14, 131072, 0
  s_sub_u32 s38, s38, s13
  s_sub_u32 s37, s37, s14
  s_add_u32 m0, s39, 16384
  s_add_u32 s14, s38, 8192
  buffer_load_dwordx4 v4, s[16:19], s38 offen lds
  s_add_u32 m0, s39, 17408
  s_nop 0
  buffer_load_dwordx4 v4, s[16:19], s14 offen lds
  buffer_load_dwordx4 a[72:75], v3, s[20:23], s37 offen offset:0
  buffer_load_dwordx4 a[76:79], v3, s[20:23], s37 offen offset:1024
  s_add_u32 s38, s38, 16384
  s_add_u32 s37, s37, 2048
  s_waitcnt vmcnt(30)
  ds_read_b64_tr_b16 v[200:201], v5 offset:2048
  ds_read_b64_tr_b16 v[202:203], v5 offset:2560
  ds_read_b64_tr_b16 v[204:205], v6 offset:2048
  ds_read_b64_tr_b16 v[206:207], v6 offset:2560
  s_waitcnt lgkmcnt(6)
  v_mfma_f32_32x32x16_bf16 v[40:55], v[192:195], a[8:11], v[40:55]
  v_mfma_f32_32x32x16_bf16 v[56:71], v[192:195], a[12:15], v[56:71]
  s_waitcnt lgkmcnt(4)
  v_mfma_f32_32x32x16_bf16 v[72:87], v[196:199], a[8:11], v[72:87]
  v_mfma_f32_32x32x16_bf16 v[88:103], v[196:199], a[12:15], v[88:103]
  s_add_u32 m0, s39, 18432
  s_add_u32 s14, s38, 8192
  buffer_load_dwordx4 v4, s[16:19], s38 offen lds
  s_add_u32 m0, s39, 19456
  s_nop 0
  buffer_load_dwordx4 v4, s[16:19], s14 offen lds
  buffer_load_dwordx4 a[80:83], v3, s[20:23], s37 offen offset:0
  buffer_load_dwordx4 a[84:87], v3, s[20:23], s37 offen offset:1024
  s_add_u32 s38, s38, 16384
  s_add_u32 s37, s37, 2048
  s_waitcnt vmcnt(30)
  ds_read_b64_tr_b16 v[192:193], v5 offset:4096
  ds_read_b64_tr_b16 v[194:195], v5 offset:4608
  ds_read_b64_tr_b16 v[196:197], v6 offset:4096
  ds_read_b64_tr_b16 v[198:199], v6 offset:4608
  s_waitcnt lgkmcnt(6)
  v_mfma_f32_32x32x16_bf16 v[40:55], v[200:203], a[16:19], v[40:55]
  v_mfma_f32_32x32x16_bf16 v[56:71], v[200:203], a[20:23], v[56:71]
  s_waitcnt lgkmcnt(4)
  v_mfma_f32_32x32x16_bf16 v[72:87], v[204:207], a[16:19], v[72:87]
  v_mfma_f32_32x32x16_bf16 v[88:103], v[204:207], a[20:23], v[88:103]
  s_add_u32 m0, s39, 20480
  s_add_u32 s14, s38, 8192
  buffer_load_dwordx4 v4, s[16:19], s38 offen lds
  s_add_u32 m0, s39, 21504
  s_nop 0
  buffer_load_dwordx4 v4, s[16:19], s14 offen lds
  buffer_load_dwordx4 a[88:91], v3, s[20:23], s37 offen offset:0
  buffer_load_dwordx4 a[92:95], v3, s[20:23], s37 offen offset:1024
  s_add_u32 s38, s38, 16384
  s_add_u32 s37, s37, 2048
  s_waitcnt vmcnt(30)
  ds_read_b64_tr_b16 v[200:201], v5 offset:6144
  ds_read_b64_tr_b16 v[202:203], v5 offset:6656
  ds_read_b64_tr_b16 v[204:205], v6 offset:6144
  ds_read_b64_tr_b16 v[206:207], v6 offset:6656
  s_waitcnt lgkmcnt(6)
  v_mfma_f32_32x32x16_bf16 v[40:55], v[192:195], a[24:27], v[40:55]
  v_mfma_f32_32x32x16_bf16 v[56:71], v[192:195], a[28:31], v[56:71]
  s_waitcnt lgkmcnt(4)
  v_mfma_f32_32x32x16_bf16 v[72:87], v[196:199], a[24:27], v[72:87]
  v_mfma_f32_32x32x16_bf16 v[88:103], v[196:199], a[28:31], v[88:103]
  s_add_u32 m0, s39, 22528
  s_add_u32 s14, s38, 8192
  buffer_load_dwordx4 v4, s[16:19], s38 offen lds
  s_add_u32 m0, s39, 23552
  s_nop 0
  buffer_load_dwordx4 v4, s[16:19], s14 offen lds
  buffer_load_dwordx4 a[96:99], v3, s[20:23], s37 offen offset:0
  buffer_load_dwordx4 a[100:103], v3, s[20:23], s37 offen offset:1024
  s_add_u32 s38, s38, 16384
  s_add_u32 s37, s37, 2048
  s_waitcnt vmcnt(30)
  ds_read_b64_tr_b16 v[192:193], v5 offset:8192
  ds_read_b64_tr_b16 v[194:195], v5 offset:8704
  ds_read_b64_tr_b16 v[196:197], v6 offset:8192
  ds_read_b64_tr_b16 v[198:199], v6 offset:8704
  s_waitcnt lgkmcnt(6)
  v_mfma_f32_32x32x16_bf16 v[40:55], v[200:203], a[32:35], v[40:55]
  v_mfma_f32_32x32x16_bf16 v[56:71], v[200:203], a[36:39], v[56:71]
  s_waitcnt lgkmcnt(4)
  v_mfma_f32_32x32x16_bf16 v[72:87], v[204:207], a[32:35], v[72:87]
  v_mfma_f32_32x32x16_bf16 v[88:103], v[204:207], a[36:39], v[88:103]
  s_add_u32 m0, s39, 24576
  s_add_u32 s14, s38, 8192
  buffer_load_dwordx4 v4, s[16:19], s38 offen lds
  s_add_u32 m0, s39, 25600
  s_nop 0
  buffer_load_dwordx4 v4, s[16:19], s14 offen lds
  buffer_load_dwordx4 a[104:107], v3, s[20:23], s37 offen offset:0
  buffer_load_dwordx4 a[108:111], v3, s[20:23], s37 offen offset:1024
  s_add_u32 s38, s38, 16384
  s_add_u32 s37, s37, 2048
  s_waitcnt vmcnt(30)
  ds_read_b64_tr_b16 v[200:201], v5 offset:10240
  ds_read_b64_tr_b16 v[202:203], v5 offset:10752
  ds_read_b64_tr_b16 v[204:205], v6 offset:10240
  ds_read_b64_tr_b16 v[206:207], v6 offset:10752
  s_waitcnt lgkmcnt(6)
  v_mfma_f32_32x32x16_bf16 v[40:55], v[192:195], a[40:43], v[40:55]
  v_mfma_f32_32x32x16_bf16 v[56:71], v[192:195], a[44:47], v[56:71]
  s_waitcnt lgkmcnt(4)
  v_mfma_f32_32x32x16_bf16 v[72:87], v[196:199], a[40:43], v[72:87]
  v_mfma_f32_32x32x16_bf16 v[88:103], v[196:199], a[44:47], v[88:103]
  s_add_u32 m0, s39, 26624
  s_add_u32 s14, s38, 8192
  buffer_load_dwordx4 v4, s[16:19], s38 offen lds
  s_add_u32 m0, s39, 27648
  s_nop 0
  buffer_load_dwordx4 v4, s[16:19], s14 offen lds
  buffer_load_dwordx4 a[112:115], v3, s[20:23], s37 offen offset:0
  buffer_load_dwordx4 a[116:119], v3, s[20:23], s37 offen offset:1024
  s_add_u32 s38, s38, 16384
  s_add_u32 s37, s37, 2048
  s_waitcnt vmcnt(30)
  ds_read_b64_tr_b16 v[192:193], v5 offset:12288
  ds_read_b64_tr_b16 v[194:195], v5 offset:12800
  ds_read_b64_tr_b16 v[196:197], v6 offset:12288
  ds_read_b64_tr_b16 v[198:199], v6 offset:12800
  s_waitcnt lgkmcnt(6)
  v_mfma_f32_32x32x16_bf16 v[40:55], v[200:203], a[48:51], v[40:55]
  v_mfma_f32_32x32x16_bf16 v[56:71], v[200:203], a[52:55], v[56:71]
  s_waitcnt lgkmcnt(4)
  v_mfma_f32_32x32x16_bf16 v[72:87], v[204:207], a[48:51], v[72:87]
  v_mfma_f32_32x32x16_bf16 v[88:103], v[204:207], a[52:55], v[88:103]
  s_add_u32 m0, s39, 28672
  s_add_u32 s14, s38, 8192
  buffer_load_dwordx4 v4, s[16:19], s38 offen lds
  s_add_u32 m0, s39, 29696
  s_nop 0
  buffer_load_dwordx4 v4, s[16:19], s14 offen lds
  buffer_load_dwordx4 a[120:123], v3, s[20:23], s37 offen offset:0
  buffer_load_dwordx4 a[124:127], v3, s[20:23], s37 offen offset:1024
  s_add_u32 s38, s38, 16384
  s_add_u32 s37, s37, 2048
  s_waitcnt vmcnt(30)
  ds_read_b64_tr_b16 v[200:201], v5 offset:14336
  ds_read_b64_tr_b16 v[202:203], v5 offset:14848
  ds_read_b64_tr_b16 v[204:205], v6 offset:14336
  ds_read_b64_tr_b16 v[206:207], v6 offset:14848
  s_waitcnt lgkmcnt(6)
  v_mfma_f32_32x32x16_bf16 v[40:55], v[192:195], a[56:59], v[40:55]
  v_mfma_f32_32x32x16_bf16 v[56:71], v[192:195], a[60:63], v[56:71]
  s_waitcnt lgkmcnt(4)
  v_mfma_f32_32x32x16_bf16 v[72:87], v[196:199], a[56:59], v[72:87]
  v_mfma_f32_32x32x16_bf16 v[88:103], v[196:199], a[60:63], v[88:103]
  s_add_u32 m0, s39, 30720
  s_add_u32 s14, s38, 8192
  buffer_load_dwordx4 v4, s[16:19], s38 offen lds
  s_add_u32 m0, s39, 31744
  s_nop 0
  buffer_load_dwordx4 v4, s[16:19], s14 offen lds
  buffer_load_dwordx4 a[128:131], v3, s[20:23], s37 offen offset:0
  buffer_load_dwordx4 a[132:135], v3, s[20:23], s37 offen offset:1024
  s_add_u32 s38, s38, 16384
  s_add_u32 s37, s37, 2048
  s_waitcnt vmcnt(30)
  ds_read_b64_tr_b16 v[192:193], v5 offset:16384
  ds_read_b64_tr_b16 v[194:195], v5 offset:16896
  ds_read_b64_tr_b16 v[196:197], v6 offset:16384
  ds_read_b64_tr_b16 v[198:199], v6 offset:16896
  s_waitcnt lgkmcnt(6)
  v_mfma_f32_32x32x16_bf16 v[40:55], v[200:203], a[64:67], v[40:55]
  v_mfma_f32_32x32x16_bf16 v[56:71], v[200:203], a[68:71], v[56:71]
  s_waitcnt lgkmcnt(4)
  v_mfma_f32_32x32x16_bf16 v[72:87], v[204:207], a[64:67], v[72:87]
  v_mfma_f32_32x32x16_bf16 v[88:103], v[204:207], a[68:71], v[88:103]
  s_waitcnt vmcnt(26)
  ds_read_b64_tr_b16 v[200:201], v5 offset:18432
  ds_read_b64_tr_b16 v[202:203], v5 offset:18944
  ds_read_b64_tr_b16 v[204:205], v6 offset:18432
  ds_read_b64_tr_b16 v[206:207], v6 offset:18944
  s_waitcnt lgkmcnt(6)
  v_mfma_f32_32x32x16_bf16 v[40:55], v[192:195], a[72:75], v[40:55]
  v_mfma_f32_32x32x16_bf16 v[56:71], v[192:195], a[76:79], v[56:71]
  s_waitcnt lgkmcnt(4)
  v_mfma_f32_32x32x16_bf16 v[72:87], v[196:199], a[72:75], v[72:87]
  v_mfma_f32_32x32x16_bf16 v[88:103], v[196:199], a[76:79], v[88:103]
  s_waitcnt vmcnt(22)
  ds_read_b64_tr_b16 v[192:193], v5 offset:20480
  ds_read_b64_tr_b16 v[194:195], v5 offset:20992
  ds_read_b64_tr_b16 v[196:197], v6 offset:20480
  ds_read_b64_tr_b16 v[198:199], v6 offset:20992
  s_waitcnt lgkmcnt(6)
  v_mfma_f32_32x32x16_bf16 v[40:55], v[200:203], a[80:83], v[40:55]
  v_mfma_f32_32x32x16_bf16 v[56:71], v[200:203], a[84:87], v[56:71]
  s_waitcnt lgkmcnt(4)
  v_mfma_f32_32x32x16_bf16 v[72:87], v[204:207], a[80:83], v[72:87]
  v_mfma_f32_32x32x16_bf16 v[88:103], v[204:207], a[84:87], v[88:103]
  s_waitcnt vmcnt(18)
  ds_read_b64_tr_b16 v[200:201], v5 offset:22528
  ds_read_b64_tr_b16 v[202:203], v5 offset:23040
  ds_read_b64_tr_b16 v[204:205], v6 offset:22528
  ds_read_b64_tr_b16 v[206:207], v6 offset:23040
  s_waitcnt lgkmcnt(6)
  v_mfma_f32_32x32x16_bf16 v[40:55], v[192:195], a[88:91], v[40:55]
  v_mfma_f32_32x32x16_bf16 v[56:71], v[192:195], a[92:95], v[56:71]
  s_waitcnt lgkmcnt(4)
  v_mfma_f32_32x32x16_bf16 v[72:87], v[196:199], a[88:91], v[72:87]
  v_mfma_f32_32x32x16_bf16 v[88:103], v[196:199], a[92:95], v[88:103]
  s_waitcnt vmcnt(14)
  ds_read_b64_tr_b16 v[192:193], v5 offset:24576
  ds_read_b64_tr_b16 v[194:195], v5 offset:25088
  ds_read_b64_tr_b16 v[196:197], v6 offset:24576
  ds_read_b64_tr_b16 v[198:199], v6 offset:25088
  s_waitcnt lgkmcnt(6)
  v_mfma_f32_32x32x16_bf16 v[40:55], v[200:203], a[96:99], v[40:55]
  v_mfma_f32_32x32x16_bf16 v[56:71], v[200:203], a[100:103], v[56:71]
  s_waitcnt lgkmcnt(4)
  v_mfma_f32_32x32x16_bf16 v[72:87], v[204:207], a[96:99], v[72:87]
  v_mfma_f32_32x32x16_bf16 v[88:103], v[204:207], a[100:103], v[88:103]
  s_waitcnt vmcnt(10)
  ds_read_b64_tr_b16 v[200:201], v5 offset:26624
  ds_read_b64_tr_b16 v[202:203], v5 offset:27136
  ds_read_b64_tr_b16 v[204:205], v6 offset:26624
  ds_read_b64_tr_b16 v[206:207], v6 offset:27136
  s_waitcnt lgkmcnt(6)
  v_mfma_f32_32x32x16_bf16 v[40:55], v[192:195], a[104:107], v[40:55]
  v_mfma_f32_32x32x16_bf16 v[56:71], v[192:195], a[108:111], v[56:71]
  s_waitcnt lgkmcnt(4)
  v_mfma_f32_32x32x16_bf16 v[72:87], v[196:199], a[104:107], v[72:87]
  v_mfma_f32_32x32x16_bf16 v[88:103], v[196:199], a[108:111], v[88:103]
  s_waitcnt vmcnt(6)
  ds_read_b64_tr_b16 v[192:193], v5 offset:28672
  ds_read_b64_tr_b16 v[194:195], v5 offset:29184
  ds_read_b64_tr_b16 v[196:197], v6 offset:28672
  ds_read_b64_tr_b16 v[198:199], v6 offset:29184
  s_waitcnt lgkmcnt(6)
  v_mfma_f32_32x32x16_bf16 v[40:55], v[200:203], a[112:115], v[40:55]
  v_mfma_f32_32x32x16_bf16 v[56:71], v[200:203], a[116:119], v[56:71]
  s_waitcnt lgkmcnt(4)
  v_mfma_f32_32x32x16_bf16 v[72:87], v[204:207], a[112:115], v[72:87]
  v_mfma_f32_32x32x16_bf16 v[88:103], v[204:207], a[116:119], v[88:103]
  s_waitcnt vmcnt(2)
  ds_read_b64_tr_b16 v[200:201], v5 offset:30720
  ds_read_b64_tr_b16 v[202:203], v5 offset:31232
  ds_read_b64_tr_b16 v[204:205], v6 offset:30720
  ds_read_b64_tr_b16 v[206:207], v6 offset:31232
  s_waitcnt lgkmcnt(6)
  v_mfma_f32_32x32x16_bf16 v[40:55], v[192:195], a[120:123], v[40:55]
  v_mfma_f32_32x32x16_bf16 v[56:71], v[192:195], a[124:127], v[56:71]
  s_waitcnt lgkmcnt(4)
  v_mfma_f32_32x32x16_bf16 v[72:87], v[196:199], a[120:123], v[72:87]
  v_mfma_f32_32x32x16_bf16 v[88:103], v[196:199], a[124:127], v[88:103]
  s_waitcnt vmcnt(1) lgkmcnt(2)
  v_mfma_f32_32x32x16_bf16 v[40:55], v[200:203], a[128:131], v[40:55]
  s_waitcnt vmcnt(0)
  v_mfma_f32_32x32x16_bf16 v[56:71], v[200:203], a[132:135], v[56:71]
  s_waitcnt lgkmcnt(0)
  v_mfma_f32_32x32x16_bf16 v[72:87], v[204:207], a[128:131], v[72:87]
  v_mfma_f32_32x32x16_bf16 v[88:103], v[204:207], a[132:135], v[88:103]
  v_add_u32 v208, s39, v3
  s_waitcnt vmcnt(0)
  s_nop 4
  ds_write_b128 v208, v[40:43] offset:0
  ds_write_b128 v208, v[44:47] offset:1024
  ds_write_b128 v208, v[48:51] offset:2048
  ds_write_b128 v208, v[52:55] offset:3072
  ds_write_b128 v208, v[56:59] offset:4096
  ds_write_b128 v208, v[60:63] offset:5120
  ds_write_b128 v208, v[64:67] offset:6144
  ds_write_b128 v208, v[68:71] offset:7168
  ds_write_b128 v208, v[72:75] offset:8192
  ds_write_b128 v208, v[76:79] offset:9216
  ds_write_b128 v208, v[80:83] offset:10240
  ds_write_b128 v208, v[84:87] offset:11264
  ds_write_b128 v208, v[88:91] offset:12288
  ds_write_b128 v208, v[92:95] offset:13312
  ds_write_b128 v208, v[96:99] offset:14336
  ds_write_b128 v208, v[100:103] offset:15360
  s_waitcnt lgkmcnt(0)
  s_barrier
  s_cmp_lg_u32 s10, 3
  s_cbranch_scc1 k3_cs2
  v_lshlrev_b32 v176, 2, v1
  v_lshrrev_b32 v177, 5, v1
  v_lshlrev_b32 v177, 9, v177
  v_and_b32 v168, 127, v176
  v_add_u32 v177, v168, v177
  v_add_u32 v176, 131072, v176
  ds_read_b32 v168, v176 offset:0
  ds_read_b32 v169, v176 offset:512
  ds_read_b32 v170, v176 offset:1024
  ds_read_b32 v171, v176 offset:1536
  ds_read_b32 v172, v176 offset:256
  ds_read_b32 v173, v176 offset:768
  ds_read_b32 v174, v176 offset:1280
  ds_read_b32 v175, v176 offset:1792
  s_waitcnt lgkmcnt(6)
  v_add_f32 v168, v168, v169
  s_waitcnt lgkmcnt(4)
  v_add_f32 v170, v170, v171
  v_add_f32 v168, v168, v170
  buffer_store_dword v168, v177, s[60:63], s70 offen offset:0
  s_waitcnt lgkmcnt(2)
  v_add_f32 v172, v172, v173
  s_waitcnt lgkmcnt(0)
  v_add_f32 v174, v174, v175
  v_add_f32 v172, v172, v174
  buffer_store_dword v172, v177, s[60:63], s70 offen offset:128
k3_cs2:
  s_lshl_b32 s13, s10, 12
  v_add_u32 v8, s13, v3
  v_add_u32 v7, 0x10000, v8
  ds_read_b128 v[104:107], v8 offset:0
  ds_read_b128 v[108:111], v8 offset:1024
  ds_read_b128 v[112:115], v8 offset:2048
  ds_read_b128 v[116:119], v8 offset:3072
  ds_read_b128 v[120:123], v8 offset:32768
  ds_read_b128 v[124:127], v8 offset:33792
  ds_read_b128 v[128:131], v8 offset:34816
  ds_read_b128 v[132:135], v8 offset:35840
  ds_read_b128 v[136:139], v7 offset:0
  ds_read_b128 v[140:143], v7 offset:1024
  ds_read_b128 v[144:147], v7 offset:2048
  ds_read_b128 v[148:151], v7 offset:3072
  ds_read_b128 v[152:155], v7 offset:32768
  ds_read_b128 v[156:159], v7 offset:33792
  ds_read_b128 v[160:163], v7 offset:34816
  ds_read_b128 v[164:167], v7 offset:35840
  s_waitcnt lgkmcnt(11)
  v_add_f32 v104, v104, v120
  s_waitcnt lgkmcnt(3)
  v_add_f32 v136, v136, v152
  v_add_f32 v105, v105, v121
  v_add_f32 v137, v137, v153
  v_add_f32 v106, v106, v122
  v_add_f32 v138, v138, v154
  v_add_f32 v107, v107, v123
  v_add_f32 v139, v139, v155
  v_add_f32 v108, v108, v124
  s_waitcnt lgkmcnt(2)
  v_add_f32 v140, v140, v156
  v_add_f32 v109, v109, v125
  v_add_f32 v141, v141, v157
  v_add_f32 v110, v110, v126
  v_add_f32 v142, v142, v158
  v_add_f32 v111, v111, v127
  v_add_f32 v143, v143, v159
  v_add_f32 v112, v112, v128
  s_waitcnt lgkmcnt(1)
  v_add_f32 v144, v144, v160
  v_add_f32 v113, v113, v129
  v_add_f32 v145, v145, v161
  v_add_f32 v114, v114, v130
  v_add_f32 v146, v146, v162
  v_add_f32 v115, v115, v131
  v_add_f32 v147, v147, v163
  v_add_f32 v116, v116, v132
  s_waitcnt lgkmcnt(0)
  v_add_f32 v148, v148, v164
  v_add_f32 v117, v117, v133
  v_add_f32 v149, v149, v165
  v_add_f32 v118, v118, v134
  v_add_f32 v150, v150, v166
  v_add_f32 v119, v119, v135
  v_add_f32 v151, v151, v167
  v_add_f32 v104, v104, v136
  v_add_f32 v105, v105, v137
  v_add_f32 v106, v106, v138
  v_add_f32 v107, v107, v139
  v_add_f32 v108, v108, v140
  v_add_f32 v109, v109, v141
  v_add_f32 v110, v110, v142
  v_add_f32 v111, v111, v143
  v_add_f32 v112, v112, v144
  v_add_f32 v113, v113, v145
  v_add_f32 v114, v114, v146
  v_add_f32 v115, v115, v147
  v_add_f32 v116, v116, v148
  v_add_f32 v117, v117, v149
  v_add_f32 v118, v118, v150
  v_add_f32 v119, v119, v151
  v_lshlrev_b32 v120, 16, v16
  v_and_b32 v121, 0xffff0000, v16
  v_lshlrev_b32 v122, 16, v17
  v_and_b32 v123, 0xffff0000, v17
  v_lshlrev_b32 v124, 16, v18
  v_and_b32 v125, 0xffff0000, v18
  v_lshlrev_b32 v126, 16, v19
  v_and_b32 v127, 0xffff0000, v19
  v_lshlrev_b32 v128, 16, v20
  v_and_b32 v129, 0xffff0000, v20
  v_lshlrev_b32 v130, 16, v21
  v_and_b32 v131, 0xffff0000, v21
  v_lshlrev_b32 v132, 16, v22
  v_and_b32 v133, 0xffff0000, v22
  v_lshlrev_b32 v134, 16, v23
  v_and_b32 v135, 0xffff0000, v23
  v_fma_f32 v104, v24, v104, v120
  v_fma_f32 v105, v25, v105, v121
  v_fma_f32 v106, v26, v106, v122
  v_fma_f32 v107, v27, v107, v123
  v_fma_f32 v108, v28, v108, v124
  v_fma_f32 v109, v29, v109, v125
  v_fma_f32 v110, v30, v110, v126
  v_fma_f32 v111, v31, v111, v127
  v_fma_f32 v112, v32, v112, v128
  v_fma_f32 v113, v33, v113, v129
  v_fma_f32 v114, v34, v114, v130
  v_fma_f32 v115, v35, v115, v131
  v_fma_f32 v116, v36, v116, v132
  v_fma_f32 v117, v37, v117, v133
  v_fma_f32 v118, v38, v118, v134
  v_fma_f32 v119, v39, v119, v135
  v_cvt_pk_bf16_f32 v16, v104, v105
  v_cvt_pk_bf16_f32 v17, v106, v107
  v_cvt_pk_bf16_f32 v18, v108, v109
  v_cvt_pk_bf16_f32 v19, v110, v111
  v_cvt_pk_bf16_f32 v20, v112, v113
  v_cvt_pk_bf16_f32 v21, v114, v115
  v_cvt_pk_bf16_f32 v22, v116, v117
  v_cvt_pk_bf16_f32 v23, v118, v119
  buffer_store_dwordx4 v[16:19], v12, s[28:31], 0 offen
  buffer_store_dwordx4 v[20:23], v12, s[28:31], 0 offen offset:1024
  v_lshlrev_b32 v120, 16, v16
  v_and_b32 v121, 0xffff0000, v16
  v_lshlrev_b32 v122, 16, v17
  v_and_b32 v123, 0xffff0000, v17
  v_lshlrev_b32 v124, 16, v18
  v_and_b32 v125, 0xffff0000, v18
  v_lshlrev_b32 v126, 16, v19
  v_and_b32 v127, 0xffff0000, v19
  v_lshlrev_b32 v128, 16, v20
  v_and_b32 v129, 0xffff0000, v20
  v_lshlrev_b32 v130, 16, v21
  v_and_b32 v131, 0xffff0000, v21
  v_lshlrev_b32 v132, 16, v22
  v_and_b32 v133, 0xffff0000, v22
  v_lshlrev_b32 v134, 16, v23
  v_and_b32 v135, 0xffff0000, v23
  v_add_f32 v136, v120, v121
  v_mul_f32 v137, v120, v120
  v_fmac_f32 v137, v121, v121
  v_add_f32 v136, v136, v122
  v_fmac_f32 v137, v122, v122
  v_add_f32 v136, v136, v123
  v_fmac_f32 v137, v123, v123
  v_add_f32 v136, v136, v124
  v_fmac_f32 v137, v124, v124
  v_add_f32 v136, v136, v125
  v_fmac_f32 v137, v125, v125
  v_add_f32 v136, v136, v126
  v_fmac_f32 v137, v126, v126
  v_add_f32 v136, v136, v127
  v_fmac_f32 v137, v127, v127
  v_add_f32 v136, v136, v128
  v_fmac_f32 v137, v128, v128
  v_add_f32 v136, v136, v129
  v_fmac_f32 v137, v129, v129
  v_add_f32 v136, v136, v130
  v_fmac_f32 v137, v130, v130
  v_add_f32 v136, v136, v131
  v_fmac_f32 v137, v131, v131
  v_add_f32 v136, v136, v132
  v_fmac_f32 v137, v132, v132
  v_add_f32 v136, v136, v133
  v_fmac_f32 v137, v133, v133
  v_add_f32 v136, v136, v134
  v_fmac_f32 v137, v134, v134
  v_add_f32 v136, v136, v135
  v_fmac_f32 v137, v135, v135
  v_mov_b32 v138, v136
  v_mov_b32 v139, v137
  s_nop 0
  v_permlane32_swap_b32 v136, v138
  v_permlane32_swap_b32 v137, v139
  v_add_f32 v136, v136, v138
  v_add_f32 v137, v137, v139
  s_add_u32 s76, s6, 131072
  s_addc_u32 s77, s7, 0
  s_mov_b32 s78, 262144
  s_mov_b32 s79, 0x20000
  s_lshl_b32 s13, s45, 9
  s_lshl_b32 s14, s46, 3
  s_add_u32 s13, s13, s14
  v_lshlrev_b32 v5, 3, v10
  v_cmp_gt_u32 vcc, 32, v1
  s_nop 0
  s_and_saveexec_b64 s[90:91], vcc
  buffer_store_dwordx2 v[136:137], v5, s[76:79], s13 offen
  s_endpgm
.text
.globl k4_kernel
.p2align 8
.type k4_kernel,@function
k4_kernel:
  s_cmp_lt_u32 s2, 256
  s_cbranch_scc1 k4_go1
  s_endpgm
k4_go1:
  s_load_dwordx2 s[4:5], s[0:1], 104
  s_load_dwordx2 s[8:9], s[0:1], 64
  v_and_b32 v1, 63, v0
  v_lshrrev_b32 v2, 6, v0
  s_nop 0
  v_readfirstlane_b32 s12, v2
  s_and_b32 s15, s2, 7
  s_lshr_b32 s16, s2, 3
  s_and_b32 s13, s15, 1
  s_lshl_b32 s13, s13, 3
  s_and_b32 s14, s16, 7
  s_add_u32 s13, s13, s14
  s_lshr_b32 s14, s15, 1
  s_lshr_b32 s16, s16, 3
  s_lshl_b32 s16, s16, 2
  s_add_u32 s14, s14, s16
  s_mul_i32 s17, s14, 3
  s_lshl_b32 s15, s14, 1
  s_add_u32 s15, s15, 11
  s_cmp_lt_u32 s14, 11
  s_cselect_b32 s17, s17, s15
  s_cselect_b32 s18, 1, 0
  s_waitcnt lgkmcnt(0)
  s_add_u32 s20, s4, 5242880
  s_addc_u32 s21, s5, 0
  s_mov_b32 s22, 2818048
  s_mov_b32 s23, 0x20000
  s_add_u32 s24, s4, 5242880
  s_addc_u32 s25, s5, 0
  s_mov_b32 s26, 2818048
  s_mov_b32 s27, 0x20000
  s_mul_i32 s26, s18, 2818048
  s_add_u32 s28, s4, 3145728
  s_addc_u32 s29, s5, 0
  s_mov_b32 s30, 2097152
  s_mov_b32 s31, 0x20000
  s_add_u32 s32, s4, 131072
  s_addc_u32 s33, s5, 0
  s_mov_b32 s34, 262144
  s_mov_b32 s35, 0x20000
  s_add_u32 s36, s4, 524288
  s_addc_u32 s37, s5, 0
  s_mov_b32 s38, 90112
  s_mov_b32 s39, 0x20000
  s_add_u32 s40, s4, 8388608
  s_addc_u32 s41, s5, 0
  s_mov_b32 s42, 5636096
  s_mov_b32 s43, 0x20000
  s_mov_b32 s10, 1409024
  s_mov_b32 s11, 0x00020000
  s_lshr_b32 s44, s2, 3
  s_lshl_b32 s44, s44, 2
  s_add_u32 s44, s44, s12
  s_mul_i32 s44, s44, 11264
  s_and_b32 s15, s2, 1
  s_lshl_b32 s15, s15, 9
  s_add_u32 s44, s44, s15
  v_lshrrev_b32 v3, 2, v1
  v_min_u32 v3, 10, v3
  v_lshlrev_b32 v3, 10, v3
  v_and_b32 v2, 3, v1
  v_lshl_add_u32 v3, v2, 7, v3
  v_lshlrev_b32 v5, 4, v1
  s_lshl_b32 s45, s17, 16
  s_lshl_b32 s46, s12, 13
  s_add_u32 s45, s45, s46
  s_lshl_b32 s48, s13, 2
  s_add_u32 s48, s48, s12
  s_lshl_b32 s47, s48, 15
  s_lshl_b32 s49, s17, 9
  s_lshl_b32 s51, s12, 11
  s_lshl_b32 s50, s17, 16
  s_add_u32 s50, s50, s51
  s_add_u32 m0, s51, 0
  s_add_u32 s16, s50, 0
  buffer_load_dwordx4 v5, s[20:23], s16 offen lds
  buffer_load_dwordx4 v5, s[20:23], s16 offen offset:1024 lds
  s_add_u32 s52, s47, 0
  buffer_load_dwordx4 a[0:3], v5, s[28:31], s52 offen offset:0
  buffer_load_dwordx4 a[4:7], v5, s[28:31], s52 offen offset:1024
  buffer_load_dwordx4 a[8:11], v5, s[28:31], s52 offen offset:2048
  buffer_load_dwordx4 a[12:15], v5, s[28:31], s52 offen offset:3072
  s_add_u32 m0, s51, 8192
  s_add_u32 s16, s50, 8192
  buffer_load_dwordx4 v5, s[20:23], s16 offen lds
  buffer_load_dwordx4 v5, s[20:23], s16 offen offset:1024 lds
  s_add_u32 s52, s47, 4096
  buffer_load_dwordx4 a[16:19], v5, s[28:31], s52 offen offset:0
  buffer_load_dwordx4 a[20:23], v5, s[28:31], s52 offen offset:1024
  buffer_load_dwordx4 a[24:27], v5, s[28:31], s52 offen offset:2048
  buffer_load_dwordx4 a[28:31], v5, s[28:31], s52 offen offset:3072
  s_add_u32 m0, s51, 16384
  s_add_u32 s16, s50, 16384
  buffer_load_dwordx4 v5, s[20:23], s16 offen lds
  buffer_load_dwordx4 v5, s[20:23], s16 offen offset:1024 lds
  s_add_u32 s52, s47, 8192
  buffer_load_dwordx4 a[32:35], v5, s[28:31], s52 offen offset:0
  buffer_load_dwordx4 a[36:39], v5, s[28:31], s52 offen offset:1024
  buffer_load_dwordx4 a[40:43], v5, s[28:31], s52 offen offset:2048
  buffer_load_dwordx4 a[44:47], v5, s[28:31], s52 offen offset:3072
  s_add_u32 m0, s51, 24576
  s_add_u32 s16, s50, 24576
  buffer_load_dwordx4 v5, s[20:23], s16 offen lds
  buffer_load_dwordx4 v5, s[20:23], s16 offen offset:1024 lds
  s_add_u32 s52, s47, 12288
  buffer_load_dwordx4 a[48:51], v5, s[28:31], s52 offen offset:0
  buffer_load_dwordx4 a[52:55], v5, s[28:31], s52 offen offset:1024
  buffer_load_dwordx4 a[56:59], v5, s[28:31], s52 offen offset:2048
  buffer_load_dwordx4 a[60:63], v5, s[28:31], s52 offen offset:3072
  v_lshrrev_b32 v6, 5, v1
  v_and_b32 v7, 31, v1
  v_lshlrev_b32 v8, 17, v6
  v_lshl_add_u32 v8, v7, 3, v8
  s_lshl_b32 s15, s48, 8
  s_mov_b32 s53, s15
  v_lshlrev_b32 v76, 3, v0
  v_lshlrev_b32 v77, 5, v6
  v_add_u32 v77, 131072, v77
  s_lshr_b32 s15, s48, 1
  s_mul_i32 s54, s15, 176128
  s_and_b32 s15, s48, 1
  s_lshl_b32 s15, s15, 10
  s_add_u32 s54, s54, s15
  s_lshl_b32 s15, s17, 12
  s_add_u32 s54, s54, s15
  v_add_u32 v172, 0x10000, v5
  s_waitcnt vmcnt(22)
  s_barrier
  ds_read_b128 v[84:87], v5 offset:0
  ds_read_b128 v[88:91], v5 offset:1024
  ds_read_b128 v[92:95], v5 offset:2048
  ds_read_b128 v[96:99], v5 offset:3072
  ds_read_b128 v[100:103], v5 offset:4096
  ds_read_b128 v[104:107], v5 offset:5120
  ds_read_b128 v[108:111], v5 offset:6144
  s_waitcnt vmcnt(21) lgkmcnt(6)
  v_mfma_f32_32x32x16_bf16 v[12:27], v[84:87], a[0:3], 0
  s_add_u32 m0, s51, 32768
  s_add_u32 s16, s50, 32768
  buffer_load_dwordx4 v5, s[20:23], s16 offen lds
  ds_read_b128 v[112:115], v5 offset:7168
  s_waitcnt lgkmcnt(6)
  v_mfma_f32_32x32x16_bf16 v[28:43], v[88:91], a[0:3], 0
  buffer_load_dwordx4 v5, s[20:23], s16 offen offset:1024 lds
  s_waitcnt vmcnt(18)
  s_barrier
  ds_read_b128 v[84:87], v5 offset:8192
  s_waitcnt lgkmcnt(6)
  v_mfma_f32_32x32x16_bf16 v[12:27], v[92:95], a[4:7], v[12:27]
  s_add_u32 s52, s47, 16384
  buffer_load_dwordx4 a[64:67], v5, s[28:31], s52 offen offset:0
  ds_read_b128 v[88:91], v5 offset:9216
  s_waitcnt lgkmcnt(6)
  v_mfma_f32_32x32x16_bf16 v[28:43], v[96:99], a[4:7], v[28:43]
  buffer_load_dwordx4 a[68:71], v5, s[28:31], s52 offen offset:1024
  ds_read_b128 v[92:95], v5 offset:10240
  s_waitcnt lgkmcnt(6)
  v_mfma_f32_32x32x16_bf16 v[12:27], v[100:103], a[8:11], v[12:27]
  buffer_load_dwordx4 a[72:75], v5, s[28:31], s52 offen offset:2048
  ds_read_b128 v[96:99], v5 offset:11264
  s_waitcnt lgkmcnt(6)
  v_mfma_f32_32x32x16_bf16 v[28:43], v[104:107], a[8:11], v[28:43]
  buffer_load_dwordx4 a[76:79], v5, s[28:31], s52 offen offset:3072
  ds_read_b128 v[100:103], v5 offset:12288
  s_waitcnt lgkmcnt(6)
  v_mfma_f32_32x32x16_bf16 v[12:27], v[108:111], a[12:15], v[12:27]
  s_add_u32 m0, s51, 40960
  s_add_u32 s16, s50, 40960
  buffer_load_dwordx4 v5, s[20:23], s16 offen lds
  ds_read_b128 v[104:107], v5 offset:13312
  s_waitcnt lgkmcnt(6)
  v_mfma_f32_32x32x16_bf16 v[28:43], v[112:115], a[12:15], v[28:43]
  buffer_load_dwordx4 v5, s[20:23], s16 offen offset:1024 lds
  ds_read_b128 v[108:111], v5 offset:14336
  s_waitcnt vmcnt(23) lgkmcnt(6)
  v_mfma_f32_32x32x16_bf16 v[12:27], v[84:87], a[16:19], v[12:27]
  ds_read_b128 v[112:115], v5 offset:15360
  s_waitcnt lgkmcnt(6)
  v_mfma_f32_32x32x16_bf16 v[28:43], v[88:91], a[16:19], v[28:43]
  s_add_u32 s52, s47, 20480
  buffer_load_dwordx4 a[80:83], v5, s[28:31], s52 offen offset:0
  s_waitcnt vmcnt(19)
  s_barrier
  ds_read_b128 v[84:87], v5 offset:16384
  s_waitcnt lgkmcnt(6)
  v_mfma_f32_32x32x16_bf16 v[12:27], v[92:95], a[20:23], v[12:27]
  buffer_load_dwordx4 a[84:87], v5, s[28:31], s52 offen offset:1024
  ds_read_b128 v[88:91], v5 offset:17408
  s_waitcnt lgkmcnt(6)
  v_mfma_f32_32x32x16_bf16 v[28:43], v[96:99], a[20:23], v[28:43]
  buffer_load_dwordx4 a[88:91], v5, s[28:31], s52 offen offset:2048
  ds_read_b128 v[92:95], v5 offset:18432
  s_waitcnt lgkmcnt(6)
  v_mfma_f32_32x32x16_bf16 v[12:27], v[100:103], a[24:27], v[12:27]
  buffer_load_dwordx4 a[92:95], v5, s[28:31], s52 offen offset:3072
  ds_read_b128 v[96:99], v5 offset:19456
  s_waitcnt lgkmcnt(6)
  v_mfma_f32_32x32x16_bf16 v[28:43], v[104:107], a[24:27], v[28:43]
  buffer_load_dwordx2 v[60:61], v76, s[36:39], s49 offen
  ds_read_b128 v[100:103], v5 offset:20480
  s_waitcnt lgkmcnt(6)
  v_mfma_f32_32x32x16_bf16 v[12:27], v[108:111], a[28:31], v[12:27]
  s_add_u32 s49, s49, 22528
  buffer_load_dwordx2 v[62:63], v76, s[36:39], s49 offen
  ds_read_b128 v[104:107], v5 offset:21504
  s_waitcnt lgkmcnt(6)
  v_mfma_f32_32x32x16_bf16 v[28:43], v[112:115], a[28:31], v[28:43]
  s_add_u32 s49, s49, 22528
  buffer_load_dwordx2 v[64:65], v76, s[36:39], s49 offen
  ds_read_b128 v[108:111], v5 offset:22528
  s_waitcnt vmcnt(24) lgkmcnt(6)
  v_mfma_f32_32x32x16_bf16 v[12:27], v[84:87], a[32:35], v[12:27]
  ds_read_b128 v[112:115], v5 offset:23552
  s_waitcnt lgkmcnt(6)
  v_mfma_f32_32x32x16_bf16 v[28:43], v[88:91], a[32:35], v[28:43]
  s_add_u32 s49, s49, 22528
  buffer_load_dwordx2 v[66:67], v76, s[36:39], s49 offen
  s_waitcnt vmcnt(20)
  s_barrier
  ds_read_b128 v[84:87], v5 offset:24576
  s_waitcnt lgkmcnt(6)
  v_mfma_f32_32x32x16_bf16 v[12:27], v[92:95], a[36:39], v[12:27]
  buffer_load_dwordx2 v[44:45], v8, s[32:35], s53 offen
  ds_read_b128 v[88:91], v5 offset:25600
  s_waitcnt lgkmcnt(6)
  v_mfma_f32_32x32x16_bf16 v[28:43], v[96:99], a[36:39], v[28:43]
  s_add_u32 s53, s53, 16384
  buffer_load_dwordx2 v[46:47], v8, s[32:35], s53 offen
  ds_read_b128 v[92:95], v5 offset:26624
  s_waitcnt lgkmcnt(6)
  v_mfma_f32_32x32x16_bf16 v[12:27], v[100:103], a[40:43], v[12:27]
  s_add_u32 s53, s53, 16384
  buffer_load_dwordx2 v[48:49], v8, s[32:35], s53 offen
  ds_read_b128 v[96:99], v5 offset:27648
  s_waitcnt lgkmcnt(6)
  v_mfma_f32_32x32x16_bf16 v[28:43], v[104:107], a[40:43], v[28:43]
  s_add_u32 s53, s53, 16384
  buffer_load_dwordx2 v[50:51], v8, s[32:35], s53 offen
  ds_read_b128 v[100:103], v5 offset:28672
  s_waitcnt lgkmcnt(6)
  v_mfma_f32_32x32x16_bf16 v[12:27], v[108:111], a[44:47], v[12:27]
  s_add_u32 s53, s53, 16384
  buffer_load_dwordx2 v[52:53], v8, s[32:35], s53 offen
  ds_read_b128 v[104:107], v5 offset:29696
  s_waitcnt lgkmcnt(6)
  v_mfma_f32_32x32x16_bf16 v[28:43], v[112:115], a[44:47], v[28:43]
  s_add_u32 s53, s53, 16384
  buffer_load_dwordx2 v[54:55], v8, s[32:35], s53 offen
  ds_read_b128 v[108:111], v5 offset:30720
  s_waitcnt vmcnt(25) lgkmcnt(6)
  v_mfma_f32_32x32x16_bf16 v[12:27], v[84:87], a[48:51], v[12:27]
  ds_read_b128 v[112:115], v5 offset:31744
  s_waitcnt lgkmcnt(6)
  v_mfma_f32_32x32x16_bf16 v[28:43], v[88:91], a[48:51], v[28:43]
  s_add_u32 s53, s53, 16384
  buffer_load_dwordx2 v[56:57], v8, s[32:35], s53 offen
  s_waitcnt vmcnt(21)
  s_barrier
  ds_read_b128 v[84:87], v5 offset:32768
  s_waitcnt lgkmcnt(6)
  v_mfma_f32_32x32x16_bf16 v[12:27], v[92:95], a[52:55], v[12:27]
  s_add_u32 s53, s53, 16384
  buffer_load_dwordx2 v[58:59], v8, s[32:35], s53 offen
  ds_read_b128 v[88:91], v5 offset:33792
  s_waitcnt lgkmcnt(6)
  v_mfma_f32_32x32x16_bf16 v[28:43], v[96:99], a[52:55], v[28:43]
  s_add_u32 m0, s51, 49152
  s_add_u32 s16, s50, 49152
  buffer_load_dwordx4 v5, s[20:23], s16 offen lds
  ds_read_b128 v[92:95], v5 offset:34816
  s_waitcnt lgkmcnt(6)
  v_mfma_f32_32x32x16_bf16 v[12:27], v[100:103], a[56:59], v[12:27]
  buffer_load_dwordx4 v5, s[20:23], s16 offen offset:1024 lds
  ds_read_b128 v[96:99], v5 offset:35840
  s_waitcnt lgkmcnt(6)
  v_mfma_f32_32x32x16_bf16 v[28:43], v[104:107], a[56:59], v[28:43]
  s_add_u32 s52, s47, 24576
  buffer_load_dwordx4 a[96:99], v5, s[28:31], s52 offen offset:0
  ds_read_b128 v[100:103], v5 offset:36864
  s_waitcnt lgkmcnt(6)
  v_mfma_f32_32x32x16_bf16 v[12:27], v[108:111], a[60:63], v[12:27]
  buffer_load_dwordx4 a[100:103], v5, s[28:31], s52 offen offset:1024
  ds_read_b128 v[104:107], v5 offset:37888
  s_waitcnt lgkmcnt(6)
  v_mfma_f32_32x32x16_bf16 v[28:43], v[112:115], a[60:63], v[28:43]
  buffer_load_dwordx4 a[104:107], v5, s[28:31], s52 offen offset:2048
  ds_read_b128 v[108:111], v5 offset:38912
  s_waitcnt vmcnt(26) lgkmcnt(6)
  v_mfma_f32_32x32x16_bf16 v[12:27], v[84:87], a[64:67], v[12:27]
  buffer_load_dwordx4 a[108:111], v5, s[28:31], s52 offen offset:3072
  ds_read_b128 v[112:115], v5 offset:39936
  s_waitcnt lgkmcnt(6)
  v_mfma_f32_32x32x16_bf16 v[28:43], v[88:91], a[64:67], v[28:43]
  s_waitcnt vmcnt(22)
  s_barrier
  ds_read_b128 v[84:87], v5 offset:40960
  s_waitcnt lgkmcnt(6)
  v_mfma_f32_32x32x16_bf16 v[12:27], v[92:95], a[68:71], v[12:27]
  s_add_u32 m0, s51, 57344
  s_add_u32 s16, s50, 57344
  buffer_load_dwordx4 v5, s[20:23], s16 offen lds
  ds_read_b128 v[88:91], v5 offset:41984
  s_waitcnt lgkmcnt(6)
  v_mfma_f32_32x32x16_bf16 v[28:43], v[96:99], a[68:71], v[28:43]
  buffer_load_dwordx4 v5, s[20:23], s16 offen offset:1024 lds
  ds_read_b128 v[92:95], v5 offset:43008
  s_waitcnt lgkmcnt(6)
  v_mfma_f32_32x32x16_bf16 v[12:27], v[100:103], a[72:75], v[12:27]
  s_add_u32 s52, s47, 28672
  buffer_load_dwordx4 a[112:115], v5, s[28:31], s52 offen offset:0
  ds_read_b128 v[96:99], v5 offset:44032
  s_waitcnt lgkmcnt(6)
  v_mfma_f32_32x32x16_bf16 v[28:43], v[104:107], a[72:75], v[28:43]
  buffer_load_dwordx4 a[116:119], v5, s[28:31], s52 offen offset:1024
  ds_read_b128 v[100:103], v5 offset:45056
  s_waitcnt lgkmcnt(6)
  v_mfma_f32_32x32x16_bf16 v[12:27], v[108:111], a[76:79], v[12:27]
  buffer_load_dwordx4 a[120:123], v5, s[28:31], s52 offen offset:2048
  ds_read_b128 v[104:107], v5 offset:46080
  s_waitcnt lgkmcnt(6)
  v_mfma_f32_32x32x16_bf16 v[28:43], v[112:115], a[76:79], v[28:43]
  buffer_load_dwordx4 a[124:127], v5, s[28:31], s52 offen offset:3072
  ds_read_b128 v[108:111], v5 offset:47104
  s_waitcnt vmcnt(27) lgkmcnt(6)
  v_mfma_f32_32x32x16_bf16 v[12:27], v[84:87], a[80:83], v[12:27]
  s_add_u32 m0, s46, 65536
  s_add_u32 s16, s45, 65536
  buffer_load_dwordx4 v5, s[20:23], s16 offen offset:0 lds
  ds_read_b128 v[112:115], v5 offset:48128
  s_waitcnt lgkmcnt(6)
  v_mfma_f32_32x32x16_bf16 v[28:43], v[88:91], a[80:83], v[28:43]
  s_waitcnt vmcnt(11)
  s_barrier
  ds_read_b128 v[84:87], v5 offset:49152
  s_waitcnt lgkmcnt(6)
  v_mfma_f32_32x32x16_bf16 v[12:27], v[92:95], a[84:87], v[12:27]
  buffer_load_dwordx4 v5, s[20:23], s16 offen offset:1024 lds
  ds_read_b128 v[88:91], v5 offset:50176
  s_waitcnt lgkmcnt(6)
  v_mfma_f32_32x32x16_bf16 v[28:43], v[96:99], a[84:87], v[28:43]
  buffer_load_dwordx4 v5, s[20:23], s16 offen offset:2048 lds
  ds_read_b128 v[92:95], v5 offset:51200
  s_waitcnt lgkmcnt(6)
  v_mfma_f32_32x32x16_bf16 v[12:27], v[100:103], a[88:91], v[12:27]
  buffer_load_dwordx4 v5, s[20:23], s16 offen offset:3072 lds
  ds_read_b128 v[96:99], v5 offset:52224
  s_waitcnt lgkmcnt(6)
  v_mfma_f32_32x32x16_bf16 v[28:43], v[104:107], a[88:91], v[28:43]
  s_add_u32 m0, s46, 69632
  s_add_u32 s16, s45, 69632
  buffer_load_dwordx4 v5, s[20:23], s16 offen offset:0 lds
  ds_read_b128 v[100:103], v5 offset:53248
  s_waitcnt lgkmcnt(6)
  v_mfma_f32_32x32x16_bf16 v[12:27], v[108:111], a[92:95], v[12:27]
  buffer_load_dwordx4 v5, s[20:23], s16 offen offset:1024 lds
  ds_read_b128 v[104:107], v5 offset:54272
  s_waitcnt lgkmcnt(6)
  v_mfma_f32_32x32x16_bf16 v[28:43], v[112:115], a[92:95], v[28:43]
  buffer_load_dwordx4 v5, s[20:23], s16 offen offset:2048 lds
  ds_read_b128 v[108:111], v5 offset:55296
  s_waitcnt vmcnt(16) lgkmcnt(6)
  v_mfma_f32_32x32x16_bf16 v[12:27], v[84:87], a[96:99], v[12:27]
  buffer_load_dwordx4 v5, s[20:23], s16 offen offset:3072 lds
  ds_read_b128 v[112:115], v5 offset:56320
  s_waitcnt lgkmcnt(6)
  v_mfma_f32_32x32x16_bf16 v[28:43], v[88:91], a[96:99], v[28:43]
  s_waitcnt vmcnt(12)
  s_barrier
  ds_read_b128 v[84:87], v5 offset:57344
  s_waitcnt lgkmcnt(6)
  v_mfma_f32_32x32x16_bf16 v[12:27], v[92:95], a[100:103], v[12:27]
  v_add_f32 v60, v60, v62
  v_add_f32 v64, v64, v66
  v_add_f32 v61, v61, v63
  v_add_f32 v65, v65, v67
  v_add_f32 v60, v60, v64
  ds_read_b128 v[88:91], v5 offset:58368
  s_waitcnt lgkmcnt(6)
  v_mfma_f32_32x32x16_bf16 v[28:43], v[96:99], a[100:103], v[28:43]
  v_add_f32 v61, v61, v65
  v_add_u32 v76, 131072, v76
  ds_write_b64 v76, v[60:61]
  v_add_f32 v44, v44, v46
  ds_read_b128 v[92:95], v5 offset:59392
  s_waitcnt lgkmcnt(7)
  v_mfma_f32_32x32x16_bf16 v[12:27], v[100:103], a[104:107], v[12:27]
  v_add_f32 v45, v45, v47
  v_add_f32 v44, v44, v48
  v_add_f32 v45, v45, v49
  v_add_f32 v44, v44, v50
  v_add_f32 v45, v45, v51
  ds_read_b128 v[96:99], v5 offset:60416
  s_waitcnt lgkmcnt(7)
  v_mfma_f32_32x32x16_bf16 v[28:43], v[104:107], a[104:107], v[28:43]
  v_add_f32 v44, v44, v52
  v_add_f32 v45, v45, v53
  v_add_f32 v44, v44, v54
  v_add_f32 v45, v45, v55
  ds_read_b128 v[100:103], v5 offset:61440
  s_waitcnt lgkmcnt(7)
  v_mfma_f32_32x32x16_bf16 v[12:27], v[108:111], a[108:111], v[12:27]
  v_add_f32 v44, v44, v56
  v_add_f32 v45, v45, v57
  v_add_f32 v44, v44, v58
  v_add_f32 v45, v45, v59
  v_mov_b32 v46, v44
  ds_read_b128 v[104:107], v5 offset:62464
  s_waitcnt lgkmcnt(7)
  v_mfma_f32_32x32x16_bf16 v[28:43], v[112:115], a[108:111], v[28:43]
  v_mov_b32 v47, v45
  v_permlane32_swap_b32 v44, v46
  s_nop 0
  v_permlane32_swap_b32 v45, v47
  v_add_f32 v44, v44, v46
  v_add_f32 v45, v45, v47
  ds_read_b128 v[108:111], v5 offset:63488
  s_waitcnt vmcnt(11) lgkmcnt(7)
  v_mfma_f32_32x32x16_bf16 v[12:27], v[84:87], a[112:115], v[12:27]
  v_mul_f32 v78, 0xbb000000, v44
  v_mul_f32 v45, 0x3b000000, v45
  v_fma_f32 v45, -v78, v78, v45
  v_max_f32 v45, 0, v45
  ds_read_b128 v[112:115], v5 offset:64512
  s_waitcnt lgkmcnt(7)
  v_mfma_f32_32x32x16_bf16 v[28:43], v[88:91], a[112:115], v[28:43]
  v_add_f32 v45, 0x3727c5ac, v45
  v_rsq_f32 v79, v45
  v_mov_b32 v80, 0xc0135761
  v_mov_b32 v81, 0xbdd2d3e8
  s_waitcnt vmcnt(0) lgkmcnt(0)
  s_barrier
  ds_read_b128 v[84:87], v172 offset:0
  v_mfma_f32_32x32x16_bf16 v[12:27], v[92:95], a[116:119], v[12:27]
  ds_read_b128 v[88:91], v172 offset:1024
  v_mfma_f32_32x32x16_bf16 v[28:43], v[96:99], a[116:119], v[28:43]
  ds_read_b128 v[92:95], v172 offset:2048
  v_mfma_f32_32x32x16_bf16 v[12:27], v[100:103], a[120:123], v[12:27]
  ds_read_b128 v[96:99], v172 offset:3072
  v_mfma_f32_32x32x16_bf16 v[28:43], v[104:107], a[120:123], v[28:43]
  ds_read_b128 v[100:103], v172 offset:4096
  v_mfma_f32_32x32x16_bf16 v[12:27], v[108:111], a[124:127], v[12:27]
  ds_read_b128 v[104:107], v172 offset:5120
  v_mfma_f32_32x32x16_bf16 v[28:43], v[112:115], a[124:127], v[28:43]
  ds_read_b128 v[108:111], v172 offset:6144
  s_waitcnt lgkmcnt(6)
  v_mfma_f32_32x32x16_bf16 v[44:59], v[84:87], a[0:3], 0
  s_add_u32 m0, s46, 98304
  s_add_u32 s16, s45, 98304
  buffer_load_dwordx4 v5, s[20:23], s16 offen offset:0 lds
  ds_read_b128 v[112:115], v172 offset:7168
  s_waitcnt lgkmcnt(6)
  v_mfma_f32_32x32x16_bf16 v[60:75], v[88:91], a[0:3], 0
  ds_read_b128 v[84:87], v172 offset:8192
  s_waitcnt lgkmcnt(6)
  v_mfma_f32_32x32x16_bf16 v[44:59], v[92:95], a[4:7], v[44:59]
  buffer_load_dwordx4 v5, s[20:23], s16 offen offset:1024 lds
  ds_read_b128 v[140:143], v77 offset:0
  ds_read_b128 v[144:147], v77 offset:128
  ds_read_b128 v[148:151], v77 offset:256
  ds_read_b128 v[152:155], v77 offset:384
  ds_read_b128 v[88:91], v172 offset:9216
  s_waitcnt lgkmcnt(10)
  v_mfma_f32_32x32x16_bf16 v[60:75], v[96:99], a[4:7], v[60:75]
  s_waitcnt lgkmcnt(4)
  v_fma_f32 v116, v78, v140, v12
  v_fma_f32 v117, v78, v141, v13
  v_fma_f32 v118, v78, v142, v14
  v_fma_f32 v119, v78, v143, v15
  ds_read_b128 v[92:95], v172 offset:10240
  v_mfma_f32_32x32x16_bf16 v[44:59], v[100:103], a[8:11], v[44:59]
  buffer_load_dwordx4 v5, s[20:23], s16 offen offset:2048 lds
  s_waitcnt lgkmcnt(3)
  v_fma_f32 v120, v78, v148, v28
  v_fma_f32 v121, v78, v149, v29
  v_fma_f32 v122, v78, v150, v30
  v_fma_f32 v123, v78, v151, v31
  v_fma_f32 v116, v116, v79, v144
  ds_read_b128 v[96:99], v172 offset:11264
  v_mfma_f32_32x32x16_bf16 v[60:75], v[104:107], a[8:11], v[60:75]
  v_fma_f32 v117, v117, v79, v145
  v_fma_f32 v118, v118, v79, v146
  v_fma_f32 v119, v119, v79, v147
  s_waitcnt lgkmcnt(3)
  v_fma_f32 v120, v120, v79, v152
  ds_read_b128 v[100:103], v172 offset:12288
  v_mfma_f32_32x32x16_bf16 v[44:59], v[108:111], a[12:15], v[44:59]
  buffer_load_dwordx4 v5, s[20:23], s16 offen offset:3072 lds
  v_fma_f32 v121, v121, v79, v153
  v_fma_f32 v122, v122, v79, v154
  v_fma_f32 v123, v123, v79, v155
  v_mul_f32 v124, v116, v116
  ds_read_b128 v[104:107], v172 offset:13312
  v_mfma_f32_32x32x16_bf16 v[60:75], v[112:115], a[12:15], v[60:75]
  ds_read_b128 v[156:159], v77 offset:16
  v_mul_f32 v125, v117, v117
  ds_read_b128 v[160:163], v77 offset:144
  v_mul_f32 v126, v118, v118
  ds_read_b128 v[108:111], v172 offset:14336
  v_mfma_f32_32x32x16_bf16 v[44:59], v[84:87], a[16:19], v[44:59]
  s_add_u32 m0, s46, 102400
  s_add_u32 s16, s45, 102400
  buffer_load_dwordx4 v5, s[20:23], s16 offen offset:0 lds
  ds_read_b128 v[164:167], v77 offset:272
  v_mul_f32 v127, v119, v119
  ds_read_b128 v[168:171], v77 offset:400
  v_fma_f32 v124, v124, v81, v80
  ds_read_b128 v[112:115], v172 offset:15360
  s_waitcnt lgkmcnt(10)
  v_mfma_f32_32x32x16_bf16 v[60:75], v[88:91], a[16:19], v[60:75]
  v_fma_f32 v125, v125, v81, v80
  v_fma_f32 v126, v126, v81, v80
  v_fma_f32 v127, v127, v81, v80
  v_mul_f32 v124, v116, v124
  v_mul_f32 v125, v117, v125
  ds_read_b128 v[84:87], v172 offset:16384
  s_waitcnt lgkmcnt(10)
  v_mfma_f32_32x32x16_bf16 v[44:59], v[92:95], a[20:23], v[44:59]
  buffer_load_dwordx4 v5, s[20:23], s16 offen offset:1024 lds
  v_mul_f32 v126, v118, v126
  v_mul_f32 v127, v119, v127
  v_exp_f32 v124, v124
  ds_read_b128 v[88:91], v172 offset:17408
  s_waitcnt lgkmcnt(10)
  v_mfma_f32_32x32x16_bf16 v[60:75], v[96:99], a[20:23], v[60:75]
  v_mul_f32 v128, v116, v120
  v_exp_f32 v125, v125
  v_mul_f32 v129, v117, v121
  ds_read_b128 v[92:95], v172 offset:18432
  s_waitcnt lgkmcnt(10)
  v_mfma_f32_32x32x16_bf16 v[44:59], v[100:103], a[24:27], v[44:59]
  buffer_load_dwordx4 v5, s[20:23], s16 offen offset:2048 lds
  v_exp_f32 v126, v126
  v_mul_f32 v130, v118, v122
  v_exp_f32 v127, v127
  ds_read_b128 v[96:99], v172 offset:19456
  s_waitcnt lgkmcnt(10)
  v_mfma_f32_32x32x16_bf16 v[60:75], v[104:107], a[24:27], v[60:75]
  v_mul_f32 v131, v119, v123
  v_add_f32 v124, 1.0, v124
  v_add_f32 v125, 1.0, v125
  ds_read_b128 v[100:103], v172 offset:20480
  s_waitcnt lgkmcnt(8)
  v_mfma_f32_32x32x16_bf16 v[44:59], v[108:111], a[28:31], v[44:59]
  buffer_load_dwordx4 v5, s[20:23], s16 offen offset:3072 lds
  v_add_f32 v126, 1.0, v126
  v_add_f32 v127, 1.0, v127
  v_rcp_f32 v124, v124
  ds_read_b128 v[104:107], v172 offset:21504
  s_waitcnt lgkmcnt(6)
  v_mfma_f32_32x32x16_bf16 v[60:75], v[112:115], a[28:31], v[60:75]
  v_rcp_f32 v125, v125
  v_rcp_f32 v126, v126
  ds_read_b128 v[108:111], v172 offset:22528
  s_waitcnt lgkmcnt(6)
  v_mfma_f32_32x32x16_bf16 v[44:59], v[84:87], a[32:35], v[44:59]
  s_add_u32 m0, s46, 0
  s_add_u32 s16, s45, 131072
  buffer_load_dwordx4 v5, s[24:27], s16 offen offset:0 lds
  v_rcp_f32 v127, v127
  v_mul_f32 v128, v128, v124
  v_mul_f32 v129, v129, v125
  v_mul_f32 v130, v130, v126
  ds_read_b128 v[112:115], v172 offset:23552
  s_waitcnt lgkmcnt(6)
  v_mfma_f32_32x32x16_bf16 v[60:75], v[88:91], a[32:35], v[60:75]
  v_mul_f32 v131, v131, v127
  v_cvt_pk_bf16_f32 v132, v128, v129
  v_cvt_pk_bf16_f32 v133, v130, v131
  v_fma_f32 v116, v78, v156, v16
  ds_read_b128 v[84:87], v172 offset:24576
  s_waitcnt lgkmcnt(6)
  v_mfma_f32_32x32x16_bf16 v[44:59], v[92:95], a[36:39], v[44:59]
  buffer_load_dwordx4 v5, s[24:27], s16 offen offset:1024 lds
  v_fma_f32 v117, v78, v157, v17
  v_fma_f32 v118, v78, v158, v18
  v_fma_f32 v119, v78, v159, v19
  v_fma_f32 v120, v78, v164, v32
  v_fma_f32 v121, v78, v165, v33
  ds_read_b128 v[88:91], v172 offset:25600
  s_waitcnt lgkmcnt(6)
  v_mfma_f32_32x32x16_bf16 v[60:75], v[96:99], a[36:39], v[60:75]
  v_fma_f32 v122, v78, v166, v34
  v_fma_f32 v123, v78, v167, v35
  v_fma_f32 v116, v116, v79, v160
  v_fma_f32 v117, v117, v79, v161
  ds_read_b128 v[92:95], v172 offset:26624
  s_waitcnt lgkmcnt(6)
  v_mfma_f32_32x32x16_bf16 v[44:59], v[100:103], a[40:43], v[44:59]
  buffer_load_dwordx4 v5, s[24:27], s16 offen offset:2048 lds
  v_fma_f32 v118, v118, v79, v162
  v_fma_f32 v119, v119, v79, v163
  v_fma_f32 v120, v120, v79, v168
  v_fma_f32 v121, v121, v79, v169
  ds_read_b128 v[96:99], v172 offset:27648
  s_waitcnt lgkmcnt(6)
  v_mfma_f32_32x32x16_bf16 v[60:75], v[104:107], a[40:43], v[60:75]
  v_fma_f32 v122, v122, v79, v170
  v_fma_f32 v123, v123, v79, v171
  v_mul_f32 v124, v116, v116
  ds_read_b128 v[140:143], v77 offset:64
  ds_read_b128 v[100:103], v172 offset:28672
  s_waitcnt lgkmcnt(7)
  v_mfma_f32_32x32x16_bf16 v[44:59], v[108:111], a[44:47], v[44:59]
  buffer_load_dwordx4 v5, s[24:27], s16 offen offset:3072 lds
  v_mul_f32 v125, v117, v117
  ds_read_b128 v[144:147], v77 offset:192
  v_mul_f32 v126, v118, v118
  ds_read_b128 v[148:151], v77 offset:320
  ds_read_b128 v[104:107], v172 offset:29696
  s_waitcnt lgkmcnt(9)
  v_mfma_f32_32x32x16_bf16 v[60:75], v[112:115], a[44:47], v[60:75]
  v_mul_f32 v127, v119, v119
  ds_read_b128 v[152:155], v77 offset:448
  v_fma_f32 v124, v124, v81, v80
  v_fma_f32 v125, v125, v81, v80
  v_fma_f32 v126, v126, v81, v80
  ds_read_b128 v[108:111], v172 offset:30720
  s_waitcnt lgkmcnt(10)
  v_mfma_f32_32x32x16_bf16 v[44:59], v[84:87], a[48:51], v[44:59]
  s_add_u32 m0, s46, 4096
  s_add_u32 s16, s45, 135168
  buffer_load_dwordx4 v5, s[24:27], s16 offen offset:0 lds
  v_fma_f32 v127, v127, v81, v80
  v_mul_f32 v124, v116, v124
  v_mul_f32 v125, v117, v125
  v_mul_f32 v126, v118, v126
  ds_read_b128 v[112:115], v172 offset:31744
  s_waitcnt lgkmcnt(10)
  v_mfma_f32_32x32x16_bf16 v[60:75], v[88:91], a[48:51], v[60:75]
  v_mul_f32 v127, v119, v127
  v_exp_f32 v124, v124
  v_mul_f32 v128, v116, v120
  s_waitcnt vmcnt(5)
  s_barrier
  ds_read_b128 v[84:87], v172 offset:32768
  s_waitcnt lgkmcnt(10)
  v_mfma_f32_32x32x16_bf16 v[44:59], v[92:95], a[52:55], v[44:59]
  buffer_load_dwordx4 v5, s[24:27], s16 offen offset:1024 lds
  v_exp_f32 v125, v125
  v_mul_f32 v129, v117, v121
  v_exp_f32 v126, v126
  ds_read_b128 v[88:91], v172 offset:33792
  s_waitcnt lgkmcnt(10)
  v_mfma_f32_32x32x16_bf16 v[60:75], v[96:99], a[52:55], v[60:75]
  v_mul_f32 v130, v118, v122
  v_exp_f32 v127, v127
  ds_read_b128 v[92:95], v172 offset:34816
  s_waitcnt lgkmcnt(9)
  v_mfma_f32_32x32x16_bf16 v[44:59], v[100:103], a[56:59], v[44:59]
  buffer_load_dwordx4 v5, s[24:27], s16 offen offset:2048 lds
  v_mul_f32 v131, v119, v123
  v_add_f32 v124, 1.0, v124
  v_add_f32 v125, 1.0, v125
  v_add_f32 v126, 1.0, v126
  v_add_f32 v127, 1.0, v127
  ds_read_b128 v[96:99], v172 offset:35840
  s_waitcnt lgkmcnt(7)
  v_mfma_f32_32x32x16_bf16 v[60:75], v[104:107], a[56:59], v[60:75]
  v_rcp_f32 v124, v124
  v_rcp_f32 v125, v125
  ds_read_b128 v[100:103], v172 offset:36864
  s_waitcnt lgkmcnt(6)
  v_mfma_f32_32x32x16_bf16 v[44:59], v[108:111], a[60:63], v[44:59]
  buffer_load_dwordx4 v5, s[24:27], s16 offen offset:3072 lds
  v_rcp_f32 v126, v126
  v_rcp_f32 v127, v127
  ds_read_b128 v[104:107], v172 offset:37888
  s_waitcnt lgkmcnt(6)
  v_mfma_f32_32x32x16_bf16 v[60:75], v[112:115], a[60:63], v[60:75]
  v_mul_f32 v128, v128, v124
  v_mul_f32 v129, v129, v125
  v_mul_f32 v130, v130, v126
  v_mul_f32 v131, v131, v127
  ds_read_b128 v[108:111], v172 offset:38912
  s_waitcnt lgkmcnt(6)
  v_mfma_f32_32x32x16_bf16 v[44:59], v[84:87], a[64:67], v[44:59]
  v_cvt_pk_bf16_f32 v134, v128, v129
  v_cvt_pk_bf16_f32 v135, v130, v131
  s_add_u32 s15, s54, 0
  buffer_store_dwordx4 v[132:135], v5, s[40:43], s15 offen
  ds_read_b128 v[112:115], v172 offset:39936
  s_waitcnt lgkmcnt(6)
  v_mfma_f32_32x32x16_bf16 v[60:75], v[88:91], a[64:67], v[60:75]
  v_fma_f32 v116, v78, v140, v20
  v_fma_f32 v117, v78, v141, v21
  v_fma_f32 v118, v78, v142, v22
  v_fma_f32 v119, v78, v143, v23
  ds_read_b128 v[84:87], v172 offset:40960
  s_waitcnt lgkmcnt(6)
  v_mfma_f32_32x32x16_bf16 v[44:59], v[92:95], a[68:71], v[44:59]
  s_add_u32 m0, s46, 32768
  s_add_u32 s16, s45, 163840
  buffer_load_dwordx4 v5, s[24:27], s16 offen offset:0 lds
  v_fma_f32 v120, v78, v148, v36
  v_fma_f32 v121, v78, v149, v37
  v_fma_f32 v122, v78, v150, v38
  v_fma_f32 v123, v78, v151, v39
  v_fma_f32 v116, v116, v79, v144
  ds_read_b128 v[88:91], v172 offset:41984
  s_waitcnt lgkmcnt(6)
  v_mfma_f32_32x32x16_bf16 v[60:75], v[96:99], a[68:71], v[60:75]
  v_fma_f32 v117, v117, v79, v145
  v_fma_f32 v118, v118, v79, v146
  v_fma_f32 v119, v119, v79, v147
  v_fma_f32 v120, v120, v79, v152
  ds_read_b128 v[92:95], v172 offset:43008
  s_waitcnt lgkmcnt(6)
  v_mfma_f32_32x32x16_bf16 v[44:59], v[100:103], a[72:75], v[44:59]
  buffer_load_dwordx4 v5, s[24:27], s16 offen offset:1024 lds
  v_fma_f32 v121, v121, v79, v153
  v_fma_f32 v122, v122, v79, v154
  v_fma_f32 v123, v123, v79, v155
  v_mul_f32 v124, v116, v116
  ds_read_b128 v[96:99], v172 offset:44032
  s_waitcnt lgkmcnt(6)
  v_mfma_f32_32x32x16_bf16 v[60:75], v[104:107], a[72:75], v[60:75]
  ds_read_b128 v[156:159], v77 offset:80
  v_mul_f32 v125, v117, v117
  ds_read_b128 v[160:163], v77 offset:208
  v_mul_f32 v126, v118, v118
  ds_read_b128 v[100:103], v172 offset:45056
  s_waitcnt lgkmcnt(8)
  v_mfma_f32_32x32x16_bf16 v[44:59], v[108:111], a[76:79], v[44:59]
  buffer_load_dwordx4 v5, s[24:27], s16 offen offset:2048 lds
  ds_read_b128 v[164:167], v77 offset:336
  v_mul_f32 v127, v119, v119
  ds_read_b128 v[168:171], v77 offset:464
  v_fma_f32 v124, v124, v81, v80
  ds_read_b128 v[104:107], v172 offset:46080
  s_waitcnt lgkmcnt(10)
  v_mfma_f32_32x32x16_bf16 v[60:75], v[112:115], a[76:79], v[60:75]
  v_fma_f32 v125, v125, v81, v80
  v_fma_f32 v126, v126, v81, v80
  v_fma_f32 v127, v127, v81, v80
  v_mul_f32 v124, v116, v124
  v_mul_f32 v125, v117, v125
  ds_read_b128 v[108:111], v172 offset:47104
  s_waitcnt lgkmcnt(10)
  v_mfma_f32_32x32x16_bf16 v[44:59], v[84:87], a[80:83], v[44:59]
  buffer_load_dwordx4 v5, s[24:27], s16 offen offset:3072 lds
  v_mul_f32 v126, v118, v126
  v_mul_f32 v127, v119, v127
  v_exp_f32 v124, v124
  ds_read_b128 v[112:115], v172 offset:48128
  s_waitcnt lgkmcnt(10)
  v_mfma_f32_32x32x16_bf16 v[60:75], v[88:91], a[80:83], v[60:75]
  v_mul_f32 v128, v116, v120
  v_exp_f32 v125, v125
  v_mul_f32 v129, v117, v121
  ds_read_b128 v[84:87], v172 offset:49152
  s_waitcnt lgkmcnt(10)
  v_mfma_f32_32x32x16_bf16 v[44:59], v[92:95], a[84:87], v[44:59]
  s_add_u32 m0, s46, 36864
  s_add_u32 s16, s45, 167936
  buffer_load_dwordx4 v5, s[24:27], s16 offen offset:0 lds
  v_exp_f32 v126, v126
  v_mul_f32 v130, v118, v122
  v_exp_f32 v127, v127
  ds_read_b128 v[88:91], v172 offset:50176
  s_waitcnt lgkmcnt(10)
  v_mfma_f32_32x32x16_bf16 v[60:75], v[96:99], a[84:87], v[60:75]
  v_mul_f32 v131, v119, v123
  v_add_f32 v124, 1.0, v124
  v_add_f32 v125, 1.0, v125
  ds_read_b128 v[92:95], v172 offset:51200
  s_waitcnt lgkmcnt(8)
  v_mfma_f32_32x32x16_bf16 v[44:59], v[100:103], a[88:91], v[44:59]
  buffer_load_dwordx4 v5, s[24:27], s16 offen offset:1024 lds
  v_add_f32 v126, 1.0, v126
  v_add_f32 v127, 1.0, v127
  v_rcp_f32 v124, v124
  ds_read_b128 v[96:99], v172 offset:52224
  s_waitcnt lgkmcnt(6)
  v_mfma_f32_32x32x16_bf16 v[60:75], v[104:107], a[88:91], v[60:75]
  v_rcp_f32 v125, v125
  v_rcp_f32 v126, v126
  ds_read_b128 v[100:103], v172 offset:53248
  s_waitcnt lgkmcnt(6)
  v_mfma_f32_32x32x16_bf16 v[44:59], v[108:111], a[92:95], v[44:59]
  buffer_load_dwordx4 v5, s[24:27], s16 offen offset:2048 lds
  v_rcp_f32 v127, v127
  v_mul_f32 v128, v128, v124
  v_mul_f32 v129, v129, v125
  v_mul_f32 v130, v130, v126
  ds_read_b128 v[104:107], v172 offset:54272
  s_waitcnt lgkmcnt(6)
  v_mfma_f32_32x32x16_bf16 v[60:75], v[112:115], a[92:95], v[60:75]
  v_mul_f32 v131, v131, v127
  v_cvt_pk_bf16_f32 v136, v128, v129
  v_cvt_pk_bf16_f32 v137, v130, v131
  v_fma_f32 v116, v78, v156, v24
  ds_read_b128 v[108:111], v172 offset:55296
  s_waitcnt lgkmcnt(6)
  v_mfma_f32_32x32x16_bf16 v[44:59], v[84:87], a[96:99], v[44:59]
  buffer_load_dwordx4 v5, s[24:27], s16 offen offset:3072 lds
  v_fma_f32 v117, v78, v157, v25
  v_fma_f32 v118, v78, v158, v26
  v_fma_f32 v119, v78, v159, v27
  v_fma_f32 v120, v78, v164, v40
  v_fma_f32 v121, v78, v165, v41
  ds_read_b128 v[112:115], v172 offset:56320
  s_waitcnt lgkmcnt(6)
  v_mfma_f32_32x32x16_bf16 v[60:75], v[88:91], a[96:99], v[60:75]
  v_fma_f32 v122, v78, v166, v42
  v_fma_f32 v123, v78, v167, v43
  v_fma_f32 v116, v116, v79, v160
  v_fma_f32 v117, v117, v79, v161
  ds_read_b128 v[84:87], v172 offset:57344
  s_waitcnt lgkmcnt(6)
  v_mfma_f32_32x32x16_bf16 v[44:59], v[92:95], a[100:103], v[44:59]
  v_fma_f32 v118, v118, v79, v162
  v_fma_f32 v119, v119, v79, v163
  v_fma_f32 v120, v120, v79, v168
  v_fma_f32 v121, v121, v79, v169
  ds_read_b128 v[88:91], v172 offset:58368
  s_waitcnt lgkmcnt(6)
  v_mfma_f32_32x32x16_bf16 v[60:75], v[96:99], a[100:103], v[60:75]
  v_fma_f32 v122, v122, v79, v170
  v_fma_f32 v123, v123, v79, v171
  v_mul_f32 v124, v116, v116
  v_mul_f32 v125, v117, v117
  ds_read_b128 v[92:95], v172 offset:59392
  s_waitcnt lgkmcnt(6)
  v_mfma_f32_32x32x16_bf16 v[44:59], v[100:103], a[104:107], v[44:59]
  buffer_load_dword v4, v3, s[8:11], s44 offen
  v_mul_f32 v126, v118, v118
  v_mul_f32 v127, v119, v119
  v_fma_f32 v124, v124, v81, v80
  v_fma_f32 v125, v125, v81, v80
  ds_read_b128 v[96:99], v172 offset:60416
  s_waitcnt lgkmcnt(6)
  v_mfma_f32_32x32x16_bf16 v[60:75], v[104:107], a[104:107], v[60:75]
  v_fma_f32 v126, v126, v81, v80
  v_fma_f32 v127, v127, v81, v80
  v_mul_f32 v124, v116, v124
  v_mul_f32 v125, v117, v125
  v_mul_f32 v126, v118, v126
  ds_read_b128 v[100:103], v172 offset:61440
  s_waitcnt lgkmcnt(6)
  v_mfma_f32_32x32x16_bf16 v[44:59], v[108:111], a[108:111], v[44:59]
  v_mul_f32 v127, v119, v127
  v_exp_f32 v124, v124
  v_mul_f32 v128, v116, v120
  ds_read_b128 v[104:107], v172 offset:62464
  s_waitcnt lgkmcnt(6)
  v_mfma_f32_32x32x16_bf16 v[60:75], v[112:115], a[108:111], v[60:75]
  v_exp_f32 v125, v125
  v_mul_f32 v129, v117, v121
  ds_read_b128 v[108:111], v172 offset:63488
  s_waitcnt lgkmcnt(6)
  v_mfma_f32_32x32x16_bf16 v[44:59], v[84:87], a[112:115], v[44:59]
  v_exp_f32 v126, v126
  v_mul_f32 v130, v118, v122
  v_exp_f32 v127, v127
  ds_read_b128 v[112:115], v172 offset:64512
  s_waitcnt lgkmcnt(6)
  v_mfma_f32_32x32x16_bf16 v[60:75], v[88:91], a[112:115], v[60:75]
  v_mul_f32 v131, v119, v123
  v_add_f32 v124, 1.0, v124
  v_add_f32 v125, 1.0, v125
  v_add_f32 v126, 1.0, v126
  s_waitcnt vmcnt(10)
  s_barrier
  ds_read_b128 v[84:87], v5 offset:0
  s_waitcnt lgkmcnt(6)
  v_mfma_f32_32x32x16_bf16 v[44:59], v[92:95], a[116:119], v[44:59]
  v_add_f32 v127, 1.0, v127
  v_rcp_f32 v124, v124
  v_rcp_f32 v125, v125
  ds_read_b128 v[88:91], v5 offset:1024
  s_waitcnt lgkmcnt(6)
  v_mfma_f32_32x32x16_bf16 v[60:75], v[96:99], a[116:119], v[60:75]
  v_rcp_f32 v126, v126
  v_rcp_f32 v127, v127
  ds_read_b128 v[92:95], v5 offset:2048
  s_waitcnt lgkmcnt(6)
  v_mfma_f32_32x32x16_bf16 v[44:59], v[100:103], a[120:123], v[44:59]
  v_mul_f32 v128, v128, v124
  v_mul_f32 v129, v129, v125
  v_mul_f32 v130, v130, v126
  v_mul_f32 v131, v131, v127
  ds_read_b128 v[96:99], v5 offset:3072
  s_waitcnt lgkmcnt(6)
  v_mfma_f32_32x32x16_bf16 v[60:75], v[104:107], a[120:123], v[60:75]
  v_cvt_pk_bf16_f32 v138, v128, v129
  v_cvt_pk_bf16_f32 v139, v130, v131
  s_add_u32 s15, s54, 2048
  buffer_store_dwordx4 v[136:139], v5, s[40:43], s15 offen
  ds_read_b128 v[100:103], v5 offset:4096
  s_waitcnt lgkmcnt(6)
  v_mfma_f32_32x32x16_bf16 v[44:59], v[108:111], a[124:127], v[44:59]
  ds_read_b128 v[104:107], v5 offset:5120
  s_waitcnt lgkmcnt(6)
  v_mfma_f32_32x32x16_bf16 v[60:75], v[112:115], a[124:127], v[60:75]
  s_cmp_eq_u32 s18, 0
  s_cbranch_scc1 k4_t22
  ds_read_b128 v[108:111], v5 offset:6144
  s_waitcnt lgkmcnt(6)
  v_mfma_f32_32x32x16_bf16 v[12:27], v[84:87], a[0:3], 0
  ds_read_b128 v[112:115], v5 offset:7168
  s_waitcnt lgkmcnt(6)
  v_mfma_f32_32x32x16_bf16 v[28:43], v[88:91], a[0:3], 0
  ds_read_b128 v[84:87], v5 offset:8192
  s_waitcnt lgkmcnt(6)
  v_mfma_f32_32x32x16_bf16 v[12:27], v[92:95], a[4:7], v[12:27]
  ds_read_b128 v[140:143], v77 offset:512
  ds_read_b128 v[144:147], v77 offset:640
  ds_read_b128 v[148:151], v77 offset:768
  ds_read_b128 v[152:155], v77 offset:896
  ds_read_b128 v[88:91], v5 offset:9216
  s_waitcnt lgkmcnt(10)
  v_mfma_f32_32x32x16_bf16 v[28:43], v[96:99], a[4:7], v[28:43]
  s_waitcnt lgkmcnt(4)
  v_fma_f32 v116, v78, v140, v44
  v_fma_f32 v117, v78, v141, v45
  v_fma_f32 v118, v78, v142, v46
  v_fma_f32 v119, v78, v143, v47
  ds_read_b128 v[92:95], v5 offset:10240
  v_mfma_f32_32x32x16_bf16 v[12:27], v[100:103], a[8:11], v[12:27]
  s_waitcnt lgkmcnt(3)
  v_fma_f32 v120, v78, v148, v60
  v_fma_f32 v121, v78, v149, v61
  v_fma_f32 v122, v78, v150, v62
  v_fma_f32 v123, v78, v151, v63
  v_fma_f32 v116, v116, v79, v144
  ds_read_b128 v[96:99], v5 offset:11264
  v_mfma_f32_32x32x16_bf16 v[28:43], v[104:107], a[8:11], v[28:43]
  v_fma_f32 v117, v117, v79, v145
  v_fma_f32 v118, v118, v79, v146
  v_fma_f32 v119, v119, v79, v147
  s_waitcnt lgkmcnt(3)
  v_fma_f32 v120, v120, v79, v152
  ds_read_b128 v[100:103], v5 offset:12288
  v_mfma_f32_32x32x16_bf16 v[12:27], v[108:111], a[12:15], v[12:27]
  v_fma_f32 v121, v121, v79, v153
  v_fma_f32 v122, v122, v79, v154
  v_fma_f32 v123, v123, v79, v155
  v_mul_f32 v124, v116, v116
  ds_read_b128 v[104:107], v5 offset:13312
  v_mfma_f32_32x32x16_bf16 v[28:43], v[112:115], a[12:15], v[28:43]
  ds_read_b128 v[156:159], v77 offset:528
  v_mul_f32 v125, v117, v117
  ds_read_b128 v[160:163], v77 offset:656
  v_mul_f32 v126, v118, v118
  ds_read_b128 v[108:111], v5 offset:14336
  v_mfma_f32_32x32x16_bf16 v[12:27], v[84:87], a[16:19], v[12:27]
  ds_read_b128 v[164:167], v77 offset:784
  v_mul_f32 v127, v119, v119
  ds_read_b128 v[168:171], v77 offset:912
  v_fma_f32 v124, v124, v81, v80
  ds_read_b128 v[112:115], v5 offset:15360
  s_waitcnt lgkmcnt(10)
  v_mfma_f32_32x32x16_bf16 v[28:43], v[88:91], a[16:19], v[28:43]
  v_fma_f32 v125, v125, v81, v80
  v_fma_f32 v126, v126, v81, v80
  v_fma_f32 v127, v127, v81, v80
  v_mul_f32 v124, v116, v124
  v_mul_f32 v125, v117, v125
  ds_read_b128 v[84:87], v5 offset:16384
  s_waitcnt lgkmcnt(10)
  v_mfma_f32_32x32x16_bf16 v[12:27], v[92:95], a[20:23], v[12:27]
  v_mul_f32 v126, v118, v126
  v_mul_f32 v127, v119, v127
  v_exp_f32 v124, v124
  ds_read_b128 v[88:91], v5 offset:17408
  s_waitcnt lgkmcnt(10)
  v_mfma_f32_32x32x16_bf16 v[28:43], v[96:99], a[20:23], v[28:43]
  v_mul_f32 v128, v116, v120
  v_exp_f32 v125, v125
  v_mul_f32 v129, v117, v121
  ds_read_b128 v[92:95], v5 offset:18432
  s_waitcnt lgkmcnt(10)
  v_mfma_f32_32x32x16_bf16 v[12:27], v[100:103], a[24:27], v[12:27]
  v_exp_f32 v126, v126
  v_mul_f32 v130, v118, v122
  v_exp_f32 v127, v127
  ds_read_b128 v[96:99], v5 offset:19456
  s_waitcnt lgkmcnt(10)
  v_mfma_f32_32x32x16_bf16 v[28:43], v[104:107], a[24:27], v[28:43]
  v_mul_f32 v131, v119, v123
  v_add_f32 v124, 1.0, v124
  v_add_f32 v125, 1.0, v125
  ds_read_b128 v[100:103], v5 offset:20480
  s_waitcnt lgkmcnt(8)
  v_mfma_f32_32x32x16_bf16 v[12:27], v[108:111], a[28:31], v[12:27]
  v_add_f32 v126, 1.0, v126
  v_add_f32 v127, 1.0, v127
  v_rcp_f32 v124, v124
  ds_read_b128 v[104:107], v5 offset:21504
  s_waitcnt lgkmcnt(6)
  v_mfma_f32_32x32x16_bf16 v[28:43], v[112:115], a[28:31], v[28:43]
  v_rcp_f32 v125, v125
  v_rcp_f32 v126, v126
  ds_read_b128 v[108:111], v5 offset:22528
  s_waitcnt lgkmcnt(6)
  v_mfma_f32_32x32x16_bf16 v[12:27], v[84:87], a[32:35], v[12:27]
  v_rcp_f32 v127, v127
  v_mul_f32 v128, v128, v124
  v_mul_f32 v129, v129, v125
  v_mul_f32 v130, v130, v126
  ds_read_b128 v[112:115], v5 offset:23552
  s_waitcnt lgkmcnt(6)
  v_mfma_f32_32x32x16_bf16 v[28:43], v[88:91], a[32:35], v[28:43]
  v_mul_f32 v131, v131, v127
  v_cvt_pk_bf16_f32 v132, v128, v129
  v_cvt_pk_bf16_f32 v133, v130, v131
  v_fma_f32 v116, v78, v156, v48
  ds_read_b128 v[84:87], v5 offset:24576
  s_waitcnt lgkmcnt(6)
  v_mfma_f32_32x32x16_bf16 v[12:27], v[92:95], a[36:39], v[12:27]
  v_fma_f32 v117, v78, v157, v49
  v_fma_f32 v118, v78, v158, v50
  v_fma_f32 v119, v78, v159, v51
  v_fma_f32 v120, v78, v164, v64
  v_fma_f32 v121, v78, v165, v65
  ds_read_b128 v[88:91], v5 offset:25600
  s_waitcnt lgkmcnt(6)
  v_mfma_f32_32x32x16_bf16 v[28:43], v[96:99], a[36:39], v[28:43]
  v_fma_f32 v122, v78, v166, v66
  v_fma_f32 v123, v78, v167, v67
  v_fma_f32 v116, v116, v79, v160
  v_fma_f32 v117, v117, v79, v161
  ds_read_b128 v[92:95], v5 offset:26624
  s_waitcnt lgkmcnt(6)
  v_mfma_f32_32x32x16_bf16 v[12:27], v[100:103], a[40:43], v[12:27]
  v_fma_f32 v118, v118, v79, v162
  v_fma_f32 v119, v119, v79, v163
  v_fma_f32 v120, v120, v79, v168
  v_fma_f32 v121, v121, v79, v169
  ds_read_b128 v[96:99], v5 offset:27648
  s_waitcnt lgkmcnt(6)
  v_mfma_f32_32x32x16_bf16 v[28:43], v[104:107], a[40:43], v[28:43]
  v_fma_f32 v122, v122, v79, v170
  v_fma_f32 v123, v123, v79, v171
  v_mul_f32 v124, v116, v116
  ds_read_b128 v[140:143], v77 offset:576
  ds_read_b128 v[100:103], v5 offset:28672
  s_waitcnt lgkmcnt(7)
  v_mfma_f32_32x32x16_bf16 v[12:27], v[108:111], a[44:47], v[12:27]
  v_mul_f32 v125, v117, v117
  ds_read_b128 v[144:147], v77 offset:704
  v_mul_f32 v126, v118, v118
  ds_read_b128 v[148:151], v77 offset:832
  ds_read_b128 v[104:107], v5 offset:29696
  s_waitcnt lgkmcnt(9)
  v_mfma_f32_32x32x16_bf16 v[28:43], v[112:115], a[44:47], v[28:43]
  v_mul_f32 v127, v119, v119
  ds_read_b128 v[152:155], v77 offset:960
  v_fma_f32 v124, v124, v81, v80
  v_fma_f32 v125, v125, v81, v80
  v_fma_f32 v126, v126, v81, v80
  ds_read_b128 v[108:111], v5 offset:30720
  s_waitcnt lgkmcnt(10)
  v_mfma_f32_32x32x16_bf16 v[12:27], v[84:87], a[48:51], v[12:27]
  v_fma_f32 v127, v127, v81, v80
  v_mul_f32 v124, v116, v124
  v_mul_f32 v125, v117, v125
  v_mul_f32 v126, v118, v126
  ds_read_b128 v[112:115], v5 offset:31744
  s_waitcnt lgkmcnt(10)
  v_mfma_f32_32x32x16_bf16 v[28:43], v[88:91], a[48:51], v[28:43]
  v_mul_f32 v127, v119, v127
  v_exp_f32 v124, v124
  v_mul_f32 v128, v116, v120
  s_waitcnt vmcnt(2)
  s_barrier
  ds_read_b128 v[84:87], v5 offset:32768
  s_waitcnt lgkmcnt(10)
  v_mfma_f32_32x32x16_bf16 v[12:27], v[92:95], a[52:55], v[12:27]
  v_exp_f32 v125, v125
  v_mul_f32 v129, v117, v121
  v_exp_f32 v126, v126
  ds_read_b128 v[88:91], v5 offset:33792
  s_waitcnt lgkmcnt(10)
  v_mfma_f32_32x32x16_bf16 v[28:43], v[96:99], a[52:55], v[28:43]
  v_mul_f32 v130, v118, v122
  v_exp_f32 v127, v127
  ds_read_b128 v[92:95], v5 offset:34816
  s_waitcnt lgkmcnt(9)
  v_mfma_f32_32x32x16_bf16 v[12:27], v[100:103], a[56:59], v[12:27]
  v_mul_f32 v131, v119, v123
  v_add_f32 v124, 1.0, v124
  v_add_f32 v125, 1.0, v125
  v_add_f32 v126, 1.0, v126
  v_add_f32 v127, 1.0, v127
  ds_read_b128 v[96:99], v5 offset:35840
  s_waitcnt lgkmcnt(7)
  v_mfma_f32_32x32x16_bf16 v[28:43], v[104:107], a[56:59], v[28:43]
  v_rcp_f32 v124, v124
  v_rcp_f32 v125, v125
  ds_read_b128 v[100:103], v5 offset:36864
  s_waitcnt lgkmcnt(6)
  v_mfma_f32_32x32x16_bf16 v[12:27], v[108:111], a[60:63], v[12:27]
  v_rcp_f32 v126, v126
  v_rcp_f32 v127, v127
  ds_read_b128 v[104:107], v5 offset:37888
  s_waitcnt lgkmcnt(6)
  v_mfma_f32_32x32x16_bf16 v[28:43], v[112:115], a[60:63], v[28:43]
  v_mul_f32 v128, v128, v124
  v_mul_f32 v129, v129, v125
  v_mul_f32 v130, v130, v126
  v_mul_f32 v131, v131, v127
  ds_read_b128 v[108:111], v5 offset:38912
  s_waitcnt lgkmcnt(6)
  v_mfma_f32_32x32x16_bf16 v[12:27], v[84:87], a[64:67], v[12:27]
  v_cvt_pk_bf16_f32 v134, v128, v129
  v_cvt_pk_bf16_f32 v135, v130, v131
  s_add_u32 s15, s54, 4096
  buffer_store_dwordx4 v[132:135], v5, s[40:43], s15 offen
  ds_read_b128 v[112:115], v5 offset:39936
  s_waitcnt lgkmcnt(6)
  v_mfma_f32_32x32x16_bf16 v[28:43], v[88:91], a[64:67], v[28:43]
  v_fma_f32 v116, v78, v140, v52
  v_fma_f32 v117, v78, v141, v53
  v_fma_f32 v118, v78, v142, v54
  v_fma_f32 v119, v78, v143, v55
  ds_read_b128 v[84:87], v5 offset:40960
  s_waitcnt lgkmcnt(6)
  v_mfma_f32_32x32x16_bf16 v[12:27], v[92:95], a[68:71], v[12:27]
  v_fma_f32 v120, v78, v148, v68
  v_fma_f32 v121, v78, v149, v69
  v_fma_f32 v122, v78, v150, v70
  v_fma_f32 v123, v78, v151, v71
  v_fma_f32 v116, v116, v79, v144
  ds_read_b128 v[88:91], v5 offset:41984
  s_waitcnt lgkmcnt(6)
  v_mfma_f32_32x32x16_bf16 v[28:43], v[96:99], a[68:71], v[28:43]
  v_fma_f32 v117, v117, v79, v145
  v_fma_f32 v118, v118, v79, v146
  v_fma_f32 v119, v119, v79, v147
  v_fma_f32 v120, v120, v79, v152
  ds_read_b128 v[92:95], v5 offset:43008
  s_waitcnt lgkmcnt(6)
  v_mfma_f32_32x32x16_bf16 v[12:27], v[100:103], a[72:75], v[12:27]
  v_fma_f32 v121, v121, v79, v153
  v_fma_f32 v122, v122, v79, v154
  v_fma_f32 v123, v123, v79, v155
  v_mul_f32 v124, v116, v116
  ds_read_b128 v[96:99], v5 offset:44032
  s_waitcnt lgkmcnt(6)
  v_mfma_f32_32x32x16_bf16 v[28:43], v[104:107], a[72:75], v[28:43]
  ds_read_b128 v[156:159], v77 offset:592
  v_mul_f32 v125, v117, v117
  ds_read_b128 v[160:163], v77 offset:720
  v_mul_f32 v126, v118, v118
  ds_read_b128 v[100:103], v5 offset:45056
  s_waitcnt lgkmcnt(8)
  v_mfma_f32_32x32x16_bf16 v[12:27], v[108:111], a[76:79], v[12:27]
  ds_read_b128 v[164:167], v77 offset:848
  v_mul_f32 v127, v119, v119
  ds_read_b128 v[168:171], v77 offset:976
  v_fma_f32 v124, v124, v81, v80
  ds_read_b128 v[104:107], v5 offset:46080
  s_waitcnt lgkmcnt(10)
  v_mfma_f32_32x32x16_bf16 v[28:43], v[112:115], a[76:79], v[28:43]
  v_fma_f32 v125, v125, v81, v80
  v_fma_f32 v126, v126, v81, v80
  v_fma_f32 v127, v127, v81, v80
  v_mul_f32 v124, v116, v124
  v_mul_f32 v125, v117, v125
  ds_read_b128 v[108:111], v5 offset:47104
  s_waitcnt lgkmcnt(10)
  v_mfma_f32_32x32x16_bf16 v[12:27], v[84:87], a[80:83], v[12:27]
  v_mul_f32 v126, v118, v126
  v_mul_f32 v127, v119, v127
  v_exp_f32 v124, v124
  ds_read_b128 v[112:115], v5 offset:48128
  s_waitcnt lgkmcnt(10)
  v_mfma_f32_32x32x16_bf16 v[28:43], v[88:91], a[80:83], v[28:43]
  v_mul_f32 v128, v116, v120
  v_exp_f32 v125, v125
  v_mul_f32 v129, v117, v121
  ds_read_b128 v[84:87], v5 offset:49152
  s_waitcnt lgkmcnt(10)
  v_mfma_f32_32x32x16_bf16 v[12:27], v[92:95], a[84:87], v[12:27]
  v_exp_f32 v126, v126
  v_mul_f32 v130, v118, v122
  v_exp_f32 v127, v127
  ds_read_b128 v[88:91], v5 offset:50176
  s_waitcnt lgkmcnt(10)
  v_mfma_f32_32x32x16_bf16 v[28:43], v[96:99], a[84:87], v[28:43]
  v_mul_f32 v131, v119, v123
  v_add_f32 v124, 1.0, v124
  v_add_f32 v125, 1.0, v125
  ds_read_b128 v[92:95], v5 offset:51200
  s_waitcnt lgkmcnt(8)
  v_mfma_f32_32x32x16_bf16 v[12:27], v[100:103], a[88:91], v[12:27]
  v_add_f32 v126, 1.0, v126
  v_add_f32 v127, 1.0, v127
  v_rcp_f32 v124, v124
  ds_read_b128 v[96:99], v5 offset:52224
  s_waitcnt lgkmcnt(6)
  v_mfma_f32_32x32x16_bf16 v[28:43], v[104:107], a[88:91], v[28:43]
  v_rcp_f32 v125, v125
  v_rcp_f32 v126, v126
  ds_read_b128 v[100:103], v5 offset:53248
  s_waitcnt lgkmcnt(6)
  v_mfma_f32_32x32x16_bf16 v[12:27], v[108:111], a[92:95], v[12:27]
  v_rcp_f32 v127, v127
  v_mul_f32 v128, v128, v124
  v_mul_f32 v129, v129, v125
  v_mul_f32 v130, v130, v126
  ds_read_b128 v[104:107], v5 offset:54272
  s_waitcnt lgkmcnt(6)
  v_mfma_f32_32x32x16_bf16 v[28:43], v[112:115], a[92:95], v[28:43]
  v_mul_f32 v131, v131, v127
  v_cvt_pk_bf16_f32 v136, v128, v129
  v_cvt_pk_bf16_f32 v137, v130, v131
  v_fma_f32 v116, v78, v156, v56
  ds_read_b128 v[108:111], v5 offset:55296
  s_waitcnt lgkmcnt(6)
  v_mfma_f32_32x32x16_bf16 v[12:27], v[84:87], a[96:99], v[12:27]
  v_fma_f32 v117, v78, v157, v57
  v_fma_f32 v118, v78, v158, v58
  v_fma_f32 v119, v78, v159, v59
  v_fma_f32 v120, v78, v164, v72
  v_fma_f32 v121, v78, v165, v73
  ds_read_b128 v[112:115], v5 offset:56320
  s_waitcnt lgkmcnt(6)
  v_mfma_f32_32x32x16_bf16 v[28:43], v[88:91], a[96:99], v[28:43]
  v_fma_f32 v122, v78, v166, v74
  v_fma_f32 v123, v78, v167, v75
  v_fma_f32 v116, v116, v79, v160
  v_fma_f32 v117, v117, v79, v161
  ds_read_b128 v[84:87], v5 offset:57344
  s_waitcnt lgkmcnt(6)
  v_mfma_f32_32x32x16_bf16 v[12:27], v[92:95], a[100:103], v[12:27]
  v_fma_f32 v118, v118, v79, v162
  v_fma_f32 v119, v119, v79, v163
  v_fma_f32 v120, v120, v79, v168
  v_fma_f32 v121, v121, v79, v169
  ds_read_b128 v[88:91], v5 offset:58368
  s_waitcnt lgkmcnt(6)
  v_mfma_f32_32x32x16_bf16 v[28:43], v[96:99], a[100:103], v[28:43]
  v_fma_f32 v122, v122, v79, v170
  v_fma_f32 v123, v123, v79, v171
  v_mul_f32 v124, v116, v116
  v_mul_f32 v125, v117, v117
  ds_read_b128 v[92:95], v5 offset:59392
  s_waitcnt lgkmcnt(6)
  v_mfma_f32_32x32x16_bf16 v[12:27], v[100:103], a[104:107], v[12:27]
  v_mul_f32 v126, v118, v118
  v_mul_f32 v127, v119, v119
  v_fma_f32 v124, v124, v81, v80
  v_fma_f32 v125, v125, v81, v80
  ds_read_b128 v[96:99], v5 offset:60416
  s_waitcnt lgkmcnt(6)
  v_mfma_f32_32x32x16_bf16 v[28:43], v[104:107], a[104:107], v[28:43]
  v_fma_f32 v126, v126, v81, v80
  v_fma_f32 v127, v127, v81, v80
  v_mul_f32 v124, v116, v124
  v_mul_f32 v125, v117, v125
  v_mul_f32 v126, v118, v126
  ds_read_b128 v[100:103], v5 offset:61440
  s_waitcnt lgkmcnt(6)
  v_mfma_f32_32x32x16_bf16 v[12:27], v[108:111], a[108:111], v[12:27]
  v_mul_f32 v127, v119, v127
  v_exp_f32 v124, v124
  v_mul_f32 v128, v116, v120
  ds_read_b128 v[104:107], v5 offset:62464
  s_waitcnt lgkmcnt(6)
  v_mfma_f32_32x32x16_bf16 v[28:43], v[112:115], a[108:111], v[28:43]
  v_exp_f32 v125, v125
  v_mul_f32 v129, v117, v121
  ds_read_b128 v[108:111], v5 offset:63488
  s_waitcnt lgkmcnt(6)
  v_mfma_f32_32x32x16_bf16 v[12:27], v[84:87], a[112:115], v[12:27]
  v_exp_f32 v126, v126
  v_mul_f32 v130, v118, v122
  v_exp_f32 v127, v127
  ds_read_b128 v[112:115], v5 offset:64512
  s_waitcnt lgkmcnt(6)
  v_mfma_f32_32x32x16_bf16 v[28:43], v[88:91], a[112:115], v[28:43]
  v_mul_f32 v131, v119, v123
  v_add_f32 v124, 1.0, v124
  v_add_f32 v125, 1.0, v125
  v_add_f32 v126, 1.0, v126
  s_waitcnt lgkmcnt(5)
  v_mfma_f32_32x32x16_bf16 v[12:27], v[92:95], a[116:119], v[12:27]
  v_add_f32 v127, 1.0, v127
  v_rcp_f32 v124, v124
  v_rcp_f32 v125, v125
  s_waitcnt lgkmcnt(4)
  v_mfma_f32_32x32x16_bf16 v[28:43], v[96:99], a[116:119], v[28:43]
  v_rcp_f32 v126, v126
  v_rcp_f32 v127, v127
  s_waitcnt lgkmcnt(3)
  v_mfma_f32_32x32x16_bf16 v[12:27], v[100:103], a[120:123], v[12:27]
  v_mul_f32 v128, v128, v124
  v_mul_f32 v129, v129, v125
  v_mul_f32 v130, v130, v126
  v_mul_f32 v131, v131, v127
  s_waitcnt lgkmcnt(2)
  v_mfma_f32_32x32x16_bf16 v[28:43], v[104:107], a[120:123], v[28:43]
  v_cvt_pk_bf16_f32 v138, v128, v129
  v_cvt_pk_bf16_f32 v139, v130, v131
  s_add_u32 s15, s54, 6144
  buffer_store_dwordx4 v[136:139], v5, s[40:43], s15 offen
  s_waitcnt lgkmcnt(1)
  v_mfma_f32_32x32x16_bf16 v[12:27], v[108:111], a[124:127], v[12:27]
  s_waitcnt lgkmcnt(0)
  v_mfma_f32_32x32x16_bf16 v[28:43], v[112:115], a[124:127], v[28:43]
  ds_read_b128 v[140:143], v77 offset:1024
  ds_read_b128 v[144:147], v77 offset:1152
  ds_read_b128 v[148:151], v77 offset:1280
  ds_read_b128 v[152:155], v77 offset:1408
  s_waitcnt lgkmcnt(3)
  s_nop 4
  v_fma_f32 v116, v78, v140, v12
  v_fma_f32 v117, v78, v141, v13
  v_fma_f32 v118, v78, v142, v14
  v_fma_f32 v119, v78, v143, v15
  s_waitcnt lgkmcnt(1)
  v_fma_f32 v120, v78, v148, v28
  v_fma_f32 v121, v78, v149, v29
  v_fma_f32 v122, v78, v150, v30
  v_fma_f32 v123, v78, v151, v31
  v_fma_f32 v116, v116, v79, v144
  v_fma_f32 v117, v117, v79, v145
  v_fma_f32 v118, v118, v79, v146
  v_fma_f32 v119, v119, v79, v147
  s_waitcnt lgkmcnt(0)
  v_fma_f32 v120, v120, v79, v152
  v_fma_f32 v121, v121, v79, v153
  v_fma_f32 v122, v122, v79, v154
  v_fma_f32 v123, v123, v79, v155
  v_mul_f32 v124, v116, v116
  ds_read_b128 v[156:159], v77 offset:1040
  v_mul_f32 v125, v117, v117
  ds_read_b128 v[160:163], v77 offset:1168
  v_mul_f32 v126, v118, v118
  ds_read_b128 v[164:167], v77 offset:1296
  v_mul_f32 v127, v119, v119
  ds_read_b128 v[168:171], v77 offset:1424
  v_fma_f32 v124, v124, v81, v80
  v_fma_f32 v125, v125, v81, v80
  v_fma_f32 v126, v126, v81, v80
  v_fma_f32 v127, v127, v81, v80
  v_mul_f32 v124, v116, v124
  v_mul_f32 v125, v117, v125
  v_mul_f32 v126, v118, v126
  v_mul_f32 v127, v119, v127
  v_exp_f32 v124, v124
  v_mul_f32 v128, v116, v120
  v_exp_f32 v125, v125
  v_mul_f32 v129, v117, v121
  v_exp_f32 v126, v126
  v_mul_f32 v130, v118, v122
  v_exp_f32 v127, v127
  v_mul_f32 v131, v119, v123
  v_add_f32 v124, 1.0, v124
  v_add_f32 v125, 1.0, v125
  v_add_f32 v126, 1.0, v126
  v_add_f32 v127, 1.0, v127
  v_rcp_f32 v124, v124
  v_rcp_f32 v125, v125
  v_rcp_f32 v126, v126
  v_rcp_f32 v127, v127
  v_mul_f32 v128, v128, v124
  v_mul_f32 v129, v129, v125
  v_mul_f32 v130, v130, v126
  v_mul_f32 v131, v131, v127
  v_cvt_pk_bf16_f32 v132, v128, v129
  v_cvt_pk_bf16_f32 v133, v130, v131
  s_waitcnt lgkmcnt(3)
  v_fma_f32 v116, v78, v156, v16
  v_fma_f32 v117, v78, v157, v17
  v_fma_f32 v118, v78, v158, v18
  v_fma_f32 v119, v78, v159, v19
  s_waitcnt lgkmcnt(1)
  v_fma_f32 v120, v78, v164, v32
  v_fma_f32 v121, v78, v165, v33
  v_fma_f32 v122, v78, v166, v34
  v_fma_f32 v123, v78, v167, v35
  v_fma_f32 v116, v116, v79, v160
  v_fma_f32 v117, v117, v79, v161
  v_fma_f32 v118, v118, v79, v162
  v_fma_f32 v119, v119, v79, v163
  s_waitcnt lgkmcnt(0)
  v_fma_f32 v120, v120, v79, v168
  v_fma_f32 v121, v121, v79, v169
  v_fma_f32 v122, v122, v79, v170
  v_fma_f32 v123, v123, v79, v171
  v_mul_f32 v124, v116, v116
  ds_read_b128 v[140:143], v77 offset:1088
  v_mul_f32 v125, v117, v117
  ds_read_b128 v[144:147], v77 offset:1216
  v_mul_f32 v126, v118, v118
  ds_read_b128 v[148:151], v77 offset:1344
  v_mul_f32 v127, v119, v119
  ds_read_b128 v[152:155], v77 offset:1472
  v_fma_f32 v124, v124, v81, v80
  v_fma_f32 v125, v125, v81, v80
  v_fma_f32 v126, v126, v81, v80
  v_fma_f32 v127, v127, v81, v80
  v_mul_f32 v124, v116, v124
  v_mul_f32 v125, v117, v125
  v_mul_f32 v126, v118, v126
  v_mul_f32 v127, v119, v127
  v_exp_f32 v124, v124
  v_mul_f32 v128, v116, v120
  v_exp_f32 v125, v125
  v_mul_f32 v129, v117, v121
  v_exp_f32 v126, v126
  v_mul_f32 v130, v118, v122
  v_exp_f32 v127, v127
  v_mul_f32 v131, v119, v123
  v_add_f32 v124, 1.0, v124
  v_add_f32 v125, 1.0, v125
  v_add_f32 v126, 1.0, v126
  v_add_f32 v127, 1.0, v127
  v_rcp_f32 v124, v124
  v_rcp_f32 v125, v125
  v_rcp_f32 v126, v126
  v_rcp_f32 v127, v127
  v_mul_f32 v128, v128, v124
  v_mul_f32 v129, v129, v125
  v_mul_f32 v130, v130, v126
  v_mul_f32 v131, v131, v127
  v_cvt_pk_bf16_f32 v134, v128, v129
  v_cvt_pk_bf16_f32 v135, v130, v131
  s_add_u32 s15, s54, 8192
  buffer_store_dwordx4 v[132:135], v5, s[40:43], s15 offen
  s_waitcnt lgkmcnt(3)
  v_fma_f32 v116, v78, v140, v20
  v_fma_f32 v117, v78, v141, v21
  v_fma_f32 v118, v78, v142, v22
  v_fma_f32 v119, v78, v143, v23
  s_waitcnt lgkmcnt(1)
  v_fma_f32 v120, v78, v148, v36
  v_fma_f32 v121, v78, v149, v37
  v_fma_f32 v122, v78, v150, v38
  v_fma_f32 v123, v78, v151, v39
  v_fma_f32 v116, v116, v79, v144
  v_fma_f32 v117, v117, v79, v145
  v_fma_f32 v118, v118, v79, v146
  v_fma_f32 v119, v119, v79, v147
  s_waitcnt lgkmcnt(0)
  v_fma_f32 v120, v120, v79, v152
  v_fma_f32 v121, v121, v79, v153
  v_fma_f32 v122, v122, v79, v154
  v_fma_f32 v123, v123, v79, v155
  v_mul_f32 v124, v116, v116
  ds_read_b128 v[156:159], v77 offset:1104
  v_mul_f32 v125, v117, v117
  ds_read_b128 v[160:163], v77 offset:1232
  v_mul_f32 v126, v118, v118
  ds_read_b128 v[164:167], v77 offset:1360
  v_mul_f32 v127, v119, v119
  ds_read_b128 v[168:171], v77 offset:1488
  v_fma_f32 v124, v124, v81, v80
  v_fma_f32 v125, v125, v81, v80
  v_fma_f32 v126, v126, v81, v80
  v_fma_f32 v127, v127, v81, v80
  v_mul_f32 v124, v116, v124
  v_mul_f32 v125, v117, v125
  v_mul_f32 v126, v118, v126
  v_mul_f32 v127, v119, v127
  v_exp_f32 v124, v124
  v_mul_f32 v128, v116, v120
  v_exp_f32 v125, v125
  v_mul_f32 v129, v117, v121
  v_exp_f32 v126, v126
  v_mul_f32 v130, v118, v122
  v_exp_f32 v127, v127
  v_mul_f32 v131, v119, v123
  v_add_f32 v124, 1.0, v124
  v_add_f32 v125, 1.0, v125
  v_add_f32 v126, 1.0, v126
  v_add_f32 v127, 1.0, v127
  v_rcp_f32 v124, v124
  v_rcp_f32 v125, v125
  v_rcp_f32 v126, v126
  v_rcp_f32 v127, v127
  v_mul_f32 v128, v128, v124
  v_mul_f32 v129, v129, v125
  v_mul_f32 v130, v130, v126
  v_mul_f32 v131, v131, v127
  v_cvt_pk_bf16_f32 v136, v128, v129
  v_cvt_pk_bf16_f32 v137, v130, v131
  s_waitcnt lgkmcnt(3)
  v_fma_f32 v116, v78, v156, v24
  v_fma_f32 v117, v78, v157, v25
  v_fma_f32 v118, v78, v158, v26
  v_fma_f32 v119, v78, v159, v27
  s_waitcnt lgkmcnt(1)
  v_fma_f32 v120, v78, v164, v40
  v_fma_f32 v121, v78, v165, v41
  v_fma_f32 v122, v78, v166, v42
  v_fma_f32 v123, v78, v167, v43
  v_fma_f32 v116, v116, v79, v160
  v_fma_f32 v117, v117, v79, v161
  v_fma_f32 v118, v118, v79, v162
  v_fma_f32 v119, v119, v79, v163
  s_waitcnt lgkmcnt(0)
  v_fma_f32 v120, v120, v79, v168
  v_fma_f32 v121, v121, v79, v169
  v_fma_f32 v122, v122, v79, v170
  v_fma_f32 v123, v123, v79, v171
  v_mul_f32 v124, v116, v116
  v_mul_f32 v125, v117, v117
  v_mul_f32 v126, v118, v118
  v_mul_f32 v127, v119, v119
  v_fma_f32 v124, v124, v81, v80
  v_fma_f32 v125, v125, v81, v80
  v_fma_f32 v126, v126, v81, v80
  v_fma_f32 v127, v127, v81, v80
  v_mul_f32 v124, v116, v124
  v_mul_f32 v125, v117, v125
  v_mul_f32 v126, v118, v126
  v_mul_f32 v127, v119, v127
  v_exp_f32 v124, v124
  v_mul_f32 v128, v116, v120
  v_exp_f32 v125, v125
  v_mul_f32 v129, v117, v121
  v_exp_f32 v126, v126
  v_mul_f32 v130, v118, v122
  v_exp_f32 v127, v127
  v_mul_f32 v131, v119, v123
  v_add_f32 v124, 1.0, v124
  v_add_f32 v125, 1.0, v125
  v_add_f32 v126, 1.0, v126
  v_add_f32 v127, 1.0, v127
  v_rcp_f32 v124, v124
  v_rcp_f32 v125, v125
  v_rcp_f32 v126, v126
  v_rcp_f32 v127, v127
  v_mul_f32 v128, v128, v124
  v_mul_f32 v129, v129, v125
  v_mul_f32 v130, v130, v126
  v_mul_f32 v131, v131, v127
  v_cvt_pk_bf16_f32 v138, v128, v129
  v_cvt_pk_bf16_f32 v139, v130, v131
  s_add_u32 s15, s54, 10240
  buffer_store_dwordx4 v[136:139], v5, s[40:43], s15 offen
  s_branch k4_end3
k4_t22:
  s_waitcnt lgkmcnt(0)
  ds_read_b128 v[140:143], v77 offset:512
  ds_read_b128 v[144:147], v77 offset:640
  ds_read_b128 v[148:151], v77 offset:768
  ds_read_b128 v[152:155], v77 offset:896
  s_waitcnt lgkmcnt(3)
  s_nop 0
  v_fma_f32 v116, v78, v140, v44
  v_fma_f32 v117, v78, v141, v45
  v_fma_f32 v118, v78, v142, v46
  v_fma_f32 v119, v78, v143, v47
  s_waitcnt lgkmcnt(1)
  v_fma_f32 v120, v78, v148, v60
  v_fma_f32 v121, v78, v149, v61
  v_fma_f32 v122, v78, v150, v62
  v_fma_f32 v123, v78, v151, v63
  v_fma_f32 v116, v116, v79, v144
  v_fma_f32 v117, v117, v79, v145
  v_fma_f32 v118, v118, v79, v146
  v_fma_f32 v119, v119, v79, v147
  s_waitcnt lgkmcnt(0)
  v_fma_f32 v120, v120, v79, v152
  v_fma_f32 v121, v121, v79, v153
  v_fma_f32 v122, v122, v79, v154
  v_fma_f32 v123, v123, v79, v155
  v_mul_f32 v124, v116, v116
  ds_read_b128 v[156:159], v77 offset:528
  v_mul_f32 v125, v117, v117
  ds_read_b128 v[160:163], v77 offset:656
  v_mul_f32 v126, v118, v118
  ds_read_b128 v[164:167], v77 offset:784
  v_mul_f32 v127, v119, v119
  ds_read_b128 v[168:171], v77 offset:912
  v_fma_f32 v124, v124, v81, v80
  v_fma_f32 v125, v125, v81, v80
  v_fma_f32 v126, v126, v81, v80
  v_fma_f32 v127, v127, v81, v80
  v_mul_f32 v124, v116, v124
  v_mul_f32 v125, v117, v125
  v_mul_f32 v126, v118, v126
  v_mul_f32 v127, v119, v127
  v_exp_f32 v124, v124
  v_mul_f32 v128, v116, v120
  v_exp_f32 v125, v125
  v_mul_f32 v129, v117, v121
  v_exp_f32 v126, v126
  v_mul_f32 v130, v118, v122
  v_exp_f32 v127, v127
  v_mul_f32 v131, v119, v123
  v_add_f32 v124, 1.0, v124
  v_add_f32 v125, 1.0, v125
  v_add_f32 v126, 1.0, v126
  v_add_f32 v127, 1.0, v127
  v_rcp_f32 v124, v124
  v_rcp_f32 v125, v125
  v_rcp_f32 v126, v126
  v_rcp_f32 v127, v127
  v_mul_f32 v128, v128, v124
  v_mul_f32 v129, v129, v125
  v_mul_f32 v130, v130, v126
  v_mul_f32 v131, v131, v127
  v_cvt_pk_bf16_f32 v132, v128, v129
  v_cvt_pk_bf16_f32 v133, v130, v131
  s_waitcnt lgkmcnt(3)
  v_fma_f32 v116, v78, v156, v48
  v_fma_f32 v117, v78, v157, v49
  v_fma_f32 v118, v78, v158, v50
  v_fma_f32 v119, v78, v159, v51
  s_waitcnt lgkmcnt(1)
  v_fma_f32 v120, v78, v164, v64
  v_fma_f32 v121, v78, v165, v65
  v_fma_f32 v122, v78, v166, v66
  v_fma_f32 v123, v78, v167, v67
  v_fma_f32 v116, v116, v79, v160
  v_fma_f32 v117, v117, v79, v161
  v_fma_f32 v118, v118, v79, v162
  v_fma_f32 v119, v119, v79, v163
  s_waitcnt lgkmcnt(0)
  v_fma_f32 v120, v120, v79, v168
  v_fma_f32 v121, v121, v79, v169
  v_fma_f32 v122, v122, v79, v170
  v_fma_f32 v123, v123, v79, v171
  v_mul_f32 v124, v116, v116
  ds_read_b128 v[140:143], v77 offset:576
  v_mul_f32 v125, v117, v117
  ds_read_b128 v[144:147], v77 offset:704
  v_mul_f32 v126, v118, v118
  ds_read_b128 v[148:151], v77 offset:832
  v_mul_f32 v127, v119, v119
  ds_read_b128 v[152:155], v77 offset:960
  v_fma_f32 v124, v124, v81, v80
  v_fma_f32 v125, v125, v81, v80
  v_fma_f32 v126, v126, v81, v80
  v_fma_f32 v127, v127, v81, v80
  v_mul_f32 v124, v116, v124
  v_mul_f32 v125, v117, v125
  v_mul_f32 v126, v118, v126
  v_mul_f32 v127, v119, v127
  v_exp_f32 v124, v124
  v_mul_f32 v128, v116, v120
  v_exp_f32 v125, v125
  v_mul_f32 v129, v117, v121
  v_exp_f32 v126, v126
  v_mul_f32 v130, v118, v122
  v_exp_f32 v127, v127
  v_mul_f32 v131, v119, v123
  v_add_f32 v124, 1.0, v124
  v_add_f32 v125, 1.0, v125
  v_add_f32 v126, 1.0, v126
  v_add_f32 v127, 1.0, v127
  v_rcp_f32 v124, v124
  v_rcp_f32 v125, v125
  v_rcp_f32 v126, v126
  v_rcp_f32 v127, v127
  v_mul_f32 v128, v128, v124
  v_mul_f32 v129, v129, v125
  v_mul_f32 v130, v130, v126
  v_mul_f32 v131, v131, v127
  v_cvt_pk_bf16_f32 v134, v128, v129
  v_cvt_pk_bf16_f32 v135, v130, v131
  s_add_u32 s15, s54, 4096
  buffer_store_dwordx4 v[132:135], v5, s[40:43], s15 offen
  s_waitcnt lgkmcnt(3)
  v_fma_f32 v116, v78, v140, v52
  v_fma_f32 v117, v78, v141, v53
  v_fma_f32 v118, v78, v142, v54
  v_fma_f32 v119, v78, v143, v55
  s_waitcnt lgkmcnt(1)
  v_fma_f32 v120, v78, v148, v68
  v_fma_f32 v121, v78, v149, v69
  v_fma_f32 v122, v78, v150, v70
  v_fma_f32 v123, v78, v151, v71
  v_fma_f32 v116, v116, v79, v144
  v_fma_f32 v117, v117, v79, v145
  v_fma_f32 v118, v118, v79, v146
  v_fma_f32 v119, v119, v79, v147
  s_waitcnt lgkmcnt(0)
  v_fma_f32 v120, v120, v79, v152
  v_fma_f32 v121, v121, v79, v153
  v_fma_f32 v122, v122, v79, v154
  v_fma_f32 v123, v123, v79, v155
  v_mul_f32 v124, v116, v116
  ds_read_b128 v[156:159], v77 offset:592
  v_mul_f32 v125, v117, v117
  ds_read_b128 v[160:163], v77 offset:720
  v_mul_f32 v126, v118, v118
  ds_read_b128 v[164:167], v77 offset:848
  v_mul_f32 v127, v119, v119
  ds_read_b128 v[168:171], v77 offset:976
  v_fma_f32 v124, v124, v81, v80
  v_fma_f32 v125, v125, v81, v80
  v_fma_f32 v126, v126, v81, v80
  v_fma_f32 v127, v127, v81, v80
  v_mul_f32 v124, v116, v124
  v_mul_f32 v125, v117, v125
  v_mul_f32 v126, v118, v126
  v_mul_f32 v127, v119, v127
  v_exp_f32 v124, v124
  v_mul_f32 v128, v116, v120
  v_exp_f32 v125, v125
  v_mul_f32 v129, v117, v121
  v_exp_f32 v126, v126
  v_mul_f32 v130, v118, v122
  v_exp_f32 v127, v127
  v_mul_f32 v131, v119, v123
  v_add_f32 v124, 1.0, v124
  v_add_f32 v125, 1.0, v125
  v_add_f32 v126, 1.0, v126
  v_add_f32 v127, 1.0, v127
  v_rcp_f32 v124, v124
  v_rcp_f32 v125, v125
  v_rcp_f32 v126, v126
  v_rcp_f32 v127, v127
  v_mul_f32 v128, v128, v124
  v_mul_f32 v129, v129, v125
  v_mul_f32 v130, v130, v126
  v_mul_f32 v131, v131, v127
  v_cvt_pk_bf16_f32 v136, v128, v129
  v_cvt_pk_bf16_f32 v137, v130, v131
  s_waitcnt lgkmcnt(3)
  v_fma_f32 v116, v78, v156, v56
  v_fma_f32 v117, v78, v157, v57
  v_fma_f32 v118, v78, v158, v58
  v_fma_f32 v119, v78, v159, v59
  s_waitcnt lgkmcnt(1)
  v_fma_f32 v120, v78, v164, v72
  v_fma_f32 v121, v78, v165, v73
  v_fma_f32 v122, v78, v166, v74
  v_fma_f32 v123, v78, v167, v75
  v_fma_f32 v116, v116, v79, v160
  v_fma_f32 v117, v117, v79, v161
  v_fma_f32 v118, v118, v79, v162
  v_fma_f32 v119, v119, v79, v163
  s_waitcnt lgkmcnt(0)
  v_fma_f32 v120, v120, v79, v168
  v_fma_f32 v121, v121, v79, v169
  v_fma_f32 v122, v122, v79, v170
  v_fma_f32 v123, v123, v79, v171
  v_mul_f32 v124, v116, v116
  v_mul_f32 v125, v117, v117
  v_mul_f32 v126, v118, v118
  v_mul_f32 v127, v119, v119
  v_fma_f32 v124, v124, v81, v80
  v_fma_f32 v125, v125, v81, v80
  v_fma_f32 v126, v126, v81, v80
  v_fma_f32 v127, v127, v81, v80
  v_mul_f32 v124, v116, v124
  v_mul_f32 v125, v117, v125
  v_mul_f32 v126, v118, v126
  v_mul_f32 v127, v119, v127
  v_exp_f32 v124, v124
  v_mul_f32 v128, v116, v120
  v_exp_f32 v125, v125
  v_mul_f32 v129, v117, v121
  v_exp_f32 v126, v126
  v_mul_f32 v130, v118, v122
  v_exp_f32 v127, v127
  v_mul_f32 v131, v119, v123
  v_add_f32 v124, 1.0, v124
  v_add_f32 v125, 1.0, v125
  v_add_f32 v126, 1.0, v126
  v_add_f32 v127, 1.0, v127
  v_rcp_f32 v124, v124
  v_rcp_f32 v125, v125
  v_rcp_f32 v126, v126
  v_rcp_f32 v127, v127
  v_mul_f32 v128, v128, v124
  v_mul_f32 v129, v129, v125
  v_mul_f32 v130, v130, v126
  v_mul_f32 v131, v131, v127
  v_cvt_pk_bf16_f32 v138, v128, v129
  v_cvt_pk_bf16_f32 v139, v130, v131
  s_add_u32 s15, s54, 6144
  buffer_store_dwordx4 v[136:139], v5, s[40:43], s15 offen
k4_end3:
  s_waitcnt vmcnt(0)
  s_endpgm
.text
.globl k5_kernel
.p2align 8
.type k5_kernel,@function
k5_kernel:
  s_cmp_lt_u32 s2, 256
  s_cbranch_scc1 k5_go1
  s_endpgm
k5_go1:
  s_load_dwordx2 s[4:5], s[0:1], 64
  s_load_dwordx2 s[6:7], s[0:1], 104
  s_load_dwordx2 s[8:9], s[0:1], 88
  v_and_b32 v1, 63, v0
  v_lshrrev_b32 v2, 6, v0
  s_nop 0
  v_readfirstlane_b32 s10, v2
  s_and_b32 s13, s2, 7
  s_lshr_b32 s14, s2, 3
  s_lshr_b32 s11, s13, 1
  s_lshl_b32 s11, s11, 3
  s_lshr_b32 s12, s14, 2
  s_add_u32 s11, s11, s12
  s_and_b32 s12, s13, 1
  s_lshl_b32 s12, s12, 2
  s_and_b32 s14, s14, 3
  s_add_u32 s12, s12, s14
  s_waitcnt lgkmcnt(0)
  s_mov_b32 s16, s4
  s_mov_b32 s17, s5
  s_mov_b32 s18, 1409024
  s_mov_b32 s19, 0x20000
  s_add_u32 s20, s6, 8388608
  s_addc_u32 s21, s7, 0
  s_mov_b32 s22, 5636096
  s_mov_b32 s23, 0x20000
  s_add_u32 s32, s6, 75776
  s_addc_u32 s33, s7, 0
  s_mov_b32 s34, 2048
  s_mov_b32 s35, 0x20000
  s_add_u32 s24, s6, 3145728
  s_addc_u32 s25, s7, 0
  s_mov_b32 s26, 2097152
  s_mov_b32 s27, 0x20000
  s_mov_b32 s28, s8
  s_mov_b32 s29, s9
  s_mov_b32 s30, 2097152
  s_mov_b32 s31, 0x20000
  s_mul_i32 s36, s10, 22
  s_cmp_eq_u32 s10, 3
  s_cselect_b32 s13, 1, 0
  s_sub_u32 s36, s36, s13
  v_lshlrev_b32 v3, 4, v1
  s_mul_i32 s37, s11, 176128
  s_lshl_b32 s13, s36, 11
  s_add_u32 s37, s37, s13
  v_lshrrev_b32 v4, 3, v1
  v_lshlrev_b32 v4, 10, v4
  v_bfe_u32 v2, v1, 4, 1
  v_lshlrev_b32 v2, 2, v2
  v_xor_b32 v2, v2, v1
  v_and_b32 v2, 7, v2
  v_lshl_add_u32 v4, v2, 4, v4
  s_lshl_b32 s38, s36, 14
  s_lshl_b32 s13, s12, 7
  s_add_u32 s38, s38, s13
  s_lshl_b32 s39, s10, 15
  v_lshrrev_b32 v5, 5, v1
  v_lshlrev_b32 v5, 10, v5
  v_bfe_u32 v2, v1, 2, 2
  v_lshl_add_u32 v5, v2, 7, v5
  v_bfe_u32 v2, v1, 4, 1
  v_lshl_add_u32 v5, v2, 5, v5
  v_and_b32 v2, 1, v1
  v_lshl_add_u32 v5, v2, 4, v5
  v_bfe_u32 v2, v1, 1, 1
  v_lshl_add_u32 v5, v2, 3, v5
  v_add_u32 v5, s39, v5
  v_bfe_u32 v2, v1, 3, 1
  v_lshlrev_b32 v2, 6, v2
  v_xor_b32 v6, 64, v2
  v_add_u32 v6, v5, v6
  v_add_u32 v5, v5, v2
  v_lshlrev_b32 v7, 7, v1
  v_lshlrev_b32 v8, 10, v1
  s_and_b32 s13, s12, 3
  s_lshl_b32 s13, s13, 13
  s_add_u32 s40, s37, s13
  s_and_b32 s13, s11, 7
  s_lshl_b32 s13, s13, 16
  s_add_u32 s41, s38, s13
  s_lshr_b32 s42, s10, 1
  s_and_b32 s43, s10, 1
  v_lshrrev_b32 v9, 5, v1
  v_and_b32 v10, 31, v1
  s_lshl_b32 s44, s12, 6
  s_lshl_b32 s13, s42, 5
  s_add_u32 s44, s44, s13
  s_lshl_b32 s13, s11, 6
  s_lshl_b32 s14, s43, 5
  s_add_u32 s13, s13, s14
  s_mov_b32 s45, s13
  v_add_u32 v11, s13, v10
  v_lshlrev_b32 v11, 10, v11
  v_lshl_add_u32 v11, v9, 4, v11
  s_lshl_b32 s14, s44, 1
  v_add_u32 v11, s14, v11
  s_lshl_b32 s13, s45, 10
  s_lshl_b32 s14, s44, 6
  s_add_u32 s13, s13, s14
  v_add_u32 v12, s13, v3
  s_lshl_b32 s13, s44, 2
  v_lshlrev_b32 v13, 5, v9
  v_add_u32 v13, s13, v13
  s_add_u32 m0, s39, 0
  s_add_u32 s14, s38, 8192
  buffer_load_dwordx4 v4, s[16:19], s38 offen lds
  s_add_u32 m0, s39, 1024
  s_nop 0
  buffer_load_dwordx4 v4, s[16:19], s14 offen lds
  buffer_load_dwordx4 v[104:107], v3, s[20:23], s37 offen offset:0
  buffer_load_dwordx4 v[108:111], v3, s[20:23], s37 offen offset:1024
  s_add_u32 s38, s38, 16384
  s_add_u32 s37, s37, 2048
  s_add_u32 m0, s39, 2048
  s_add_u32 s14, s38, 8192
  buffer_load_dwordx4 v4, s[16:19], s38 offen lds
  s_add_u32 m0, s39, 3072
  s_nop 0
  buffer_load_dwordx4 v4, s[16:19], s14 offen lds
  buffer_load_dwordx4 v[112:115], v3, s[20:23], s37 offen offset:0
  buffer_load_dwordx4 v[116:119], v3, s[20:23], s37 offen offset:1024
  s_add_u32 s38, s38, 16384
  s_add_u32 s37, s37, 2048
  s_add_u32 m0, s39, 4096
  s_add_u32 s14, s38, 8192
  buffer_load_dwordx4 v4, s[16:19], s38 offen lds
  s_add_u32 m0, s39, 5120
  s_nop 0
  buffer_load_dwordx4 v4, s[16:19], s14 offen lds
  buffer_load_dwordx4 v[120:123], v3, s[20:23], s37 offen offset:0
  buffer_load_dwordx4 v[124:127], v3, s[20:23], s37 offen offset:1024
  s_add_u32 s38, s38, 16384
  s_add_u32 s37, s37, 2048
  s_waitcnt vmcnt(10)
  ds_read_b64_tr_b16 v[232:233], v5 offset:0
  ds_read_b64_tr_b16 v[234:235], v5 offset:512
  ds_read_b64_tr_b16 v[236:237], v6 offset:0
  ds_read_b64_tr_b16 v[238:239], v6 offset:512
  s_add_u32 m0, s39, 6144
  s_add_u32 s14, s38, 8192
  buffer_load_dwordx4 v4, s[16:19], s38 offen lds
  s_add_u32 m0, s39, 7168
  s_nop 0
  buffer_load_dwordx4 v4, s[16:19], s14 offen lds
  buffer_load_dwordx4 v[128:131], v3, s[20:23], s37 offen offset:0
  buffer_load_dwordx4 v[132:135], v3, s[20:23], s37 offen offset:1024
  s_add_u32 s38, s38, 16384
  s_add_u32 s37, s37, 2048
  s_add_u32 m0, s39, 8192
  s_add_u32 s14, s38, 8192
  buffer_load_dwordx4 v4, s[16:19], s38 offen lds
  s_add_u32 m0, s39, 9216
  s_nop 0
  buffer_load_dwordx4 v4, s[16:19], s14 offen lds
  buffer_load_dwordx4 v[136:139], v3, s[20:23], s37 offen offset:0
  buffer_load_dwordx4 v[140:143], v3, s[20:23], s37 offen offset:1024
  s_add_u32 s38, s38, 16384
  s_add_u32 s37, s37, 2048
  s_add_u32 m0, s39, 10240
  s_add_u32 s14, s38, 8192
  buffer_load_dwordx4 v4, s[16:19], s38 offen lds
  s_add_u32 m0, s39, 11264
  s_nop 0
  buffer_load_dwordx4 v4, s[16:19], s14 offen lds
  buffer_load_dwordx4 v[144:147], v3, s[20:23], s37 offen offset:0
  buffer_load_dwordx4 v[148:151], v3, s[20:23], s37 offen offset:1024
  s_add_u32 s38, s38, 16384
  s_add_u32 s37, s37, 2048
  s_waitcnt vmcnt(18)
  ds_read_b64_tr_b16 v[240:241], v5 offset:2048
  ds_read_b64_tr_b16 v[242:243], v5 offset:2560
  ds_read_b64_tr_b16 v[244:245], v6 offset:2048
  ds_read_b64_tr_b16 v[246:247], v6 offset:2560
  s_waitcnt lgkmcnt(6)
  v_mfma_f32_32x32x16_bf16 v[40:55], v[232:235], v[104:107], 0
  v_mfma_f32_32x32x16_bf16 v[56:71], v[232:235], v[108:111], 0
  s_waitcnt lgkmcnt(4)
  v_mfma_f32_32x32x16_bf16 v[72:87], v[236:239], v[104:107], 0
  v_mfma_f32_32x32x16_bf16 v[88:103], v[236:239], v[108:111], 0
  s_add_u32 m0, s39, 12288
  s_add_u32 s14, s38, 8192
  buffer_load_dwordx4 v4, s[16:19], s38 offen lds
  s_add_u32 m0, s39, 13312
  s_nop 0
  buffer_load_dwordx4 v4, s[16:19], s14 offen lds
  buffer_load_dwordx4 v[152:155], v3, s[20:23], s37 offen offset:0
  buffer_load_dwordx4 v[156:159], v3, s[20:23], s37 offen offset:1024
  s_add_u32 s38, s38, 16384
  s_add_u32 s37, s37, 2048
  s_add_u32 m0, s39, 14336
  s_add_u32 s14, s38, 8192
  buffer_load_dwordx4 v4, s[16:19], s38 offen lds
  s_add_u32 m0, s39, 15360
  s_nop 0
  buffer_load_dwordx4 v4, s[16:19], s14 offen lds
  buffer_load_dwordx4 v[160:163], v3, s[20:23], s37 offen offset:0
  buffer_load_dwordx4 v[164:167], v3, s[20:23], s37 offen offset:1024
  s_add_u32 s38, s38, 16384
  s_add_u32 s37, s37, 2048
  s_add_u32 m0, s39, 16384
  s_add_u32 s14, s38, 8192
  buffer_load_dwordx4 v4, s[16:19], s38 offen lds
  s_add_u32 m0, s39, 17408
  s_nop 0
  buffer_load_dwordx4 v4, s[16:19], s14 offen lds
  buffer_load_dwordx4 v[168:171], v3, s[20:23], s37 offen offset:0
  buffer_load_dwordx4 v[172:175], v3, s[20:23], s37 offen offset:1024
  s_add_u32 s38, s38, 16384
  s_add_u32 s37, s37, 2048
  s_waitcnt vmcnt(26)
  ds_read_b64_tr_b16 v[232:233], v5 offset:4096
  ds_read_b64_tr_b16 v[234:235], v5 offset:4608
  ds_read_b64_tr_b16 v[236:237], v6 offset:4096
  ds_read_b64_tr_b16 v[238:239], v6 offset:4608
  s_waitcnt lgkmcnt(6)
  v_mfma_f32_32x32x16_bf16 v[40:55], v[240:243], v[112:115], v[40:55]
  v_mfma_f32_32x32x16_bf16 v[56:71], v[240:243], v[116:119], v[56:71]
  s_waitcnt lgkmcnt(4)
  v_mfma_f32_32x32x16_bf16 v[72:87], v[244:247], v[112:115], v[72:87]
  v_mfma_f32_32x32x16_bf16 v[88:103], v[244:247], v[116:119], v[88:103]
  s_add_u32 m0, s39, 18432
  s_add_u32 s14, s38, 8192
  buffer_load_dwordx4 v4, s[16:19], s38 offen lds
  s_add_u32 m0, s39, 19456
  s_nop 0
  buffer_load_dwordx4 v4, s[16:19], s14 offen lds
  buffer_load_dwordx4 v[176:179], v3, s[20:23], s37 offen offset:0
  buffer_load_dwordx4 v[180:183], v3, s[20:23], s37 offen offset:1024
  s_add_u32 s38, s38, 16384
  s_add_u32 s37, s37, 2048
  s_add_u32 m0, s39, 20480
  s_add_u32 s14, s38, 8192
  buffer_load_dwordx4 v4, s[16:19], s38 offen lds
  s_add_u32 m0, s39, 21504
  s_nop 0
  buffer_load_dwordx4 v4, s[16:19], s14 offen lds
  buffer_load_dwordx4 v[184:187], v3, s[20:23], s37 offen offset:0
  buffer_load_dwordx4 v[188:191], v3, s[20:23], s37 offen offset:1024
  s_add_u32 s38, s38, 16384
  s_add_u32 s37, s37, 2048
  s_waitcnt vmcnt(30)
  ds_read_b64_tr_b16 v[240:241], v5 offset:6144
  ds_read_b64_tr_b16 v[242:243], v5 offset:6656
  ds_read_b64_tr_b16 v[244:245], v6 offset:6144
  ds_read_b64_tr_b16 v[246:247], v6 offset:6656
  s_waitcnt lgkmcnt(6)
  v_mfma_f32_32x32x16_bf16 v[40:55], v[232:235], v[120:123], v[40:55]
  v_mfma_f32_32x32x16_bf16 v[56:71], v[232:235], v[124:127], v[56:71]
  s_waitcnt lgkmcnt(4)
  v_mfma_f32_32x32x16_bf16 v[72:87], v[236:239], v[120:123], v[72:87]
  v_mfma_f32_32x32x16_bf16 v[88:103], v[236:239], v[124:127], v[88:103]
  s_add_u32 m0, s39, 22528
  s_add_u32 s14, s38, 8192
  buffer_load_dwordx4 v4, s[16:19], s38 offen lds
  s_add_u32 m0, s39, 23552
  s_nop 0
  buffer_load_dwordx4 v4, s[16:19], s14 offen lds
  buffer_load_dwordx4 v[192:195], v3, s[20:23], s37 offen offset:0
  buffer_load_dwordx4 v[196:199], v3, s[20:23], s37 offen offset:1024
  s_add_u32 s38, s38, 16384
  s_add_u32 s37, s37, 2048
  s_waitcnt vmcnt(30)
  ds_read_b64_tr_b16 v[232:233], v5 offset:8192
  ds_read_b64_tr_b16 v[234:235], v5 offset:8704
  ds_read_b64_tr_b16 v[236:237], v6 offset:8192
  ds_read_b64_tr_b16 v[238:239], v6 offset:8704
  s_waitcnt lgkmcnt(6)
  v_mfma_f32_32x32x16_bf16 v[40:55], v[240:243], v[128:131], v[40:55]
  v_mfma_f32_32x32x16_bf16 v[56:71], v[240:243], v[132:135], v[56:71]
  s_waitcnt lgkmcnt(4)
  v_mfma_f32_32x32x16_bf16 v[72:87], v[244:247], v[128:131], v[72:87]
  v_mfma_f32_32x32x16_bf16 v[88:103], v[244:247], v[132:135], v[88:103]
  s_add_u32 m0, s39, 24576
  s_add_u32 s14, s38, 8192
  buffer_load_dwordx4 v4, s[16:19], s38 offen lds
  s_add_u32 m0, s39, 25600
  s_nop 0
  buffer_load_dwordx4 v4, s[16:19], s14 offen lds
  buffer_load_dwordx4 v[200:203], v3, s[20:23], s37 offen offset:0
  buffer_load_dwordx4 v[204:207], v3, s[20:23], s37 offen offset:1024
  s_add_u32 s38, s38, 16384
  s_add_u32 s37, s37, 2048
  s_waitcnt vmcnt(30)
  ds_read_b64_tr_b16 v[240:241], v5 offset:10240
  ds_read_b64_tr_b16 v[242:243], v5 offset:10752
  ds_read_b64_tr_b16 v[244:245], v6 offset:10240
  ds_read_b64_tr_b16 v[246:247], v6 offset:10752
  s_waitcnt lgkmcnt(6)
  v_mfma_f32_32x32x16_bf16 v[40:55], v[232:235], v[136:139], v[40:55]
  v_mfma_f32_32x32x16_bf16 v[56:71], v[232:235], v[140:143], v[56:71]
  s_waitcnt lgkmcnt(4)
  v_mfma_f32_32x32x16_bf16 v[72:87], v[236:239], v[136:139], v[72:87]
  v_mfma_f32_32x32x16_bf16 v[88:103], v[236:239], v[140:143], v[88:103]
  s_add_u32 m0, s39, 26624
  s_add_u32 s14, s38, 8192
  buffer_load_dwordx4 v4, s[16:19], s38 offen lds
  s_add_u32 m0, s39, 27648
  s_nop 0
  buffer_load_dwordx4 v4, s[16:19], s14 offen lds
  buffer_load_dwordx4 v[208:211], v3, s[20:23], s37 offen offset:0
  buffer_load_dwordx4 v[212:215], v3, s[20:23], s37 offen offset:1024
  s_add_u32 s38, s38, 16384
  s_add_u32 s37, s37, 2048
  s_waitcnt vmcnt(30)
  ds_read_b64_tr_b16 v[232:233], v5 offset:12288
  ds_read_b64_tr_b16 v[234:235], v5 offset:12800
  ds_read_b64_tr_b16 v[236:237], v6 offset:12288
  ds_read_b64_tr_b16 v[238:239], v6 offset:12800
  s_waitcnt lgkmcnt(6)
  v_mfma_f32_32x32x16_bf16 v[40:55], v[240:243], v[144:147], v[40:55]
  v_mfma_f32_32x32x16_bf16 v[56:71], v[240:243], v[148:151], v[56:71]
  s_waitcnt lgkmcnt(4)
  v_mfma_f32_32x32x16_bf16 v[72:87], v[244:247], v[144:147], v[72:87]
  v_mfma_f32_32x32x16_bf16 v[88:103], v[244:247], v[148:151], v[88:103]
  s_add_u32 m0, s39, 28672
  s_add_u32 s14, s38, 8192
  buffer_load_dwordx4 v4, s[16:19], s38 offen lds
  s_add_u32 m0, s39, 29696
  s_nop 0
  buffer_load_dwordx4 v4, s[16:19], s14 offen lds
  buffer_load_dwordx4 v[216:219], v3, s[20:23], s37 offen offset:0
  buffer_load_dwordx4 v[220:223], v3, s[20:23], s37 offen offset:1024
  s_add_u32 s38, s38, 16384
  s_add_u32 s37, s37, 2048
  s_waitcnt vmcnt(30)
  ds_read_b64_tr_b16 v[240:241], v5 offset:14336
  ds_read_b64_tr_b16 v[242:243], v5 offset:14848
  ds_read_b64_tr_b16 v[244:245], v6 offset:14336
  ds_read_b64_tr_b16 v[246:247], v6 offset:14848
  s_waitcnt lgkmcnt(6)
  v_mfma_f32_32x32x16_bf16 v[40:55], v[232:235], v[152:155], v[40:55]
  v_mfma_f32_32x32x16_bf16 v[56:71], v[232:235], v[156:159], v[56:71]
  s_waitcnt lgkmcnt(4)
  v_mfma_f32_32x32x16_bf16 v[72:87], v[236:239], v[152:155], v[72:87]
  v_mfma_f32_32x32x16_bf16 v[88:103], v[236:239], v[156:159], v[88:103]
  s_add_u32 m0, s39, 30720
  s_add_u32 s14, s38, 8192
  buffer_load_dwordx4 v4, s[16:19], s38 offen lds
  s_add_u32 m0, s39, 31744
  s_nop 0
  buffer_load_dwordx4 v4, s[16:19], s14 offen lds
  buffer_load_dwordx4 v[224:227], v3, s[20:23], s37 offen offset:0
  buffer_load_dwordx4 v[228:231], v3, s[20:23], s37 offen offset:1024
  s_add_u32 s38, s38, 16384
  s_add_u32 s37, s37, 2048
  s_waitcnt vmcnt(30)
  ds_read_b64_tr_b16 v[232:233], v5 offset:16384
  ds_read_b64_tr_b16 v[234:235], v5 offset:16896
  ds_read_b64_tr_b16 v[236:237], v6 offset:16384
  ds_read_b64_tr_b16 v[238:239], v6 offset:16896
  s_waitcnt lgkmcnt(6)
  v_mfma_f32_32x32x16_bf16 v[40:55], v[240:243], v[160:163], v[40:55]
  v_mfma_f32_32x32x16_bf16 v[56:71], v[240:243], v[164:167], v[56:71]
  s_waitcnt lgkmcnt(4)
  v_mfma_f32_32x32x16_bf16 v[72:87], v[244:247], v[160:163], v[72:87]
  v_mfma_f32_32x32x16_bf16 v[88:103], v[244:247], v[164:167], v[88:103]
  s_add_u32 m0, s39, 0
  s_add_u32 s14, s38, 8192
  buffer_load_dwordx4 v4, s[16:19], s38 offen lds
  s_add_u32 m0, s39, 1024
  s_nop 0
  buffer_load_dwordx4 v4, s[16:19], s14 offen lds
  buffer_load_dwordx4 v[104:107], v3, s[20:23], s37 offen offset:0
  buffer_load_dwordx4 v[108:111], v3, s[20:23], s37 offen offset:1024
  s_add_u32 s38, s38, 16384
  s_add_u32 s37, s37, 2048
  s_waitcnt vmcnt(30)
  ds_read_b64_tr_b16 v[240:241], v5 offset:18432
  ds_read_b64_tr_b16 v[242:243], v5 offset:18944
  ds_read_b64_tr_b16 v[244:245], v6 offset:18432
  ds_read_b64_tr_b16 v[246:247], v6 offset:18944
  s_waitcnt lgkmcnt(6)
  v_mfma_f32_32x32x16_bf16 v[40:55], v[232:235], v[168:171], v[40:55]
  v_mfma_f32_32x32x16_bf16 v[56:71], v[232:235], v[172:175], v[56:71]
  s_waitcnt lgkmcnt(4)
  v_mfma_f32_32x32x16_bf16 v[72:87], v[236:239], v[168:171], v[72:87]
  v_mfma_f32_32x32x16_bf16 v[88:103], v[236:239], v[172:175], v[88:103]
  s_add_u32 m0, s39, 2048
  s_add_u32 s14, s38, 8192
  buffer_load_dwordx4 v4, s[16:19], s38 offen lds
  s_add_u32 m0, s39, 3072
  s_nop 0
  buffer_load_dwordx4 v4, s[16:19], s14 offen lds
  buffer_load_dwordx4 v[112:115], v3, s[20:23], s37 offen offset:0
  buffer_load_dwordx4 v[116:119], v3, s[20:23], s37 offen offset:1024
  s_add_u32 s38, s38, 16384
  s_add_u32 s37, s37, 2048
  buffer_load_dwordx4 v[16:19], v12, s[24:27], 0 offen
  buffer_load_dwordx4 v[20:23], v12, s[24:27], 0 offen offset:1024
  buffer_load_dwordx4 v[24:27], v13, s[32:35], 0 offen offset:0
  buffer_load_dwordx4 v[28:31], v13, s[32:35], 0 offen offset:16
  buffer_load_dwordx4 v[32:35], v13, s[32:35], 0 offen offset:64
  buffer_load_dwordx4 v[36:39], v13, s[32:35], 0 offen offset:80
  s_waitcnt vmcnt(36)
  ds_read_b64_tr_b16 v[232:233], v5 offset:20480
  ds_read_b64_tr_b16 v[234:235], v5 offset:20992
  ds_read_b64_tr_b16 v[236:237], v6 offset:20480
  ds_read_b64_tr_b16 v[238:239], v6 offset:20992
  s_waitcnt lgkmcnt(6)
  v_mfma_f32_32x32x16_bf16 v[40:55], v[240:243], v[176:179], v[40:55]
  v_mfma_f32_32x32x16_bf16 v[56:71], v[240:243], v[180:183], v[56:71]
  s_waitcnt lgkmcnt(4)
  v_mfma_f32_32x32x16_bf16 v[72:87], v[244:247], v[176:179], v[72:87]
  v_mfma_f32_32x32x16_bf16 v[88:103], v[244:247], v[180:183], v[88:103]
  s_add_u32 m0, s39, 4096
  s_add_u32 s14, s38, 8192
  buffer_load_dwordx4 v4, s[16:19], s38 offen lds
  s_add_u32 m0, s39, 5120
  s_nop 0
  buffer_load_dwordx4 v4, s[16:19], s14 offen lds
  buffer_load_dwordx4 v[120:123], v3, s[20:23], s37 offen offset:0
  buffer_load_dwordx4 v[124:127], v3, s[20:23], s37 offen offset:1024
  s_add_u32 s38, s38, 16384
  s_add_u32 s37, s37, 2048
  s_waitcnt vmcnt(36)
  ds_read_b64_tr_b16 v[240:241], v5 offset:22528
  ds_read_b64_tr_b16 v[242:243], v5 offset:23040
  ds_read_b64_tr_b16 v[244:245], v6 offset:22528
  ds_read_b64_tr_b16 v[246:247], v6 offset:23040
  s_waitcnt lgkmcnt(6)
  v_mfma_f32_32x32x16_bf16 v[40:55], v[232:235], v[184:187], v[40:55]
  v_mfma_f32_32x32x16_bf16 v[56:71], v[232:235], v[188:191], v[56:71]
  s_waitcnt lgkmcnt(4)
  v_mfma_f32_32x32x16_bf16 v[72:87], v[236:239], v[184:187], v[72:87]
  v_mfma_f32_32x32x16_bf16 v[88:103], v[236:239], v[188:191], v[88:103]
  s_add_u32 m0, s39, 6144
  s_add_u32 s14, s38, 8192
  buffer_load_dwordx4 v4, s[16:19], s38 offen lds
  s_add_u32 m0, s39, 7168
  s_nop 0
  buffer_load_dwordx4 v4, s[16:19], s14 offen lds
  buffer_load_dwordx4 v[128:131], v3, s[20:23], s37 offen offset:0
  buffer_load_dwordx4 v[132:135], v3, s[20:23], s37 offen offset:1024
  s_add_u32 s38, s38, 16384
  s_add_u32 s37, s37, 2048
  s_waitcnt vmcnt(36)
  ds_read_b64_tr_b16 v[232:233], v5 offset:24576
  ds_read_b64_tr_b16 v[234:235], v5 offset:25088
  ds_read_b64_tr_b16 v[236:237], v6 offset:24576
  ds_read_b64_tr_b16 v[238:239], v6 offset:25088
  s_waitcnt lgkmcnt(6)
  v_mfma_f32_32x32x16_bf16 v[40:55], v[240:243], v[192:195], v[40:55]
  v_mfma_f32_32x32x16_bf16 v[56:71], v[240:243], v[196:199], v[56:71]
  s_waitcnt lgkmcnt(4)
  v_mfma_f32_32x32x16_bf16 v[72:87], v[244:247], v[192:195], v[72:87]
  v_mfma_f32_32x32x16_bf16 v[88:103], v[244:247], v[196:199], v[88:103]
  s_add_u32 m0, s39, 8192
  s_add_u32 s14, s38, 8192
  buffer_load_dwordx4 v4, s[16:19], s38 offen lds
  s_add_u32 m0, s39, 9216
  s_nop 0
  buffer_load_dwordx4 v4, s[16:19], s14 offen lds
  buffer_load_dwordx4 v[136:139], v3, s[20:23], s37 offen offset:0
  buffer_load_dwordx4 v[140:143], v3, s[20:23], s37 offen offset:1024
  s_add_u32 s38, s38, 16384
  s_add_u32 s37, s37, 2048
  s_waitcnt vmcnt(36)
  ds_read_b64_tr_b16 v[240:241], v5 offset:26624
  ds_read_b64_tr_b16 v[242:243], v5 offset:27136
  ds_read_b64_tr_b16 v[244:245], v6 offset:26624
  ds_read_b64_tr_b16 v[246:247], v6 offset:27136
  s_waitcnt lgkmcnt(6)
  v_mfma_f32_32x32x16_bf16 v[40:55], v[232:235], v[200:203], v[40:55]
  v_mfma_f32_32x32x16_bf16 v[56:71], v[232:235], v[204:207], v[56:71]
  s_waitcnt lgkmcnt(4)
  v_mfma_f32_32x32x16_bf16 v[72:87], v[236:239], v[200:203], v[72:87]
  v_mfma_f32_32x32x16_bf16 v[88:103], v[236:239], v[204:207], v[88:103]
  s_cmp_ge_u32 s10, 2
  s_cbranch_scc1 k5_sk2
  s_add_u32 m0, s39, 10240
  s_add_u32 s14, s38, 8192
  buffer_load_dwordx4 v4, s[16:19], s38 offen lds
  s_add_u32 m0, s39, 11264
  s_nop 0
  buffer_load_dwordx4 v4, s[16:19], s14 offen lds
  buffer_load_dwordx4 v[144:147], v3, s[20:23], s37 offen offset:0
  buffer_load_dwordx4 v[148:151], v3, s[20:23], s37 offen offset:1024
  s_add_u32 s38, s38, 16384
  s_add_u32 s37, s37, 2048
k5_sk2:
  s_waitcnt vmcnt(32)
  ds_read_b64_tr_b16 v[232:233], v5 offset:28672
  ds_read_b64_tr_b16 v[234:235], v5 offset:29184
  ds_read_b64_tr_b16 v[236:237], v6 offset:28672
  ds_read_b64_tr_b16 v[238:239], v6 offset:29184
  s_waitcnt lgkmcnt(6)
  v_mfma_f32_32x32x16_bf16 v[40:55], v[240:243], v[208:211], v[40:55]
  v_mfma_f32_32x32x16_bf16 v[56:71], v[240:243], v[212:215], v[56:71]
  s_waitcnt lgkmcnt(4)
  v_mfma_f32_32x32x16_bf16 v[72:87], v[244:247], v[208:211], v[72:87]
  v_mfma_f32_32x32x16_bf16 v[88:103], v[244:247], v[212:215], v[88:103]
  s_waitcnt vmcnt(28)
  ds_read_b64_tr_b16 v[240:241], v5 offset:30720
  ds_read_b64_tr_b16 v[242:243], v5 offset:31232
  ds_read_b64_tr_b16 v[244:245], v6 offset:30720
  ds_read_b64_tr_b16 v[246:247], v6 offset:31232
  s_waitcnt lgkmcnt(6)
  v_mfma_f32_32x32x16_bf16 v[40:55], v[232:235], v[216:219], v[40:55]
  v_mfma_f32_32x32x16_bf16 v[56:71], v[232:235], v[220:223], v[56:71]
  s_waitcnt lgkmcnt(4)
  v_mfma_f32_32x32x16_bf16 v[72:87], v[236:239], v[216:219], v[72:87]
  v_mfma_f32_32x32x16_bf16 v[88:103], v[236:239], v[220:223], v[88:103]
  s_waitcnt vmcnt(24)
  ds_read_b64_tr_b16 v[232:233], v5 offset:0
  ds_read_b64_tr_b16 v[234:235], v5 offset:512
  ds_read_b64_tr_b16 v[236:237], v6 offset:0
  ds_read_b64_tr_b16 v[238:239], v6 offset:512
  s_waitcnt lgkmcnt(6)
  v_mfma_f32_32x32x16_bf16 v[40:55], v[240:243], v[224:227], v[40:55]
  v_mfma_f32_32x32x16_bf16 v[56:71], v[240:243], v[228:231], v[56:71]
  s_waitcnt lgkmcnt(4)
  v_mfma_f32_32x32x16_bf16 v[72:87], v[244:247], v[224:227], v[72:87]
  v_mfma_f32_32x32x16_bf16 v[88:103], v[244:247], v[228:231], v[88:103]
  s_waitcnt vmcnt(20)
  ds_read_b64_tr_b16 v[240:241], v5 offset:2048
  ds_read_b64_tr_b16 v[242:243], v5 offset:2560
  ds_read_b64_tr_b16 v[244:245], v6 offset:2048
  ds_read_b64_tr_b16 v[246:247], v6 offset:2560
  s_waitcnt lgkmcnt(6)
  v_mfma_f32_32x32x16_bf16 v[40:55], v[232:235], v[104:107], v[40:55]
  v_mfma_f32_32x32x16_bf16 v[56:71], v[232:235], v[108:111], v[56:71]
  s_waitcnt lgkmcnt(4)
  v_mfma_f32_32x32x16_bf16 v[72:87], v[236:239], v[104:107], v[72:87]
  v_mfma_f32_32x32x16_bf16 v[88:103], v[236:239], v[108:111], v[88:103]
  s_waitcnt vmcnt(10)
  ds_read_b64_tr_b16 v[232:233], v5 offset:4096
  ds_read_b64_tr_b16 v[234:235], v5 offset:4608
  ds_read_b64_tr_b16 v[236:237], v6 offset:4096
  ds_read_b64_tr_b16 v[238:239], v6 offset:4608
  s_waitcnt lgkmcnt(6)
  v_mfma_f32_32x32x16_bf16 v[40:55], v[240:243], v[112:115], v[40:55]
  v_mfma_f32_32x32x16_bf16 v[56:71], v[240:243], v[116:119], v[56:71]
  s_waitcnt lgkmcnt(4)
  v_mfma_f32_32x32x16_bf16 v[72:87], v[244:247], v[112:115], v[72:87]
  v_mfma_f32_32x32x16_bf16 v[88:103], v[244:247], v[116:119], v[88:103]
  s_waitcnt vmcnt(6)
  ds_read_b64_tr_b16 v[240:241], v5 offset:6144
  ds_read_b64_tr_b16 v[242:243], v5 offset:6656
  ds_read_b64_tr_b16 v[244:245], v6 offset:6144
  ds_read_b64_tr_b16 v[246:247], v6 offset:6656
  s_waitcnt lgkmcnt(6)
  v_mfma_f32_32x32x16_bf16 v[40:55], v[232:235], v[120:123], v[40:55]
  v_mfma_f32_32x32x16_bf16 v[56:71], v[232:235], v[124:127], v[56:71]
  s_waitcnt lgkmcnt(4)
  v_mfma_f32_32x32x16_bf16 v[72:87], v[236:239], v[120:123], v[72:87]
  v_mfma_f32_32x32x16_bf16 v[88:103], v[236:239], v[124:127], v[88:103]
  s_waitcnt vmcnt(2)
  ds_read_b64_tr_b16 v[232:233], v5 offset:8192
  ds_read_b64_tr_b16 v[234:235], v5 offset:8704
  ds_read_b64_tr_b16 v[236:237], v6 offset:8192
  ds_read_b64_tr_b16 v[238:239], v6 offset:8704
  s_waitcnt lgkmcnt(6)
  v_mfma_f32_32x32x16_bf16 v[40:55], v[240:243], v[128:131], v[40:55]
  v_mfma_f32_32x32x16_bf16 v[56:71], v[240:243], v[132:135], v[56:71]
  s_waitcnt lgkmcnt(4)
  v_mfma_f32_32x32x16_bf16 v[72:87], v[244:247], v[128:131], v[72:87]
  v_mfma_f32_32x32x16_bf16 v[88:103], v[244:247], v[132:135], v[88:103]
  s_cmp_ge_u32 s10, 2
  s_cbranch_scc1 k5_sk3
  s_waitcnt vmcnt(2)
  ds_read_b64_tr_b16 v[240:241], v5 offset:10240
  ds_read_b64_tr_b16 v[242:243], v5 offset:10752
  ds_read_b64_tr_b16 v[244:245], v6 offset:10240
  ds_read_b64_tr_b16 v[246:247], v6 offset:10752
  s_waitcnt vmcnt(1) lgkmcnt(6)
  v_mfma_f32_32x32x16_bf16 v[40:55], v[232:235], v[136:139], v[40:55]
  s_waitcnt vmcnt(0)
  v_mfma_f32_32x32x16_bf16 v[56:71], v[232:235], v[140:143], v[56:71]
  s_waitcnt lgkmcnt(4)
  v_mfma_f32_32x32x16_bf16 v[72:87], v[236:239], v[136:139], v[72:87]
  v_mfma_f32_32x32x16_bf16 v[88:103], v[236:239], v[140:143], v[88:103]
  s_waitcnt lgkmcnt(2)
  v_mfma_f32_32x32x16_bf16 v[40:55], v[240:243], v[144:147], v[40:55]
  v_mfma_f32_32x32x16_bf16 v[56:71], v[240:243], v[148:151], v[56:71]
  s_waitcnt lgkmcnt(0)
  v_mfma_f32_32x32x16_bf16 v[72:87], v[244:247], v[144:147], v[72:87]
  v_mfma_f32_32x32x16_bf16 v[88:103], v[244:247], v[148:151], v[88:103]
  s_branch k5_sk3x
k5_sk3:
  s_waitcnt vmcnt(1) lgkmcnt(2)
  v_mfma_f32_32x32x16_bf16 v[40:55], v[232:235], v[136:139], v[40:55]
  s_waitcnt vmcnt(0)
  v_mfma_f32_32x32x16_bf16 v[56:71], v[232:235], v[140:143], v[56:71]
  s_waitcnt lgkmcnt(0)
  v_mfma_f32_32x32x16_bf16 v[72:87], v[236:239], v[136:139], v[72:87]
  v_mfma_f32_32x32x16_bf16 v[88:103], v[236:239], v[140:143], v[88:103]
k5_sk3x:
  v_add_u32 v248, s39, v3
  s_waitcnt vmcnt(0)
  s_nop 9
  ds_write_b128 v248, v[40:43] offset:0
  ds_write_b128 v248, v[44:47] offset:1024
  ds_write_b128 v248, v[48:51] offset:2048
  ds_write_b128 v248, v[52:55] offset:3072
  ds_write_b128 v248, v[56:59] offset:4096
  ds_write_b128 v248, v[60:63] offset:5120
  ds_write_b128 v248, v[64:67] offset:6144
  ds_write_b128 v248, v[68:71] offset:7168
  ds_write_b128 v248, v[72:75] offset:8192
  ds_write_b128 v248, v[76:79] offset:9216
  ds_write_b128 v248, v[80:83] offset:10240
  ds_write_b128 v248, v[84:87] offset:11264
  ds_write_b128 v248, v[88:91] offset:12288
  ds_write_b128 v248, v[92:95] offset:13312
  ds_write_b128 v248, v[96:99] offset:14336
  ds_write_b128 v248, v[100:103] offset:15360
  s_waitcnt lgkmcnt(0)
  s_barrier
  s_lshl_b32 s13, s10, 12
  v_add_u32 v8, s13, v3
  v_add_u32 v7, 0x10000, v8
  ds_read_b128 v[104:107], v8 offset:0
  ds_read_b128 v[108:111], v8 offset:1024
  ds_read_b128 v[112:115], v8 offset:2048
  ds_read_b128 v[116:119], v8 offset:3072
  ds_read_b128 v[120:123], v8 offset:32768
  ds_read_b128 v[124:127], v8 offset:33792
  ds_read_b128 v[128:131], v8 offset:34816
  ds_read_b128 v[132:135], v8 offset:35840
  ds_read_b128 v[136:139], v7 offset:0
  ds_read_b128 v[140:143], v7 offset:1024
  ds_read_b128 v[144:147], v7 offset:2048
  ds_read_b128 v[148:151], v7 offset:3072
  ds_read_b128 v[152:155], v7 offset:32768
  ds_read_b128 v[156:159], v7 offset:33792
  ds_read_b128 v[160:163], v7 offset:34816
  ds_read_b128 v[164:167], v7 offset:35840
  s_waitcnt lgkmcnt(11)
  v_add_f32 v104, v104, v120
  s_waitcnt lgkmcnt(3)
  v_add_f32 v136, v136, v152
  v_add_f32 v105, v105, v121
  v_add_f32 v137, v137, v153
  v_add_f32 v106, v106, v122
  v_add_f32 v138, v138, v154
  v_add_f32 v107, v107, v123
  v_add_f32 v139, v139, v155
  v_add_f32 v108, v108, v124
  s_waitcnt lgkmcnt(2)
  v_add_f32 v140, v140, v156
  v_add_f32 v109, v109, v125
  v_add_f32 v141, v141, v157
  v_add_f32 v110, v110, v126
  v_add_f32 v142, v142, v158
  v_add_f32 v111, v111, v127
  v_add_f32 v143, v143, v159
  v_add_f32 v112, v112, v128
  s_waitcnt lgkmcnt(1)
  v_add_f32 v144, v144, v160
  v_add_f32 v113, v113, v129
  v_add_f32 v145, v145, v161
  v_add_f32 v114, v114, v130
  v_add_f32 v146, v146, v162
  v_add_f32 v115, v115, v131
  v_add_f32 v147, v147, v163
  v_add_f32 v116, v116, v132
  s_waitcnt lgkmcnt(0)
  v_add_f32 v148, v148, v164
  v_add_f32 v117, v117, v133
  v_add_f32 v149, v149, v165
  v_add_f32 v118, v118, v134
  v_add_f32 v150, v150, v166
  v_add_f32 v119, v119, v135
  v_add_f32 v151, v151, v167
  v_add_f32 v104, v104, v136
  v_add_f32 v105, v105, v137
  v_add_f32 v106, v106, v138
  v_add_f32 v107, v107, v139
  v_add_f32 v108, v108, v140
  v_add_f32 v109, v109, v141
  v_add_f32 v110, v110, v142
  v_add_f32 v111, v111, v143
  v_add_f32 v112, v112, v144
  v_add_f32 v113, v113, v145
  v_add_f32 v114, v114, v146
  v_add_f32 v115, v115, v147
  v_add_f32 v116, v116, v148
  v_add_f32 v117, v117, v149
  v_add_f32 v118, v118, v150
  v_add_f32 v119, v119, v151
  v_lshlrev_b32 v120, 16, v16
  v_and_b32 v121, 0xffff0000, v16
  v_lshlrev_b32 v122, 16, v17
  v_and_b32 v123, 0xffff0000, v17
  v_lshlrev_b32 v124, 16, v18
  v_and_b32 v125, 0xffff0000, v18
  v_lshlrev_b32 v126, 16, v19
  v_and_b32 v127, 0xffff0000, v19
  v_lshlrev_b32 v128, 16, v20
  v_and_b32 v129, 0xffff0000, v20
  v_lshlrev_b32 v130, 16, v21
  v_and_b32 v131, 0xffff0000, v21
  v_lshlrev_b32 v132, 16, v22
  v_and_b32 v133, 0xffff0000, v22
  v_lshlrev_b32 v134, 16, v23
  v_and_b32 v135, 0xffff0000, v23
  v_fma_f32 v104, v24, v104, v120
  v_fma_f32 v105, v25, v105, v121
  v_fma_f32 v106, v26, v106, v122
  v_fma_f32 v107, v27, v107, v123
  v_fma_f32 v108, v28, v108, v124
  v_fma_f32 v109, v29, v109, v125
  v_fma_f32 v110, v30, v110, v126
  v_fma_f32 v111, v31, v111, v127
  v_fma_f32 v112, v32, v112, v128
  v_fma_f32 v113, v33, v113, v129
  v_fma_f32 v114, v34, v114, v130
  v_fma_f32 v115, v35, v115, v131
  v_fma_f32 v116, v36, v116, v132
  v_fma_f32 v117, v37, v117, v133
  v_fma_f32 v118, v38, v118, v134
  v_fma_f32 v119, v39, v119, v135
  v_cvt_pk_bf16_f32 v16, v104, v105
  v_cvt_pk_bf16_f32 v17, v106, v107
  v_cvt_pk_bf16_f32 v18, v108, v109
  v_cvt_pk_bf16_f32 v19, v110, v111
  v_cvt_pk_bf16_f32 v20, v112, v113
  v_cvt_pk_bf16_f32 v21, v114, v115
  v_cvt_pk_bf16_f32 v22, v116, v117
  v_cvt_pk_bf16_f32 v23, v118, v119
  buffer_store_dwordx4 v[16:19], v11, s[28:31], 0 offen
  buffer_store_dwordx4 v[20:23], v11, s[28:31], 0 offen offset:32
  s_endpgm
text_end:
.section .rodata,"a"
.p2align 6
.amdhsa_kernel k1_kernel
  .amdhsa_next_free_vgpr 68
  .amdhsa_next_free_sgpr 102
  .amdhsa_accum_offset 68
  .amdhsa_group_segment_fixed_size 0
  .amdhsa_kernarg_size 112
  .amdhsa_user_sgpr_count 2
  .amdhsa_user_sgpr_kernarg_segment_ptr 1
  .amdhsa_system_sgpr_workgroup_id_x 1
.end_amdhsa_kernel
.section .rodata,"a"
.p2align 6
.amdhsa_kernel k2_kernel
  .amdhsa_next_free_vgpr 492
  .amdhsa_next_free_sgpr 102
  .amdhsa_accum_offset 236
  .amdhsa_group_segment_fixed_size 0
  .amdhsa_kernarg_size 112
  .amdhsa_user_sgpr_count 2
  .amdhsa_user_sgpr_kernarg_segment_ptr 1
  .amdhsa_system_sgpr_workgroup_id_x 1
.end_amdhsa_kernel
.section .rodata,"a"
.p2align 6
.amdhsa_kernel k3_kernel
  .amdhsa_next_free_vgpr 348
  .amdhsa_next_free_sgpr 102
  .amdhsa_accum_offset 212
  .amdhsa_group_segment_fixed_size 0
  .amdhsa_kernarg_size 112
  .amdhsa_user_sgpr_count 2
  .amdhsa_user_sgpr_kernarg_segment_ptr 1
  .amdhsa_system_sgpr_workgroup_id_x 1
.end_amdhsa_kernel
.section .rodata,"a"
.p2align 6
.amdhsa_kernel k4_kernel
  .amdhsa_next_free_vgpr 304
  .amdhsa_next_free_sgpr 102
  .amdhsa_accum_offset 176
  .amdhsa_group_segment_fixed_size 0
  .amdhsa_kernarg_size 112
  .amdhsa_user_sgpr_count 2
  .amdhsa_user_sgpr_kernarg_segment_ptr 1
  .amdhsa_system_sgpr_workgroup_id_x 1
.end_amdhsa_kernel
.section .rodata,"a"
.p2align 6
.amdhsa_kernel k5_kernel
  .amdhsa_next_free_vgpr 260
  .amdhsa_next_free_sgpr 102
  .amdhsa_accum_offset 252
  .amdhsa_group_segment_fixed_size 0
  .amdhsa_kernarg_size 112
  .amdhsa_user_sgpr_count 2
  .amdhsa_user_sgpr_kernarg_segment_ptr 1
  .amdhsa_system_sgpr_workgroup_id_x 1
.end_amdhsa_kernel
```
